```python
import torch

def _softmax(x, axis=-1):
    return torch.softmax(x, dim=axis)
def _gelu(x):
    return torch.nn.functional.gelu(x, approximate="tanh")
def _silu(x):
    return torch.nn.functional.silu(x)
def _sigmoid(x):
    return torch.sigmoid(x)
def _layernorm(x, axis=-1, eps=1e-5):
    m = x.mean(dim=axis, keepdim=True)
    v = x.var(dim=axis, keepdim=True, unbiased=False)
    return (x - m) / torch.sqrt(v + eps)
def _scatter_add(tgt, idx, src, axis=0):
    return tgt.clone().index_add_(axis, idx, src)
def _segment_sum(src, seg, n):
    out = torch.zeros((n,) + src.shape[1:], dtype=src.dtype)
    return out.index_add_(0, seg, src)
def _pad(x, pw):
    flat = tuple(v for pair in reversed(pw) for v in pair)
    return torch.nn.functional.pad(x, flat)

kernel_name = 'parallel_sum__mha_block__glu_gated_geglu__prompt'

def setup_inputs():

    _w = (lambda a: (lambda t: t.to(torch.bfloat16) if t.is_floating_point() else t)(torch.as_tensor(a)))
    def _A_setup():
        B, S, D, H = 1, 2048, 576, 32
        return {
            "x": _w((lambda *s: torch.randn(*s, dtype=torch.bfloat16) * 0.05)(B, S, D)),
            "wqkv": _w((lambda *s: torch.randn(*s, dtype=torch.bfloat16) * 0.05)(D, 3 * D)),
            "wo": _w((lambda *s: torch.randn(*s, dtype=torch.bfloat16) * 0.05)(D, D)),
        }
    _A_in = _A_setup()

    def _B_setup():
        B, S, Dm, Df = 1, 2048, 576, 4608
        return {
            "x": _w((lambda *s: torch.randn(*s, dtype=torch.bfloat16) * 0.05)(B, S, Dm)),
            "w_gate": _w((lambda *s: torch.randn(*s, dtype=torch.bfloat16) * 0.8)(Dm, Df) * (Dm ** -0.5)),
            "w_up": _w((lambda *s: torch.randn(*s, dtype=torch.bfloat16) * 0.8)(Dm, Df) * (Dm ** -0.5)),
            "w_down": _w((lambda *s: torch.randn(*s, dtype=torch.bfloat16) * 0.8)(Df, Dm) * (Df ** -0.5)),
        }
    _B_in = _B_setup()

    return {
        "A_x": _A_in["x"],
        "A_wqkv": _A_in["wqkv"],
        "A_wo": _A_in["wo"],
        "B_x": _B_in["x"],
        "B_w_gate": _B_in["w_gate"],
        "B_w_up": _B_in["w_up"],
        "B_w_down": _B_in["w_down"],
    }

def reference(A_x, A_wqkv, A_wo, B_x, B_w_gate, B_w_up, B_w_down):
    def _A_ref(x, wqkv, wo):
        B, S, D = x.shape
        H = 32
        Dh = D // H
        qkv = (lambda x, *d: x.permute(*d))((x @ wqkv).reshape(B, S, 3, H, Dh), 2, 0, 3, 1, 4)
        q, k, v = qkv[0], qkv[1], qkv[2]
        scores = torch.einsum("bhqd,bhkd->bhqk", q, k) * (Dh ** -0.5)
        p = _softmax(scores, axis=-1)
        o = torch.einsum("bhqk,bhkd->bhqd", p, v)
        return (lambda x, *d: x.permute(*d))(o, 0, 2, 1, 3).reshape(B, S, D) @ wo

    def _B_ref(x, w_gate, w_up, w_down):
        g = torch.einsum("bsd,df->bsf", x, w_gate)
        u = torch.einsum("bsd,df->bsf", x, w_up)
        h = _gelu(g) * u
        return torch.einsum("bsf,fd->bsd", h, w_down)

    x = A_x
    xn = _layernorm(x, axis=-1)
    return x + _A_ref(xn, A_wqkv, A_wo) + _B_ref(xn, B_w_gate, B_w_up, B_w_down)
```

```asm
; @launch grid=(256,1,1) block=(256,1,1) lds=163840
.amdgcn_target "amdgcn-amd-amdhsa--gfx950"
.text
.globl parallel_sum__mha_block__glu_gated_geglu__prompt_kernel
.p2align 8
.type parallel_sum__mha_block__glu_gated_geglu__prompt_kernel,@function
parallel_sum__mha_block__glu_gated_geglu__prompt_kernel:
    s_cmp_ge_u32 s2, 256
    s_cbranch_scc1 L_end
    s_load_dwordx2 s[8:9], s[0:1], 0
    v_lshrrev_b32 v232, 6, v0
    v_and_b32 v236, 7, v0
    s_getpc_b64 s[52:53]
L_pc:
    s_lshr_b32 s69, s2, 3
    v_lshl_add_u32 v30, s69, 2, v232
    v_lshl_add_u32 v30, v236, 7, v30
    v_min_u32 v30, (L_code_end-L_pc-4)/128, v30
    v_lshlrev_b32 v30, 7, v30
    v_add_co_u32 v30, vcc, s52, v30
    v_mov_b32 v31, s53
    s_and_b32 s66, s69, 1
    v_addc_co_u32 v31, vcc, 0, v31, vcc
    global_load_dword a241, v[30:31], off
    s_lshr_b32 s46, s2, 4
    s_and_b32 s71, s2, 1
    s_lshl4_add_u32 s70, s46, s71
    v_bfe_u32 v235, v0, 3, 3
    v_lshl_add_u32 v28, v232, 2, s70
    v_lshl_add_u32 v28, v28, 3, v235
    v_xor_b32 v216, 8, v28
    s_movk_i32 s48, 1152
    v_lshlrev_b32 v237, 4, v236
    v_mad_u32_u24 v28, v28, s48, v237
    s_and_b32 s49, s46, 7
    s_lshl_b32 s49, s49, 1
    s_lshr_b32 s49, 0x9249200, s49
    s_movk_i32 s39, 0x180
    s_and_b32 s36, s49, s39
    s_lshr_b32 s49, s49, 2
    s_and_b32 s37, s49, s39
    s_lshr_b32 s49, s49, 2
    s_and_b32 s38, s49, s39
    s_lshl_b32 s10, s48, 11
    s_mov_b32 s11, 0x00020000
    v_mad_u32_u24 v216, v216, s48, v237
    s_waitcnt lgkmcnt(0)
    buffer_load_dwordx4 v[104:107], v28, s[8:11], s36 offen offset:0
    buffer_load_dwordx4 v[108:111], v28, s[8:11], s37 offen offset:0
    buffer_load_dwordx4 v[112:115], v28, s[8:11], s38 offen offset:0
    buffer_load_dwordx4 v[116:119], v28, s[8:11], s36 offen offset:384
    buffer_load_dwordx4 v[120:123], v28, s[8:11], s37 offen offset:384
    buffer_load_dwordx4 v[124:127], v28, s[8:11], s38 offen offset:384
    buffer_load_dwordx4 v[128:131], v28, s[8:11], s36 offen offset:768
    buffer_load_dwordx4 v[132:135], v28, s[8:11], s37 offen offset:768
    buffer_load_dwordx4 v[136:139], v28, s[8:11], s38 offen offset:768
    s_load_dwordx2 s[34:35], s[0:1], 8
    s_load_dwordx2 s[92:93], s[0:1], 16
    s_load_dwordx2 s[16:17], s[0:1], 32
    s_load_dwordx2 s[20:21], s[0:1], 40
    s_load_dwordx2 s[24:25], s[0:1], 48
    s_load_dwordx4 s[88:91], s[0:1], 56
    s_load_dwordx2 s[12:13], s[0:1], 72
    buffer_load_dwordx4 v[140:143], v216, s[8:11], s36 offen offset:0
    buffer_load_dwordx4 v[144:147], v216, s[8:11], s37 offen offset:0
    v_readfirstlane_b32 s44, v232
    v_and_b32 v29, 63, v0
    s_and_b32 s45, s2, 7
    s_lshl1_add_u32 s45, s45, s66
    s_mov_b32 s64, s46
    v_and_b32 v233, 15, v29
    v_lshrrev_b32 v234, 4, v29
    s_lshl2_add_u32 s69, s46, s44
    v_lshlrev_b32 v1, 4, v29
    s_and_b32 s49, s44, 1
    s_add_u32 s32, s36, s39
    s_add_u32 s33, s37, s39
    s_add_u32 s84, s38, s39
    s_add_u32 s85, s32, s39
    s_add_u32 s97, s33, s39
    s_add_u32 s99, s84, s39
    s_mov_b32 s18, 5308416
    s_mov_b32 s19, s11
    s_mov_b32 s30, s18
    s_mov_b32 s31, s11
    v_min_u32 v221, 8, v29
    v_mul_u32_u24 v221, 9216, v221
    s_lshl1_add_u32 s64, s64, s66
    s_lshl1_add_u32 s64, s64, s49
    s_mul_i32 s64, s64, 82944
    s_or_b32 s65, s45, 1
    s_mul_i32 s65, s65, 576
    s_add_u32 s76, s64, s65
    v_and_b32 v237, 2, v235
    v_lshlrev_b32 v237, 1, v237
    v_xor_b32 v237, v237, v236
    v_and_b32 v238, 6, v235
    v_xor_b32 v238, v238, v236
    s_lshl_b32 s48, s44, 3
    v_add_u32 v235, s48, v235
    v_mul_u32_u24 v3, 9216, v235
    v_lshl_add_u32 v3, v237, 4, v3
    v_mov_b32 v6, v3
    v_mul_u32_u24 v4, 3456, v235
    v_lshl_add_u32 v4, v237, 4, v4
    v_mul_u32_u24 v5, 1152, v235
    v_lshl_add_u32 v5, v238, 4, v5
    v_lshrrev_b32 v235, 2, v29
    v_and_b32 v236, 3, v29
    v_lshrrev_b32 v237, 5, v29
    v_lshlrev_b32 v237, 1, v237
    v_xor_b32 v237, v237, v236
    s_lshl_b32 s48, s49, 4
    v_add_u32 v235, s48, v235
    v_mul_u32_u24 v2, 9216, v235
    v_lshl_add_u32 v2, v237, 4, v2
    v_bfe_u32 v235, v29, 2, 2
    v_lshlrev_b32 v236, 3, v236
    v_mul_u32_u24 v9, 1056, v234
    v_lshl_add_u32 v9, v235, 7, v9
    v_lshrrev_b32 v237, 1, v235
    v_xor_b32 v238, s49, v237
    v_lshl_add_u32 v9, v238, 6, v9
    v_add_u32 v9, v9, v236
    v_add_u32 v10, 38016, v9
    v_lshrrev_b32 v238, 1, v234
    v_mul_u32_u24 v238, 1056, v238
    v_add_u32 v238, v238, v236
    v_and_b32 v239, 1, v234
    v_lshl_add_u32 v7, v239, 9, v238
    v_lshl_add_u32 v7, v235, 6, v7
    v_xor_b32 v240, s49, v239
    v_lshl_add_u32 v7, v240, 5, v7
    v_add_u32 v8, 38016, v7
    v_lshl_add_u32 v11, v239, 9, v238
    v_lshl_add_u32 v11, v235, 7, v11
    v_lshl_or_b32 v240, v239, 1, v237
    v_xor_b32 v240, s44, v240
    v_lshl_add_u32 v11, v240, 5, v11
    s_mov_b32 s14, 268435456
    s_mov_b32 s15, s11
    s_mov_b32 s22, s18
    s_mov_b32 s23, s11
    s_mov_b32 s26, s18
    s_mov_b32 s27, s11
    s_mov_b32 s94, 663552
    s_mov_b32 s95, s11
    s_mul_i32 s47, s44, 1056
    s_mul_i32 s74, s45, 576
    s_lshl_b32 s57, s66, 6
    s_add_u32 s57, s57, s74
    s_xor_b32 s48, s66, 1
    s_lshl_b32 s48, s48, 9
    s_add_u32 s74, s74, s48
    s_mov_b32 s50, 294912
    s_mul_i32 s62, s45, 331776
    s_mov_b32 s72, 0x3ae38e39
    s_mov_b32 s73, 0xffff0000
    s_mov_b32 s68, 3231527164
    s_mov_b32 s3, 1046539269
    v_add_u32 v217, 18432, v28
    v_add_u32 v218, 18432, v216
    s_movk_i32 s40, 4608
    s_mov_b32 s41, s57
    s_mov_b32 s42, s57
    v_add_u32 v16, 76032, v1
    s_xor_b32 s48, s66, 1
    s_lshl_b32 s48, s48, 16
    s_lshl_b32 s51, s49, 3
    s_add_u32 s48, s48, s51
    s_add_u32 s51, s49, s66
    s_lshl_b32 s51, s51, 13
    s_sub_u32 s4, s51, s48
    s_lshr_b32 s65, s44, 1
    s_lshl_b32 s65, s65, 12
    s_add_u32 s64, s51, s65
    s_sub_u32 s6, s64, 73720
    s_cmp_lt_u32 s2, 8
    s_cselect_b32 s7, 12, 14
    s_lshl_b32 s51, s44, 11
    s_add_u32 s67, s48, s51
    v_add_u32 v12, s67, v16
    s_xor_b32 s67, s67, 2048
    v_add_u32 v14, s67, v16
    s_lshl_b32 s51, s49, 11
    s_add_u32 s67, s51, 73728
    v_add_u32 v13, s67, v16
    s_xor_b32 s67, s67, 2048
    v_add_u32 v15, s67, v16
    s_mul_i32 s48, s2, 3641
    s_lshr_b32 s48, s48, 15
    s_mul_i32 s51, s48, 9
    s_sub_u32 s51, s2, s51
    s_lshl_b32 s67, s51, 2
    s_add_u32 s67, s67, s44
    s_mul_i32 s67, s67, 18
    s_add_u32 s67, s67, s48
    s_lshl_b32 s67, s67, 10
    s_add_u32 s67, s67, 11534336
    s_cmp_lt_u32 s2, 162
    s_cselect_b32 s87, s67, 536870912
    s_lshl_b32 s86, s51, 7
    v_lshrrev_b32 v235, 3, v29
    v_lshrrev_b32 v236, 1, v235
    v_mul_u32_u24 v236, 18, v236
    v_and_or_b32 v236, v235, 1, v236
    s_mul_i32 s67, s48, 36
    s_lshr_b32 s65, s44, 1
    s_mul_i32 s75, s65, 18
    s_add_u32 s67, s67, s75
    s_lshl_b32 s75, s49, 3
    s_add_u32 s67, s67, s75
    s_lshl_b32 s75, s48, 2
    s_add_u32 s75, s75, s44
    s_mul_i32 s75, s75, 72
    s_sub_u32 s75, s75, 4592
    s_cmp_ge_u32 s48, 16
    s_cselect_b32 s67, s75, s67
    s_cselect_b64 vcc, -1, 0
    v_cndmask_b32 v236, v235, v236, vcc
    v_add_u32 v236, s67, v236
    v_mul_u32_u24 v24, 1152, v236
    v_and_b32 v236, 0x70, v3
    v_add_u32 v24, v24, v236
    s_xor_b32 s75, s65, s49
    s_lshl_b32 s75, s75, 6
    v_mul_u32_u24 v236, 1056, v234
    v_sub_u32 v23, v9, v236
    v_xor_b32 v23, s75, v23
    s_lshl_b32 s75, s49, 5
    s_add_u32 s75, s75, 153856
    v_add3_u32 v23, v23, v236, s75
    v_cmp_eq_u32 vcc, 0, v0
    v_mov_b32 v236, 536870912
    v_mov_b32 v22, 1
    v_cndmask_b32 v21, v236, 0, vcc
    s_lshl_b32 s96, s46, 4
    s_add_u32 s96, s96, s45
    s_lshl_b32 s96, s96, 2
    s_add_u32 s96, s96, 12582912
    s_mul_i32 s67, s45, 2359296
    s_mul_i32 s51, s46, 147456
    s_add_u32 s67, s67, s51
    s_lshl_b32 s51, s44, 10
    s_add_u32 s67, s67, s51
    s_add_u32 s67, s67, 16777216
    v_mov_b32 v19, 0x3f803f80
    v_lshrrev_b32 v235, 3, v29
    v_and_b32 v236, 7, v29
    v_xor_b32 v235, v235, v236
    v_lshlrev_b32 v235, 4, v235
    v_lshl_add_u32 v235, v236, 8, v235
    s_mul_i32 s51, s44, 18432
    s_add_u32 s51, s51, 76032
    s_lshl_b32 s48, s71, 7
    s_add_u32 s48, s48, s51
    v_add_u32 v252, s48, v235
    v_xor_b32 v255, 128, v252
    v_xor_b32 v235, v233, v234
    v_lshlrev_b32 v235, 4, v235
    v_lshl_add_u32 v235, v234, 8, v235
    v_xor_b32 v236, 64, v235
    v_add_u32 v253, s51, v235
    v_add_u32 v254, s51, v236
    s_xor_b32 s51, s44, 1
    s_mul_i32 s51, s51, 18432
    s_add_u32 s51, s51, 76032
    v_add_u32 v228, s51, v235
    v_add_u32 v229, s51, v236
    v_bfe_i32 v205, v29, 1, 1
    v_not_b32 v205, v205
    v_bfi_b32 v204, v1, 0, 16
    v_add_u32 v17, 40960, v16
    v_add_u32 v25, 38016, v11
    v_min_u32 v0, 10, v29
    v_lshlrev_b32 v0, 7, v0
    s_lshl_b32 s51, s46, 2
    s_add_u32 s51, s51, s44
    s_mul_i32 s51, s51, 5184
    s_add_u32 s75, s51, s62
    s_mul_i32 s63, s2, 9344
    s_add_u32 s63, s63, 5252096
    s_cmp_eq_u32 s44, 0
    s_cselect_b32 s63, s63, 536870912
    v_and_b32 v231, 31, v29
    v_lshlrev_b32 v231, 2, v231
    s_waitcnt lgkmcnt(0)
    s_cmp_lt_u32 s44, 2
    s_cselect_b64 s[28:29], s[16:17], s[20:21]
    v_mov_b32 v184, 0
    v_mov_b32 v185, 0
    v_mov_b32 v186, 0
    v_mov_b32 v187, 0
    v_mov_b32 v188, 0
    v_mov_b32 v189, 0
    v_mov_b32 v190, 0
    v_mov_b32 v191, 0
    v_mov_b32 v192, 0
    v_mov_b32 v193, 0
    v_mov_b32 v194, 0
    v_mov_b32 v195, 0
    v_mov_b32 v196, 0
    v_mov_b32 v197, 0
    v_mov_b32 v198, 0
    v_mov_b32 v199, 0
    s_movk_i32 s43, 4224
    s_mov_b32 s51, 0
    v_mov_b32 v248, 0
    v_mov_b32 v249, 0
    s_waitcnt vmcnt(10)
    v_dot2c_f32_bf16 v248, v104, v19
    v_dot2c_f32_bf16 v249, v104, v104
    v_dot2c_f32_bf16 v248, v105, v19
    v_dot2c_f32_bf16 v249, v105, v105
    v_dot2c_f32_bf16 v248, v106, v19
    v_dot2c_f32_bf16 v249, v106, v106
    v_dot2c_f32_bf16 v248, v107, v19
    v_dot2c_f32_bf16 v249, v107, v107
    s_waitcnt vmcnt(9)
    v_dot2c_f32_bf16 v248, v108, v19
    v_dot2c_f32_bf16 v249, v108, v108
    v_dot2c_f32_bf16 v248, v109, v19
    v_dot2c_f32_bf16 v249, v109, v109
    v_dot2c_f32_bf16 v248, v110, v19
    v_dot2c_f32_bf16 v249, v110, v110
    v_dot2c_f32_bf16 v248, v111, v19
    v_dot2c_f32_bf16 v249, v111, v111
    buffer_load_dwordx4 v[148:151], v216, s[8:11], s38 offen offset:0
    s_waitcnt vmcnt(9)
    v_dot2c_f32_bf16 v248, v112, v19
    v_dot2c_f32_bf16 v249, v112, v112
    v_dot2c_f32_bf16 v248, v113, v19
    v_dot2c_f32_bf16 v249, v113, v113
    v_dot2c_f32_bf16 v248, v114, v19
    v_dot2c_f32_bf16 v249, v114, v114
    v_dot2c_f32_bf16 v248, v115, v19
    v_dot2c_f32_bf16 v249, v115, v115
    buffer_load_dwordx4 v[152:155], v216, s[8:11], s36 offen offset:384
    s_waitcnt vmcnt(9)
    v_dot2c_f32_bf16 v248, v116, v19
    v_dot2c_f32_bf16 v249, v116, v116
    v_dot2c_f32_bf16 v248, v117, v19
    v_dot2c_f32_bf16 v249, v117, v117
    v_dot2c_f32_bf16 v248, v118, v19
    v_dot2c_f32_bf16 v249, v118, v118
    v_dot2c_f32_bf16 v248, v119, v19
    v_dot2c_f32_bf16 v249, v119, v119
    s_waitcnt vmcnt(8)
    v_dot2c_f32_bf16 v248, v120, v19
    v_dot2c_f32_bf16 v249, v120, v120
    v_dot2c_f32_bf16 v248, v121, v19
    v_dot2c_f32_bf16 v249, v121, v121
    v_dot2c_f32_bf16 v248, v122, v19
    v_dot2c_f32_bf16 v249, v122, v122
    v_dot2c_f32_bf16 v248, v123, v19
    v_dot2c_f32_bf16 v249, v123, v123
    buffer_load_dwordx4 v[156:159], v216, s[8:11], s37 offen offset:384
    s_waitcnt vmcnt(8)
    v_dot2c_f32_bf16 v248, v124, v19
    v_dot2c_f32_bf16 v249, v124, v124
    v_dot2c_f32_bf16 v248, v125, v19
    v_dot2c_f32_bf16 v249, v125, v125
    v_dot2c_f32_bf16 v248, v126, v19
    v_dot2c_f32_bf16 v249, v126, v126
    v_dot2c_f32_bf16 v248, v127, v19
    v_dot2c_f32_bf16 v249, v127, v127
    buffer_load_dwordx4 v[160:163], v216, s[8:11], s38 offen offset:384
    s_waitcnt vmcnt(8)
    v_dot2c_f32_bf16 v248, v128, v19
    v_dot2c_f32_bf16 v249, v128, v128
    v_dot2c_f32_bf16 v248, v129, v19
    v_dot2c_f32_bf16 v249, v129, v129
    v_dot2c_f32_bf16 v248, v130, v19
    v_dot2c_f32_bf16 v249, v130, v130
    v_dot2c_f32_bf16 v248, v131, v19
    v_dot2c_f32_bf16 v249, v131, v131
    s_waitcnt vmcnt(7)
    v_dot2c_f32_bf16 v248, v132, v19
    v_dot2c_f32_bf16 v249, v132, v132
    v_dot2c_f32_bf16 v248, v133, v19
    v_dot2c_f32_bf16 v249, v133, v133
    v_dot2c_f32_bf16 v248, v134, v19
    v_dot2c_f32_bf16 v249, v134, v134
    v_dot2c_f32_bf16 v248, v135, v19
    v_dot2c_f32_bf16 v249, v135, v135
    buffer_load_dwordx4 v[164:167], v216, s[8:11], s36 offen offset:768
    s_waitcnt vmcnt(7)
    v_dot2c_f32_bf16 v248, v136, v19
    v_dot2c_f32_bf16 v249, v136, v136
    v_dot2c_f32_bf16 v248, v137, v19
    v_dot2c_f32_bf16 v249, v137, v137
    v_dot2c_f32_bf16 v248, v138, v19
    v_dot2c_f32_bf16 v249, v138, v138
    v_dot2c_f32_bf16 v248, v139, v19
    v_dot2c_f32_bf16 v249, v139, v139
    buffer_load_dwordx4 v[168:171], v216, s[8:11], s37 offen offset:768
    s_nop 2
    v_add_f32_dpp v248, v248, v248 quad_perm:[1,0,3,2] row_mask:0xf bank_mask:0xf
    v_add_f32_dpp v249, v249, v249 quad_perm:[1,0,3,2] row_mask:0xf bank_mask:0xf
    s_nop 0
    v_add_f32_dpp v248, v248, v248 quad_perm:[2,3,0,1] row_mask:0xf bank_mask:0xf
    v_add_f32_dpp v249, v249, v249 quad_perm:[2,3,0,1] row_mask:0xf bank_mask:0xf
    s_nop 0
    v_add_f32_dpp v248, v248, v248 row_half_mirror row_mask:0xf bank_mask:0xf
    v_add_f32_dpp v249, v249, v249 row_half_mirror row_mask:0xf bank_mask:0xf
    s_nop 0
    v_mul_f32 v248, s72, v248
    v_mul_f32 v249, s72, v249
    v_fma_f32 v249, -v248, v248, v249
    v_max_f32 v249, 0, v249
    v_cvt_pk_bf16_f32 v249, 0, v249
    v_add_f32 v249, 0x3727c5ac, v249
    v_cvt_pk_bf16_f32 v249, 0, v249
    v_sqrt_f32 v249, v249
    v_cvt_pk_bf16_f32 v248, 0, -v248
    v_cvt_pk_bf16_f32 v249, 0, v249
    v_rcp_f32 v249, v249
    s_nop 0
    v_mul_f32 v249, 1055913304, v249
    v_and_b32 v251, s73, v249
    v_sub_f32 v249, v249, v251
    v_cvt_pk_bf16_f32 v207, 0, v249
    v_add_f32 v249, v251, v207
    v_mul_f32 v200, v248, v249
    v_lshrrev_b32 v251, v204, v251
    v_mov_b32 v201, v200
    v_and_b32 v250, v205, v251
    v_mov_b32 v202, v200
    v_xor_b32 v251, v250, v251
    v_mov_b32 v203, v200
    v_lshrrev_b32 v207, v204, v207
    v_and_b32 v206, v205, v207
    v_xor_b32 v207, v206, v207
    v_mfma_f32_4x4x4_16b_bf16 v[232:235], v[250:251], v[104:105], v[200:203]
    v_mfma_f32_4x4x4_16b_bf16 v[236:239], v[250:251], v[106:107], v[200:203]
    s_nop 0
    v_mfma_f32_4x4x4_16b_bf16 v[232:235], v[206:207], v[104:105], v[232:235]
    v_mfma_f32_4x4x4_16b_bf16 v[236:239], v[206:207], v[106:107], v[236:239]
    s_nop 2
    v_mfma_f32_4x4x4_16b_bf16 v[240:243], v[250:251], v[108:109], v[200:203]
    v_cvt_pk_bf16_f32 v104, v232, v233
    v_mfma_f32_4x4x4_16b_bf16 v[244:247], v[250:251], v[110:111], v[200:203]
    v_cvt_pk_bf16_f32 v105, v234, v235
    v_mfma_f32_4x4x4_16b_bf16 v[240:243], v[206:207], v[108:109], v[240:243]
    v_cvt_pk_bf16_f32 v106, v236, v237
    v_mfma_f32_4x4x4_16b_bf16 v[244:247], v[206:207], v[110:111], v[244:247]
    v_cvt_pk_bf16_f32 v107, v238, v239
    ds_write_b128 v252, v[104:107] offset:0
    buffer_load_dwordx4 v[172:175], v216, s[8:11], s38 offen offset:768
    v_mfma_f32_4x4x4_16b_bf16 v[232:235], v[250:251], v[112:113], v[200:203]
    v_cvt_pk_bf16_f32 v108, v240, v241
    v_mfma_f32_4x4x4_16b_bf16 v[236:239], v[250:251], v[114:115], v[200:203]
    v_cvt_pk_bf16_f32 v109, v242, v243
    v_mfma_f32_4x4x4_16b_bf16 v[232:235], v[206:207], v[112:113], v[232:235]
    v_cvt_pk_bf16_f32 v110, v244, v245
    v_mfma_f32_4x4x4_16b_bf16 v[236:239], v[206:207], v[114:115], v[236:239]
    v_cvt_pk_bf16_f32 v111, v246, v247
    ds_write_b128 v252, v[108:111] offset:2048
    buffer_load_dword v224, v221, s[28:31], s76 offen nt
    v_mfma_f32_4x4x4_16b_bf16 v[240:243], v[250:251], v[116:117], v[200:203]
    v_cvt_pk_bf16_f32 v112, v232, v233
    v_mfma_f32_4x4x4_16b_bf16 v[244:247], v[250:251], v[118:119], v[200:203]
    v_cvt_pk_bf16_f32 v113, v234, v235
    v_mfma_f32_4x4x4_16b_bf16 v[240:243], v[206:207], v[116:117], v[240:243]
    v_cvt_pk_bf16_f32 v114, v236, v237
    v_mfma_f32_4x4x4_16b_bf16 v[244:247], v[206:207], v[118:119], v[244:247]
    v_cvt_pk_bf16_f32 v115, v238, v239
    ds_write_b128 v252, v[112:115] offset:4096
    buffer_load_dwordx4 v[32:35], v217, s[8:11], s36 offen offset:0
    v_mfma_f32_4x4x4_16b_bf16 v[232:235], v[250:251], v[120:121], v[200:203]
    v_cvt_pk_bf16_f32 v116, v240, v241
    v_mfma_f32_4x4x4_16b_bf16 v[236:239], v[250:251], v[122:123], v[200:203]
    v_cvt_pk_bf16_f32 v117, v242, v243
    v_mfma_f32_4x4x4_16b_bf16 v[232:235], v[206:207], v[120:121], v[232:235]
    v_cvt_pk_bf16_f32 v118, v244, v245
    v_mfma_f32_4x4x4_16b_bf16 v[236:239], v[206:207], v[122:123], v[236:239]
    v_cvt_pk_bf16_f32 v119, v246, v247
    ds_write_b128 v252, v[116:119] offset:6144
    buffer_load_dwordx4 v[36:39], v217, s[8:11], s37 offen offset:0
    v_mfma_f32_4x4x4_16b_bf16 v[240:243], v[250:251], v[124:125], v[200:203]
    v_cvt_pk_bf16_f32 v120, v232, v233
    v_mfma_f32_4x4x4_16b_bf16 v[244:247], v[250:251], v[126:127], v[200:203]
    v_cvt_pk_bf16_f32 v121, v234, v235
    v_mfma_f32_4x4x4_16b_bf16 v[240:243], v[206:207], v[124:125], v[240:243]
    v_cvt_pk_bf16_f32 v122, v236, v237
    v_mfma_f32_4x4x4_16b_bf16 v[244:247], v[206:207], v[126:127], v[244:247]
    v_cvt_pk_bf16_f32 v123, v238, v239
    ds_write_b128 v252, v[120:123] offset:8192
    buffer_load_dwordx4 v[40:43], v217, s[8:11], s38 offen offset:0
    v_mfma_f32_4x4x4_16b_bf16 v[232:235], v[250:251], v[128:129], v[200:203]
    v_cvt_pk_bf16_f32 v124, v240, v241
    v_mfma_f32_4x4x4_16b_bf16 v[236:239], v[250:251], v[130:131], v[200:203]
    v_cvt_pk_bf16_f32 v125, v242, v243
    v_mfma_f32_4x4x4_16b_bf16 v[232:235], v[206:207], v[128:129], v[232:235]
    v_cvt_pk_bf16_f32 v126, v244, v245
    v_mfma_f32_4x4x4_16b_bf16 v[236:239], v[206:207], v[130:131], v[236:239]
    v_cvt_pk_bf16_f32 v127, v246, v247
    ds_write_b128 v252, v[124:127] offset:10240
    buffer_load_dwordx4 v[44:47], v217, s[8:11], s36 offen offset:384
    v_mfma_f32_4x4x4_16b_bf16 v[240:243], v[250:251], v[132:133], v[200:203]
    v_cvt_pk_bf16_f32 v128, v232, v233
    v_mfma_f32_4x4x4_16b_bf16 v[244:247], v[250:251], v[134:135], v[200:203]
    v_cvt_pk_bf16_f32 v129, v234, v235
    v_mfma_f32_4x4x4_16b_bf16 v[240:243], v[206:207], v[132:133], v[240:243]
    v_cvt_pk_bf16_f32 v130, v236, v237
    v_mfma_f32_4x4x4_16b_bf16 v[244:247], v[206:207], v[134:135], v[244:247]
    v_cvt_pk_bf16_f32 v131, v238, v239
    ds_write_b128 v252, v[128:131] offset:12288
    buffer_load_dwordx4 v[48:51], v217, s[8:11], s37 offen offset:384
    v_mfma_f32_4x4x4_16b_bf16 v[232:235], v[250:251], v[136:137], v[200:203]
    v_cvt_pk_bf16_f32 v132, v240, v241
    v_mfma_f32_4x4x4_16b_bf16 v[236:239], v[250:251], v[138:139], v[200:203]
    v_cvt_pk_bf16_f32 v133, v242, v243
    v_mfma_f32_4x4x4_16b_bf16 v[232:235], v[206:207], v[136:137], v[232:235]
    v_cvt_pk_bf16_f32 v134, v244, v245
    v_mfma_f32_4x4x4_16b_bf16 v[236:239], v[206:207], v[138:139], v[236:239]
    v_cvt_pk_bf16_f32 v135, v246, v247
    ds_write_b128 v252, v[132:135] offset:14336
    buffer_load_dwordx4 v[52:55], v217, s[8:11], s38 offen offset:384
    s_nop 1
    v_cvt_pk_bf16_f32 v136, v232, v233
    v_cvt_pk_bf16_f32 v137, v234, v235
    v_cvt_pk_bf16_f32 v138, v236, v237
    v_cvt_pk_bf16_f32 v139, v238, v239
    ds_write_b128 v252, v[136:139] offset:16384
    buffer_load_dwordx4 v[56:59], v217, s[8:11], s36 offen offset:768
    v_mov_b32 v248, 0
    v_mov_b32 v249, 0
    s_waitcnt vmcnt(14)
    v_dot2c_f32_bf16 v248, v140, v19
    v_dot2c_f32_bf16 v249, v140, v140
    v_dot2c_f32_bf16 v248, v141, v19
    v_dot2c_f32_bf16 v249, v141, v141
    v_dot2c_f32_bf16 v248, v142, v19
    v_dot2c_f32_bf16 v249, v142, v142
    v_dot2c_f32_bf16 v248, v143, v19
    v_dot2c_f32_bf16 v249, v143, v143
    v_dot2c_f32_bf16 v248, v144, v19
    v_dot2c_f32_bf16 v249, v144, v144
    v_dot2c_f32_bf16 v248, v145, v19
    v_dot2c_f32_bf16 v249, v145, v145
    v_dot2c_f32_bf16 v248, v146, v19
    v_dot2c_f32_bf16 v249, v146, v146
    v_dot2c_f32_bf16 v248, v147, v19
    v_dot2c_f32_bf16 v249, v147, v147
    v_dot2c_f32_bf16 v248, v148, v19
    v_dot2c_f32_bf16 v249, v148, v148
    v_dot2c_f32_bf16 v248, v149, v19
    v_dot2c_f32_bf16 v249, v149, v149
    v_dot2c_f32_bf16 v248, v150, v19
    v_dot2c_f32_bf16 v249, v150, v150
    v_dot2c_f32_bf16 v248, v151, v19
    v_dot2c_f32_bf16 v249, v151, v151
    buffer_load_dwordx4 v[60:63], v217, s[8:11], s37 offen offset:768
    s_waitcnt vmcnt(12)
    v_dot2c_f32_bf16 v248, v152, v19
    v_dot2c_f32_bf16 v249, v152, v152
    v_dot2c_f32_bf16 v248, v153, v19
    v_dot2c_f32_bf16 v249, v153, v153
    v_dot2c_f32_bf16 v248, v154, v19
    v_dot2c_f32_bf16 v249, v154, v154
    v_dot2c_f32_bf16 v248, v155, v19
    v_dot2c_f32_bf16 v249, v155, v155
    v_dot2c_f32_bf16 v248, v156, v19
    v_dot2c_f32_bf16 v249, v156, v156
    v_dot2c_f32_bf16 v248, v157, v19
    v_dot2c_f32_bf16 v249, v157, v157
    v_dot2c_f32_bf16 v248, v158, v19
    v_dot2c_f32_bf16 v249, v158, v158
    v_dot2c_f32_bf16 v248, v159, v19
    v_dot2c_f32_bf16 v249, v159, v159
    v_dot2c_f32_bf16 v248, v160, v19
    v_dot2c_f32_bf16 v249, v160, v160
    v_dot2c_f32_bf16 v248, v161, v19
    v_dot2c_f32_bf16 v249, v161, v161
    v_dot2c_f32_bf16 v248, v162, v19
    v_dot2c_f32_bf16 v249, v162, v162
    v_dot2c_f32_bf16 v248, v163, v19
    v_dot2c_f32_bf16 v249, v163, v163
    buffer_load_dwordx4 v[64:67], v217, s[8:11], s38 offen offset:768
    s_waitcnt vmcnt(10)
    v_dot2c_f32_bf16 v248, v164, v19
    v_dot2c_f32_bf16 v249, v164, v164
    v_dot2c_f32_bf16 v248, v165, v19
    v_dot2c_f32_bf16 v249, v165, v165
    v_dot2c_f32_bf16 v248, v166, v19
    v_dot2c_f32_bf16 v249, v166, v166
    v_dot2c_f32_bf16 v248, v167, v19
    v_dot2c_f32_bf16 v249, v167, v167
    v_dot2c_f32_bf16 v248, v168, v19
    v_dot2c_f32_bf16 v249, v168, v168
    v_dot2c_f32_bf16 v248, v169, v19
    v_dot2c_f32_bf16 v249, v169, v169
    v_dot2c_f32_bf16 v248, v170, v19
    v_dot2c_f32_bf16 v249, v170, v170
    v_dot2c_f32_bf16 v248, v171, v19
    v_dot2c_f32_bf16 v249, v171, v171
    v_dot2c_f32_bf16 v248, v172, v19
    v_dot2c_f32_bf16 v249, v172, v172
    v_dot2c_f32_bf16 v248, v173, v19
    v_dot2c_f32_bf16 v249, v173, v173
    v_dot2c_f32_bf16 v248, v174, v19
    v_dot2c_f32_bf16 v249, v174, v174
    v_dot2c_f32_bf16 v248, v175, v19
    v_dot2c_f32_bf16 v249, v175, v175
    buffer_load_dwordx4 v[68:71], v218, s[8:11], s36 offen offset:0
    s_nop 2
    v_add_f32_dpp v248, v248, v248 quad_perm:[1,0,3,2] row_mask:0xf bank_mask:0xf
    v_add_f32_dpp v249, v249, v249 quad_perm:[1,0,3,2] row_mask:0xf bank_mask:0xf
    s_nop 0
    v_add_f32_dpp v248, v248, v248 quad_perm:[2,3,0,1] row_mask:0xf bank_mask:0xf
    v_add_f32_dpp v249, v249, v249 quad_perm:[2,3,0,1] row_mask:0xf bank_mask:0xf
    s_nop 0
    v_add_f32_dpp v248, v248, v248 row_half_mirror row_mask:0xf bank_mask:0xf
    v_add_f32_dpp v249, v249, v249 row_half_mirror row_mask:0xf bank_mask:0xf
    s_nop 0
    v_mul_f32 v248, s72, v248
    v_mul_f32 v249, s72, v249
    v_fma_f32 v249, -v248, v248, v249
    v_max_f32 v249, 0, v249
    v_cvt_pk_bf16_f32 v249, 0, v249
    v_add_f32 v249, 0x3727c5ac, v249
    v_cvt_pk_bf16_f32 v249, 0, v249
    v_sqrt_f32 v249, v249
    v_cvt_pk_bf16_f32 v248, 0, -v248
    v_cvt_pk_bf16_f32 v249, 0, v249
    v_rcp_f32 v249, v249
    s_nop 0
    v_mul_f32 v249, 1055913304, v249
    v_and_b32 v251, s73, v249
    v_sub_f32 v249, v249, v251
    v_cvt_pk_bf16_f32 v207, 0, v249
    v_add_f32 v249, v251, v207
    v_mul_f32 v200, v248, v249
    v_lshrrev_b32 v251, v204, v251
    v_mov_b32 v201, v200
    v_and_b32 v250, v205, v251
    v_mov_b32 v202, v200
    v_xor_b32 v251, v250, v251
    v_mov_b32 v203, v200
    v_lshrrev_b32 v207, v204, v207
    v_and_b32 v206, v205, v207
    v_xor_b32 v207, v206, v207
    v_mfma_f32_4x4x4_16b_bf16 v[232:235], v[250:251], v[140:141], v[200:203]
    v_mfma_f32_4x4x4_16b_bf16 v[236:239], v[250:251], v[142:143], v[200:203]
    s_nop 0
    v_mfma_f32_4x4x4_16b_bf16 v[232:235], v[206:207], v[140:141], v[232:235]
    v_mfma_f32_4x4x4_16b_bf16 v[236:239], v[206:207], v[142:143], v[236:239]
    s_nop 2
    v_mfma_f32_4x4x4_16b_bf16 v[240:243], v[250:251], v[144:145], v[200:203]
    v_cvt_pk_bf16_f32 v140, v232, v233
    v_mfma_f32_4x4x4_16b_bf16 v[244:247], v[250:251], v[146:147], v[200:203]
    v_cvt_pk_bf16_f32 v141, v234, v235
    v_mfma_f32_4x4x4_16b_bf16 v[240:243], v[206:207], v[144:145], v[240:243]
    v_cvt_pk_bf16_f32 v142, v236, v237
    v_mfma_f32_4x4x4_16b_bf16 v[244:247], v[206:207], v[146:147], v[244:247]
    v_cvt_pk_bf16_f32 v143, v238, v239
    ds_write_b128 v255, v[140:143] offset:0
    buffer_load_dwordx4 v[72:75], v218, s[8:11], s37 offen offset:0
    v_mfma_f32_4x4x4_16b_bf16 v[232:235], v[250:251], v[148:149], v[200:203]
    v_cvt_pk_bf16_f32 v144, v240, v241
    v_mfma_f32_4x4x4_16b_bf16 v[236:239], v[250:251], v[150:151], v[200:203]
    v_cvt_pk_bf16_f32 v145, v242, v243
    v_mfma_f32_4x4x4_16b_bf16 v[232:235], v[206:207], v[148:149], v[232:235]
    v_cvt_pk_bf16_f32 v146, v244, v245
    v_mfma_f32_4x4x4_16b_bf16 v[236:239], v[206:207], v[150:151], v[236:239]
    v_cvt_pk_bf16_f32 v147, v246, v247
    ds_write_b128 v255, v[144:147] offset:2048
    buffer_load_dwordx4 v[76:79], v218, s[8:11], s38 offen offset:0
    v_mfma_f32_4x4x4_16b_bf16 v[240:243], v[250:251], v[152:153], v[200:203]
    v_cvt_pk_bf16_f32 v148, v232, v233
    v_mfma_f32_4x4x4_16b_bf16 v[244:247], v[250:251], v[154:155], v[200:203]
    v_cvt_pk_bf16_f32 v149, v234, v235
    v_mfma_f32_4x4x4_16b_bf16 v[240:243], v[206:207], v[152:153], v[240:243]
    v_cvt_pk_bf16_f32 v150, v236, v237
    v_mfma_f32_4x4x4_16b_bf16 v[244:247], v[206:207], v[154:155], v[244:247]
    v_cvt_pk_bf16_f32 v151, v238, v239
    ds_write_b128 v255, v[148:151] offset:4096
    buffer_load_dwordx4 v[80:83], v218, s[8:11], s36 offen offset:384
    v_mfma_f32_4x4x4_16b_bf16 v[232:235], v[250:251], v[156:157], v[200:203]
    v_cvt_pk_bf16_f32 v152, v240, v241
    v_mfma_f32_4x4x4_16b_bf16 v[236:239], v[250:251], v[158:159], v[200:203]
    v_cvt_pk_bf16_f32 v153, v242, v243
    v_mfma_f32_4x4x4_16b_bf16 v[232:235], v[206:207], v[156:157], v[232:235]
    v_cvt_pk_bf16_f32 v154, v244, v245
    v_mfma_f32_4x4x4_16b_bf16 v[236:239], v[206:207], v[158:159], v[236:239]
    v_cvt_pk_bf16_f32 v155, v246, v247
    ds_write_b128 v255, v[152:155] offset:6144
    buffer_load_dwordx4 v[84:87], v218, s[8:11], s37 offen offset:384
    v_mfma_f32_4x4x4_16b_bf16 v[240:243], v[250:251], v[160:161], v[200:203]
    v_cvt_pk_bf16_f32 v156, v232, v233
    v_mfma_f32_4x4x4_16b_bf16 v[244:247], v[250:251], v[162:163], v[200:203]
    v_cvt_pk_bf16_f32 v157, v234, v235
    v_mfma_f32_4x4x4_16b_bf16 v[240:243], v[206:207], v[160:161], v[240:243]
    v_cvt_pk_bf16_f32 v158, v236, v237
    v_mfma_f32_4x4x4_16b_bf16 v[244:247], v[206:207], v[162:163], v[244:247]
    v_cvt_pk_bf16_f32 v159, v238, v239
    ds_write_b128 v255, v[156:159] offset:8192
    buffer_load_dwordx4 v[88:91], v218, s[8:11], s38 offen offset:384
    v_mfma_f32_4x4x4_16b_bf16 v[232:235], v[250:251], v[164:165], v[200:203]
    v_cvt_pk_bf16_f32 v160, v240, v241
    v_mfma_f32_4x4x4_16b_bf16 v[236:239], v[250:251], v[166:167], v[200:203]
    v_cvt_pk_bf16_f32 v161, v242, v243
    v_mfma_f32_4x4x4_16b_bf16 v[232:235], v[206:207], v[164:165], v[232:235]
    v_cvt_pk_bf16_f32 v162, v244, v245
    v_mfma_f32_4x4x4_16b_bf16 v[236:239], v[206:207], v[166:167], v[236:239]
    v_cvt_pk_bf16_f32 v163, v246, v247
    ds_write_b128 v255, v[160:163] offset:10240
    buffer_load_dwordx4 v[92:95], v218, s[8:11], s36 offen offset:768
    v_mfma_f32_4x4x4_16b_bf16 v[240:243], v[250:251], v[168:169], v[200:203]
    v_cvt_pk_bf16_f32 v164, v232, v233
    v_mfma_f32_4x4x4_16b_bf16 v[244:247], v[250:251], v[170:171], v[200:203]
    v_cvt_pk_bf16_f32 v165, v234, v235
    v_mfma_f32_4x4x4_16b_bf16 v[240:243], v[206:207], v[168:169], v[240:243]
    v_cvt_pk_bf16_f32 v166, v236, v237
    v_mfma_f32_4x4x4_16b_bf16 v[244:247], v[206:207], v[170:171], v[244:247]
    v_cvt_pk_bf16_f32 v167, v238, v239
    ds_write_b128 v255, v[164:167] offset:12288
    buffer_load_dwordx4 v[96:99], v218, s[8:11], s37 offen offset:768
    v_mfma_f32_4x4x4_16b_bf16 v[232:235], v[250:251], v[172:173], v[200:203]
    v_cvt_pk_bf16_f32 v168, v240, v241
    v_mfma_f32_4x4x4_16b_bf16 v[236:239], v[250:251], v[174:175], v[200:203]
    v_cvt_pk_bf16_f32 v169, v242, v243
    v_mfma_f32_4x4x4_16b_bf16 v[232:235], v[206:207], v[172:173], v[232:235]
    v_cvt_pk_bf16_f32 v170, v244, v245
    v_mfma_f32_4x4x4_16b_bf16 v[236:239], v[206:207], v[174:175], v[236:239]
    v_cvt_pk_bf16_f32 v171, v246, v247
    ds_write_b128 v255, v[168:171] offset:14336
    buffer_load_dwordx4 v[100:103], v218, s[8:11], s38 offen offset:768
    s_nop 1
    v_cvt_pk_bf16_f32 v172, v232, v233
    v_cvt_pk_bf16_f32 v173, v234, v235
    v_cvt_pk_bf16_f32 v174, v236, v237
    v_cvt_pk_bf16_f32 v175, v238, v239
    s_add_u32 m0, s47, 153856
    s_cmp_eq_u32 s2, 0
    ds_write_b128 v255, v[172:175] offset:16384
    buffer_load_dwordx4 v24, s[92:95], s86 offen nt lds
    s_cbranch_scc1 L_k_z
L_k_noz:
    s_sub_u32 m0, s47, s43
    s_mov_b64 s[92:93], s[90:91]
    s_movk_i32 s94, 256
    s_mov_b32 s86, 36864
    s_mul_i32 s39, s36, s40
    s_waitcnt lgkmcnt(0)
    s_barrier
    v_mov_b32 v248, 0
    v_mov_b32 v249, 0
    s_waitcnt vmcnt(16)
    v_dot2c_f32_bf16 v248, v32, v19
    v_dot2c_f32_bf16 v249, v32, v32
    v_dot2c_f32_bf16 v248, v33, v19
    v_dot2c_f32_bf16 v249, v33, v33
    v_dot2c_f32_bf16 v248, v34, v19
    v_dot2c_f32_bf16 v249, v34, v34
    v_dot2c_f32_bf16 v248, v35, v19
    v_dot2c_f32_bf16 v249, v35, v35
    ds_read_b128 a[0:3], v228 offset:0
    ds_read_b128 a[4:7], v229 offset:1024
    ds_read_b128 a[144:147], v253 offset:0
    ds_read_b128 a[148:151], v254 offset:1024
    v_dot2c_f32_bf16 v248, v36, v19
    v_dot2c_f32_bf16 v249, v36, v36
    v_dot2c_f32_bf16 v248, v37, v19
    v_dot2c_f32_bf16 v249, v37, v37
    v_dot2c_f32_bf16 v248, v38, v19
    v_dot2c_f32_bf16 v249, v38, v38
    v_dot2c_f32_bf16 v248, v39, v19
    v_dot2c_f32_bf16 v249, v39, v39
    ds_read_b128 a[8:11], v228 offset:2048
    ds_read_b128 a[12:15], v229 offset:3072
    ds_read_b128 a[152:155], v253 offset:2048
    ds_read_b128 a[156:159], v254 offset:3072
    v_dot2c_f32_bf16 v248, v40, v19
    v_dot2c_f32_bf16 v249, v40, v40
    v_dot2c_f32_bf16 v248, v41, v19
    v_dot2c_f32_bf16 v249, v41, v41
    v_dot2c_f32_bf16 v248, v42, v19
    v_dot2c_f32_bf16 v249, v42, v42
    v_dot2c_f32_bf16 v248, v43, v19
    v_dot2c_f32_bf16 v249, v43, v43
    ds_read_b128 a[16:19], v228 offset:4096
    ds_read_b128 a[20:23], v229 offset:5120
    ds_read_b128 a[160:163], v253 offset:4096
    ds_read_b128 a[164:167], v254 offset:5120
    s_waitcnt vmcnt(13)
    v_dot2c_f32_bf16 v248, v44, v19
    v_dot2c_f32_bf16 v249, v44, v44
    v_dot2c_f32_bf16 v248, v45, v19
    v_dot2c_f32_bf16 v249, v45, v45
    v_dot2c_f32_bf16 v248, v46, v19
    v_dot2c_f32_bf16 v249, v46, v46
    v_dot2c_f32_bf16 v248, v47, v19
    v_dot2c_f32_bf16 v249, v47, v47
    ds_read_b128 a[24:27], v228 offset:6144
    ds_read_b128 a[28:31], v229 offset:7168
    ds_read_b128 a[168:171], v253 offset:6144
    ds_read_b128 a[172:175], v254 offset:7168
    v_dot2c_f32_bf16 v248, v48, v19
    v_dot2c_f32_bf16 v249, v48, v48
    v_dot2c_f32_bf16 v248, v49, v19
    v_dot2c_f32_bf16 v249, v49, v49
    v_dot2c_f32_bf16 v248, v50, v19
    v_dot2c_f32_bf16 v249, v50, v50
    v_dot2c_f32_bf16 v248, v51, v19
    v_dot2c_f32_bf16 v249, v51, v51
    ds_read_b128 a[32:35], v228 offset:8192
    ds_read_b128 a[36:39], v229 offset:9216
    ds_read_b128 a[176:179], v253 offset:8192
    ds_read_b128 a[180:183], v254 offset:9216
    v_dot2c_f32_bf16 v248, v52, v19
    v_dot2c_f32_bf16 v249, v52, v52
    v_dot2c_f32_bf16 v248, v53, v19
    v_dot2c_f32_bf16 v249, v53, v53
    v_dot2c_f32_bf16 v248, v54, v19
    v_dot2c_f32_bf16 v249, v54, v54
    v_dot2c_f32_bf16 v248, v55, v19
    v_dot2c_f32_bf16 v249, v55, v55
    ds_read_b128 a[40:43], v228 offset:10240
    ds_read_b128 a[44:47], v229 offset:11264
    ds_read_b128 a[184:187], v253 offset:10240
    ds_read_b128 a[188:191], v254 offset:11264
    s_waitcnt vmcnt(10)
    v_dot2c_f32_bf16 v248, v56, v19
    v_dot2c_f32_bf16 v249, v56, v56
    v_dot2c_f32_bf16 v248, v57, v19
    v_dot2c_f32_bf16 v249, v57, v57
    v_dot2c_f32_bf16 v248, v58, v19
    v_dot2c_f32_bf16 v249, v58, v58
    v_dot2c_f32_bf16 v248, v59, v19
    v_dot2c_f32_bf16 v249, v59, v59
    ds_read_b128 a[48:51], v228 offset:12288
    ds_read_b128 a[52:55], v229 offset:13312
    ds_read_b128 a[192:195], v253 offset:12288
    ds_read_b128 a[196:199], v254 offset:13312
    v_dot2c_f32_bf16 v248, v60, v19
    v_dot2c_f32_bf16 v249, v60, v60
    v_dot2c_f32_bf16 v248, v61, v19
    v_dot2c_f32_bf16 v249, v61, v61
    v_dot2c_f32_bf16 v248, v62, v19
    v_dot2c_f32_bf16 v249, v62, v62
    v_dot2c_f32_bf16 v248, v63, v19
    v_dot2c_f32_bf16 v249, v63, v63
    ds_read_b128 a[56:59], v228 offset:14336
    ds_read_b128 a[60:63], v229 offset:15360
    ds_read_b128 a[200:203], v253 offset:14336
    ds_read_b128 a[204:207], v254 offset:15360
    v_dot2c_f32_bf16 v248, v64, v19
    v_dot2c_f32_bf16 v249, v64, v64
    v_dot2c_f32_bf16 v248, v65, v19
    v_dot2c_f32_bf16 v249, v65, v65
    v_dot2c_f32_bf16 v248, v66, v19
    v_dot2c_f32_bf16 v249, v66, v66
    v_dot2c_f32_bf16 v248, v67, v19
    v_dot2c_f32_bf16 v249, v67, v67
    ds_read_b128 a[64:67], v228 offset:16384
    ds_read_b128 a[68:71], v229 offset:17408
    ds_read_b128 a[208:211], v253 offset:16384
    ds_read_b128 a[212:215], v254 offset:17408
    s_nop 2
    v_add_f32_dpp v248, v248, v248 quad_perm:[1,0,3,2] row_mask:0xf bank_mask:0xf
    v_add_f32_dpp v249, v249, v249 quad_perm:[1,0,3,2] row_mask:0xf bank_mask:0xf
    s_nop 0
    v_add_f32_dpp v248, v248, v248 quad_perm:[2,3,0,1] row_mask:0xf bank_mask:0xf
    v_add_f32_dpp v249, v249, v249 quad_perm:[2,3,0,1] row_mask:0xf bank_mask:0xf
    s_nop 0
    v_add_f32_dpp v248, v248, v248 row_half_mirror row_mask:0xf bank_mask:0xf
    v_add_f32_dpp v249, v249, v249 row_half_mirror row_mask:0xf bank_mask:0xf
    s_nop 0
    v_mul_f32 v248, s72, v248
    v_mul_f32 v249, s72, v249
    v_fma_f32 v249, -v248, v248, v249
    v_max_f32 v249, 0, v249
    v_cvt_pk_bf16_f32 v249, 0, v249
    v_add_f32 v249, 0x3727c5ac, v249
    v_cvt_pk_bf16_f32 v249, 0, v249
    v_sqrt_f32 v249, v249
    v_cvt_pk_bf16_f32 v248, 0, -v248
    v_cvt_pk_bf16_f32 v249, 0, v249
    v_rcp_f32 v249, v249
    s_nop 0
    v_mul_f32 v249, 1055913304, v249
    v_and_b32 v251, s73, v249
    v_sub_f32 v249, v249, v251
    v_cvt_pk_bf16_f32 v207, 0, v249
    v_add_f32 v249, v251, v207
    v_mul_f32 v200, v248, v249
    v_lshrrev_b32 v251, v204, v251
    v_mov_b32 v201, v200
    v_and_b32 v250, v205, v251
    v_mov_b32 v202, v200
    v_xor_b32 v251, v250, v251
    v_mov_b32 v203, v200
    v_lshrrev_b32 v207, v204, v207
    v_and_b32 v206, v205, v207
    v_xor_b32 v207, v206, v207
    v_mfma_f32_4x4x4_16b_bf16 v[232:235], v[250:251], v[32:33], v[200:203]
    v_mfma_f32_4x4x4_16b_bf16 v[236:239], v[250:251], v[34:35], v[200:203]
    s_nop 0
    v_mfma_f32_4x4x4_16b_bf16 v[232:235], v[206:207], v[32:33], v[232:235]
    v_mfma_f32_4x4x4_16b_bf16 v[236:239], v[206:207], v[34:35], v[236:239]
    s_nop 2
    v_mfma_f32_4x4x4_16b_bf16 v[240:243], v[250:251], v[36:37], v[200:203]
    v_cvt_pk_bf16_f32 v32, v232, v233
    v_mfma_f32_4x4x4_16b_bf16 v[244:247], v[250:251], v[38:39], v[200:203]
    v_cvt_pk_bf16_f32 v33, v234, v235
    v_mfma_f32_4x4x4_16b_bf16 v[240:243], v[206:207], v[36:37], v[240:243]
    v_cvt_pk_bf16_f32 v34, v236, v237
    v_mfma_f32_4x4x4_16b_bf16 v[244:247], v[206:207], v[38:39], v[244:247]
    v_cvt_pk_bf16_f32 v35, v238, v239
    s_waitcnt lgkmcnt(0)
    s_barrier
    s_add_u32 m0, m0, s43
    s_add_u32 s48, s39, s74
    ds_write_b128 v252, v[32:35] offset:0
    buffer_load_dwordx4 v2, s[28:31], s48 offen nt lds
    s_mul_i32 s39, s37, s40
    v_mfma_f32_4x4x4_16b_bf16 v[232:235], v[250:251], v[40:41], v[200:203]
    v_cvt_pk_bf16_f32 v36, v240, v241
    v_mfma_f32_4x4x4_16b_bf16 v[236:239], v[250:251], v[42:43], v[200:203]
    v_cvt_pk_bf16_f32 v37, v242, v243
    v_mfma_f32_4x4x4_16b_bf16 v[232:235], v[206:207], v[40:41], v[232:235]
    v_cvt_pk_bf16_f32 v38, v244, v245
    v_mfma_f32_4x4x4_16b_bf16 v[236:239], v[206:207], v[42:43], v[236:239]
    v_cvt_pk_bf16_f32 v39, v246, v247
    s_add_u32 m0, m0, s43
    s_add_u32 s48, s48, s50
    ds_write_b128 v252, v[36:39] offset:2048
    buffer_load_dwordx4 v2, s[28:31], s48 offen nt lds
    v_mfma_f32_4x4x4_16b_bf16 v[240:243], v[250:251], v[44:45], v[200:203]
    v_cvt_pk_bf16_f32 v40, v232, v233
    v_mfma_f32_4x4x4_16b_bf16 v[244:247], v[250:251], v[46:47], v[200:203]
    v_cvt_pk_bf16_f32 v41, v234, v235
    v_mfma_f32_4x4x4_16b_bf16 v[240:243], v[206:207], v[44:45], v[240:243]
    v_cvt_pk_bf16_f32 v42, v236, v237
    v_mfma_f32_4x4x4_16b_bf16 v[244:247], v[206:207], v[46:47], v[244:247]
    v_cvt_pk_bf16_f32 v43, v238, v239
    s_add_u32 m0, m0, s43
    s_add_u32 s48, s39, s74
    ds_write_b128 v252, v[40:43] offset:4096
    buffer_load_dwordx4 v2, s[28:31], s48 offen nt lds
    s_mul_i32 s39, s38, s40
    v_mfma_f32_4x4x4_16b_bf16 v[232:235], v[250:251], v[48:49], v[200:203]
    v_cvt_pk_bf16_f32 v44, v240, v241
    v_mfma_f32_4x4x4_16b_bf16 v[236:239], v[250:251], v[50:51], v[200:203]
    v_cvt_pk_bf16_f32 v45, v242, v243
    v_mfma_f32_4x4x4_16b_bf16 v[232:235], v[206:207], v[48:49], v[232:235]
    v_cvt_pk_bf16_f32 v46, v244, v245
    v_mfma_f32_4x4x4_16b_bf16 v[236:239], v[206:207], v[50:51], v[236:239]
    v_cvt_pk_bf16_f32 v47, v246, v247
    s_add_u32 m0, m0, s43
    s_add_u32 s48, s48, s50
    ds_write_b128 v252, v[44:47] offset:6144
    buffer_load_dwordx4 v2, s[28:31], s48 offen nt lds
    v_mfma_f32_4x4x4_16b_bf16 v[240:243], v[250:251], v[52:53], v[200:203]
    v_cvt_pk_bf16_f32 v48, v232, v233
    v_mfma_f32_4x4x4_16b_bf16 v[244:247], v[250:251], v[54:55], v[200:203]
    v_cvt_pk_bf16_f32 v49, v234, v235
    v_mfma_f32_4x4x4_16b_bf16 v[240:243], v[206:207], v[52:53], v[240:243]
    v_cvt_pk_bf16_f32 v50, v236, v237
    v_mfma_f32_4x4x4_16b_bf16 v[244:247], v[206:207], v[54:55], v[244:247]
    v_cvt_pk_bf16_f32 v51, v238, v239
    s_add_u32 m0, m0, s43
    s_add_u32 s48, s39, s74
    ds_write_b128 v252, v[48:51] offset:8192
    buffer_load_dwordx4 v2, s[28:31], s48 offen nt lds
    s_mul_i32 s39, s32, s40
    v_mfma_f32_4x4x4_16b_bf16 v[232:235], v[250:251], v[56:57], v[200:203]
    v_cvt_pk_bf16_f32 v52, v240, v241
    v_mfma_f32_4x4x4_16b_bf16 v[236:239], v[250:251], v[58:59], v[200:203]
    v_cvt_pk_bf16_f32 v53, v242, v243
    v_mfma_f32_4x4x4_16b_bf16 v[232:235], v[206:207], v[56:57], v[232:235]
    v_cvt_pk_bf16_f32 v54, v244, v245
    v_mfma_f32_4x4x4_16b_bf16 v[236:239], v[206:207], v[58:59], v[236:239]
    v_cvt_pk_bf16_f32 v55, v246, v247
    s_add_u32 m0, m0, s43
    s_add_u32 s48, s48, s50
    ds_write_b128 v252, v[52:55] offset:10240
    buffer_load_dwordx4 v2, s[28:31], s48 offen nt lds
    v_mfma_f32_4x4x4_16b_bf16 v[240:243], v[250:251], v[60:61], v[200:203]
    v_cvt_pk_bf16_f32 v56, v232, v233
    v_mfma_f32_4x4x4_16b_bf16 v[244:247], v[250:251], v[62:63], v[200:203]
    v_cvt_pk_bf16_f32 v57, v234, v235
    v_mfma_f32_4x4x4_16b_bf16 v[240:243], v[206:207], v[60:61], v[240:243]
    v_cvt_pk_bf16_f32 v58, v236, v237
    v_mfma_f32_4x4x4_16b_bf16 v[244:247], v[206:207], v[62:63], v[244:247]
    v_cvt_pk_bf16_f32 v59, v238, v239
    s_add_u32 m0, m0, s43
    s_add_u32 s48, s39, s74
    ds_write_b128 v252, v[56:59] offset:12288
    buffer_load_dwordx4 v2, s[28:31], s48 offen nt lds
    s_mul_i32 s39, s33, s40
    v_mfma_f32_4x4x4_16b_bf16 v[232:235], v[250:251], v[64:65], v[200:203]
    v_cvt_pk_bf16_f32 v60, v240, v241
    v_mfma_f32_4x4x4_16b_bf16 v[236:239], v[250:251], v[66:67], v[200:203]
    v_cvt_pk_bf16_f32 v61, v242, v243
    v_mfma_f32_4x4x4_16b_bf16 v[232:235], v[206:207], v[64:65], v[232:235]
    v_cvt_pk_bf16_f32 v62, v244, v245
    v_mfma_f32_4x4x4_16b_bf16 v[236:239], v[206:207], v[66:67], v[236:239]
    v_cvt_pk_bf16_f32 v63, v246, v247
    s_add_u32 m0, m0, s43
    s_add_u32 s48, s48, s50
    ds_write_b128 v252, v[60:63] offset:14336
    buffer_load_dwordx4 v2, s[28:31], s48 offen nt lds
    s_nop 1
    v_cvt_pk_bf16_f32 v64, v232, v233
    v_cvt_pk_bf16_f32 v65, v234, v235
    v_cvt_pk_bf16_f32 v66, v236, v237
    v_cvt_pk_bf16_f32 v67, v238, v239
    s_add_u32 m0, m0, s43
    s_add_u32 s48, s39, s74
    ds_write_b128 v252, v[64:67] offset:16384
    buffer_load_dwordx4 v2, s[28:31], s48 offen nt lds
    s_mul_i32 s39, s84, s40
    v_mov_b32 v248, 0
    v_mov_b32 v249, 0
    s_waitcnt vmcnt(16)
    v_dot2c_f32_bf16 v248, v68, v19
    v_dot2c_f32_bf16 v249, v68, v68
    v_dot2c_f32_bf16 v248, v69, v19
    v_dot2c_f32_bf16 v249, v69, v69
    v_dot2c_f32_bf16 v248, v70, v19
    v_dot2c_f32_bf16 v249, v70, v70
    v_dot2c_f32_bf16 v248, v71, v19
    v_dot2c_f32_bf16 v249, v71, v71
    v_dot2c_f32_bf16 v248, v72, v19
    v_dot2c_f32_bf16 v249, v72, v72
    v_dot2c_f32_bf16 v248, v73, v19
    v_dot2c_f32_bf16 v249, v73, v73
    v_dot2c_f32_bf16 v248, v74, v19
    v_dot2c_f32_bf16 v249, v74, v74
    v_dot2c_f32_bf16 v248, v75, v19
    v_dot2c_f32_bf16 v249, v75, v75
    v_dot2c_f32_bf16 v248, v76, v19
    v_dot2c_f32_bf16 v249, v76, v76
    v_dot2c_f32_bf16 v248, v77, v19
    v_dot2c_f32_bf16 v249, v77, v77
    v_dot2c_f32_bf16 v248, v78, v19
    v_dot2c_f32_bf16 v249, v78, v78
    v_dot2c_f32_bf16 v248, v79, v19
    v_dot2c_f32_bf16 v249, v79, v79
    s_add_u32 m0, m0, s43
    s_add_u32 s48, s48, s50
    buffer_load_dwordx4 v2, s[28:31], s48 offen nt lds
    s_waitcnt vmcnt(14)
    v_dot2c_f32_bf16 v248, v80, v19
    v_dot2c_f32_bf16 v249, v80, v80
    v_dot2c_f32_bf16 v248, v81, v19
    v_dot2c_f32_bf16 v249, v81, v81
    v_dot2c_f32_bf16 v248, v82, v19
    v_dot2c_f32_bf16 v249, v82, v82
    v_dot2c_f32_bf16 v248, v83, v19
    v_dot2c_f32_bf16 v249, v83, v83
    v_dot2c_f32_bf16 v248, v84, v19
    v_dot2c_f32_bf16 v249, v84, v84
    v_dot2c_f32_bf16 v248, v85, v19
    v_dot2c_f32_bf16 v249, v85, v85
    v_dot2c_f32_bf16 v248, v86, v19
    v_dot2c_f32_bf16 v249, v86, v86
    v_dot2c_f32_bf16 v248, v87, v19
    v_dot2c_f32_bf16 v249, v87, v87
    v_dot2c_f32_bf16 v248, v88, v19
    v_dot2c_f32_bf16 v249, v88, v88
    v_dot2c_f32_bf16 v248, v89, v19
    v_dot2c_f32_bf16 v249, v89, v89
    v_dot2c_f32_bf16 v248, v90, v19
    v_dot2c_f32_bf16 v249, v90, v90
    v_dot2c_f32_bf16 v248, v91, v19
    v_dot2c_f32_bf16 v249, v91, v91
    s_add_u32 m0, m0, s43
    s_add_u32 s48, s39, s74
    buffer_load_dwordx4 v2, s[28:31], s48 offen nt lds
    s_mul_i32 s39, s85, s40
    s_waitcnt vmcnt(12)
    v_dot2c_f32_bf16 v248, v92, v19
    v_dot2c_f32_bf16 v249, v92, v92
    v_dot2c_f32_bf16 v248, v93, v19
    v_dot2c_f32_bf16 v249, v93, v93
    v_dot2c_f32_bf16 v248, v94, v19
    v_dot2c_f32_bf16 v249, v94, v94
    v_dot2c_f32_bf16 v248, v95, v19
    v_dot2c_f32_bf16 v249, v95, v95
    v_dot2c_f32_bf16 v248, v96, v19
    v_dot2c_f32_bf16 v249, v96, v96
    v_dot2c_f32_bf16 v248, v97, v19
    v_dot2c_f32_bf16 v249, v97, v97
    v_dot2c_f32_bf16 v248, v98, v19
    v_dot2c_f32_bf16 v249, v98, v98
    v_dot2c_f32_bf16 v248, v99, v19
    v_dot2c_f32_bf16 v249, v99, v99
    v_dot2c_f32_bf16 v248, v100, v19
    v_dot2c_f32_bf16 v249, v100, v100
    v_dot2c_f32_bf16 v248, v101, v19
    v_dot2c_f32_bf16 v249, v101, v101
    v_dot2c_f32_bf16 v248, v102, v19
    v_dot2c_f32_bf16 v249, v102, v102
    v_dot2c_f32_bf16 v248, v103, v19
    v_dot2c_f32_bf16 v249, v103, v103
    s_add_u32 m0, m0, s43
    s_add_u32 s48, s48, s50
    buffer_load_dwordx4 v2, s[28:31], s48 offen nt lds
    s_nop 2
    v_add_f32_dpp v248, v248, v248 quad_perm:[1,0,3,2] row_mask:0xf bank_mask:0xf
    v_add_f32_dpp v249, v249, v249 quad_perm:[1,0,3,2] row_mask:0xf bank_mask:0xf
    s_nop 0
    v_add_f32_dpp v248, v248, v248 quad_perm:[2,3,0,1] row_mask:0xf bank_mask:0xf
    v_add_f32_dpp v249, v249, v249 quad_perm:[2,3,0,1] row_mask:0xf bank_mask:0xf
    s_nop 0
    v_add_f32_dpp v248, v248, v248 row_half_mirror row_mask:0xf bank_mask:0xf
    v_add_f32_dpp v249, v249, v249 row_half_mirror row_mask:0xf bank_mask:0xf
    s_nop 0
    v_mul_f32 v248, s72, v248
    v_mul_f32 v249, s72, v249
    v_fma_f32 v249, -v248, v248, v249
    v_max_f32 v249, 0, v249
    v_cvt_pk_bf16_f32 v249, 0, v249
    v_add_f32 v249, 0x3727c5ac, v249
    v_cvt_pk_bf16_f32 v249, 0, v249
    v_sqrt_f32 v249, v249
    v_cvt_pk_bf16_f32 v248, 0, -v248
    v_cvt_pk_bf16_f32 v249, 0, v249
    v_rcp_f32 v249, v249
    s_nop 0
    v_mul_f32 v249, 1055913304, v249
    v_and_b32 v251, s73, v249
    v_sub_f32 v249, v249, v251
    v_cvt_pk_bf16_f32 v207, 0, v249
    v_add_f32 v249, v251, v207
    v_mul_f32 v200, v248, v249
    v_lshrrev_b32 v251, v204, v251
    v_mov_b32 v201, v200
    v_and_b32 v250, v205, v251
    v_mov_b32 v202, v200
    v_xor_b32 v251, v250, v251
    v_mov_b32 v203, v200
    v_lshrrev_b32 v207, v204, v207
    v_and_b32 v206, v205, v207
    v_xor_b32 v207, v206, v207
    v_mfma_f32_4x4x4_16b_bf16 v[232:235], v[250:251], v[68:69], v[200:203]
    v_mfma_f32_4x4x4_16b_bf16 v[236:239], v[250:251], v[70:71], v[200:203]
    s_nop 0
    v_mfma_f32_4x4x4_16b_bf16 v[232:235], v[206:207], v[68:69], v[232:235]
    v_mfma_f32_4x4x4_16b_bf16 v[236:239], v[206:207], v[70:71], v[236:239]
    s_nop 2
    v_mfma_f32_4x4x4_16b_bf16 v[240:243], v[250:251], v[72:73], v[200:203]
    v_cvt_pk_bf16_f32 v68, v232, v233
    v_mfma_f32_4x4x4_16b_bf16 v[244:247], v[250:251], v[74:75], v[200:203]
    v_cvt_pk_bf16_f32 v69, v234, v235
    v_mfma_f32_4x4x4_16b_bf16 v[240:243], v[206:207], v[72:73], v[240:243]
    v_cvt_pk_bf16_f32 v70, v236, v237
    v_mfma_f32_4x4x4_16b_bf16 v[244:247], v[206:207], v[74:75], v[244:247]
    v_cvt_pk_bf16_f32 v71, v238, v239
    s_add_u32 m0, m0, s43
    s_add_u32 s48, s39, s74
    ds_write_b128 v255, v[68:71] offset:0
    buffer_load_dwordx4 v2, s[28:31], s48 offen nt lds
    s_mul_i32 s39, s97, s40
    v_mfma_f32_4x4x4_16b_bf16 v[232:235], v[250:251], v[76:77], v[200:203]
    v_cvt_pk_bf16_f32 v72, v240, v241
    v_mfma_f32_4x4x4_16b_bf16 v[236:239], v[250:251], v[78:79], v[200:203]
    v_cvt_pk_bf16_f32 v73, v242, v243
    v_mfma_f32_4x4x4_16b_bf16 v[232:235], v[206:207], v[76:77], v[232:235]
    v_cvt_pk_bf16_f32 v74, v244, v245
    v_mfma_f32_4x4x4_16b_bf16 v[236:239], v[206:207], v[78:79], v[236:239]
    v_cvt_pk_bf16_f32 v75, v246, v247
    s_add_u32 m0, m0, s43
    s_add_u32 s48, s48, s50
    ds_write_b128 v255, v[72:75] offset:2048
    buffer_load_dwordx4 v2, s[28:31], s48 offen nt lds
    v_mfma_f32_4x4x4_16b_bf16 v[240:243], v[250:251], v[80:81], v[200:203]
    v_cvt_pk_bf16_f32 v76, v232, v233
    v_mfma_f32_4x4x4_16b_bf16 v[244:247], v[250:251], v[82:83], v[200:203]
    v_cvt_pk_bf16_f32 v77, v234, v235
    v_mfma_f32_4x4x4_16b_bf16 v[240:243], v[206:207], v[80:81], v[240:243]
    v_cvt_pk_bf16_f32 v78, v236, v237
    v_mfma_f32_4x4x4_16b_bf16 v[244:247], v[206:207], v[82:83], v[244:247]
    v_cvt_pk_bf16_f32 v79, v238, v239
    s_add_u32 m0, m0, s43
    s_add_u32 s48, s39, s74
    ds_write_b128 v255, v[76:79] offset:4096
    buffer_load_dwordx4 v2, s[28:31], s48 offen nt lds
    s_mul_i32 s39, s99, s40
    v_mfma_f32_4x4x4_16b_bf16 v[232:235], v[250:251], v[84:85], v[200:203]
    v_cvt_pk_bf16_f32 v80, v240, v241
    v_mfma_f32_4x4x4_16b_bf16 v[236:239], v[250:251], v[86:87], v[200:203]
    v_cvt_pk_bf16_f32 v81, v242, v243
    v_mfma_f32_4x4x4_16b_bf16 v[232:235], v[206:207], v[84:85], v[232:235]
    v_cvt_pk_bf16_f32 v82, v244, v245
    v_mfma_f32_4x4x4_16b_bf16 v[236:239], v[206:207], v[86:87], v[236:239]
    v_cvt_pk_bf16_f32 v83, v246, v247
    ds_write_b128 v255, v[80:83] offset:6144
    v_mfma_f32_4x4x4_16b_bf16 v[240:243], v[250:251], v[88:89], v[200:203]
    v_cvt_pk_bf16_f32 v84, v232, v233
    v_mfma_f32_4x4x4_16b_bf16 v[244:247], v[250:251], v[90:91], v[200:203]
    v_cvt_pk_bf16_f32 v85, v234, v235
    v_mfma_f32_4x4x4_16b_bf16 v[240:243], v[206:207], v[88:89], v[240:243]
    v_cvt_pk_bf16_f32 v86, v236, v237
    v_mfma_f32_4x4x4_16b_bf16 v[244:247], v[206:207], v[90:91], v[244:247]
    v_cvt_pk_bf16_f32 v87, v238, v239
    ds_write_b128 v255, v[84:87] offset:8192
    v_mfma_f32_4x4x4_16b_bf16 v[232:235], v[250:251], v[92:93], v[200:203]
    v_cvt_pk_bf16_f32 v88, v240, v241
    v_mfma_f32_4x4x4_16b_bf16 v[236:239], v[250:251], v[94:95], v[200:203]
    v_cvt_pk_bf16_f32 v89, v242, v243
    v_mfma_f32_4x4x4_16b_bf16 v[232:235], v[206:207], v[92:93], v[232:235]
    v_cvt_pk_bf16_f32 v90, v244, v245
    v_mfma_f32_4x4x4_16b_bf16 v[236:239], v[206:207], v[94:95], v[236:239]
    v_cvt_pk_bf16_f32 v91, v246, v247
    ds_write_b128 v255, v[88:91] offset:10240
    v_mfma_f32_4x4x4_16b_bf16 v[240:243], v[250:251], v[96:97], v[200:203]
    v_cvt_pk_bf16_f32 v92, v232, v233
    v_mfma_f32_4x4x4_16b_bf16 v[244:247], v[250:251], v[98:99], v[200:203]
    v_cvt_pk_bf16_f32 v93, v234, v235
    v_mfma_f32_4x4x4_16b_bf16 v[240:243], v[206:207], v[96:97], v[240:243]
    v_cvt_pk_bf16_f32 v94, v236, v237
    v_mfma_f32_4x4x4_16b_bf16 v[244:247], v[206:207], v[98:99], v[244:247]
    v_cvt_pk_bf16_f32 v95, v238, v239
    ds_write_b128 v255, v[92:95] offset:12288
    v_mfma_f32_4x4x4_16b_bf16 v[232:235], v[250:251], v[100:101], v[200:203]
    v_cvt_pk_bf16_f32 v96, v240, v241
    v_mfma_f32_4x4x4_16b_bf16 v[236:239], v[250:251], v[102:103], v[200:203]
    v_cvt_pk_bf16_f32 v97, v242, v243
    v_mfma_f32_4x4x4_16b_bf16 v[232:235], v[206:207], v[100:101], v[232:235]
    v_cvt_pk_bf16_f32 v98, v244, v245
    v_mfma_f32_4x4x4_16b_bf16 v[236:239], v[206:207], v[102:103], v[236:239]
    v_cvt_pk_bf16_f32 v99, v246, v247
    ds_write_b128 v255, v[96:99] offset:14336
    s_nop 1
    v_cvt_pk_bf16_f32 v100, v232, v233
    v_cvt_pk_bf16_f32 v101, v234, v235
    v_cvt_pk_bf16_f32 v102, v236, v237
    v_cvt_pk_bf16_f32 v103, v238, v239
    ds_write_b128 v255, v[100:103] offset:16384
    s_waitcnt vmcnt(11) lgkmcnt(0)
    s_barrier
    s_cmp_eq_u32 s2, 0
    s_cbranch_scc1 L_k_c
L_k_noc:
    ds_read_b64_tr_b16 a[216:217], v7 offset:0
    ds_read_b64_tr_b16 a[218:219], v7 offset:256
    ds_read_b128 v[32:35], v253 offset:0
    ds_read_b128 a[72:75], v228 offset:0
    ds_read_b64_tr_b16 a[220:221], v7 offset:4224
    ds_read_b64_tr_b16 a[222:223], v7 offset:4480
    ds_read_b128 v[36:39], v254 offset:1024
    ds_read_b128 a[76:79], v229 offset:1024
    ds_read_b64_tr_b16 a[224:225], v7 offset:2112
    ds_read_b64_tr_b16 a[226:227], v7 offset:2368
    ds_read_b64_tr_b16 a[228:229], v7 offset:6336
    ds_read_b64_tr_b16 a[230:231], v7 offset:6592
    s_waitcnt lgkmcnt(4)
    v_mfma_f32_16x16x32_bf16 v[104:107], a[216:219], a[144:147], 0
    s_add_u32 m0, m0, s43
    ds_read_b64_tr_b16 a[232:233], v7 offset:8448
    v_mov_b32 v216, -1
    v_mfma_f32_16x16x32_bf16 v[104:107], a[220:223], a[148:151], v[104:107]
    s_add_u32 s48, s48, s50
    ds_read_b64_tr_b16 a[234:235], v7 offset:8704
    v_mov_b32 v217, -1
    v_mfma_f32_16x16x32_bf16 v[108:111], a[220:223], v[36:39], 0
    ds_read_b128 v[40:43], v253 offset:2048
    v_mov_b32 v218, -1
    v_mfma_f32_16x16x32_bf16 v[108:111], a[216:219], v[32:35], v[108:111]
    ds_read_b128 a[80:83], v228 offset:2048
    v_mov_b32 v219, -1
    v_mfma_f32_16x16x32_bf16 v[112:115], a[216:219], a[0:3], 0
    s_mul_i32 s70, s2, 9
    ds_read_b64_tr_b16 a[236:237], v7 offset:12672
    v_mfma_f32_16x16x32_bf16 v[112:115], a[220:223], a[4:7], v[112:115]
    s_add_u32 s70, s70, s44
    ds_read_b64_tr_b16 a[238:239], v7 offset:12928
    v_mfma_f32_16x16x32_bf16 v[116:119], a[220:223], a[76:79], 0
    s_lshl_b32 s70, s70, 10
    ds_read_b128 v[44:47], v254 offset:3072
    v_mfma_f32_16x16x32_bf16 v[116:119], a[216:219], a[72:75], v[116:119]
    s_waitcnt lgkmcnt(7)
    buffer_load_dwordx4 v2, s[28:31], s48 offen nt lds
    v_mfma_f32_16x16x32_bf16 v[148:151], a[224:227], a[72:75], 0
    s_add_u32 m0, m0, s43
    ds_read_b64_tr_b16 a[216:217], v7 offset:10560
    v_mfma_f32_16x16x32_bf16 v[148:151], a[228:231], a[76:79], v[148:151]
    s_add_u32 s48, s39, s74
    ds_read_b64_tr_b16 a[218:219], v7 offset:10816
    v_mfma_f32_16x16x32_bf16 v[144:147], a[228:231], a[4:7], 0
    s_add_u32 s70, s70, 8388608
    ds_read_b128 a[84:87], v229 offset:3072
    v_mfma_f32_16x16x32_bf16 v[144:147], a[224:227], a[0:3], v[144:147]
    s_mul_i32 s39, s36, s40
    ds_read_b64_tr_b16 a[244:245], v23 offset:0
    v_mfma_f32_16x16x32_bf16 v[140:143], a[224:227], v[32:35], 0
    s_add_u32 s71, s70, 4096
    ds_read_b64_tr_b16 a[220:221], v7 offset:14784
    v_mfma_f32_16x16x32_bf16 v[140:143], a[228:231], v[36:39], v[140:143]
    s_waitcnt vmcnt(8)
    ds_read_b64_tr_b16 a[222:223], v7 offset:15040
    v_mfma_f32_16x16x32_bf16 v[136:139], a[228:231], a[148:151], 0
    s_barrier
    ds_read_b64_tr_b16 a[246:247], v23 offset:512
    v_mfma_f32_16x16x32_bf16 v[136:139], a[224:227], a[144:147], v[136:139]
    s_waitcnt lgkmcnt(4)
    buffer_load_dwordx4 v2, s[28:31], s48 offen nt lds
    v_mfma_f32_16x16x32_bf16 v[104:107], a[232:235], a[152:155], v[104:107]
    s_add_u32 m0, m0, s43
    ds_read_b64_tr_b16 a[224:225], v7 offset:16896
    v_mfma_f32_16x16x32_bf16 v[104:107], a[236:239], a[156:159], v[104:107]
    s_add_u32 s48, s48, s50
    ds_read_b64_tr_b16 a[226:227], v7 offset:17152
    v_mfma_f32_16x16x32_bf16 v[108:111], a[236:239], v[44:47], v[108:111]
    s_add_u32 s69, s70, 8192
    ds_read_b128 v[48:51], v253 offset:4096
    v_mfma_f32_16x16x32_bf16 v[108:111], a[232:235], v[40:43], v[108:111]
    s_cmp_eq_u32 s44, 0
    s_cselect_b32 s69, s69, 536870912
    ds_read_b128 a[88:91], v228 offset:4096
    v_mfma_f32_16x16x32_bf16 v[112:115], a[232:235], a[8:11], v[112:115]
    ds_read_b64_tr_b16 a[228:229], v7 offset:21120
    v_mfma_f32_16x16x32_bf16 v[112:115], a[236:239], a[12:15], v[112:115]
    ds_read_b64_tr_b16 a[230:231], v7 offset:21376
    v_mfma_f32_16x16x32_bf16 v[116:119], a[236:239], a[84:87], v[116:119]
    ds_read_b128 v[52:55], v254 offset:5120
    v_mfma_f32_16x16x32_bf16 v[116:119], a[232:235], a[80:83], v[116:119]
    s_waitcnt lgkmcnt(8)
    buffer_load_dwordx4 v2, s[28:31], s48 offen nt lds
    v_mfma_f32_16x16x32_bf16 v[148:151], a[216:219], a[80:83], v[148:151]
    s_mov_b32 m0, s47
    ds_read_b64_tr_b16 a[232:233], v7 offset:19008
    v_mfma_f32_16x16x32_bf16 v[148:151], a[220:223], a[84:87], v[148:151]
    s_add_u32 s48, s39, s41
    ds_read_b64_tr_b16 a[234:235], v7 offset:19264
    v_mfma_f32_16x16x32_bf16 v[144:147], a[220:223], a[12:15], v[144:147]
    ds_read_b128 a[92:95], v229 offset:5120
    v_mfma_f32_16x16x32_bf16 v[144:147], a[216:219], a[8:11], v[144:147]
    buffer_store_dword v19, v231, s[12:15], s63 offen sc1
    v_mfma_f32_16x16x32_bf16 v[140:143], a[216:219], v[40:43], v[140:143]
    ds_read_b64_tr_b16 a[236:237], v7 offset:23232
    v_mfma_f32_16x16x32_bf16 v[140:143], a[220:223], v[44:47], v[140:143]
    ds_read_b64_tr_b16 a[238:239], v7 offset:23488
    v_mfma_f32_16x16x32_bf16 v[136:139], a[220:223], a[156:159], v[136:139]
    v_mfma_f32_16x16x32_bf16 v[136:139], a[216:219], a[152:155], v[136:139]
    s_waitcnt lgkmcnt(2)
    buffer_load_dwordx4 v6, s[16:19], s48 offen nt lds
    v_mfma_f32_16x16x32_bf16 v[104:107], a[224:227], a[160:163], v[104:107]
    s_add_u32 m0, m0, s43
    ds_read_b64_tr_b16 a[216:217], v7 offset:25344
    v_mfma_f32_16x16x32_bf16 v[104:107], a[228:231], a[164:167], v[104:107]
    s_add_u32 s48, s48, s50
    ds_read_b64_tr_b16 a[218:219], v7 offset:25600
    v_mfma_f32_16x16x32_bf16 v[108:111], a[228:231], v[52:55], v[108:111]
    ds_read_b128 v[56:59], v253 offset:6144
    v_mfma_f32_16x16x32_bf16 v[108:111], a[224:227], v[48:51], v[108:111]
    ds_read_b128 a[96:99], v228 offset:6144
    v_mfma_f32_16x16x32_bf16 v[112:115], a[224:227], a[16:19], v[112:115]
    ds_read_b64_tr_b16 a[220:221], v7 offset:29568
    v_mfma_f32_16x16x32_bf16 v[112:115], a[228:231], a[20:23], v[112:115]
    ds_read_b64_tr_b16 a[222:223], v7 offset:29824
    v_mfma_f32_16x16x32_bf16 v[116:119], a[228:231], a[92:95], v[116:119]
    ds_read_b128 v[60:63], v254 offset:7168
    v_mfma_f32_16x16x32_bf16 v[116:119], a[224:227], a[88:91], v[116:119]
    s_waitcnt lgkmcnt(7)
    buffer_load_dwordx4 v6, s[16:19], s48 offen nt lds
    v_mfma_f32_16x16x32_bf16 v[148:151], a[232:235], a[88:91], v[148:151]
    s_add_u32 m0, m0, s43
    ds_read_b64_tr_b16 a[224:225], v7 offset:27456
    v_mfma_f32_16x16x32_bf16 v[148:151], a[236:239], a[92:95], v[148:151]
    s_add_u32 s49, s39, s42
    ds_read_b64_tr_b16 a[226:227], v7 offset:27712
    v_mfma_f32_16x16x32_bf16 v[144:147], a[236:239], a[20:23], v[144:147]
    ds_read_b128 a[100:103], v229 offset:7168
    v_mfma_f32_16x16x32_bf16 v[144:147], a[232:235], a[16:19], v[144:147]
    s_mul_i32 s39, s37, s40
    v_mfma_f32_16x16x32_bf16 v[140:143], a[232:235], v[48:51], v[140:143]
    ds_read_b64_tr_b16 a[228:229], v7 offset:31680
    v_mfma_f32_16x16x32_bf16 v[140:143], a[236:239], v[52:55], v[140:143]
    s_waitcnt vmcnt(9)
    ds_read_b64_tr_b16 a[230:231], v7 offset:31936
    v_mfma_f32_16x16x32_bf16 v[136:139], a[236:239], a[164:167], v[136:139]
    s_barrier
    v_mfma_f32_16x16x32_bf16 v[136:139], a[232:235], a[160:163], v[136:139]
    s_waitcnt lgkmcnt(2)
    buffer_load_dwordx4 v6, s[20:23], s49 offen nt lds
    v_mfma_f32_16x16x32_bf16 v[104:107], a[216:219], a[168:171], v[104:107]
    s_add_u32 m0, m0, s43
    ds_read_b64_tr_b16 a[232:233], v7 offset:33792
    v_mfma_f32_16x16x32_bf16 v[104:107], a[220:223], a[172:175], v[104:107]
    s_add_u32 s49, s49, s50
    ds_read_b64_tr_b16 a[234:235], v7 offset:34048
    v_mfma_f32_16x16x32_bf16 v[108:111], a[220:223], v[60:63], v[108:111]
    ds_read_b128 v[64:67], v253 offset:8192
    v_mfma_f32_16x16x32_bf16 v[108:111], a[216:219], v[56:59], v[108:111]
    ds_read_b128 a[104:107], v228 offset:8192
    v_mfma_f32_16x16x32_bf16 v[112:115], a[216:219], a[24:27], v[112:115]
    ds_read_b64_tr_b16 a[236:237], v8 offset:0
    v_mfma_f32_16x16x32_bf16 v[112:115], a[220:223], a[28:31], v[112:115]
    ds_read_b64_tr_b16 a[238:239], v8 offset:256
    v_mfma_f32_16x16x32_bf16 v[116:119], a[220:223], a[100:103], v[116:119]
    ds_read_b128 v[68:71], v254 offset:9216
    v_mfma_f32_16x16x32_bf16 v[116:119], a[216:219], a[96:99], v[116:119]
    s_waitcnt lgkmcnt(7)
    buffer_load_dwordx4 v6, s[20:23], s49 offen nt lds
    v_mfma_f32_16x16x32_bf16 v[148:151], a[224:227], a[96:99], v[148:151]
    s_add_u32 m0, m0, s43
    ds_read_b64_tr_b16 a[216:217], v7 offset:35904
    v_mfma_f32_16x16x32_bf16 v[148:151], a[228:231], a[100:103], v[148:151]
    s_add_u32 s48, s39, s41
    ds_read_b64_tr_b16 a[218:219], v7 offset:36160
    v_mfma_f32_16x16x32_bf16 v[144:147], a[228:231], a[28:31], v[144:147]
    ds_read_b128 a[108:111], v229 offset:9216
    v_mfma_f32_16x16x32_bf16 v[144:147], a[224:227], a[24:27], v[144:147]
    v_mfma_f32_16x16x32_bf16 v[140:143], a[224:227], v[56:59], v[140:143]
    ds_read_b64_tr_b16 a[220:221], v8 offset:2112
    v_mfma_f32_16x16x32_bf16 v[140:143], a[228:231], v[60:63], v[140:143]
    ds_read_b64_tr_b16 a[222:223], v8 offset:2368
    v_mfma_f32_16x16x32_bf16 v[136:139], a[228:231], a[172:175], v[136:139]
    v_mfma_f32_16x16x32_bf16 v[136:139], a[224:227], a[168:171], v[136:139]
    s_waitcnt lgkmcnt(2)
    buffer_load_dwordx4 v6, s[16:19], s48 offen nt lds
    v_mfma_f32_16x16x32_bf16 v[104:107], a[232:235], a[176:179], v[104:107]
    s_add_u32 m0, m0, s43
    ds_read_b64_tr_b16 a[224:225], v8 offset:4224
    v_mfma_f32_16x16x32_bf16 v[104:107], a[236:239], a[180:183], v[104:107]
    s_add_u32 s48, s48, s50
    ds_read_b64_tr_b16 a[226:227], v8 offset:4480
    v_mfma_f32_16x16x32_bf16 v[108:111], a[236:239], v[68:71], v[108:111]
    s_and_b32 s28, s2, 7
    ds_read_b128 v[72:75], v253 offset:10240
    v_mfma_f32_16x16x32_bf16 v[108:111], a[232:235], v[64:67], v[108:111]
    ds_read_b128 a[112:115], v228 offset:10240
    v_mfma_f32_16x16x32_bf16 v[112:115], a[232:235], a[32:35], v[112:115]
    ds_read_b64_tr_b16 a[228:229], v8 offset:8448
    v_mfma_f32_16x16x32_bf16 v[112:115], a[236:239], a[36:39], v[112:115]
    ds_read_b64_tr_b16 a[230:231], v8 offset:8704
    v_mfma_f32_16x16x32_bf16 v[116:119], a[236:239], a[108:111], v[116:119]
    ds_read_b128 v[76:79], v254 offset:11264
    v_mfma_f32_16x16x32_bf16 v[116:119], a[232:235], a[104:107], v[116:119]
    s_waitcnt lgkmcnt(7)
    buffer_load_dwordx4 v6, s[16:19], s48 offen nt lds
    v_mfma_f32_16x16x32_bf16 v[148:151], a[216:219], a[104:107], v[148:151]
    s_add_u32 m0, m0, s43
    ds_read_b64_tr_b16 a[232:233], v8 offset:6336
    v_mfma_f32_16x16x32_bf16 v[148:151], a[220:223], a[108:111], v[148:151]
    s_add_u32 s49, s39, s42
    ds_read_b64_tr_b16 a[234:235], v8 offset:6592
    v_mfma_f32_16x16x32_bf16 v[144:147], a[220:223], a[36:39], v[144:147]
    ds_read_b128 a[116:119], v229 offset:11264
    v_mfma_f32_16x16x32_bf16 v[144:147], a[216:219], a[32:35], v[144:147]
    s_mul_i32 s39, s38, s40
    buffer_store_dwordx4 a[244:247], v1, s[12:15], s87 offen sc1
    v_mfma_f32_16x16x32_bf16 v[140:143], a[216:219], v[64:67], v[140:143]
    ds_read_b64_tr_b16 a[236:237], v8 offset:10560
    v_mfma_f32_16x16x32_bf16 v[140:143], a[220:223], v[68:71], v[140:143]
    s_waitcnt vmcnt(10)
    ds_read_b64_tr_b16 a[238:239], v8 offset:10816
    v_mfma_f32_16x16x32_bf16 v[136:139], a[220:223], a[180:183], v[136:139]
    s_barrier
    v_mfma_f32_16x16x32_bf16 v[136:139], a[216:219], a[176:179], v[136:139]
    s_waitcnt lgkmcnt(2)
    buffer_load_dwordx4 v6, s[20:23], s49 offen nt lds
    v_mfma_f32_16x16x32_bf16 v[104:107], a[224:227], a[184:187], v[104:107]
    s_add_u32 m0, m0, s43
    ds_read_b64_tr_b16 a[216:217], v8 offset:12672
    v_mfma_f32_16x16x32_bf16 v[104:107], a[228:231], a[188:191], v[104:107]
    s_add_u32 s49, s49, s50
    ds_read_b64_tr_b16 a[218:219], v8 offset:12928
    v_mfma_f32_16x16x32_bf16 v[108:111], a[228:231], v[76:79], v[108:111]
    ds_read_b128 v[80:83], v253 offset:12288
    v_mfma_f32_16x16x32_bf16 v[108:111], a[224:227], v[72:75], v[108:111]
    ds_read_b128 a[120:123], v228 offset:12288
    v_mfma_f32_16x16x32_bf16 v[112:115], a[224:227], a[40:43], v[112:115]
    ds_read_b64_tr_b16 a[220:221], v8 offset:16896
    v_mfma_f32_16x16x32_bf16 v[112:115], a[228:231], a[44:47], v[112:115]
    ds_read_b64_tr_b16 a[222:223], v8 offset:17152
    v_mfma_f32_16x16x32_bf16 v[116:119], a[228:231], a[116:119], v[116:119]
    ds_read_b128 v[84:87], v254 offset:13312
    v_mfma_f32_16x16x32_bf16 v[116:119], a[224:227], a[112:115], v[116:119]
    s_waitcnt lgkmcnt(7)
    buffer_load_dwordx4 v6, s[20:23], s49 offen nt lds
    v_mfma_f32_16x16x32_bf16 v[148:151], a[232:235], a[112:115], v[148:151]
    s_add_u32 m0, m0, s43
    ds_read_b64_tr_b16 a[224:225], v8 offset:14784
    v_mfma_f32_16x16x32_bf16 v[148:151], a[236:239], a[116:119], v[148:151]
    s_add_u32 s48, s39, s41
    ds_read_b64_tr_b16 a[226:227], v8 offset:15040
    v_mfma_f32_16x16x32_bf16 v[144:147], a[236:239], a[44:47], v[144:147]
    ds_read_b128 a[124:127], v229 offset:13312
    v_mfma_f32_16x16x32_bf16 v[144:147], a[232:235], a[40:43], v[144:147]
    buffer_store_dwordx4 v[216:219], v1, s[12:15], s70 offen sc1
    v_mfma_f32_16x16x32_bf16 v[140:143], a[232:235], v[72:75], v[140:143]
    ds_read_b64_tr_b16 a[228:229], v8 offset:19008
    v_mfma_f32_16x16x32_bf16 v[140:143], a[236:239], v[76:79], v[140:143]
    ds_read_b64_tr_b16 a[230:231], v8 offset:19264
    v_mfma_f32_16x16x32_bf16 v[136:139], a[236:239], a[188:191], v[136:139]
    v_mfma_f32_16x16x32_bf16 v[136:139], a[232:235], a[184:187], v[136:139]
    s_waitcnt lgkmcnt(2)
    buffer_load_dwordx4 v6, s[16:19], s48 offen nt lds
    v_mfma_f32_16x16x32_bf16 v[104:107], a[216:219], a[192:195], v[104:107]
    s_add_u32 m0, m0, s43
    ds_read_b64_tr_b16 a[232:233], v8 offset:21120
    v_mfma_f32_16x16x32_bf16 v[104:107], a[220:223], a[196:199], v[104:107]
    s_add_u32 s48, s48, s50
    ds_read_b64_tr_b16 a[234:235], v8 offset:21376
    v_mfma_f32_16x16x32_bf16 v[108:111], a[220:223], v[84:87], v[108:111]
    ds_read_b128 v[88:91], v253 offset:14336
    v_mfma_f32_16x16x32_bf16 v[108:111], a[216:219], v[80:83], v[108:111]
    ds_read_b128 a[128:131], v228 offset:14336
    v_mfma_f32_16x16x32_bf16 v[112:115], a[216:219], a[48:51], v[112:115]
    ds_read_b64_tr_b16 a[236:237], v8 offset:25344
    v_mfma_f32_16x16x32_bf16 v[112:115], a[220:223], a[52:55], v[112:115]
    ds_read_b64_tr_b16 a[238:239], v8 offset:25600
    v_mfma_f32_16x16x32_bf16 v[116:119], a[220:223], a[124:127], v[116:119]
    ds_read_b128 v[92:95], v254 offset:15360
    v_mfma_f32_16x16x32_bf16 v[116:119], a[216:219], a[120:123], v[116:119]
    s_waitcnt lgkmcnt(7)
    buffer_load_dwordx4 v6, s[16:19], s48 offen nt lds
    v_mfma_f32_16x16x32_bf16 v[148:151], a[224:227], a[120:123], v[148:151]
    s_add_u32 m0, m0, s43
    ds_read_b64_tr_b16 a[216:217], v8 offset:23232
    v_mfma_f32_16x16x32_bf16 v[148:151], a[228:231], a[124:127], v[148:151]
    s_add_u32 s49, s39, s42
    ds_read_b64_tr_b16 a[218:219], v8 offset:23488
    v_mfma_f32_16x16x32_bf16 v[144:147], a[228:231], a[52:55], v[144:147]
    ds_read_b128 a[132:135], v229 offset:15360
    v_mfma_f32_16x16x32_bf16 v[144:147], a[224:227], a[48:51], v[144:147]
    s_mul_i32 s39, s32, s40
    buffer_store_dwordx4 v[216:219], v1, s[12:15], s71 offen sc1
    v_mfma_f32_16x16x32_bf16 v[140:143], a[224:227], v[80:83], v[140:143]
    ds_read_b64_tr_b16 a[220:221], v8 offset:27456
    v_mfma_f32_16x16x32_bf16 v[140:143], a[228:231], v[84:87], v[140:143]
    s_waitcnt vmcnt(11)
    ds_read_b64_tr_b16 a[222:223], v8 offset:27712
    v_mfma_f32_16x16x32_bf16 v[136:139], a[228:231], a[196:199], v[136:139]
    s_barrier
    v_mfma_f32_16x16x32_bf16 v[136:139], a[224:227], a[192:195], v[136:139]
    s_waitcnt lgkmcnt(2)
    buffer_load_dwordx4 v6, s[20:23], s49 offen nt lds
    v_mfma_f32_16x16x32_bf16 v[104:107], a[232:235], a[200:203], v[104:107]
    s_add_u32 m0, m0, s43
    ds_read_b64_tr_b16 a[224:225], v8 offset:29568
    v_mfma_f32_16x16x32_bf16 v[104:107], a[236:239], a[204:207], v[104:107]
    s_add_u32 s49, s49, s50
    ds_read_b64_tr_b16 a[226:227], v8 offset:29824
    v_mfma_f32_16x16x32_bf16 v[108:111], a[236:239], v[92:95], v[108:111]
    ds_read_b128 v[96:99], v253 offset:16384
    v_mfma_f32_16x16x32_bf16 v[108:111], a[232:235], v[88:91], v[108:111]
    ds_read_b128 a[136:139], v228 offset:16384
    v_mfma_f32_16x16x32_bf16 v[112:115], a[232:235], a[56:59], v[112:115]
    ds_read_b64_tr_b16 a[228:229], v8 offset:33792
    v_mfma_f32_16x16x32_bf16 v[112:115], a[236:239], a[60:63], v[112:115]
    ds_read_b64_tr_b16 a[230:231], v8 offset:34048
    v_mfma_f32_16x16x32_bf16 v[116:119], a[236:239], a[132:135], v[116:119]
    ds_read_b128 v[100:103], v254 offset:17408
    v_mfma_f32_16x16x32_bf16 v[116:119], a[232:235], a[128:131], v[116:119]
    s_waitcnt lgkmcnt(7)
    buffer_load_dwordx4 v6, s[20:23], s49 offen nt lds
    v_mfma_f32_16x16x32_bf16 v[148:151], a[216:219], a[128:131], v[148:151]
    s_add_u32 m0, m0, s43
    ds_read_b64_tr_b16 a[232:233], v8 offset:31680
    v_mfma_f32_16x16x32_bf16 v[148:151], a[220:223], a[132:135], v[148:151]
    s_add_u32 s48, s39, s41
    ds_read_b64_tr_b16 a[234:235], v8 offset:31936
    v_mfma_f32_16x16x32_bf16 v[144:147], a[220:223], a[60:63], v[144:147]
    ds_read_b128 a[140:143], v229 offset:17408
    v_mfma_f32_16x16x32_bf16 v[144:147], a[216:219], a[56:59], v[144:147]
    buffer_store_dwordx4 v[216:219], v1, s[12:15], s69 offen sc1
    v_mfma_f32_16x16x32_bf16 v[140:143], a[216:219], v[88:91], v[140:143]
    ds_read_b64_tr_b16 a[236:237], v8 offset:35904
    v_mfma_f32_16x16x32_bf16 v[140:143], a[220:223], v[92:95], v[140:143]
    ds_read_b64_tr_b16 a[238:239], v8 offset:36160
    v_mfma_f32_16x16x32_bf16 v[136:139], a[220:223], a[204:207], v[136:139]
    v_mfma_f32_16x16x32_bf16 v[136:139], a[216:219], a[200:203], v[136:139]
    s_waitcnt lgkmcnt(2)
    buffer_load_dwordx4 v6, s[16:19], s48 offen nt lds
    v_mfma_f32_16x16x32_bf16 v[104:107], a[224:227], a[208:211], v[104:107]
    s_add_u32 m0, m0, s43
    ds_read_b64_tr_b16 a[216:217], v9 offset:0
    v_mfma_f32_16x16x32_bf16 v[168:171], a[228:231], a[212:215], v[104:107]
    s_add_u32 s48, s48, s50
    ds_read_b64_tr_b16 a[218:219], v9 offset:512
    v_mfma_f32_16x16x32_bf16 v[108:111], a[228:231], v[100:103], v[108:111]
    v_mfma_f32_16x16x32_bf16 v[172:175], a[224:227], v[96:99], v[108:111]
    v_mfma_f32_16x16x32_bf16 v[112:115], a[224:227], a[64:67], v[112:115]
    ds_read_b64_tr_b16 a[220:221], v9 offset:4224
    v_mfma_f32_16x16x32_bf16 v[176:179], a[228:231], a[68:71], v[112:115]
    ds_read_b64_tr_b16 a[222:223], v9 offset:4736
    v_mfma_f32_16x16x32_bf16 v[116:119], a[228:231], a[140:143], v[116:119]
    v_mfma_f32_16x16x32_bf16 v[180:183], a[224:227], a[136:139], v[116:119]
    s_waitcnt lgkmcnt(4)
    buffer_load_dwordx4 v6, s[16:19], s48 offen nt lds
    v_mfma_f32_16x16x32_bf16 v[148:151], a[232:235], a[136:139], v[148:151]
    s_add_u32 m0, m0, s43
    ds_read_b64_tr_b16 a[224:225], v9 offset:32
    v_mfma_f32_16x16x32_bf16 v[212:215], a[236:239], a[140:143], v[148:151]
    s_add_u32 s49, s39, s42
    ds_read_b64_tr_b16 a[226:227], v9 offset:544
    v_mfma_f32_16x16x32_bf16 v[144:147], a[236:239], a[68:71], v[144:147]
    v_mfma_f32_16x16x32_bf16 v[208:211], a[232:235], a[64:67], v[144:147]
    s_mul_i32 s39, s33, s40
    v_mfma_f32_16x16x32_bf16 v[140:143], a[232:235], v[96:99], v[140:143]
    ds_read_b64_tr_b16 a[228:229], v9 offset:4256
    v_mfma_f32_16x16x32_bf16 v[204:207], a[236:239], v[100:103], v[140:143]
    s_waitcnt vmcnt(12)
    ds_read_b64_tr_b16 a[230:231], v9 offset:4768
    v_mfma_f32_16x16x32_bf16 v[136:139], a[236:239], a[212:215], v[136:139]
    s_barrier
    v_mfma_f32_16x16x32_bf16 v[200:203], a[232:235], a[208:211], v[136:139]
    s_waitcnt lgkmcnt(4)
    buffer_load_dwordx4 v6, s[20:23], s49 offen nt lds
    s_cmp_lt_u32 s2, 8
    s_cbranch_scc1 L_k_t0
L_k_u:
    v_mfma_f32_16x16x32_bf16 v[104:107], a[216:219], a[144:147], 0
    s_add_u32 m0, m0, s43
    v_fma_f32 v232, -v168, v168, s68
    v_mul_f32 v232, v232, v168
    v_mfma_f32_16x16x32_bf16 v[104:107], a[220:223], a[148:151], v[104:107]
    s_add_u32 s49, s49, s50
    v_exp_f32 v232, v232
    v_mfma_f32_16x16x32_bf16 v[108:111], a[220:223], v[36:39], 0
    s_add_u32 s71, s57, 128
    ds_read_b64_tr_b16 a[232:233], v9 offset:8448
    v_mul_f32 v233, v168, v200
    v_mfma_f32_16x16x32_bf16 v[108:111], a[216:219], v[32:35], v[108:111]
    ds_read_b64_tr_b16 a[234:235], v9 offset:8960
    v_fma_f32 v232, v232, s3, s3
    v_mfma_f32_16x16x32_bf16 v[112:115], a[216:219], a[0:3], 0
    s_mov_b32 s5, s6
    ds_read_b64_tr_b16 a[236:237], v9 offset:12672
    v_fma_f32 v234, -v169, v169, s68
    v_mfma_f32_16x16x32_bf16 v[112:115], a[220:223], a[4:7], v[112:115]
    s_movk_i32 s6, 16384
    ds_read_b64_tr_b16 a[238:239], v9 offset:13184
    v_mul_f32 v234, v234, v169
    v_mfma_f32_16x16x32_bf16 v[116:119], a[220:223], a[76:79], 0
    v_rcp_f32 v232, v232
    v_mfma_f32_16x16x32_bf16 v[116:119], a[216:219], a[72:75], v[116:119]
    s_waitcnt lgkmcnt(4)
    buffer_load_dwordx4 v6, s[20:23], s49 offen nt lds
    v_mfma_f32_16x16x32_bf16 v[132:135], a[224:227], a[72:75], 0
    s_add_u32 m0, m0, s43
    ds_read_b64_tr_b16 a[216:217], v9 offset:8480
    v_mul_f32 v232, v232, v233
    v_mfma_f32_16x16x32_bf16 v[132:135], a[228:231], a[76:79], v[132:135]
    s_add_u32 s48, s39, s41
    ds_read_b64_tr_b16 a[218:219], v9 offset:8992
    v_mul_f32 v235, v169, v201
    v_mfma_f32_16x16x32_bf16 v[128:131], a[228:231], a[4:7], 0
    s_cmp_eq_u32 s51, 3
    ds_read_b64_tr_b16 a[220:221], v9 offset:12704
    v_fma_f32 v236, -v170, v170, s68
    v_mfma_f32_16x16x32_bf16 v[128:131], a[224:227], a[0:3], v[128:131]
    s_cselect_b64 s[52:53], s[34:35], s[16:17]
    ds_read_b64_tr_b16 a[222:223], v9 offset:13216
    v_mul_f32 v236, v236, v170
    v_mfma_f32_16x16x32_bf16 v[124:127], a[224:227], v[32:35], 0
    s_cselect_b64 s[54:55], s[34:35], s[20:21]
    v_exp_f32 v234, v234
    v_mfma_f32_16x16x32_bf16 v[124:127], a[228:231], v[36:39], v[124:127]
    s_cselect_b32 s56, 1990656, s18
    v_exp_f32 v236, v236
    v_mfma_f32_16x16x32_bf16 v[120:123], a[228:231], a[148:151], 0
    v_fma_f32 v234, v234, s3, s3
    v_mul_f32 v237, v170, v202
    v_mfma_f32_16x16x32_bf16 v[120:123], a[224:227], a[144:147], v[120:123]
    s_waitcnt lgkmcnt(4)
    buffer_load_dwordx4 v6, s[16:19], s48 offen nt lds
    v_mfma_f32_16x16x32_bf16 v[136:139], a[232:235], a[144:147], 0
    s_add_u32 m0, m0, s43
    ds_read_b64_tr_b16 a[224:225], v9 offset:16896
    v_fma_f32 v236, v236, s3, s3
    v_mfma_f32_16x16x32_bf16 v[136:139], a[236:239], a[148:151], v[136:139]
    s_add_u32 s48, s48, s50
    ds_read_b64_tr_b16 a[226:227], v9 offset:17408
    v_fma_f32 v238, -v171, v171, s68
    v_mfma_f32_16x16x32_bf16 v[140:143], a[236:239], v[36:39], 0
    ds_read_b64_tr_b16 a[228:229], v9 offset:21120
    v_mul_f32 v238, v238, v171
    v_mfma_f32_16x16x32_bf16 v[140:143], a[232:235], v[32:35], v[140:143]
    ds_read_b64_tr_b16 a[230:231], v9 offset:21632
    v_mul_f32 v239, v171, v203
    v_mfma_f32_16x16x32_bf16 v[144:147], a[232:235], a[0:3], 0
    v_rcp_f32 v234, v234
    v_mfma_f32_16x16x32_bf16 v[144:147], a[236:239], a[4:7], v[144:147]
    v_rcp_f32 v236, v236
    v_mfma_f32_16x16x32_bf16 v[148:151], a[236:239], a[76:79], 0
    v_exp_f32 v238, v238
    v_mul_f32 v234, v234, v235
    v_mfma_f32_16x16x32_bf16 v[148:151], a[232:235], a[72:75], v[148:151]
    s_waitcnt lgkmcnt(4)
    buffer_load_dwordx4 v6, s[16:19], s48 offen nt lds
    v_mfma_f32_16x16x32_bf16 v[164:167], a[216:219], a[72:75], 0
    s_mov_b32 m0, s47
    ds_read_b64_tr_b16 a[232:233], v9 offset:16928
    v_cvt_pk_bf16_f32 v248, v232, v234
    v_mfma_f32_16x16x32_bf16 v[164:167], a[220:223], a[76:79], v[164:167]
    s_add_u32 s49, s39, s42
    ds_read_b64_tr_b16 a[234:235], v9 offset:17440
    v_mul_f32 v236, v236, v237
    v_mfma_f32_16x16x32_bf16 v[160:163], a[220:223], a[4:7], 0
    ds_read_b64_tr_b16 a[236:237], v9 offset:21152
    v_fma_f32 v238, v238, s3, s3
    v_mfma_f32_16x16x32_bf16 v[160:163], a[216:219], a[0:3], v[160:163]
    s_mul_i32 s39, s84, s40
    ds_read_b64_tr_b16 a[238:239], v9 offset:21664
    v_fma_f32 v240, -v172, v172, s68
    v_mfma_f32_16x16x32_bf16 v[156:159], a[216:219], v[32:35], 0
    s_waitcnt vmcnt(8)
    v_rcp_f32 v238, v238
    v_mfma_f32_16x16x32_bf16 v[156:159], a[220:223], v[36:39], v[156:159]
    s_barrier
    v_mfma_f32_16x16x32_bf16 v[152:155], a[220:223], a[148:151], 0
    v_mul_f32 v238, v238, v239
    v_cvt_pk_bf16_f32 v249, v236, v238
    v_mfma_f32_16x16x32_bf16 v[152:155], a[216:219], a[144:147], v[152:155]
    s_waitcnt lgkmcnt(4)
    buffer_load_dwordx4 v6, s[20:23], s49 offen nt lds
    v_mfma_f32_16x16x32_bf16 v[104:107], a[224:227], a[152:155], v[104:107]
    s_add_u32 m0, m0, s43
    ds_read_b64_tr_b16 a[216:217], v9 offset:25344
    v_mul_f32 v240, v240, v172
    v_mfma_f32_16x16x32_bf16 v[104:107], a[228:231], a[156:159], v[104:107]
    s_add_u32 s49, s49, s50
    ds_read_b64_tr_b16 a[218:219], v9 offset:25856
    v_mul_f32 v241, v172, v204
    v_mfma_f32_16x16x32_bf16 v[108:111], a[228:231], v[44:47], v[108:111]
    ds_read_b64_tr_b16 a[220:221], v9 offset:29568
    v_fma_f32 v242, -v173, v173, s68
    v_mfma_f32_16x16x32_bf16 v[108:111], a[224:227], v[40:43], v[108:111]
    ds_read_b64_tr_b16 a[222:223], v9 offset:30080
    v_mul_f32 v242, v242, v173
    v_mfma_f32_16x16x32_bf16 v[112:115], a[224:227], a[8:11], v[112:115]
    v_exp_f32 v240, v240
    v_mfma_f32_16x16x32_bf16 v[112:115], a[228:231], a[12:15], v[112:115]
    v_exp_f32 v242, v242
    v_mfma_f32_16x16x32_bf16 v[116:119], a[228:231], a[84:87], v[116:119]
    v_fma_f32 v240, v240, s3, s3
    v_mul_f32 v243, v173, v205
    v_mfma_f32_16x16x32_bf16 v[116:119], a[224:227], a[80:83], v[116:119]
    s_waitcnt lgkmcnt(4)
    buffer_load_dwordx4 v6, s[20:23], s49 offen nt lds
    v_mfma_f32_16x16x32_bf16 v[132:135], a[232:235], a[80:83], v[132:135]
    s_add_u32 m0, m0, s43
    ds_read_b64_tr_b16 a[224:225], v9 offset:25376
    v_fma_f32 v242, v242, s3, s3
    v_mfma_f32_16x16x32_bf16 v[132:135], a[236:239], a[84:87], v[132:135]
    s_add_u32 s48, s39, s41
    ds_read_b64_tr_b16 a[226:227], v9 offset:25888
    v_fma_f32 v244, -v174, v174, s68
    v_mfma_f32_16x16x32_bf16 v[128:131], a[236:239], a[12:15], v[128:131]
    s_cmp_eq_u32 s51, 3
    ds_read_b64_tr_b16 a[228:229], v9 offset:29600
    v_mul_f32 v244, v244, v174
    v_mfma_f32_16x16x32_bf16 v[128:131], a[232:235], a[8:11], v[128:131]
    s_cselect_b32 s57, s60, s71
    ds_read_b64_tr_b16 a[230:231], v9 offset:30112
    v_mul_f32 v245, v174, v206
    v_mfma_f32_16x16x32_bf16 v[124:127], a[232:235], v[40:43], v[124:127]
    s_cselect_b32 s58, s61, s71
    v_rcp_f32 v240, v240
    v_mfma_f32_16x16x32_bf16 v[124:127], a[236:239], v[44:47], v[124:127]
    s_cselect_b32 s59, 110592, s50
    v_rcp_f32 v242, v242
    v_mfma_f32_16x16x32_bf16 v[120:123], a[236:239], a[156:159], v[120:123]
    v_exp_f32 v244, v244
    v_mfma_f32_16x16x32_bf16 v[120:123], a[232:235], a[152:155], v[120:123]
    s_waitcnt lgkmcnt(4)
    buffer_load_dwordx4 v6, s[16:19], s48 offen nt lds
    v_mfma_f32_16x16x32_bf16 v[136:139], a[216:219], a[152:155], v[136:139]
    s_add_u32 m0, m0, s43
    ds_read_b64_tr_b16 a[232:233], v9 offset:33792
    v_mul_f32 v240, v240, v241
    v_mfma_f32_16x16x32_bf16 v[136:139], a[220:223], a[156:159], v[136:139]
    s_add_u32 s48, s48, s50
    ds_read_b64_tr_b16 a[234:235], v9 offset:34304
    v_mul_f32 v242, v242, v243
    v_mfma_f32_16x16x32_bf16 v[140:143], a[220:223], v[44:47], v[140:143]
    ds_read_b64_tr_b16 a[236:237], v10 offset:0
    v_cvt_pk_bf16_f32 v250, v240, v242
    v_mfma_f32_16x16x32_bf16 v[140:143], a[216:219], v[40:43], v[140:143]
    ds_read_b64_tr_b16 a[238:239], v10 offset:512
    v_fma_f32 v244, v244, s3, s3
    v_mfma_f32_16x16x32_bf16 v[144:147], a[216:219], a[8:11], v[144:147]
    v_rcp_f32 v244, v244
    v_mfma_f32_16x16x32_bf16 v[144:147], a[220:223], a[12:15], v[144:147]
    buffer_load_dword a240, v0, s[24:27], s75 offen nt
    v_mfma_f32_16x16x32_bf16 v[148:151], a[220:223], a[84:87], v[148:151]
    v_mul_f32 v244, v244, v245
    v_fma_f32 v246, -v175, v175, s68
    v_mfma_f32_16x16x32_bf16 v[148:151], a[216:219], a[80:83], v[148:151]
    s_waitcnt lgkmcnt(4)
    buffer_load_dwordx4 v6, s[16:19], s48 offen nt lds
    v_mfma_f32_16x16x32_bf16 v[164:167], a[224:227], a[80:83], v[164:167]
    s_add_u32 m0, m0, s43
    ds_read_b64_tr_b16 a[216:217], v9 offset:33824
    v_mul_f32 v246, v246, v175
    v_mfma_f32_16x16x32_bf16 v[164:167], a[228:231], a[84:87], v[164:167]
    s_add_u32 s49, s39, s42
    ds_read_b64_tr_b16 a[218:219], v9 offset:34336
    v_mul_f32 v247, v175, v207
    v_mfma_f32_16x16x32_bf16 v[160:163], a[228:231], a[12:15], v[160:163]
    ds_read_b64_tr_b16 a[220:221], v10 offset:32
    v_fma_f32 v232, -v176, v176, s68
    v_mfma_f32_16x16x32_bf16 v[160:163], a[224:227], a[8:11], v[160:163]
    s_mul_i32 s39, s85, s40
    ds_read_b64_tr_b16 a[222:223], v10 offset:544
    v_mul_f32 v232, v232, v176
    v_mfma_f32_16x16x32_bf16 v[156:159], a[224:227], v[40:43], v[156:159]
    s_waitcnt vmcnt(9)
    v_exp_f32 v246, v246
    v_mfma_f32_16x16x32_bf16 v[156:159], a[228:231], v[44:47], v[156:159]
    s_barrier
    v_mfma_f32_16x16x32_bf16 v[152:155], a[228:231], a[156:159], v[152:155]
    v_exp_f32 v232, v232
    v_mfma_f32_16x16x32_bf16 v[152:155], a[224:227], a[152:155], v[152:155]
    s_waitcnt lgkmcnt(4)
    buffer_load_dwordx4 v6, s[20:23], s49 offen nt lds
    v_mfma_f32_16x16x32_bf16 v[104:107], a[232:235], a[160:163], v[104:107]
    s_add_u32 m0, m0, s43
    ds_read_b64_tr_b16 a[224:225], v10 offset:4224
    v_fma_f32 v246, v246, s3, s3
    v_mfma_f32_16x16x32_bf16 v[104:107], a[236:239], a[164:167], v[104:107]
    s_add_u32 s49, s49, s50
    ds_read_b64_tr_b16 a[226:227], v10 offset:4736
    v_mul_f32 v233, v176, v208
    v_mfma_f32_16x16x32_bf16 v[108:111], a[236:239], v[52:55], v[108:111]
    ds_read_b64_tr_b16 a[228:229], v10 offset:8448
    v_fma_f32 v232, v232, s3, s3
    v_mfma_f32_16x16x32_bf16 v[108:111], a[232:235], v[48:51], v[108:111]
    ds_read_b64_tr_b16 a[230:231], v10 offset:8960
    v_rcp_f32 v246, v246
    v_mfma_f32_16x16x32_bf16 v[112:115], a[232:235], a[16:19], v[112:115]
    v_rcp_f32 v232, v232
    v_mfma_f32_16x16x32_bf16 v[112:115], a[236:239], a[20:23], v[112:115]
    v_mul_f32 v246, v246, v247
    v_cvt_pk_bf16_f32 v251, v244, v246
    v_mfma_f32_16x16x32_bf16 v[116:119], a[236:239], a[92:95], v[116:119]
    v_mul_f32 v232, v232, v233
    v_fma_f32 v234, -v177, v177, s68
    v_mfma_f32_16x16x32_bf16 v[116:119], a[232:235], a[88:91], v[116:119]
    s_waitcnt lgkmcnt(4)
    buffer_load_dwordx4 v6, s[20:23], s49 offen nt lds
    v_mfma_f32_16x16x32_bf16 v[132:135], a[216:219], a[88:91], v[132:135]
    s_add_u32 m0, m0, s43
    ds_read_b64_tr_b16 a[232:233], v10 offset:4256
    v_mul_f32 v234, v234, v177
    v_mfma_f32_16x16x32_bf16 v[132:135], a[220:223], a[92:95], v[132:135]
    s_add_u32 s48, s39, s41
    ds_read_b64_tr_b16 a[234:235], v10 offset:4768
    v_mul_f32 v235, v177, v209
    v_mfma_f32_16x16x32_bf16 v[128:131], a[220:223], a[20:23], v[128:131]
    s_cmp_eq_u32 s51, 3
    ds_read_b64_tr_b16 a[236:237], v10 offset:8480
    v_fma_f32 v236, -v178, v178, s68
    v_mfma_f32_16x16x32_bf16 v[128:131], a[216:219], a[16:19], v[128:131]
    s_cselect_b64 vcc, -1, 0
    ds_read_b64_tr_b16 a[238:239], v10 offset:8992
    v_mul_f32 v236, v236, v178
    v_mfma_f32_16x16x32_bf16 v[124:127], a[216:219], v[48:51], v[124:127]
    ds_write2st64_b64 v12, v[248:249], v[250:251] offset0:0 offset1:2
    v_mfma_f32_16x16x32_bf16 v[124:127], a[220:223], v[52:55], v[124:127]
    v_exp_f32 v234, v234
    v_mfma_f32_16x16x32_bf16 v[120:123], a[220:223], a[164:167], v[120:123]
    v_exp_f32 v236, v236
    v_mfma_f32_16x16x32_bf16 v[120:123], a[216:219], a[160:163], v[120:123]
    s_waitcnt lgkmcnt(5)
    buffer_load_dwordx4 v6, s[16:19], s48 offen nt lds
    v_mfma_f32_16x16x32_bf16 v[136:139], a[224:227], a[160:163], v[136:139]
    s_add_u32 m0, m0, s43
    v_add_u32 v12, s4, v12
    v_fma_f32 v234, v234, s3, s3
    v_mfma_f32_16x16x32_bf16 v[136:139], a[228:231], a[164:167], v[136:139]
    s_add_u32 s48, s48, s50
    v_rcp_f32 v234, v234
    v_mfma_f32_16x16x32_bf16 v[140:143], a[228:231], v[52:55], v[140:143]
    ds_read_b64_tr_b16 a[216:217], v10 offset:12672
    v_mul_f32 v234, v234, v235
    v_mfma_f32_16x16x32_bf16 v[140:143], a[224:227], v[48:51], v[140:143]
    ds_read_b64_tr_b16 a[218:219], v10 offset:13184
    v_cvt_pk_bf16_f32 v252, v232, v234
    v_mfma_f32_16x16x32_bf16 v[144:147], a[224:227], a[16:19], v[144:147]
    ds_read_b64_tr_b16 a[220:221], v10 offset:16896
    v_mul_f32 v237, v178, v210
    v_mfma_f32_16x16x32_bf16 v[144:147], a[228:231], a[20:23], v[144:147]
    ds_read_b64_tr_b16 a[222:223], v10 offset:17408
    v_fma_f32 v236, v236, s3, s3
    v_mfma_f32_16x16x32_bf16 v[148:151], a[228:231], a[92:95], v[148:151]
    v_rcp_f32 v236, v236
    v_mfma_f32_16x16x32_bf16 v[148:151], a[224:227], a[88:91], v[148:151]
    s_waitcnt lgkmcnt(5)
    buffer_load_dwordx4 v6, s[16:19], s48 offen nt lds
    v_mfma_f32_16x16x32_bf16 v[164:167], a[232:235], a[88:91], v[164:167]
    s_add_u32 m0, m0, s43
    ds_read_b64_tr_b16 a[224:225], v10 offset:12704
    v_mul_f32 v236, v236, v237
    v_mfma_f32_16x16x32_bf16 v[164:167], a[236:239], a[92:95], v[164:167]
    s_add_u32 s49, s39, s42
    ds_read_b64_tr_b16 a[226:227], v10 offset:13216
    v_fma_f32 v238, -v179, v179, s68
    v_mfma_f32_16x16x32_bf16 v[160:163], a[236:239], a[20:23], v[160:163]
    ds_read_b64_tr_b16 a[228:229], v10 offset:16928
    v_mul_f32 v238, v238, v179
    v_mfma_f32_16x16x32_bf16 v[160:163], a[232:235], a[16:19], v[160:163]
    s_mul_i32 s39, s97, s40
    ds_read_b64_tr_b16 a[230:231], v10 offset:17440
    v_mul_f32 v239, v179, v211
    v_mfma_f32_16x16x32_bf16 v[156:159], a[232:235], v[48:51], v[156:159]
    s_waitcnt vmcnt(9)
    v_exp_f32 v238, v238
    v_mfma_f32_16x16x32_bf16 v[156:159], a[236:239], v[52:55], v[156:159]
    s_barrier
    v_mfma_f32_16x16x32_bf16 v[152:155], a[236:239], a[164:167], v[152:155]
    v_fma_f32 v238, v238, s3, s3
    v_fma_f32 v240, -v180, v180, s68
    v_mfma_f32_16x16x32_bf16 v[152:155], a[232:235], a[160:163], v[152:155]
    s_waitcnt lgkmcnt(4)
    buffer_load_dwordx4 v6, s[20:23], s49 offen nt lds
    v_mfma_f32_16x16x32_bf16 v[104:107], a[216:219], a[168:171], v[104:107]
    s_add_u32 m0, m0, s43
    ds_read_b64_tr_b16 a[232:233], v10 offset:21120
    v_mul_f32 v240, v240, v180
    v_mfma_f32_16x16x32_bf16 v[104:107], a[220:223], a[172:175], v[104:107]
    s_add_u32 s49, s49, s50
    ds_read_b64_tr_b16 a[234:235], v10 offset:21632
    v_mul_f32 v241, v180, v212
    v_mfma_f32_16x16x32_bf16 v[108:111], a[220:223], v[60:63], v[108:111]
    ds_read_b64_tr_b16 a[236:237], v10 offset:25344
    v_fma_f32 v242, -v181, v181, s68
    v_mfma_f32_16x16x32_bf16 v[108:111], a[216:219], v[56:59], v[108:111]
    ds_read_b64_tr_b16 a[238:239], v10 offset:25856
    v_mul_f32 v242, v242, v181
    v_mfma_f32_16x16x32_bf16 v[112:115], a[216:219], a[24:27], v[112:115]
    v_rcp_f32 v238, v238
    v_mfma_f32_16x16x32_bf16 v[112:115], a[220:223], a[28:31], v[112:115]
    v_exp_f32 v240, v240
    v_mfma_f32_16x16x32_bf16 v[116:119], a[220:223], a[100:103], v[116:119]
    v_exp_f32 v242, v242
    v_mfma_f32_16x16x32_bf16 v[116:119], a[216:219], a[96:99], v[116:119]
    s_waitcnt lgkmcnt(4)
    buffer_load_dwordx4 v6, s[20:23], s49 offen nt lds
    v_mfma_f32_16x16x32_bf16 v[132:135], a[224:227], a[96:99], v[132:135]
    s_add_u32 m0, m0, s43
    ds_read_b64_tr_b16 a[216:217], v10 offset:21152
    v_mul_f32 v238, v238, v239
    v_mfma_f32_16x16x32_bf16 v[132:135], a[228:231], a[100:103], v[132:135]
    s_add_u32 s48, s39, s41
    ds_read_b64_tr_b16 a[218:219], v10 offset:21664
    v_cvt_pk_bf16_f32 v253, v236, v238
    v_mfma_f32_16x16x32_bf16 v[128:131], a[228:231], a[28:31], v[128:131]
    ds_read_b64_tr_b16 a[220:221], v10 offset:25376
    v_fma_f32 v240, v240, s3, s3
    v_mfma_f32_16x16x32_bf16 v[128:131], a[224:227], a[24:27], v[128:131]
    ds_read_b64_tr_b16 a[222:223], v10 offset:25888
    v_mul_f32 v243, v181, v213
    v_mfma_f32_16x16x32_bf16 v[124:127], a[224:227], v[56:59], v[124:127]
    v_rcp_f32 v240, v240
    v_mfma_f32_16x16x32_bf16 v[124:127], a[228:231], v[60:63], v[124:127]
    v_mul_f32 v240, v240, v241
    v_fma_f32 v242, v242, s3, s3
    v_mfma_f32_16x16x32_bf16 v[120:123], a[228:231], a[172:175], v[120:123]
    v_rcp_f32 v242, v242
    v_mfma_f32_16x16x32_bf16 v[120:123], a[224:227], a[168:171], v[120:123]
    s_waitcnt lgkmcnt(4)
    buffer_load_dwordx4 v6, s[16:19], s48 offen nt lds
    v_mfma_f32_16x16x32_bf16 v[136:139], a[232:235], a[168:171], v[136:139]
    s_add_u32 m0, m0, s43
    ds_read_b64_tr_b16 a[224:225], v10 offset:29568
    v_mul_f32 v242, v242, v243
    v_cvt_pk_bf16_f32 v254, v240, v242
    v_mfma_f32_16x16x32_bf16 v[136:139], a[236:239], a[172:175], v[136:139]
    s_add_u32 s48, s48, s50
    ds_read_b64_tr_b16 a[226:227], v10 offset:30080
    v_fma_f32 v244, -v182, v182, s68
    v_mfma_f32_16x16x32_bf16 v[140:143], a[236:239], v[60:63], v[140:143]
    ds_read_b64_tr_b16 a[228:229], v10 offset:33792
    v_mul_f32 v244, v244, v182
    v_mfma_f32_16x16x32_bf16 v[140:143], a[232:235], v[56:59], v[140:143]
    ds_read_b64_tr_b16 a[230:231], v10 offset:34304
    v_mul_f32 v245, v182, v214
    v_mfma_f32_16x16x32_bf16 v[144:147], a[232:235], a[24:27], v[144:147]
    buffer_load_dword v20, v1, s[92:95], 0 offen offset:128 sc1
    v_mfma_f32_16x16x32_bf16 v[144:147], a[236:239], a[28:31], v[144:147]
    v_exp_f32 v244, v244
    v_mfma_f32_16x16x32_bf16 v[148:151], a[236:239], a[100:103], v[148:151]
    v_fma_f32 v244, v244, s3, s3
    v_fma_f32 v246, -v183, v183, s68
    v_mfma_f32_16x16x32_bf16 v[148:151], a[232:235], a[96:99], v[148:151]
    s_waitcnt lgkmcnt(4)
    buffer_load_dwordx4 v6, s[16:19], s48 offen nt lds
    v_mfma_f32_16x16x32_bf16 v[164:167], a[216:219], a[96:99], v[164:167]
    s_add_u32 m0, m0, s43
    ds_read_b64_tr_b16 a[232:233], v10 offset:29600
    v_mul_f32 v246, v246, v183
    v_mfma_f32_16x16x32_bf16 v[164:167], a[220:223], a[100:103], v[164:167]
    s_add_u32 s49, s39, s42
    ds_read_b64_tr_b16 a[234:235], v10 offset:30112
    v_mul_f32 v247, v183, v215
    v_mfma_f32_16x16x32_bf16 v[160:163], a[220:223], a[28:31], v[160:163]
    ds_read_b64_tr_b16 a[236:237], v10 offset:33824
    v_fma_f32 v232, -v196, v196, s68
    v_mfma_f32_16x16x32_bf16 v[160:163], a[216:219], a[24:27], v[160:163]
    s_mul_i32 s39, s99, s40
    ds_read_b64_tr_b16 a[238:239], v10 offset:34336
    v_mul_f32 v232, v232, v196
    v_mfma_f32_16x16x32_bf16 v[156:159], a[216:219], v[56:59], v[156:159]
    s_waitcnt vmcnt(9)
    v_rcp_f32 v244, v244
    v_mfma_f32_16x16x32_bf16 v[156:159], a[220:223], v[60:63], v[156:159]
    s_barrier
    v_mfma_f32_16x16x32_bf16 v[152:155], a[220:223], a[172:175], v[152:155]
    v_exp_f32 v246, v246
    v_mfma_f32_16x16x32_bf16 v[152:155], a[216:219], a[168:171], v[152:155]
    s_waitcnt lgkmcnt(4)
    buffer_load_dwordx4 v6, s[20:23], s49 offen nt lds
    v_mfma_f32_16x16x32_bf16 v[104:107], a[224:227], a[176:179], v[104:107]
    s_add_u32 m0, m0, s43
    ds_read_b64_tr_b16 a[216:217], v9 offset:0
    v_mul_f32 v244, v244, v245
    v_mfma_f32_16x16x32_bf16 v[104:107], a[228:231], a[180:183], v[104:107]
    s_add_u32 s49, s49, s50
    ds_read_b64_tr_b16 a[218:219], v9 offset:512
    v_fma_f32 v246, v246, s3, s3
    v_mfma_f32_16x16x32_bf16 v[108:111], a[228:231], v[68:71], v[108:111]
    s_lshr_b32 s40, s59, 6
    ds_read_b64_tr_b16 a[220:221], v9 offset:4224
    v_mul_f32 v233, v196, v228
    v_mfma_f32_16x16x32_bf16 v[108:111], a[224:227], v[64:67], v[108:111]
    ds_read_b64_tr_b16 a[222:223], v9 offset:4736
    v_fma_f32 v234, -v197, v197, s68
    v_mfma_f32_16x16x32_bf16 v[112:115], a[224:227], a[32:35], v[112:115]
    v_rcp_f32 v246, v246
    v_mfma_f32_16x16x32_bf16 v[112:115], a[228:231], a[36:39], v[112:115]
    v_exp_f32 v232, v232
    v_mfma_f32_16x16x32_bf16 v[116:119], a[228:231], a[108:111], v[116:119]
    v_mul_f32 v246, v246, v247
    v_cvt_pk_bf16_f32 v255, v244, v246
    v_mfma_f32_16x16x32_bf16 v[116:119], a[224:227], a[104:107], v[116:119]
    s_waitcnt lgkmcnt(4)
    buffer_load_dwordx4 v6, s[20:23], s49 offen nt lds
    v_mfma_f32_16x16x32_bf16 v[132:135], a[232:235], a[104:107], v[132:135]
    s_add_u32 m0, m0, s43
    ds_read_b64_tr_b16 a[224:225], v9 offset:32
    v_fma_f32 v232, v232, s3, s3
    v_mfma_f32_16x16x32_bf16 v[132:135], a[236:239], a[108:111], v[132:135]
    s_add_u32 s48, s39, s41
    ds_read_b64_tr_b16 a[226:227], v9 offset:544
    v_mul_f32 v234, v234, v197
    v_mfma_f32_16x16x32_bf16 v[128:131], a[236:239], a[36:39], v[128:131]
    s_mov_b32 s41, s57
    ds_read_b64_tr_b16 a[228:229], v9 offset:4256
    v_mul_f32 v235, v197, v229
    v_mfma_f32_16x16x32_bf16 v[128:131], a[232:235], a[32:35], v[128:131]
    ds_read_b64_tr_b16 a[230:231], v9 offset:4768
    v_fma_f32 v236, -v198, v198, s68
    v_mfma_f32_16x16x32_bf16 v[124:127], a[232:235], v[64:67], v[124:127]
    ds_write2st64_b64 v14, v[252:253], v[254:255] offset0:0 offset1:2
    v_mfma_f32_16x16x32_bf16 v[124:127], a[236:239], v[68:71], v[124:127]
    v_rcp_f32 v232, v232
    v_mfma_f32_16x16x32_bf16 v[120:123], a[236:239], a[180:183], v[120:123]
    v_exp_f32 v234, v234
    v_mfma_f32_16x16x32_bf16 v[120:123], a[232:235], a[176:179], v[120:123]
    s_waitcnt lgkmcnt(5)
    buffer_load_dwordx4 v6, s[16:19], s48 offen nt lds
    v_mfma_f32_16x16x32_bf16 v[136:139], a[216:219], a[176:179], v[136:139]
    s_add_u32 m0, m0, s43
    v_add_u32 v14, s4, v14
    v_mul_f32 v232, v232, v233
    v_mfma_f32_16x16x32_bf16 v[136:139], a[220:223], a[180:183], v[136:139]
    s_add_u32 s48, s48, s50
    v_fma_f32 v234, v234, s3, s3
    v_mul_f32 v236, v236, v198
    v_mfma_f32_16x16x32_bf16 v[140:143], a[220:223], v[68:71], v[140:143]
    ds_read_b64_tr_b16 a[232:233], v9 offset:8448
    v_mul_f32 v237, v198, v230
    v_mfma_f32_16x16x32_bf16 v[140:143], a[216:219], v[64:67], v[140:143]
    ds_read_b64_tr_b16 a[234:235], v9 offset:8960
    v_fma_f32 v238, -v199, v199, s68
    v_mfma_f32_16x16x32_bf16 v[144:147], a[216:219], a[32:35], v[144:147]
    ds_read_b64_tr_b16 a[236:237], v9 offset:12672
    v_mul_f32 v238, v238, v199
    v_mfma_f32_16x16x32_bf16 v[144:147], a[220:223], a[36:39], v[144:147]
    ds_read_b64_tr_b16 a[238:239], v9 offset:13184
    v_mul_f32 v239, v199, v231
    v_mfma_f32_16x16x32_bf16 v[148:151], a[220:223], a[108:111], v[148:151]
    v_rcp_f32 v234, v234
    v_mfma_f32_16x16x32_bf16 v[148:151], a[216:219], a[104:107], v[148:151]
    s_waitcnt lgkmcnt(5)
    buffer_load_dwordx4 v6, s[16:19], s48 offen nt lds
    v_mfma_f32_16x16x32_bf16 v[164:167], a[224:227], a[104:107], v[164:167]
    s_add_u32 m0, m0, s43
    ds_read_b64_tr_b16 a[216:217], v9 offset:8480
    v_mul_f32 v234, v234, v235
    v_mfma_f32_16x16x32_bf16 v[164:167], a[228:231], a[108:111], v[164:167]
    s_add_u32 s49, s39, s42
    ds_read_b64_tr_b16 a[218:219], v9 offset:8992
    v_cvt_pk_bf16_f32 v248, v232, v234
    v_mfma_f32_16x16x32_bf16 v[160:163], a[228:231], a[36:39], v[160:163]
    s_mov_b64 s[16:17], s[52:53]
    ds_read_b64_tr_b16 a[220:221], v9 offset:12704
    v_fma_f32 v240, -v192, v192, s68
    v_mfma_f32_16x16x32_bf16 v[160:163], a[224:227], a[32:35], v[160:163]
    s_mul_i32 s39, s36, s40
    ds_read_b64_tr_b16 a[222:223], v9 offset:13216
    v_mul_f32 v240, v240, v192
    v_mfma_f32_16x16x32_bf16 v[156:159], a[224:227], v[64:67], v[156:159]
    s_waitcnt vmcnt(9)
    v_exp_f32 v236, v236
    v_mfma_f32_16x16x32_bf16 v[156:159], a[228:231], v[68:71], v[156:159]
    s_barrier
    v_mfma_f32_16x16x32_bf16 v[152:155], a[228:231], a[180:183], v[152:155]
    s_mov_b32 s18, s56
    v_exp_f32 v238, v238
    v_mfma_f32_16x16x32_bf16 v[152:155], a[224:227], a[176:179], v[152:155]
    s_waitcnt lgkmcnt(4)
    buffer_load_dwordx4 v6, s[20:23], s49 offen nt lds
    v_mfma_f32_16x16x32_bf16 v[104:107], a[232:235], a[184:187], v[104:107]
    s_add_u32 m0, m0, s43
    ds_read_b64_tr_b16 a[224:225], v9 offset:16896
    v_fma_f32 v236, v236, s3, s3
    v_mfma_f32_16x16x32_bf16 v[104:107], a[236:239], a[188:191], v[104:107]
    s_add_u32 s49, s49, s50
    ds_read_b64_tr_b16 a[226:227], v9 offset:17408
    v_fma_f32 v238, v238, s3, s3
    v_mfma_f32_16x16x32_bf16 v[108:111], a[236:239], v[76:79], v[108:111]
    s_mov_b32 s50, s59
    ds_read_b64_tr_b16 a[228:229], v9 offset:21120
    v_mul_f32 v241, v192, v224
    v_mfma_f32_16x16x32_bf16 v[108:111], a[232:235], v[72:75], v[108:111]
    s_mov_b32 s42, s58
    ds_read_b64_tr_b16 a[230:231], v9 offset:21632
    v_fma_f32 v242, -v193, v193, s68
    v_mfma_f32_16x16x32_bf16 v[112:115], a[232:235], a[40:43], v[112:115]
    v_rcp_f32 v236, v236
    v_mfma_f32_16x16x32_bf16 v[112:115], a[236:239], a[44:47], v[112:115]
    buffer_load_dword a240, v0, s[24:27], s75 offen
    v_mfma_f32_16x16x32_bf16 v[116:119], a[236:239], a[116:119], v[116:119]
    v_rcp_f32 v238, v238
    v_mfma_f32_16x16x32_bf16 v[116:119], a[232:235], a[112:115], v[116:119]
    s_waitcnt lgkmcnt(4)
    buffer_load_dwordx4 v6, s[20:23], s49 offen nt lds
    v_mfma_f32_16x16x32_bf16 v[132:135], a[216:219], a[112:115], v[132:135]
    s_mov_b32 m0, s47
    ds_read_b64_tr_b16 a[232:233], v9 offset:16928
    v_cndmask_b32 v6, v6, v4, vcc
    v_mfma_f32_16x16x32_bf16 v[132:135], a[220:223], a[116:119], v[132:135]
    s_add_u32 s48, s39, s41
    ds_read_b64_tr_b16 a[234:235], v9 offset:17440
    v_mul_f32 v236, v236, v237
    v_mfma_f32_16x16x32_bf16 v[128:131], a[220:223], a[44:47], v[128:131]
    s_mov_b64 s[20:21], s[54:55]
    ds_read_b64_tr_b16 a[236:237], v9 offset:21152
    v_mul_f32 v238, v238, v239
    v_mfma_f32_16x16x32_bf16 v[128:131], a[216:219], a[40:43], v[128:131]
    s_mov_b32 s22, s56
    ds_read_b64_tr_b16 a[238:239], v9 offset:21664
    v_cvt_pk_bf16_f32 v249, v236, v238
    v_mfma_f32_16x16x32_bf16 v[124:127], a[216:219], v[72:75], v[124:127]
    v_exp_f32 v240, v240
    v_mfma_f32_16x16x32_bf16 v[124:127], a[220:223], v[76:79], v[124:127]
    v_fma_f32 v240, v240, s3, s3
    v_mul_f32 v242, v242, v193
    v_mfma_f32_16x16x32_bf16 v[120:123], a[220:223], a[188:191], v[120:123]
    v_rcp_f32 v240, v240
    v_mfma_f32_16x16x32_bf16 v[120:123], a[216:219], a[184:187], v[120:123]
    s_waitcnt lgkmcnt(4)
    buffer_load_dwordx4 v6, s[16:19], s48 offen nt lds
    v_mfma_f32_16x16x32_bf16 v[136:139], a[224:227], a[184:187], v[136:139]
    s_add_u32 m0, m0, s43
    ds_read_b64_tr_b16 a[216:217], v9 offset:25344
    v_mul_f32 v240, v240, v241
    v_mfma_f32_16x16x32_bf16 v[136:139], a[228:231], a[188:191], v[136:139]
    s_add_u32 s48, s48, s50
    ds_read_b64_tr_b16 a[218:219], v9 offset:25856
    v_mul_f32 v243, v193, v225
    v_mfma_f32_16x16x32_bf16 v[140:143], a[228:231], v[76:79], v[140:143]
    ds_read_b64_tr_b16 a[220:221], v9 offset:29568
    v_fma_f32 v244, -v194, v194, s68
    v_mfma_f32_16x16x32_bf16 v[140:143], a[224:227], v[72:75], v[140:143]
    ds_read_b64_tr_b16 a[222:223], v9 offset:30080
    v_mul_f32 v244, v244, v194
    v_mfma_f32_16x16x32_bf16 v[144:147], a[224:227], a[40:43], v[144:147]
    v_exp_f32 v242, v242
    v_mfma_f32_16x16x32_bf16 v[144:147], a[228:231], a[44:47], v[144:147]
    v_exp_f32 v244, v244
    v_mfma_f32_16x16x32_bf16 v[148:151], a[228:231], a[116:119], v[148:151]
    v_fma_f32 v242, v242, s3, s3
    v_mul_f32 v245, v194, v226
    v_mfma_f32_16x16x32_bf16 v[148:151], a[224:227], a[112:115], v[148:151]
    s_waitcnt lgkmcnt(4)
    buffer_load_dwordx4 v6, s[16:19], s48 offen nt lds
    v_mfma_f32_16x16x32_bf16 v[164:167], a[232:235], a[112:115], v[164:167]
    s_add_u32 m0, m0, s43
    ds_read_b64_tr_b16 a[224:225], v9 offset:25376
    v_fma_f32 v244, v244, s3, s3
    v_mfma_f32_16x16x32_bf16 v[164:167], a[236:239], a[116:119], v[164:167]
    s_add_u32 s49, s39, s42
    ds_read_b64_tr_b16 a[226:227], v9 offset:25888
    v_fma_f32 v246, -v195, v195, s68
    v_mfma_f32_16x16x32_bf16 v[160:163], a[236:239], a[44:47], v[160:163]
    ds_read_b64_tr_b16 a[228:229], v9 offset:29600
    v_mul_f32 v246, v246, v195
    v_mfma_f32_16x16x32_bf16 v[160:163], a[232:235], a[40:43], v[160:163]
    s_mul_i32 s39, s37, s40
    ds_read_b64_tr_b16 a[230:231], v9 offset:30112
    v_mul_f32 v247, v195, v227
    v_mfma_f32_16x16x32_bf16 v[156:159], a[232:235], v[72:75], v[156:159]
    s_waitcnt vmcnt(9)
    v_rcp_f32 v242, v242
    v_mfma_f32_16x16x32_bf16 v[156:159], a[236:239], v[76:79], v[156:159]
    s_barrier
    v_mfma_f32_16x16x32_bf16 v[152:155], a[236:239], a[188:191], v[152:155]
    v_rcp_f32 v244, v244
    v_mfma_f32_16x16x32_bf16 v[152:155], a[232:235], a[184:187], v[152:155]
    s_waitcnt lgkmcnt(4)
    buffer_load_dwordx4 v6, s[20:23], s49 offen nt lds
    v_mfma_f32_16x16x32_bf16 v[104:107], a[216:219], a[192:195], v[104:107]
    s_add_u32 m0, m0, s43
    ds_read_b64_tr_b16 a[232:233], v9 offset:33792
    v_mul_f32 v242, v242, v243
    v_mfma_f32_16x16x32_bf16 v[104:107], a[220:223], a[196:199], v[104:107]
    s_add_u32 s49, s49, s50
    ds_read_b64_tr_b16 a[234:235], v9 offset:34304
    v_cvt_pk_bf16_f32 v250, v240, v242
    v_mfma_f32_16x16x32_bf16 v[108:111], a[220:223], v[84:87], v[108:111]
    s_movk_i32 s4, 16384
    ds_read_b64_tr_b16 a[236:237], v10 offset:0
    v_mul_f32 v244, v244, v245
    v_mfma_f32_16x16x32_bf16 v[108:111], a[216:219], v[80:83], v[108:111]
    ds_read_b64_tr_b16 a[238:239], v10 offset:512
    v_fma_f32 v232, -v188, v188, s68
    v_mfma_f32_16x16x32_bf16 v[112:115], a[216:219], a[48:51], v[112:115]
    v_exp_f32 v246, v246
    v_mfma_f32_16x16x32_bf16 v[112:115], a[220:223], a[52:55], v[112:115]
    v_fma_f32 v246, v246, s3, s3
    v_mul_f32 v232, v232, v188
    v_mfma_f32_16x16x32_bf16 v[116:119], a[220:223], a[124:127], v[116:119]
    v_rcp_f32 v246, v246
    v_mfma_f32_16x16x32_bf16 v[116:119], a[216:219], a[120:123], v[116:119]
    s_waitcnt lgkmcnt(4)
    buffer_load_dwordx4 v6, s[20:23], s49 offen nt lds
    v_mfma_f32_16x16x32_bf16 v[132:135], a[224:227], a[120:123], v[132:135]
    s_add_u32 m0, m0, s43
    ds_read_b64_tr_b16 a[216:217], v9 offset:33824
    v_mul_f32 v246, v246, v247
    v_mfma_f32_16x16x32_bf16 v[132:135], a[228:231], a[124:127], v[132:135]
    s_add_u32 s48, s39, s41
    ds_read_b64_tr_b16 a[218:219], v9 offset:34336
    v_cvt_pk_bf16_f32 v251, v244, v246
    v_mfma_f32_16x16x32_bf16 v[128:131], a[228:231], a[52:55], v[128:131]
    ds_read_b64_tr_b16 a[220:221], v10 offset:32
    v_exp_f32 v232, v232
    v_mfma_f32_16x16x32_bf16 v[128:131], a[224:227], a[48:51], v[128:131]
    ds_read_b64_tr_b16 a[222:223], v10 offset:544
    v_mul_f32 v233, v188, v220
    v_mfma_f32_16x16x32_bf16 v[124:127], a[224:227], v[80:83], v[124:127]
    ds_write2st64_b64 v15, v[248:249], v[250:251] offset0:2 offset1:0
    v_mfma_f32_16x16x32_bf16 v[124:127], a[228:231], v[84:87], v[124:127]
    v_add_u32 v15, s5, v15
    v_fma_f32 v232, v232, s3, s3
    v_mfma_f32_16x16x32_bf16 v[120:123], a[228:231], a[196:199], v[120:123]
    v_rcp_f32 v232, v232
    v_mfma_f32_16x16x32_bf16 v[120:123], a[224:227], a[192:195], v[120:123]
    s_waitcnt lgkmcnt(5)
    buffer_load_dwordx4 v6, s[16:19], s48 offen nt lds
    v_mfma_f32_16x16x32_bf16 v[136:139], a[232:235], a[192:195], v[136:139]
    s_add_u32 m0, m0, s43
    v_mul_f32 v232, v232, v233
    v_fma_f32 v234, -v189, v189, s68
    v_mfma_f32_16x16x32_bf16 v[136:139], a[236:239], a[196:199], v[136:139]
    s_add_u32 s48, s48, s50
    v_mul_f32 v234, v234, v189
    v_mul_f32 v235, v189, v221
    v_mfma_f32_16x16x32_bf16 v[140:143], a[236:239], v[84:87], v[140:143]
    s_waitcnt vmcnt(13)
    ds_read_b64_tr_b16 a[224:225], v10 offset:4224
    v_cmp_eq_u32 vcc, 0, v20
    v_mfma_f32_16x16x32_bf16 v[140:143], a[232:235], v[80:83], v[140:143]
    ds_read_b64_tr_b16 a[226:227], v10 offset:4736
    v_readlane_b32 s64, v20, s28
    v_mfma_f32_16x16x32_bf16 v[144:147], a[232:235], a[48:51], v[144:147]
    s_cmp_eq_u32 s51, 2
    s_cselect_b32 s65, 0xff, 0
    ds_read_b64_tr_b16 a[228:229], v10 offset:8448
    v_mfma_f32_16x16x32_bf16 v[144:147], a[236:239], a[52:55], v[144:147]
    ds_read_b64_tr_b16 a[230:231], v10 offset:8960
    v_fma_f32 v236, -v190, v190, s68
    v_mfma_f32_16x16x32_bf16 v[148:151], a[236:239], a[124:127], v[148:151]
    s_and_b32 s65, s65, vcc_lo
    s_cbranch_scc1 L_rk_spin
L_rk_ret:
    v_mul_f32 v236, v236, v190
    v_mfma_f32_16x16x32_bf16 v[148:151], a[232:235], a[120:123], v[148:151]
    s_waitcnt lgkmcnt(5)
    buffer_load_dwordx4 v6, s[16:19], s48 offen nt lds
    v_mfma_f32_16x16x32_bf16 v[164:167], a[216:219], a[120:123], v[164:167]
    s_add_u32 m0, m0, s43
    ds_read_b64_tr_b16 a[232:233], v10 offset:4256
    v_cmp_lt_u32 vcc, s64, v20
    v_mfma_f32_16x16x32_bf16 v[164:167], a[220:223], a[124:127], v[164:167]
    s_add_u32 s49, s39, s42
    ds_read_b64_tr_b16 a[234:235], v10 offset:4768
    v_mul_f32 v237, v190, v222
    v_mfma_f32_16x16x32_bf16 v[160:163], a[220:223], a[52:55], v[160:163]
    s_bcnt1_i32_b64 s64, vcc
    ds_read_b64_tr_b16 a[236:237], v10 offset:8480
    v_fma_f32 v238, -v191, v191, s68
    v_mfma_f32_16x16x32_bf16 v[160:163], a[216:219], a[48:51], v[160:163]
    s_mul_i32 s39, s38, s40
    ds_read_b64_tr_b16 a[238:239], v10 offset:8992
    v_mul_f32 v238, v238, v191
    v_mfma_f32_16x16x32_bf16 v[156:159], a[216:219], v[80:83], v[156:159]
    s_waitcnt vmcnt(9)
    v_exp_f32 v234, v234
    v_mfma_f32_16x16x32_bf16 v[156:159], a[220:223], v[84:87], v[156:159]
    s_barrier
    v_mfma_f32_16x16x32_bf16 v[152:155], a[220:223], a[196:199], v[152:155]
    s_lshl1_add_u32 s45, s64, s66
    v_exp_f32 v236, v236
    v_mfma_f32_16x16x32_bf16 v[152:155], a[216:219], a[192:195], v[152:155]
    s_waitcnt lgkmcnt(4)
    buffer_load_dwordx4 v6, s[20:23], s49 offen nt lds
    v_mfma_f32_16x16x32_bf16 v[104:107], a[224:227], a[200:203], v[104:107]
    s_add_u32 m0, m0, s43
    ds_read_b64_tr_b16 a[216:217], v10 offset:12672
    v_fma_f32 v234, v234, s3, s3
    v_mfma_f32_16x16x32_bf16 v[104:107], a[228:231], a[204:207], v[104:107]
    s_add_u32 s49, s49, s50
    ds_read_b64_tr_b16 a[218:219], v10 offset:13184
    v_fma_f32 v236, v236, s3, s3
    v_mfma_f32_16x16x32_bf16 v[108:111], a[228:231], v[92:95], v[108:111]
    s_lshl_b32 s64, s45, 1
    ds_read_b64_tr_b16 a[220:221], v10 offset:16896
    v_mul_f32 v239, v191, v223
    v_mfma_f32_16x16x32_bf16 v[108:111], a[224:227], v[88:91], v[108:111]
    s_cmp_lt_u32 s45, 2
    s_cselect_b32 s60, 18, -4
    ds_read_b64_tr_b16 a[222:223], v10 offset:17408
    v_mfma_f32_16x16x32_bf16 v[112:115], a[224:227], a[56:59], v[112:115]
    s_add_u32 s60, s60, s64
    v_rcp_f32 v234, v234
    v_mfma_f32_16x16x32_bf16 v[112:115], a[228:231], a[60:63], v[112:115]
    s_add_u32 s64, s45, 11
    v_rcp_f32 v236, v236
    v_mfma_f32_16x16x32_bf16 v[116:119], a[228:231], a[132:135], v[116:119]
    s_cmp_ge_u32 s45, 11
    s_cselect_b32 s60, s64, s60
    v_mul_f32 v234, v234, v235
    v_mfma_f32_16x16x32_bf16 v[116:119], a[224:227], a[128:131], v[116:119]
    s_waitcnt lgkmcnt(4)
    buffer_load_dwordx4 v6, s[20:23], s49 offen nt lds
    v_mfma_f32_16x16x32_bf16 v[132:135], a[232:235], a[128:131], v[132:135]
    s_add_u32 m0, m0, s43
    ds_read_b64_tr_b16 a[224:225], v10 offset:12704
    v_cvt_pk_bf16_f32 v252, v232, v234
    v_mfma_f32_16x16x32_bf16 v[132:135], a[236:239], a[132:135], v[132:135]
    s_add_u32 s48, s39, s41
    ds_read_b64_tr_b16 a[226:227], v10 offset:13216
    v_mul_f32 v236, v236, v237
    v_mfma_f32_16x16x32_bf16 v[128:131], a[236:239], a[60:63], v[128:131]
    s_cmp_ge_u32 s45, 11
    s_cselect_b32 s64, 10368, 1
    ds_read_b64_tr_b16 a[228:229], v10 offset:16928
    v_mfma_f32_16x16x32_bf16 v[128:131], a[232:235], a[56:59], v[128:131]
    s_add_u32 s61, s60, s64
    ds_read_b64_tr_b16 a[230:231], v10 offset:17440
    v_fma_f32 v240, -v184, v184, s68
    v_mfma_f32_16x16x32_bf16 v[124:127], a[232:235], v[88:91], v[124:127]
    s_lshl_b32 s60, s60, 7
    v_exp_f32 v238, v238
    v_mfma_f32_16x16x32_bf16 v[124:127], a[236:239], v[92:95], v[124:127]
    s_lshl_b32 s61, s61, 7
    v_fma_f32 v238, v238, s3, s3
    v_mul_f32 v240, v240, v184
    v_mfma_f32_16x16x32_bf16 v[120:123], a[236:239], a[204:207], v[120:123]
    v_rcp_f32 v238, v238
    v_mfma_f32_16x16x32_bf16 v[120:123], a[232:235], a[200:203], v[120:123]
    s_waitcnt lgkmcnt(4)
    buffer_load_dwordx4 v6, s[16:19], s48 offen nt lds
    v_mfma_f32_16x16x32_bf16 v[136:139], a[216:219], a[200:203], v[136:139]
    s_add_u32 m0, m0, s43
    ds_read_b64_tr_b16 a[232:233], v10 offset:21120
    v_mul_f32 v238, v238, v239
    v_mfma_f32_16x16x32_bf16 v[136:139], a[220:223], a[204:207], v[136:139]
    s_add_u32 s48, s48, s50
    ds_read_b64_tr_b16 a[234:235], v10 offset:21632
    v_cvt_pk_bf16_f32 v253, v236, v238
    v_mfma_f32_16x16x32_bf16 v[140:143], a[220:223], v[92:95], v[140:143]
    ds_read_b64_tr_b16 a[236:237], v10 offset:25344
    v_mul_f32 v241, v184, v216
    v_mfma_f32_16x16x32_bf16 v[140:143], a[216:219], v[88:91], v[140:143]
    ds_read_b64_tr_b16 a[238:239], v10 offset:25856
    v_fma_f32 v242, -v185, v185, s68
    v_mfma_f32_16x16x32_bf16 v[144:147], a[216:219], a[56:59], v[144:147]
    s_add_u32 s75, s75, 1408
    v_exp_f32 v240, v240
    v_mfma_f32_16x16x32_bf16 v[144:147], a[220:223], a[60:63], v[144:147]
    v_fma_f32 v240, v240, s3, s3
    v_mul_f32 v242, v242, v185
    v_mfma_f32_16x16x32_bf16 v[148:151], a[220:223], a[132:135], v[148:151]
    v_rcp_f32 v240, v240
    v_mfma_f32_16x16x32_bf16 v[148:151], a[216:219], a[128:131], v[148:151]
    s_waitcnt lgkmcnt(4)
    buffer_load_dwordx4 v6, s[16:19], s48 offen nt lds
    v_mul_f32 v240, v240, v241
    v_mfma_f32_16x16x32_bf16 v[164:167], a[224:227], a[128:131], v[164:167]
    s_add_u32 m0, m0, s43
    ds_read_b64_tr_b16 a[216:217], v10 offset:21152
    v_mul_f32 v243, v185, v217
    v_mfma_f32_16x16x32_bf16 v[164:167], a[228:231], a[132:135], v[164:167]
    s_add_u32 s49, s39, s42
    ds_read_b64_tr_b16 a[218:219], v10 offset:21664
    v_fma_f32 v244, -v186, v186, s68
    v_mfma_f32_16x16x32_bf16 v[160:163], a[228:231], a[60:63], v[160:163]
    ds_read_b64_tr_b16 a[220:221], v10 offset:25376
    v_mul_f32 v244, v244, v186
    v_mfma_f32_16x16x32_bf16 v[160:163], a[224:227], a[56:59], v[160:163]
    s_mul_i32 s39, s32, s40
    ds_read_b64_tr_b16 a[222:223], v10 offset:25888
    v_mul_f32 v245, v186, v218
    v_mfma_f32_16x16x32_bf16 v[156:159], a[224:227], v[88:91], v[156:159]
    s_waitcnt vmcnt(8)
    v_exp_f32 v242, v242
    v_mfma_f32_16x16x32_bf16 v[156:159], a[228:231], v[92:95], v[156:159]
    s_barrier
    v_mfma_f32_16x16x32_bf16 v[152:155], a[228:231], a[204:207], v[152:155]
    v_exp_f32 v244, v244
    v_mfma_f32_16x16x32_bf16 v[152:155], a[224:227], a[200:203], v[152:155]
    s_waitcnt lgkmcnt(4)
    buffer_load_dwordx4 v6, s[20:23], s49 offen nt lds
    v_mfma_f32_16x16x32_bf16 v[104:107], a[232:235], a[208:211], v[104:107]
    s_add_u32 m0, m0, s43
    ds_read_b64_tr_b16 a[224:225], v10 offset:29568
    v_fma_f32 v242, v242, s3, s3
    v_mfma_f32_16x16x32_bf16 v[168:171], a[236:239], a[212:215], v[104:107]
    s_add_u32 s49, s49, s50
    ds_read_b64_tr_b16 a[226:227], v10 offset:30080
    v_fma_f32 v244, v244, s3, s3
    v_mfma_f32_16x16x32_bf16 v[108:111], a[236:239], v[100:103], v[108:111]
    ds_read_b64_tr_b16 a[228:229], v10 offset:33792
    v_fma_f32 v246, -v187, v187, s68
    v_mfma_f32_16x16x32_bf16 v[172:175], a[232:235], v[96:99], v[108:111]
    ds_read_b64_tr_b16 a[230:231], v10 offset:34304
    v_mul_f32 v246, v246, v187
    v_mfma_f32_16x16x32_bf16 v[112:115], a[232:235], a[64:67], v[112:115]
    v_rcp_f32 v242, v242
    v_mfma_f32_16x16x32_bf16 v[176:179], a[236:239], a[68:71], v[112:115]
    v_rcp_f32 v244, v244
    v_mfma_f32_16x16x32_bf16 v[116:119], a[236:239], a[140:143], v[116:119]
    v_exp_f32 v246, v246
    v_mfma_f32_16x16x32_bf16 v[180:183], a[232:235], a[136:139], v[116:119]
    s_waitcnt lgkmcnt(4)
    buffer_load_dwordx4 v6, s[20:23], s49 offen nt lds
    v_mfma_f32_16x16x32_bf16 v[132:135], a[216:219], a[136:139], v[132:135]
    s_add_u32 m0, m0, s43
    ds_read_b64_tr_b16 a[232:233], v10 offset:29600
    v_mul_f32 v242, v242, v243
    v_mfma_f32_16x16x32_bf16 v[196:199], a[220:223], a[140:143], v[132:135]
    s_add_u32 s48, s39, s41
    ds_read_b64_tr_b16 a[234:235], v10 offset:30112
    v_cvt_pk_bf16_f32 v254, v240, v242
    v_mfma_f32_16x16x32_bf16 v[128:131], a[220:223], a[68:71], v[128:131]
    ds_read_b64_tr_b16 a[236:237], v10 offset:33824
    v_mul_f32 v244, v244, v245
    v_mfma_f32_16x16x32_bf16 v[192:195], a[216:219], a[64:67], v[128:131]
    ds_read_b64_tr_b16 a[238:239], v10 offset:34336
    v_mul_f32 v247, v187, v219
    v_mfma_f32_16x16x32_bf16 v[124:127], a[216:219], v[96:99], v[124:127]
    v_fma_f32 v246, v246, s3, s3
    v_mfma_f32_16x16x32_bf16 v[188:191], a[220:223], v[100:103], v[124:127]
    v_rcp_f32 v246, v246
    v_mfma_f32_16x16x32_bf16 v[120:123], a[220:223], a[212:215], v[120:123]
    v_mul_f32 v246, v246, v247
    v_cvt_pk_bf16_f32 v255, v244, v246
    v_mfma_f32_16x16x32_bf16 v[184:187], a[216:219], a[208:211], v[120:123]
    s_waitcnt lgkmcnt(4)
    buffer_load_dwordx4 v6, s[16:19], s48 offen nt lds
    v_mfma_f32_16x16x32_bf16 v[136:139], a[224:227], a[208:211], v[136:139]
    s_add_u32 m0, m0, s43
    ds_read_b64_tr_b16 a[216:217], v9 offset:0
    v_mfma_f32_16x16x32_bf16 v[200:203], a[228:231], a[212:215], v[136:139]
    s_add_u32 s48, s48, s50
    ds_read_b64_tr_b16 a[218:219], v9 offset:512
    v_mfma_f32_16x16x32_bf16 v[140:143], a[228:231], v[100:103], v[140:143]
    ds_read_b64_tr_b16 a[220:221], v9 offset:4224
    v_mfma_f32_16x16x32_bf16 v[204:207], a[224:227], v[96:99], v[140:143]
    ds_read_b64_tr_b16 a[222:223], v9 offset:4736
    v_mfma_f32_16x16x32_bf16 v[144:147], a[224:227], a[64:67], v[144:147]
    v_mfma_f32_16x16x32_bf16 v[208:211], a[228:231], a[68:71], v[144:147]
    v_mfma_f32_16x16x32_bf16 v[148:151], a[228:231], a[140:143], v[148:151]
    v_mfma_f32_16x16x32_bf16 v[212:215], a[224:227], a[136:139], v[148:151]
    s_waitcnt lgkmcnt(4)
    buffer_load_dwordx4 v6, s[16:19], s48 offen nt lds
    v_mfma_f32_16x16x32_bf16 v[164:167], a[232:235], a[136:139], v[164:167]
    s_add_u32 m0, m0, s43
    ds_read_b64_tr_b16 a[224:225], v9 offset:32
    v_mfma_f32_16x16x32_bf16 v[228:231], a[236:239], a[140:143], v[164:167]
    s_add_u32 s49, s39, s42
    ds_read_b64_tr_b16 a[226:227], v9 offset:544
    v_mfma_f32_16x16x32_bf16 v[160:163], a[236:239], a[68:71], v[160:163]
    s_add_u32 s51, s51, 1
    ds_read_b64_tr_b16 a[228:229], v9 offset:4256
    v_mfma_f32_16x16x32_bf16 v[224:227], a[232:235], a[64:67], v[160:163]
    s_mul_i32 s39, s33, s40
    ds_read_b64_tr_b16 a[230:231], v9 offset:4768
    v_mfma_f32_16x16x32_bf16 v[156:159], a[232:235], v[96:99], v[156:159]
    s_waitcnt vmcnt(8)
    ds_write2st64_b64 v13, v[252:253], v[254:255] offset0:2 offset1:0
    v_mfma_f32_16x16x32_bf16 v[220:223], a[236:239], v[100:103], v[156:159]
    s_barrier
    v_mfma_f32_16x16x32_bf16 v[152:155], a[236:239], a[212:215], v[152:155]
    s_bitcmp1_b32 s7, s51
    v_add_u32 v13, s5, v13
    v_mfma_f32_16x16x32_bf16 v[216:219], a[232:235], a[208:211], v[152:155]
    s_waitcnt lgkmcnt(5)
    buffer_load_dwordx4 v6, s[20:23], s49 offen nt lds
    s_cbranch_scc1 L_k_u
    s_cmp_lg_u32 s51, 4
    s_cbranch_scc1 L_k_s1
    s_sub_u32 s64, s45, 2
    s_cmp_ge_u32 s64, 9
    s_cbranch_scc1 L_k_vs
    v_mfma_f32_16x16x32_bf16 v[104:107], a[216:219], a[144:147], 0
    s_add_u32 m0, m0, s43
    v_fma_f32 v232, -v168, v168, s68
    v_mul_f32 v232, v232, v168
    v_mfma_f32_16x16x32_bf16 v[104:107], a[220:223], a[148:151], v[104:107]
    s_add_u32 s49, s49, s50
    v_exp_f32 v232, v232
    v_mfma_f32_16x16x32_bf16 v[108:111], a[220:223], v[36:39], 0
    s_lshl2_add_u32 s63, s46, s44
    ds_read_b64_tr_b16 a[232:233], v9 offset:8448
    v_mul_f32 v233, v168, v200
    v_mfma_f32_16x16x32_bf16 v[108:111], a[216:219], v[32:35], v[108:111]
    s_xor_b32 s64, s63, 1
    ds_read_b64_tr_b16 a[234:235], v9 offset:8960
    v_fma_f32 v232, v232, s3, s3
    v_mfma_f32_16x16x32_bf16 v[112:115], a[216:219], a[0:3], 0
    s_mul_i32 s63, s63, 256
    ds_read_b64_tr_b16 a[236:237], v9 offset:12672
    v_fma_f32 v234, -v169, v169, s68
    v_mfma_f32_16x16x32_bf16 v[112:115], a[220:223], a[4:7], v[112:115]
    s_mul_i32 s64, s64, 256
    ds_read_b64_tr_b16 a[238:239], v9 offset:13184
    v_mul_f32 v234, v234, v169
    v_mfma_f32_16x16x32_bf16 v[116:119], a[220:223], a[76:79], 0
    s_and_b32 s65, s44, 1
    buffer_load_dwordx4 v6, s[20:23], s49 offen nt lds
    v_mfma_f32_16x16x32_bf16 v[116:119], a[216:219], a[72:75], v[116:119]
    s_waitcnt lgkmcnt(4)
    v_rcp_f32 v232, v232
    v_mfma_f32_16x16x32_bf16 v[132:135], a[224:227], a[72:75], 0
    s_add_u32 m0, m0, s43
    ds_read_b64_tr_b16 a[216:217], v9 offset:8480
    v_mul_f32 v232, v232, v233
    v_mfma_f32_16x16x32_bf16 v[132:135], a[228:231], a[76:79], v[132:135]
    s_add_u32 s48, s39, s41
    ds_read_b64_tr_b16 a[218:219], v9 offset:8992
    v_mul_f32 v235, v169, v201
    v_mfma_f32_16x16x32_bf16 v[128:131], a[228:231], a[4:7], 0
    s_lshl_b32 s65, s65, 6
    ds_read_b64_tr_b16 a[220:221], v9 offset:12704
    v_fma_f32 v236, -v170, v170, s68
    v_mfma_f32_16x16x32_bf16 v[128:131], a[224:227], a[0:3], v[128:131]
    s_add_u32 s65, s65, s60
    ds_read_b64_tr_b16 a[222:223], v9 offset:13216
    v_mul_f32 v236, v236, v170
    v_mfma_f32_16x16x32_bf16 v[124:127], a[224:227], v[32:35], 0
    s_lshl_b32 s65, s65, 11
    v_exp_f32 v234, v234
    v_mfma_f32_16x16x32_bf16 v[124:127], a[228:231], v[36:39], v[124:127]
    s_add_u32 s65, s65, 0
    v_exp_f32 v236, v236
    v_mfma_f32_16x16x32_bf16 v[120:123], a[228:231], a[148:151], 0
    s_add_u32 s76, s65, s63
    buffer_load_dwordx4 v6, s[16:19], s48 offen nt lds
    v_mfma_f32_16x16x32_bf16 v[120:123], a[224:227], a[144:147], v[120:123]
    s_waitcnt lgkmcnt(4)
    v_fma_f32 v234, v234, s3, s3
    v_mul_f32 v237, v170, v202
    v_mfma_f32_16x16x32_bf16 v[136:139], a[232:235], a[144:147], 0
    s_add_u32 m0, m0, s43
    ds_read_b64_tr_b16 a[224:225], v9 offset:16896
    v_fma_f32 v236, v236, s3, s3
    v_mfma_f32_16x16x32_bf16 v[136:139], a[236:239], a[148:151], v[136:139]
    s_add_u32 s48, s48, s50
    ds_read_b64_tr_b16 a[226:227], v9 offset:17408
    v_fma_f32 v238, -v171, v171, s68
    v_mfma_f32_16x16x32_bf16 v[140:143], a[236:239], v[36:39], 0
    s_add_u32 s77, s65, s64
    ds_read_b64_tr_b16 a[228:229], v9 offset:21120
    v_mul_f32 v238, v238, v171
    v_mfma_f32_16x16x32_bf16 v[140:143], a[232:235], v[32:35], v[140:143]
    s_add_u32 s78, s76, 65536
    ds_read_b64_tr_b16 a[230:231], v9 offset:21632
    v_mul_f32 v239, v171, v203
    v_mfma_f32_16x16x32_bf16 v[144:147], a[232:235], a[0:3], 0
    s_add_u32 s79, s77, 65536
    v_rcp_f32 v234, v234
    v_mfma_f32_16x16x32_bf16 v[144:147], a[236:239], a[4:7], v[144:147]
    s_add_u32 s80, s76, 262144
    v_rcp_f32 v236, v236
    v_mfma_f32_16x16x32_bf16 v[148:151], a[236:239], a[76:79], 0
    s_add_u32 s81, s77, 262144
    buffer_load_dwordx4 v6, s[16:19], s48 offen nt lds
    v_mfma_f32_16x16x32_bf16 v[148:151], a[232:235], a[72:75], v[148:151]
    s_waitcnt lgkmcnt(4)
    v_exp_f32 v238, v238
    v_mfma_f32_16x16x32_bf16 v[164:167], a[216:219], a[72:75], 0
    s_mov_b32 m0, s47
    ds_read_b64_tr_b16 a[232:233], v9 offset:16928
    v_mul_f32 v234, v234, v235
    v_mfma_f32_16x16x32_bf16 v[164:167], a[220:223], a[76:79], v[164:167]
    s_add_u32 s49, s39, s42
    ds_read_b64_tr_b16 a[234:235], v9 offset:17440
    v_cvt_pk_bf16_f32 v248, v232, v234
    v_mfma_f32_16x16x32_bf16 v[160:163], a[220:223], a[4:7], 0
    s_add_u32 s82, s78, 262144
    ds_read_b64_tr_b16 a[236:237], v9 offset:21152
    v_mul_f32 v236, v236, v237
    v_mfma_f32_16x16x32_bf16 v[160:163], a[216:219], a[0:3], v[160:163]
    s_mul_i32 s39, s84, s40
    ds_read_b64_tr_b16 a[238:239], v9 offset:21664
    v_fma_f32 v238, v238, s3, s3
    v_mfma_f32_16x16x32_bf16 v[156:159], a[216:219], v[32:35], 0
    s_add_u32 s83, s79, 262144
    v_rcp_f32 v238, v238
    v_mfma_f32_16x16x32_bf16 v[156:159], a[220:223], v[36:39], v[156:159]
    s_waitcnt vmcnt(8)
    v_mul_f32 v238, v238, v239
    v_cvt_pk_bf16_f32 v249, v236, v238
    v_mfma_f32_16x16x32_bf16 v[152:155], a[220:223], a[148:151], 0
    s_barrier
    buffer_load_dwordx4 v6, s[20:23], s49 offen nt lds
    v_mfma_f32_16x16x32_bf16 v[152:155], a[216:219], a[144:147], v[152:155]
    s_waitcnt lgkmcnt(4)
    v_fma_f32 v240, -v172, v172, s68
    v_mul_f32 v240, v240, v172
    v_mfma_f32_16x16x32_bf16 v[104:107], a[224:227], a[152:155], v[104:107]
    s_add_u32 m0, m0, s43
    ds_read_b64_tr_b16 a[216:217], v9 offset:25344
    v_mul_f32 v241, v172, v204
    v_mfma_f32_16x16x32_bf16 v[104:107], a[228:231], a[156:159], v[104:107]
    s_add_u32 s49, s49, s50
    ds_read_b64_tr_b16 a[218:219], v9 offset:25856
    v_fma_f32 v242, -v173, v173, s68
    v_mfma_f32_16x16x32_bf16 v[108:111], a[228:231], v[44:47], v[108:111]
    s_mov_b32 s72, 1067402027
    ds_read_b64_tr_b16 a[220:221], v9 offset:29568
    v_mul_f32 v242, v242, v173
    v_mfma_f32_16x16x32_bf16 v[108:111], a[224:227], v[40:43], v[108:111]
    ds_read_b64_tr_b16 a[222:223], v9 offset:30080
    v_mul_f32 v243, v173, v205
    v_mfma_f32_16x16x32_bf16 v[112:115], a[224:227], a[8:11], v[112:115]
    v_exp_f32 v240, v240
    v_mfma_f32_16x16x32_bf16 v[112:115], a[228:231], a[12:15], v[112:115]
    v_exp_f32 v242, v242
    v_mfma_f32_16x16x32_bf16 v[116:119], a[228:231], a[84:87], v[116:119]
    buffer_load_dwordx4 v6, s[20:23], s49 offen nt lds
    v_mfma_f32_16x16x32_bf16 v[116:119], a[224:227], a[80:83], v[116:119]
    s_waitcnt lgkmcnt(4)
    v_fma_f32 v240, v240, s3, s3
    v_fma_f32 v242, v242, s3, s3
    v_mfma_f32_16x16x32_bf16 v[132:135], a[232:235], a[80:83], v[132:135]
    s_add_u32 m0, m0, s43
    ds_read_b64_tr_b16 a[224:225], v9 offset:25376
    v_fma_f32 v244, -v174, v174, s68
    v_mfma_f32_16x16x32_bf16 v[132:135], a[236:239], a[84:87], v[132:135]
    s_add_u32 s48, s39, s41
    ds_read_b64_tr_b16 a[226:227], v9 offset:25888
    v_mul_f32 v244, v244, v174
    v_mfma_f32_16x16x32_bf16 v[128:131], a[236:239], a[12:15], v[128:131]
    ds_read_b64_tr_b16 a[228:229], v9 offset:29600
    v_mul_f32 v245, v174, v206
    v_mfma_f32_16x16x32_bf16 v[128:131], a[232:235], a[8:11], v[128:131]
    ds_read_b64_tr_b16 a[230:231], v9 offset:30112
    v_fma_f32 v246, -v175, v175, s68
    v_mfma_f32_16x16x32_bf16 v[124:127], a[232:235], v[40:43], v[124:127]
    v_rcp_f32 v240, v240
    v_mfma_f32_16x16x32_bf16 v[124:127], a[236:239], v[44:47], v[124:127]
    v_rcp_f32 v242, v242
    v_mfma_f32_16x16x32_bf16 v[120:123], a[236:239], a[156:159], v[120:123]
    buffer_load_dwordx4 v6, s[16:19], s48 offen nt lds
    v_mfma_f32_16x16x32_bf16 v[120:123], a[232:235], a[152:155], v[120:123]
    s_waitcnt lgkmcnt(4)
    v_exp_f32 v244, v244
    v_mfma_f32_16x16x32_bf16 v[136:139], a[216:219], a[152:155], v[136:139]
    s_add_u32 m0, m0, s43
    ds_read_b64_tr_b16 a[232:233], v9 offset:33792
    v_mul_f32 v240, v240, v241
    v_mfma_f32_16x16x32_bf16 v[136:139], a[220:223], a[156:159], v[136:139]
    s_add_u32 s48, s48, s50
    ds_read_b64_tr_b16 a[234:235], v9 offset:34304
    v_mul_f32 v242, v242, v243
    v_mfma_f32_16x16x32_bf16 v[140:143], a[220:223], v[44:47], v[140:143]
    ds_read_b64_tr_b16 a[236:237], v10 offset:0
    v_cvt_pk_bf16_f32 v250, v240, v242
    v_mfma_f32_16x16x32_bf16 v[140:143], a[216:219], v[40:43], v[140:143]
    ds_read_b64_tr_b16 a[238:239], v10 offset:512
    v_fma_f32 v244, v244, s3, s3
    v_mfma_f32_16x16x32_bf16 v[144:147], a[216:219], a[8:11], v[144:147]
    v_rcp_f32 v244, v244
    v_mfma_f32_16x16x32_bf16 v[144:147], a[220:223], a[12:15], v[144:147]
    v_mul_f32 v244, v244, v245
    v_mul_f32 v246, v246, v175
    v_mfma_f32_16x16x32_bf16 v[148:151], a[220:223], a[84:87], v[148:151]
    buffer_load_dwordx4 v6, s[16:19], s48 offen nt lds
    v_mfma_f32_16x16x32_bf16 v[148:151], a[216:219], a[80:83], v[148:151]
    s_waitcnt lgkmcnt(4)
    v_exp_f32 v246, v246
    v_mfma_f32_16x16x32_bf16 v[164:167], a[224:227], a[80:83], v[164:167]
    s_add_u32 m0, m0, s43
    ds_read_b64_tr_b16 a[216:217], v9 offset:33824
    v_mul_f32 v247, v175, v207
    v_mfma_f32_16x16x32_bf16 v[164:167], a[228:231], a[84:87], v[164:167]
    s_add_u32 s49, s39, s42
    ds_read_b64_tr_b16 a[218:219], v9 offset:34336
    v_fma_f32 v246, v246, s3, s3
    v_mfma_f32_16x16x32_bf16 v[160:163], a[228:231], a[12:15], v[160:163]
    ds_read_b64_tr_b16 a[220:221], v10 offset:32
    v_fma_f32 v232, -v176, v176, s68
    v_mfma_f32_16x16x32_bf16 v[160:163], a[224:227], a[8:11], v[160:163]
    s_mul_i32 s39, s85, s40
    ds_read_b64_tr_b16 a[222:223], v10 offset:544
    v_mul_f32 v232, v232, v176
    v_mfma_f32_16x16x32_bf16 v[156:159], a[224:227], v[40:43], v[156:159]
    v_rcp_f32 v246, v246
    v_mfma_f32_16x16x32_bf16 v[156:159], a[228:231], v[44:47], v[156:159]
    s_waitcnt vmcnt(8)
    v_exp_f32 v232, v232
    v_mfma_f32_16x16x32_bf16 v[152:155], a[228:231], a[156:159], v[152:155]
    s_barrier
    buffer_load_dwordx4 v6, s[20:23], s49 offen nt lds
    v_mfma_f32_16x16x32_bf16 v[152:155], a[224:227], a[152:155], v[152:155]
    s_waitcnt lgkmcnt(4)
    v_mul_f32 v246, v246, v247
    v_cvt_pk_bf16_f32 v251, v244, v246
    v_mfma_f32_16x16x32_bf16 v[104:107], a[232:235], a[160:163], v[104:107]
    s_add_u32 m0, m0, s43
    ds_read_b64_tr_b16 a[224:225], v10 offset:4224
    v_mul_f32 v233, v176, v208
    v_mfma_f32_16x16x32_bf16 v[104:107], a[236:239], a[164:167], v[104:107]
    s_add_u32 s49, s49, s50
    ds_read_b64_tr_b16 a[226:227], v10 offset:4736
    v_fma_f32 v232, v232, s3, s3
    v_mfma_f32_16x16x32_bf16 v[108:111], a[236:239], v[52:55], v[108:111]
    ds_read_b64_tr_b16 a[228:229], v10 offset:8448
    v_fma_f32 v234, -v177, v177, s68
    v_mfma_f32_16x16x32_bf16 v[108:111], a[232:235], v[48:51], v[108:111]
    ds_read_b64_tr_b16 a[230:231], v10 offset:8960
    v_mul_f32 v234, v234, v177
    v_mfma_f32_16x16x32_bf16 v[112:115], a[232:235], a[16:19], v[112:115]
    v_rcp_f32 v232, v232
    v_mfma_f32_16x16x32_bf16 v[112:115], a[236:239], a[20:23], v[112:115]
    v_exp_f32 v234, v234
    v_mfma_f32_16x16x32_bf16 v[116:119], a[236:239], a[92:95], v[116:119]
    buffer_load_dwordx4 v6, s[20:23], s49 offen nt lds
    v_mfma_f32_16x16x32_bf16 v[116:119], a[232:235], a[88:91], v[116:119]
    s_waitcnt lgkmcnt(4)
    v_mul_f32 v232, v232, v233
    v_mul_f32 v235, v177, v209
    v_mfma_f32_16x16x32_bf16 v[132:135], a[216:219], a[88:91], v[132:135]
    s_add_u32 m0, m0, s43
    ds_read_b64_tr_b16 a[232:233], v10 offset:4256
    v_fma_f32 v234, v234, s3, s3
    v_mfma_f32_16x16x32_bf16 v[132:135], a[220:223], a[92:95], v[132:135]
    s_add_u32 s48, s39, s41
    ds_read_b64_tr_b16 a[234:235], v10 offset:4768
    v_fma_f32 v236, -v178, v178, s68
    v_mfma_f32_16x16x32_bf16 v[128:131], a[220:223], a[20:23], v[128:131]
    ds_read_b64_tr_b16 a[236:237], v10 offset:8480
    v_mul_f32 v236, v236, v178
    v_mfma_f32_16x16x32_bf16 v[128:131], a[216:219], a[16:19], v[128:131]
    ds_read_b64_tr_b16 a[238:239], v10 offset:8992
    v_mul_f32 v237, v178, v210
    v_mfma_f32_16x16x32_bf16 v[124:127], a[216:219], v[48:51], v[124:127]
    ds_write2st64_b64 v12, v[248:249], v[250:251] offset0:0 offset1:2
    v_mfma_f32_16x16x32_bf16 v[124:127], a[220:223], v[52:55], v[124:127]
    v_rcp_f32 v234, v234
    v_mfma_f32_16x16x32_bf16 v[120:123], a[220:223], a[164:167], v[120:123]
    buffer_load_dwordx4 v6, s[16:19], s48 offen nt lds
    v_mfma_f32_16x16x32_bf16 v[120:123], a[216:219], a[160:163], v[120:123]
    s_waitcnt lgkmcnt(5)
    v_exp_f32 v236, v236
    v_mfma_f32_16x16x32_bf16 v[136:139], a[224:227], a[160:163], v[136:139]
    s_add_u32 m0, m0, s43
    v_mul_f32 v234, v234, v235
    v_cvt_pk_bf16_f32 v252, v232, v234
    v_mfma_f32_16x16x32_bf16 v[136:139], a[228:231], a[164:167], v[136:139]
    s_add_u32 s48, s48, s50
    v_fma_f32 v236, v236, s3, s3
    v_fma_f32 v238, -v179, v179, s68
    v_mfma_f32_16x16x32_bf16 v[140:143], a[228:231], v[52:55], v[140:143]
    ds_read_b64_tr_b16 a[216:217], v10 offset:12672
    v_mul_f32 v238, v238, v179
    v_mfma_f32_16x16x32_bf16 v[140:143], a[224:227], v[48:51], v[140:143]
    ds_read_b64_tr_b16 a[218:219], v10 offset:13184
    v_mul_f32 v239, v179, v211
    v_mfma_f32_16x16x32_bf16 v[144:147], a[224:227], a[16:19], v[144:147]
    ds_read_b64_tr_b16 a[220:221], v10 offset:16896
    v_fma_f32 v240, -v180, v180, s68
    v_mfma_f32_16x16x32_bf16 v[144:147], a[228:231], a[20:23], v[144:147]
    ds_read_b64_tr_b16 a[222:223], v10 offset:17408
    v_mul_f32 v240, v240, v180
    v_mfma_f32_16x16x32_bf16 v[148:151], a[228:231], a[92:95], v[148:151]
    buffer_load_dwordx4 v6, s[16:19], s48 offen nt lds
    v_mfma_f32_16x16x32_bf16 v[148:151], a[224:227], a[88:91], v[148:151]
    s_waitcnt lgkmcnt(5)
    v_rcp_f32 v236, v236
    v_mfma_f32_16x16x32_bf16 v[164:167], a[232:235], a[88:91], v[164:167]
    s_add_u32 m0, m0, s43
    ds_read_b64_tr_b16 a[224:225], v10 offset:12704
    v_mul_f32 v236, v236, v237
    v_mfma_f32_16x16x32_bf16 v[164:167], a[236:239], a[92:95], v[164:167]
    s_add_u32 s49, s39, s42
    ds_read_b64_tr_b16 a[226:227], v10 offset:13216
    v_mul_f32 v241, v180, v212
    v_mfma_f32_16x16x32_bf16 v[160:163], a[236:239], a[20:23], v[160:163]
    ds_read_b64_tr_b16 a[228:229], v10 offset:16928
    v_fma_f32 v242, -v181, v181, s68
    v_mfma_f32_16x16x32_bf16 v[160:163], a[232:235], a[16:19], v[160:163]
    s_mul_i32 s39, s97, s40
    ds_read_b64_tr_b16 a[230:231], v10 offset:17440
    v_mul_f32 v242, v242, v181
    v_mfma_f32_16x16x32_bf16 v[156:159], a[232:235], v[48:51], v[156:159]
    v_exp_f32 v238, v238
    v_mfma_f32_16x16x32_bf16 v[156:159], a[236:239], v[52:55], v[156:159]
    s_waitcnt vmcnt(8)
    v_exp_f32 v240, v240
    v_mfma_f32_16x16x32_bf16 v[152:155], a[236:239], a[164:167], v[152:155]
    s_barrier
    buffer_load_dwordx4 v6, s[20:23], s49 offen nt lds
    v_mfma_f32_16x16x32_bf16 v[152:155], a[232:235], a[160:163], v[152:155]
    s_waitcnt lgkmcnt(4)
    v_exp_f32 v242, v242
    v_mfma_f32_16x16x32_bf16 v[104:107], a[216:219], a[168:171], v[104:107]
    s_add_u32 m0, m0, s43
    ds_read_b64_tr_b16 a[232:233], v10 offset:21120
    v_fma_f32 v238, v238, s3, s3
    v_mfma_f32_16x16x32_bf16 v[104:107], a[220:223], a[172:175], v[104:107]
    s_add_u32 s49, s49, s50
    ds_read_b64_tr_b16 a[234:235], v10 offset:21632
    v_fma_f32 v240, v240, s3, s3
    v_mfma_f32_16x16x32_bf16 v[108:111], a[220:223], v[60:63], v[108:111]
    ds_read_b64_tr_b16 a[236:237], v10 offset:25344
    v_mul_f32 v243, v181, v213
    v_mfma_f32_16x16x32_bf16 v[108:111], a[216:219], v[56:59], v[108:111]
    ds_read_b64_tr_b16 a[238:239], v10 offset:25856
    v_fma_f32 v242, v242, s3, s3
    v_mfma_f32_16x16x32_bf16 v[112:115], a[216:219], a[24:27], v[112:115]
    v_rcp_f32 v238, v238
    v_mfma_f32_16x16x32_bf16 v[112:115], a[220:223], a[28:31], v[112:115]
    v_rcp_f32 v240, v240
    v_mfma_f32_16x16x32_bf16 v[116:119], a[220:223], a[100:103], v[116:119]
    buffer_load_dwordx4 v6, s[20:23], s49 offen nt lds
    v_mfma_f32_16x16x32_bf16 v[116:119], a[216:219], a[96:99], v[116:119]
    s_waitcnt lgkmcnt(4)
    v_rcp_f32 v242, v242
    v_mfma_f32_16x16x32_bf16 v[132:135], a[224:227], a[96:99], v[132:135]
    s_add_u32 m0, m0, s43
    ds_read_b64_tr_b16 a[216:217], v10 offset:21152
    v_mul_f32 v238, v238, v239
    v_mfma_f32_16x16x32_bf16 v[132:135], a[228:231], a[100:103], v[132:135]
    s_add_u32 s48, s39, s41
    ds_read_b64_tr_b16 a[218:219], v10 offset:21664
    v_cvt_pk_bf16_f32 v253, v236, v238
    v_mfma_f32_16x16x32_bf16 v[128:131], a[228:231], a[28:31], v[128:131]
    ds_read_b64_tr_b16 a[220:221], v10 offset:25376
    v_mul_f32 v240, v240, v241
    v_mfma_f32_16x16x32_bf16 v[128:131], a[224:227], a[24:27], v[128:131]
    ds_read_b64_tr_b16 a[222:223], v10 offset:25888
    v_mul_f32 v242, v242, v243
    v_mfma_f32_16x16x32_bf16 v[124:127], a[224:227], v[56:59], v[124:127]
    v_cvt_pk_bf16_f32 v254, v240, v242
    v_fma_f32 v244, -v182, v182, s68
    v_mfma_f32_16x16x32_bf16 v[124:127], a[228:231], v[60:63], v[124:127]
    v_mul_f32 v244, v244, v182
    v_mul_f32 v245, v182, v214
    v_mfma_f32_16x16x32_bf16 v[120:123], a[228:231], a[172:175], v[120:123]
    buffer_load_dwordx4 v6, s[16:19], s48 offen nt lds
    v_mfma_f32_16x16x32_bf16 v[120:123], a[224:227], a[168:171], v[120:123]
    s_waitcnt lgkmcnt(4)
    v_exp_f32 v244, v244
    v_mfma_f32_16x16x32_bf16 v[136:139], a[232:235], a[168:171], v[136:139]
    s_add_u32 m0, m0, s43
    ds_read_b64_tr_b16 a[224:225], v10 offset:29568
    v_fma_f32 v244, v244, s3, s3
    v_mfma_f32_16x16x32_bf16 v[136:139], a[236:239], a[172:175], v[136:139]
    s_add_u32 s48, s48, s50
    ds_read_b64_tr_b16 a[226:227], v10 offset:30080
    v_fma_f32 v246, -v183, v183, s68
    v_mfma_f32_16x16x32_bf16 v[140:143], a[236:239], v[60:63], v[140:143]
    ds_read_b64_tr_b16 a[228:229], v10 offset:33792
    v_mul_f32 v246, v246, v183
    v_mfma_f32_16x16x32_bf16 v[140:143], a[232:235], v[56:59], v[140:143]
    ds_read_b64_tr_b16 a[230:231], v10 offset:34304
    v_mul_f32 v247, v183, v215
    v_mfma_f32_16x16x32_bf16 v[144:147], a[232:235], a[24:27], v[144:147]
    v_rcp_f32 v244, v244
    v_mfma_f32_16x16x32_bf16 v[144:147], a[236:239], a[28:31], v[144:147]
    ds_read_b128 a[144:147], v16 offset:0
    v_mul_f32 v244, v244, v245
    v_mfma_f32_16x16x32_bf16 v[148:151], a[236:239], a[100:103], v[148:151]
    buffer_load_dwordx4 v6, s[16:19], s48 offen nt lds
    v_mfma_f32_16x16x32_bf16 v[148:151], a[232:235], a[96:99], v[148:151]
    s_waitcnt lgkmcnt(5)
    v_exp_f32 v246, v246
    v_mfma_f32_16x16x32_bf16 v[164:167], a[216:219], a[96:99], v[164:167]
    s_add_u32 m0, m0, s43
    ds_read_b64_tr_b16 a[232:233], v10 offset:29600
    v_fma_f32 v246, v246, s3, s3
    v_mfma_f32_16x16x32_bf16 v[164:167], a[220:223], a[100:103], v[164:167]
    s_add_u32 s49, s39, s42
    ds_read_b64_tr_b16 a[234:235], v10 offset:30112
    v_fma_f32 v232, -v196, v196, s68
    v_mfma_f32_16x16x32_bf16 v[160:163], a[220:223], a[28:31], v[160:163]
    ds_read_b64_tr_b16 a[236:237], v10 offset:33824
    v_mul_f32 v232, v232, v196
    v_mfma_f32_16x16x32_bf16 v[160:163], a[216:219], a[24:27], v[160:163]
    s_mul_i32 s39, s99, s40
    ds_read_b64_tr_b16 a[238:239], v10 offset:34336
    v_mul_f32 v233, v196, v228
    v_mfma_f32_16x16x32_bf16 v[156:159], a[216:219], v[56:59], v[156:159]
    v_rcp_f32 v246, v246
    v_mfma_f32_16x16x32_bf16 v[156:159], a[220:223], v[60:63], v[156:159]
    s_waitcnt vmcnt(8)
    ds_read_b128 a[152:155], v16 offset:8192
    v_mul_f32 v246, v246, v247
    v_mfma_f32_16x16x32_bf16 v[152:155], a[220:223], a[172:175], v[152:155]
    s_barrier
    buffer_load_dwordx4 v6, s[20:23], s49 offen nt lds
    v_mfma_f32_16x16x32_bf16 v[152:155], a[216:219], a[168:171], v[152:155]
    s_waitcnt lgkmcnt(6)
    v_exp_f32 v232, v232
    v_mfma_f32_16x16x32_bf16 v[104:107], a[224:227], a[176:179], v[104:107]
    s_add_u32 m0, m0, s43
    ds_read_b64_tr_b16 a[216:217], v9 offset:0
    v_cvt_pk_bf16_f32 v255, v244, v246
    v_mfma_f32_16x16x32_bf16 v[104:107], a[228:231], a[180:183], v[104:107]
    s_add_u32 s49, s49, s50
    ds_read_b64_tr_b16 a[218:219], v9 offset:512
    v_fma_f32 v232, v232, s3, s3
    v_mfma_f32_16x16x32_bf16 v[108:111], a[228:231], v[68:71], v[108:111]
    ds_read_b64_tr_b16 a[220:221], v9 offset:4224
    v_fma_f32 v234, -v197, v197, s68
    v_mfma_f32_16x16x32_bf16 v[108:111], a[224:227], v[64:67], v[108:111]
    ds_read_b64_tr_b16 a[222:223], v9 offset:4736
    v_mul_f32 v234, v234, v197
    v_mfma_f32_16x16x32_bf16 v[112:115], a[224:227], a[32:35], v[112:115]
    v_rcp_f32 v232, v232
    v_mfma_f32_16x16x32_bf16 v[112:115], a[228:231], a[36:39], v[112:115]
    ds_read_b128 a[160:163], v16 offset:16384
    v_mul_f32 v232, v232, v233
    v_mfma_f32_16x16x32_bf16 v[116:119], a[228:231], a[108:111], v[116:119]
    buffer_load_dwordx4 v6, s[20:23], s49 offen nt lds
    v_mfma_f32_16x16x32_bf16 v[116:119], a[224:227], a[104:107], v[116:119]
    s_waitcnt lgkmcnt(6)
    v_exp_f32 v234, v234
    v_mfma_f32_16x16x32_bf16 v[132:135], a[232:235], a[104:107], v[132:135]
    s_add_u32 m0, m0, s43
    ds_read_b64_tr_b16 a[224:225], v9 offset:32
    v_mul_f32 v235, v197, v229
    v_mfma_f32_16x16x32_bf16 v[132:135], a[236:239], a[108:111], v[132:135]
    s_add_u32 s48, s39, s41
    ds_read_b64_tr_b16 a[226:227], v9 offset:544
    v_fma_f32 v234, v234, s3, s3
    v_mfma_f32_16x16x32_bf16 v[128:131], a[236:239], a[36:39], v[128:131]
    ds_read_b64_tr_b16 a[228:229], v9 offset:4256
    v_fma_f32 v236, -v198, v198, s68
    v_mfma_f32_16x16x32_bf16 v[128:131], a[232:235], a[32:35], v[128:131]
    ds_read_b64_tr_b16 a[230:231], v9 offset:4768
    v_mul_f32 v236, v236, v198
    v_mfma_f32_16x16x32_bf16 v[124:127], a[232:235], v[64:67], v[124:127]
    ds_write2st64_b64 v14, v[252:253], v[254:255] offset0:0 offset1:2
    v_mfma_f32_16x16x32_bf16 v[124:127], a[236:239], v[68:71], v[124:127]
    v_rcp_f32 v234, v234
    v_mfma_f32_16x16x32_bf16 v[120:123], a[236:239], a[180:183], v[120:123]
    buffer_load_dwordx4 v6, s[16:19], s48 offen nt lds
    v_mfma_f32_16x16x32_bf16 v[120:123], a[232:235], a[176:179], v[120:123]
    s_waitcnt lgkmcnt(6)
    v_exp_f32 v236, v236
    v_mfma_f32_16x16x32_bf16 v[136:139], a[216:219], a[176:179], v[136:139]
    s_add_u32 m0, m0, s43
    v_mul_f32 v234, v234, v235
    v_cvt_pk_bf16_f32 v248, v232, v234
    v_mfma_f32_16x16x32_bf16 v[136:139], a[220:223], a[180:183], v[136:139]
    s_add_u32 s48, s48, s50
    v_mul_f32 v237, v198, v230
    v_fma_f32 v236, v236, s3, s3
    v_mfma_f32_16x16x32_bf16 v[140:143], a[220:223], v[68:71], v[140:143]
    ds_read_b64_tr_b16 a[232:233], v9 offset:8448
    v_fma_f32 v238, -v199, v199, s68
    v_mfma_f32_16x16x32_bf16 v[140:143], a[216:219], v[64:67], v[140:143]
    ds_read_b64_tr_b16 a[234:235], v9 offset:8960
    v_mul_f32 v238, v238, v199
    v_mfma_f32_16x16x32_bf16 v[144:147], a[216:219], a[32:35], v[144:147]
    ds_read_b64_tr_b16 a[236:237], v9 offset:12672
    v_mul_f32 v239, v199, v231
    v_mfma_f32_16x16x32_bf16 v[144:147], a[220:223], a[36:39], v[144:147]
    ds_read_b64_tr_b16 a[238:239], v9 offset:13184
    v_fma_f32 v240, -v192, v192, s68
    v_mfma_f32_16x16x32_bf16 v[148:151], a[220:223], a[108:111], v[148:151]
    buffer_load_dwordx4 v6, s[16:19], s48 offen nt lds
    v_mfma_f32_16x16x32_bf16 v[148:151], a[216:219], a[104:107], v[148:151]
    s_waitcnt lgkmcnt(5)
    ds_read_b128 v[48:51], v16 offset:17408
    v_mul_f32 v240, v240, v192
    v_mfma_f32_16x16x32_bf16 v[164:167], a[224:227], a[104:107], v[164:167]
    s_add_u32 m0, m0, s43
    ds_read_b64_tr_b16 a[216:217], v9 offset:8480
    v_mul_f32 v241, v192, v224
    v_mfma_f32_16x16x32_bf16 v[164:167], a[228:231], a[108:111], v[164:167]
    s_add_u32 s49, s39, s42
    ds_read_b64_tr_b16 a[218:219], v9 offset:8992
    v_fma_f32 v242, -v193, v193, s68
    v_mfma_f32_16x16x32_bf16 v[160:163], a[228:231], a[36:39], v[160:163]
    ds_read_b64_tr_b16 a[220:221], v9 offset:12704
    v_mul_f32 v242, v242, v193
    v_mfma_f32_16x16x32_bf16 v[160:163], a[224:227], a[32:35], v[160:163]
    s_mul_i32 s39, s36, s40
    ds_read_b64_tr_b16 a[222:223], v9 offset:13216
    v_mul_f32 v243, v193, v225
    v_mfma_f32_16x16x32_bf16 v[156:159], a[224:227], v[64:67], v[156:159]
    v_rcp_f32 v236, v236
    v_mfma_f32_16x16x32_bf16 v[156:159], a[228:231], v[68:71], v[156:159]
    s_waitcnt vmcnt(8)
    ds_read_b128 v[40:43], v16 offset:9216
    v_mul_f32 v236, v236, v237
    v_mfma_f32_16x16x32_bf16 v[152:155], a[228:231], a[180:183], v[152:155]
    s_barrier
    buffer_load_dwordx4 v6, s[20:23], s49 offen nt lds
    v_mfma_f32_16x16x32_bf16 v[152:155], a[224:227], a[176:179], v[152:155]
    s_waitcnt lgkmcnt(6)
    v_exp_f32 v238, v238
    v_mfma_f32_16x16x32_bf16 v[104:107], a[232:235], a[184:187], v[104:107]
    s_add_u32 m0, m0, s43
    ds_read_b64_tr_b16 a[224:225], v9 offset:16896
    v_fma_f32 v238, v238, s3, s3
    v_mfma_f32_16x16x32_bf16 v[104:107], a[236:239], a[188:191], v[104:107]
    s_add_u32 s49, s49, s50
    ds_read_b64_tr_b16 a[226:227], v9 offset:17408
    v_fma_f32 v244, -v194, v194, s68
    v_mfma_f32_16x16x32_bf16 v[108:111], a[236:239], v[76:79], v[108:111]
    ds_read_b64_tr_b16 a[228:229], v9 offset:21120
    v_mul_f32 v244, v244, v194
    v_mfma_f32_16x16x32_bf16 v[108:111], a[232:235], v[72:75], v[108:111]
    ds_read_b64_tr_b16 a[230:231], v9 offset:21632
    v_mul_f32 v245, v194, v226
    v_mfma_f32_16x16x32_bf16 v[112:115], a[232:235], a[40:43], v[112:115]
    v_rcp_f32 v238, v238
    v_mfma_f32_16x16x32_bf16 v[112:115], a[236:239], a[44:47], v[112:115]
    ds_read_b128 v[32:35], v16 offset:1024
    v_mul_f32 v238, v238, v239
    v_mfma_f32_16x16x32_bf16 v[116:119], a[236:239], a[116:119], v[116:119]
    buffer_load_dwordx4 v6, s[20:23], s49 offen nt lds
    v_mfma_f32_16x16x32_bf16 v[116:119], a[232:235], a[112:115], v[116:119]
    s_waitcnt lgkmcnt(6)
    v_exp_f32 v240, v240
    v_mfma_f32_16x16x32_bf16 v[132:135], a[216:219], a[112:115], v[132:135]
    s_mov_b32 m0, s47
    ds_read_b64_tr_b16 a[232:233], v9 offset:16928
    v_cvt_pk_bf16_f32 v249, v236, v238
    v_mfma_f32_16x16x32_bf16 v[132:135], a[220:223], a[116:119], v[132:135]
    s_add_u32 s69, s62, 0
    ds_read_b64_tr_b16 a[234:235], v9 offset:17440
    v_fma_f32 v240, v240, s3, s3
    v_mfma_f32_16x16x32_bf16 v[128:131], a[220:223], a[44:47], v[128:131]
    ds_read_b64_tr_b16 a[236:237], v9 offset:21152
    v_fma_f32 v246, -v195, v195, s68
    v_mfma_f32_16x16x32_bf16 v[128:131], a[216:219], a[40:43], v[128:131]
    ds_read_b64_tr_b16 a[238:239], v9 offset:21664
    v_mul_f32 v246, v246, v195
    v_mfma_f32_16x16x32_bf16 v[124:127], a[216:219], v[72:75], v[124:127]
    v_rcp_f32 v240, v240
    v_mfma_f32_16x16x32_bf16 v[124:127], a[220:223], v[76:79], v[124:127]
    v_exp_f32 v242, v242
    v_mfma_f32_16x16x32_bf16 v[120:123], a[220:223], a[188:191], v[120:123]
    buffer_load_dwordx4 v5, s[24:27], s69 offen lds
    v_mfma_f32_16x16x32_bf16 v[120:123], a[216:219], a[184:187], v[120:123]
    s_waitcnt lgkmcnt(5)
    v_exp_f32 v244, v244
    v_mfma_f32_16x16x32_bf16 v[136:139], a[224:227], a[184:187], v[136:139]
    s_add_u32 m0, m0, s43
    ds_read_b64_tr_b16 a[216:217], v9 offset:25344
    v_mul_f32 v240, v240, v241
    v_mfma_f32_16x16x32_bf16 v[136:139], a[228:231], a[188:191], v[136:139]
    s_add_u32 s69, s69, s86
    ds_read_b64_tr_b16 a[218:219], v9 offset:25856
    v_fma_f32 v242, v242, s3, s3
    v_mfma_f32_16x16x32_bf16 v[140:143], a[228:231], v[76:79], v[140:143]
    ds_read_b64_tr_b16 a[220:221], v9 offset:29568
    v_fma_f32 v244, v244, s3, s3
    v_mfma_f32_16x16x32_bf16 v[140:143], a[224:227], v[72:75], v[140:143]
    ds_read_b64_tr_b16 a[222:223], v9 offset:30080
    v_mul_f32 v247, v195, v227
    v_mfma_f32_16x16x32_bf16 v[144:147], a[224:227], a[40:43], v[144:147]
    v_rcp_f32 v242, v242
    v_mfma_f32_16x16x32_bf16 v[144:147], a[228:231], a[44:47], v[144:147]
    ds_read_b128 a[0:3], v16 offset:2048
    v_mul_f32 v242, v242, v243
    v_mfma_f32_16x16x32_bf16 v[148:151], a[228:231], a[116:119], v[148:151]
    buffer_load_dwordx4 v5, s[24:27], s69 offen lds
    v_mfma_f32_16x16x32_bf16 v[148:151], a[224:227], a[112:115], v[148:151]
    s_waitcnt lgkmcnt(5)
    v_rcp_f32 v244, v244
    v_mfma_f32_16x16x32_bf16 v[164:167], a[232:235], a[112:115], v[164:167]
    s_add_u32 m0, m0, s43
    ds_read_b64_tr_b16 a[224:225], v9 offset:25376
    v_cvt_pk_bf16_f32 v250, v240, v242
    v_mfma_f32_16x16x32_bf16 v[164:167], a[236:239], a[116:119], v[164:167]
    s_add_u32 s69, s69, s86
    ds_read_b64_tr_b16 a[226:227], v9 offset:25888
    v_mul_f32 v244, v244, v245
    v_mfma_f32_16x16x32_bf16 v[160:163], a[236:239], a[44:47], v[160:163]
    ds_read_b64_tr_b16 a[228:229], v9 offset:29600
    v_fma_f32 v232, -v188, v188, s68
    v_mfma_f32_16x16x32_bf16 v[160:163], a[232:235], a[40:43], v[160:163]
    ds_read_b64_tr_b16 a[230:231], v9 offset:30112
    v_mul_f32 v232, v232, v188
    v_mfma_f32_16x16x32_bf16 v[156:159], a[232:235], v[72:75], v[156:159]
    v_exp_f32 v246, v246
    v_mfma_f32_16x16x32_bf16 v[156:159], a[236:239], v[76:79], v[156:159]
    s_waitcnt vmcnt(8)
    ds_read_b128 a[8:11], v16 offset:10240
    v_fma_f32 v246, v246, s3, s3
    v_mfma_f32_16x16x32_bf16 v[152:155], a[236:239], a[188:191], v[152:155]
    s_barrier
    buffer_load_dwordx4 v5, s[24:27], s69 offen lds
    v_mfma_f32_16x16x32_bf16 v[152:155], a[232:235], a[184:187], v[152:155]
    s_waitcnt lgkmcnt(6)
    v_rcp_f32 v246, v246
    v_mfma_f32_16x16x32_bf16 v[104:107], a[216:219], a[192:195], v[104:107]
    s_add_u32 m0, m0, s43
    ds_read_b64_tr_b16 a[232:233], v9 offset:33792
    v_mul_f32 v246, v246, v247
    v_mfma_f32_16x16x32_bf16 v[104:107], a[220:223], a[196:199], v[104:107]
    s_add_u32 s69, s69, s86
    ds_read_b64_tr_b16 a[234:235], v9 offset:34304
    v_cvt_pk_bf16_f32 v251, v244, v246
    v_mfma_f32_16x16x32_bf16 v[108:111], a[220:223], v[84:87], v[108:111]
    ds_read_b64_tr_b16 a[236:237], v10 offset:0
    v_mul_f32 v233, v188, v220
    v_mfma_f32_16x16x32_bf16 v[108:111], a[216:219], v[80:83], v[108:111]
    ds_read_b64_tr_b16 a[238:239], v10 offset:512
    v_fma_f32 v234, -v189, v189, s68
    v_mfma_f32_16x16x32_bf16 v[112:115], a[216:219], a[48:51], v[112:115]
    v_exp_f32 v232, v232
    v_mfma_f32_16x16x32_bf16 v[112:115], a[220:223], a[52:55], v[112:115]
    ds_read_b128 a[16:19], v16 offset:18432
    v_fma_f32 v232, v232, s3, s3
    v_mfma_f32_16x16x32_bf16 v[116:119], a[220:223], a[124:127], v[116:119]
    buffer_load_dwordx4 v5, s[24:27], s69 offen lds
    v_mfma_f32_16x16x32_bf16 v[116:119], a[216:219], a[120:123], v[116:119]
    s_waitcnt lgkmcnt(6)
    v_rcp_f32 v232, v232
    v_mfma_f32_16x16x32_bf16 v[132:135], a[224:227], a[120:123], v[132:135]
    s_add_u32 m0, m0, s43
    ds_read_b64_tr_b16 a[216:217], v9 offset:33824
    v_mul_f32 v232, v232, v233
    v_mfma_f32_16x16x32_bf16 v[132:135], a[228:231], a[124:127], v[132:135]
    s_add_u32 s69, s69, s86
    ds_read_b64_tr_b16 a[218:219], v9 offset:34336
    v_mul_f32 v234, v234, v189
    v_mfma_f32_16x16x32_bf16 v[128:131], a[228:231], a[52:55], v[128:131]
    ds_read_b64_tr_b16 a[220:221], v10 offset:32
    v_mul_f32 v235, v189, v221
    v_mfma_f32_16x16x32_bf16 v[128:131], a[224:227], a[48:51], v[128:131]
    ds_read_b64_tr_b16 a[222:223], v10 offset:544
    v_fma_f32 v236, -v190, v190, s68
    v_mfma_f32_16x16x32_bf16 v[124:127], a[224:227], v[80:83], v[124:127]
    ds_write2st64_b64 v15, v[248:249], v[250:251] offset0:2 offset1:0
    v_mfma_f32_16x16x32_bf16 v[124:127], a[228:231], v[84:87], v[124:127]
    v_exp_f32 v234, v234
    v_mfma_f32_16x16x32_bf16 v[120:123], a[228:231], a[196:199], v[120:123]
    buffer_load_dwordx4 v5, s[24:27], s69 offen lds
    v_mfma_f32_16x16x32_bf16 v[120:123], a[224:227], a[192:195], v[120:123]
    s_waitcnt lgkmcnt(6)
    v_fma_f32 v234, v234, s3, s3
    v_mul_f32 v236, v236, v190
    v_mfma_f32_16x16x32_bf16 v[136:139], a[232:235], a[192:195], v[136:139]
    s_add_u32 m0, m0, s43
    v_rcp_f32 v234, v234
    v_mfma_f32_16x16x32_bf16 v[136:139], a[236:239], a[196:199], v[136:139]
    s_add_u32 s69, s69, s86
    v_exp_f32 v236, v236
    v_mfma_f32_16x16x32_bf16 v[140:143], a[236:239], v[84:87], v[140:143]
    ds_read_b64_tr_b16 a[224:225], v10 offset:4224
    v_mul_f32 v234, v234, v235
    v_mfma_f32_16x16x32_bf16 v[140:143], a[232:235], v[80:83], v[140:143]
    ds_read_b64_tr_b16 a[226:227], v10 offset:4736
    v_cvt_pk_bf16_f32 v252, v232, v234
    v_mfma_f32_16x16x32_bf16 v[144:147], a[232:235], a[48:51], v[144:147]
    ds_read_b64_tr_b16 a[228:229], v10 offset:8448
    v_mul_f32 v237, v190, v222
    v_mfma_f32_16x16x32_bf16 v[144:147], a[236:239], a[52:55], v[144:147]
    ds_read_b64_tr_b16 a[230:231], v10 offset:8960
    v_fma_f32 v236, v236, s3, s3
    v_mfma_f32_16x16x32_bf16 v[148:151], a[236:239], a[124:127], v[148:151]
    buffer_load_dwordx4 v5, s[24:27], s69 offen lds
    v_mfma_f32_16x16x32_bf16 v[148:151], a[232:235], a[120:123], v[148:151]
    s_waitcnt lgkmcnt(5)
    ds_read_b128 a[88:91], v16 offset:19456
    v_fma_f32 v238, -v191, v191, s68
    v_mfma_f32_16x16x32_bf16 v[164:167], a[216:219], a[120:123], v[164:167]
    s_add_u32 m0, m0, s43
    ds_read_b64_tr_b16 a[232:233], v10 offset:4256
    v_mul_f32 v238, v238, v191
    v_mfma_f32_16x16x32_bf16 v[164:167], a[220:223], a[124:127], v[164:167]
    s_add_u32 s69, s69, s86
    ds_read_b64_tr_b16 a[234:235], v10 offset:4768
    v_mul_f32 v239, v191, v223
    v_mfma_f32_16x16x32_bf16 v[160:163], a[220:223], a[52:55], v[160:163]
    ds_read_b64_tr_b16 a[236:237], v10 offset:8480
    v_fma_f32 v240, -v184, v184, s68
    v_mfma_f32_16x16x32_bf16 v[160:163], a[216:219], a[48:51], v[160:163]
    ds_read_b64_tr_b16 a[238:239], v10 offset:8992
    v_mul_f32 v240, v240, v184
    v_mfma_f32_16x16x32_bf16 v[156:159], a[216:219], v[80:83], v[156:159]
    v_rcp_f32 v236, v236
    v_mfma_f32_16x16x32_bf16 v[156:159], a[220:223], v[84:87], v[156:159]
    s_waitcnt vmcnt(8)
    ds_read_b128 a[80:83], v16 offset:11264
    v_mul_f32 v236, v236, v237
    v_mfma_f32_16x16x32_bf16 v[152:155], a[220:223], a[196:199], v[152:155]
    s_barrier
    buffer_load_dwordx4 v5, s[24:27], s69 offen lds
    v_mfma_f32_16x16x32_bf16 v[152:155], a[216:219], a[192:195], v[152:155]
    s_waitcnt lgkmcnt(6)
    v_exp_f32 v238, v238
    v_mfma_f32_16x16x32_bf16 v[104:107], a[224:227], a[200:203], v[104:107]
    s_add_u32 m0, m0, s43
    ds_read_b64_tr_b16 a[216:217], v10 offset:12672
    v_fma_f32 v238, v238, s3, s3
    v_mfma_f32_16x16x32_bf16 v[104:107], a[228:231], a[204:207], v[104:107]
    s_add_u32 s69, s69, s86
    ds_read_b64_tr_b16 a[218:219], v10 offset:13184
    v_mul_f32 v241, v184, v216
    v_mfma_f32_16x16x32_bf16 v[108:111], a[228:231], v[92:95], v[108:111]
    ds_read_b64_tr_b16 a[220:221], v10 offset:16896
    v_fma_f32 v242, -v185, v185, s68
    v_mfma_f32_16x16x32_bf16 v[108:111], a[224:227], v[88:91], v[108:111]
    ds_read_b64_tr_b16 a[222:223], v10 offset:17408
    v_mul_f32 v242, v242, v185
    v_mfma_f32_16x16x32_bf16 v[112:115], a[224:227], a[56:59], v[112:115]
    v_rcp_f32 v238, v238
    v_mfma_f32_16x16x32_bf16 v[112:115], a[228:231], a[60:63], v[112:115]
    ds_read_b128 a[72:75], v16 offset:3072
    v_mul_f32 v238, v238, v239
    v_mfma_f32_16x16x32_bf16 v[116:119], a[228:231], a[132:135], v[116:119]
    buffer_load_dwordx4 v5, s[24:27], s69 offen lds
    v_mfma_f32_16x16x32_bf16 v[116:119], a[224:227], a[128:131], v[116:119]
    s_waitcnt lgkmcnt(6)
    v_exp_f32 v240, v240
    v_mfma_f32_16x16x32_bf16 v[132:135], a[232:235], a[128:131], v[132:135]
    s_add_u32 m0, m0, s43
    ds_read_b64_tr_b16 a[224:225], v10 offset:12704
    v_cvt_pk_bf16_f32 v253, v236, v238
    v_mfma_f32_16x16x32_bf16 v[132:135], a[236:239], a[132:135], v[132:135]
    s_add_u32 s69, s69, s86
    ds_read_b64_tr_b16 a[226:227], v10 offset:13216
    v_fma_f32 v240, v240, s3, s3
    v_mfma_f32_16x16x32_bf16 v[128:131], a[236:239], a[60:63], v[128:131]
    ds_read_b64_tr_b16 a[228:229], v10 offset:16928
    v_mul_f32 v243, v185, v217
    v_mfma_f32_16x16x32_bf16 v[128:131], a[232:235], a[56:59], v[128:131]
    ds_read_b64_tr_b16 a[230:231], v10 offset:17440
    v_fma_f32 v244, -v186, v186, s68
    v_mfma_f32_16x16x32_bf16 v[124:127], a[232:235], v[88:91], v[124:127]
    v_rcp_f32 v240, v240
    v_mfma_f32_16x16x32_bf16 v[124:127], a[236:239], v[92:95], v[124:127]
    v_exp_f32 v242, v242
    v_mfma_f32_16x16x32_bf16 v[120:123], a[236:239], a[204:207], v[120:123]
    buffer_load_dwordx4 v5, s[24:27], s69 offen lds
    v_mfma_f32_16x16x32_bf16 v[120:123], a[232:235], a[200:203], v[120:123]
    s_waitcnt lgkmcnt(5)
    v_mul_f32 v240, v240, v241
    v_fma_f32 v242, v242, s3, s3
    v_mfma_f32_16x16x32_bf16 v[136:139], a[216:219], a[200:203], v[136:139]
    s_add_u32 m0, m0, s43
    ds_read_b64_tr_b16 a[232:233], v10 offset:21120
    v_mul_f32 v244, v244, v186
    v_mfma_f32_16x16x32_bf16 v[136:139], a[220:223], a[204:207], v[136:139]
    s_add_u32 s69, s62, 128
    ds_read_b64_tr_b16 a[234:235], v10 offset:21632
    v_mul_f32 v245, v186, v218
    v_mfma_f32_16x16x32_bf16 v[140:143], a[220:223], v[92:95], v[140:143]
    ds_read_b64_tr_b16 a[236:237], v10 offset:25344
    v_fma_f32 v246, -v187, v187, s68
    v_mfma_f32_16x16x32_bf16 v[140:143], a[216:219], v[88:91], v[140:143]
    ds_read_b64_tr_b16 a[238:239], v10 offset:25856
    v_mul_f32 v246, v246, v187
    v_mfma_f32_16x16x32_bf16 v[144:147], a[216:219], a[56:59], v[144:147]
    ds_read_b128 a[148:151], v16 offset:4096
    v_mul_f32 v247, v187, v219
    v_mfma_f32_16x16x32_bf16 v[144:147], a[220:223], a[60:63], v[144:147]
    v_rcp_f32 v242, v242
    v_mfma_f32_16x16x32_bf16 v[148:151], a[220:223], a[132:135], v[148:151]
    buffer_load_dwordx4 v5, s[24:27], s69 offen lds
    v_mfma_f32_16x16x32_bf16 v[148:151], a[216:219], a[128:131], v[148:151]
    s_waitcnt lgkmcnt(5)
    ds_read_b128 a[156:159], v16 offset:12288
    v_mul_f32 v242, v242, v243
    v_mfma_f32_16x16x32_bf16 v[164:167], a[224:227], a[128:131], v[164:167]
    s_add_u32 m0, m0, s43
    ds_read_b64_tr_b16 a[216:217], v10 offset:21152
    v_cvt_pk_bf16_f32 v254, v240, v242
    v_mfma_f32_16x16x32_bf16 v[164:167], a[228:231], a[132:135], v[164:167]
    s_add_u32 s69, s69, s86
    ds_read_b64_tr_b16 a[218:219], v10 offset:21664
    v_lshrrev_b32 v20, 4, v29
    v_mfma_f32_16x16x32_bf16 v[160:163], a[228:231], a[60:63], v[160:163]
    ds_read_b64_tr_b16 a[220:221], v10 offset:25376
    v_mul_u32_u24 v20, 16128, v20
    v_mfma_f32_16x16x32_bf16 v[160:163], a[224:227], a[56:59], v[160:163]
    ds_read_b64_tr_b16 a[222:223], v10 offset:25888
    v_add_u32 v20, v20, v1
    v_mfma_f32_16x16x32_bf16 v[156:159], a[224:227], v[88:91], v[156:159]
    ds_read_b128 a[164:167], v16 offset:20480
    v_mfma_f32_16x16x32_bf16 v[156:159], a[228:231], v[92:95], v[156:159]
    s_waitcnt vmcnt(7)
    v_exp_f32 v244, v244
    v_mfma_f32_16x16x32_bf16 v[152:155], a[228:231], a[204:207], v[152:155]
    s_barrier
    buffer_load_dwordx4 v5, s[24:27], s69 offen lds
    v_mfma_f32_16x16x32_bf16 v[152:155], a[224:227], a[200:203], v[152:155]
    s_waitcnt lgkmcnt(7)
    ds_read_b128 v[52:55], v16 offset:21504
    v_fma_f32 v244, v244, s3, s3
    v_mfma_f32_16x16x32_bf16 v[104:107], a[232:235], a[208:211], v[104:107]
    s_add_u32 m0, m0, s43
    ds_read_b64_tr_b16 a[224:225], v10 offset:29568
    v_mfma_f32_16x16x32_bf16 v[168:171], a[236:239], a[212:215], v[104:107]
    s_add_u32 s69, s69, s86
    ds_read_b64_tr_b16 a[226:227], v10 offset:30080
    v_mfma_f32_16x16x32_bf16 v[108:111], a[236:239], v[100:103], v[108:111]
    ds_read_b64_tr_b16 a[228:229], v10 offset:33792
    v_mfma_f32_16x16x32_bf16 v[172:175], a[232:235], v[96:99], v[108:111]
    ds_read_b64_tr_b16 a[230:231], v10 offset:34304
    v_mfma_f32_16x16x32_bf16 v[112:115], a[232:235], a[64:67], v[112:115]
    ds_read_b128 v[44:47], v16 offset:13312
    v_mfma_f32_16x16x32_bf16 v[176:179], a[236:239], a[68:71], v[112:115]
    v_rcp_f32 v244, v244
    v_mfma_f32_16x16x32_bf16 v[116:119], a[236:239], a[140:143], v[116:119]
    buffer_load_dwordx4 v5, s[24:27], s69 offen lds
    v_mfma_f32_16x16x32_bf16 v[180:183], a[232:235], a[136:139], v[116:119]
    s_waitcnt lgkmcnt(7)
    ds_read_b128 v[36:39], v16 offset:5120
    v_mul_f32 v244, v244, v245
    v_mfma_f32_16x16x32_bf16 v[132:135], a[216:219], a[136:139], v[132:135]
    s_add_u32 m0, m0, s43
    ds_read_b64_tr_b16 a[232:233], v10 offset:29600
    v_mfma_f32_16x16x32_bf16 v[196:199], a[220:223], a[140:143], v[132:135]
    s_add_u32 s69, s69, s86
    ds_read_b64_tr_b16 a[234:235], v10 offset:30112
    v_mfma_f32_16x16x32_bf16 v[128:131], a[220:223], a[68:71], v[128:131]
    ds_read_b64_tr_b16 a[236:237], v10 offset:33824
    v_mfma_f32_16x16x32_bf16 v[192:195], a[216:219], a[64:67], v[128:131]
    ds_read_b64_tr_b16 a[238:239], v10 offset:34336
    v_mfma_f32_16x16x32_bf16 v[124:127], a[216:219], v[96:99], v[124:127]
    ds_read_b128 a[4:7], v16 offset:6144
    v_mfma_f32_16x16x32_bf16 v[188:191], a[220:223], v[100:103], v[124:127]
    v_exp_f32 v246, v246
    v_mfma_f32_16x16x32_bf16 v[120:123], a[220:223], a[212:215], v[120:123]
    buffer_load_dwordx4 v5, s[24:27], s69 offen lds
    v_mfma_f32_16x16x32_bf16 v[184:187], a[216:219], a[208:211], v[120:123]
    s_waitcnt lgkmcnt(7)
    ds_read_b128 a[12:15], v16 offset:14336
    v_fma_f32 v246, v246, s3, s3
    v_mfma_f32_16x16x32_bf16 v[136:139], a[224:227], a[208:211], v[136:139]
    s_add_u32 m0, m0, s43
    ds_read_b64_tr_b16 a[216:217], v11 offset:0
    v_mfma_f32_16x16x32_bf16 v[200:203], a[228:231], a[212:215], v[136:139]
    s_add_u32 s69, s69, s86
    ds_read_b64_tr_b16 a[218:219], v11 offset:2112
    v_mfma_f32_16x16x32_bf16 v[140:143], a[228:231], v[100:103], v[140:143]
    ds_read_b64_tr_b16 a[220:221], v11 offset:4224
    v_mfma_f32_16x16x32_bf16 v[204:207], a[224:227], v[96:99], v[140:143]
    ds_read_b64_tr_b16 a[222:223], v11 offset:6336
    v_mfma_f32_16x16x32_bf16 v[144:147], a[224:227], a[64:67], v[144:147]
    ds_read_b128 a[20:23], v16 offset:22528
    v_mfma_f32_16x16x32_bf16 v[208:211], a[228:231], a[68:71], v[144:147]
    v_rcp_f32 v246, v246
    v_mfma_f32_16x16x32_bf16 v[148:151], a[228:231], a[140:143], v[148:151]
    buffer_load_dwordx4 v5, s[24:27], s69 offen lds
    v_mfma_f32_16x16x32_bf16 v[212:215], a[224:227], a[136:139], v[148:151]
    s_waitcnt lgkmcnt(7)
    ds_read_b128 a[92:95], v16 offset:23552
    v_mul_f32 v246, v246, v247
    v_mfma_f32_16x16x32_bf16 v[164:167], a[232:235], a[136:139], v[164:167]
    s_add_u32 m0, m0, s43
    ds_read_b64_tr_b16 a[224:225], v11 offset:8448
    v_cvt_pk_bf16_f32 v255, v244, v246
    v_mfma_f32_16x16x32_bf16 v[228:231], a[236:239], a[140:143], v[164:167]
    s_add_u32 s69, s69, s86
    ds_read_b64_tr_b16 a[226:227], v11 offset:10560
    v_mfma_f32_16x16x32_bf16 v[160:163], a[236:239], a[68:71], v[160:163]
    ds_read_b128 a[84:87], v16 offset:15360
    v_mfma_f32_16x16x32_bf16 v[224:227], a[232:235], a[64:67], v[160:163]
    ds_read_b128 a[76:79], v16 offset:7168
    v_mfma_f32_16x16x32_bf16 v[156:159], a[232:235], v[96:99], v[156:159]
    s_waitcnt lgkmcnt(6)
    ds_write2st64_b64 v13, v[252:253], v[254:255] offset0:2 offset1:0
    v_mfma_f32_16x16x32_bf16 v[220:223], a[236:239], v[100:103], v[156:159]
    s_waitcnt vmcnt(8)
    v_mfma_f32_16x16x32_bf16 v[152:155], a[236:239], a[212:215], v[152:155]
    s_barrier
    buffer_load_dwordx4 v5, s[24:27], s69 offen lds
    v_mfma_f32_16x16x32_bf16 v[216:219], a[232:235], a[208:211], v[152:155]
L_k_d:
    v_mfma_f32_16x16x32_bf16 v[104:107], a[216:219], a[144:147], 0
    s_waitcnt lgkmcnt(6)
    s_add_u32 m0, m0, s43
    ds_read_b64_tr_b16 a[228:229], v11 offset:12672
    v_mfma_f32_16x16x32_bf16 v[104:107], a[220:223], a[152:155], v[104:107]
    s_waitcnt lgkmcnt(3)
    s_add_u32 s69, s69, s86
    ds_read_b64_tr_b16 a[230:231], v11 offset:14784
    ds_read_b128 a[168:171], v16 offset:24576
    v_mfma_f32_16x16x32_bf16 v[104:107], a[224:227], a[160:163], v[104:107]
    ds_read_b128 a[176:179], v16 offset:32768
    v_mfma_f32_16x16x32_bf16 v[108:111], a[224:227], v[48:51], 0
    ds_read_b128 a[184:187], v16 offset:40960
    v_mfma_f32_16x16x32_bf16 v[108:111], a[220:223], v[40:43], v[108:111]
    ds_read_b64_tr_b16 a[232:233], v11 offset:16896
    ds_read_b128 v[72:75], v16 offset:41984
    v_mfma_f32_16x16x32_bf16 v[108:111], a[216:219], v[32:35], v[108:111]
    ds_read_b64_tr_b16 a[234:235], v11 offset:19008
    v_mfma_f32_16x16x32_bf16 v[112:115], a[216:219], a[0:3], 0
    ds_read_b128 v[64:67], v16 offset:33792
    v_mfma_f32_16x16x32_bf16 v[112:115], a[220:223], a[8:11], v[112:115]
    buffer_load_dwordx4 v5, s[24:27], s69 offen lds
    v_mfma_f32_16x16x32_bf16 v[112:115], a[224:227], a[16:19], v[112:115]
    s_add_u32 m0, m0, s43
    ds_read_b64_tr_b16 a[236:237], v11 offset:21120
    ds_read_b128 v[56:59], v16 offset:25600
    v_mfma_f32_16x16x32_bf16 v[116:119], a[224:227], a[88:91], 0
    s_add_u32 s69, s69, s86
    ds_read_b64_tr_b16 a[238:239], v11 offset:23232
    ds_read_b128 a[24:27], v16 offset:26624
    v_mfma_f32_16x16x32_bf16 v[116:119], a[220:223], a[80:83], v[116:119]
    ds_read_b128 a[32:35], v16 offset:34816
    v_mul_f32 v168, s72, v168
    v_mfma_f32_16x16x32_bf16 v[116:119], a[216:219], a[72:75], v[116:119]
    ds_read_b128 a[40:43], v16 offset:43008
    v_mul_f32 v169, s72, v169
    v_mfma_f32_16x16x32_bf16 v[120:123], a[216:219], a[148:151], 0
    ds_read_b128 a[112:115], v16 offset:44032
    v_cvt_pk_bf16_f32 v168, v168, v169
    v_mfma_f32_16x16x32_bf16 v[120:123], a[220:223], a[156:159], v[120:123]
    ds_read_b128 a[104:107], v16 offset:35840
    v_mul_f32 v170, s72, v170
    v_mfma_f32_16x16x32_bf16 v[120:123], a[224:227], a[164:167], v[120:123]
    ds_read_b128 a[96:99], v16 offset:27648
    v_mul_f32 v171, s72, v171
    v_mfma_f32_16x16x32_bf16 v[124:127], a[224:227], v[52:55], 0
    buffer_load_dwordx4 v5, s[24:27], s69 offen lds
    v_mfma_f32_16x16x32_bf16 v[124:127], a[220:223], v[44:47], v[124:127]
    s_add_u32 m0, m0, s43
    ds_read_b128 a[172:175], v16 offset:28672
    v_cvt_pk_bf16_f32 v169, v170, v171
    v_mfma_f32_16x16x32_bf16 v[124:127], a[216:219], v[36:39], v[124:127]
    s_add_u32 s69, s69, s86
    ds_read_b128 a[180:183], v16 offset:36864
    v_mfma_f32_16x16x32_bf16 v[128:131], a[216:219], a[4:7], 0
    ds_read_b128 a[188:191], v16 offset:45056
    v_mul_f32 v172, s72, v172
    v_mfma_f32_16x16x32_bf16 v[128:131], a[220:223], a[12:15], v[128:131]
    ds_read_b128 v[76:79], v16 offset:46080
    v_mul_f32 v173, s72, v173
    v_mfma_f32_16x16x32_bf16 v[128:131], a[224:227], a[20:23], v[128:131]
    s_waitcnt lgkmcnt(10)
    ds_read_b128 v[68:71], v16 offset:37888
    v_cvt_pk_bf16_f32 v170, v172, v173
    v_mfma_f32_16x16x32_bf16 v[132:135], a[224:227], a[92:95], 0
    s_waitcnt vmcnt(8)
    ds_read_b128 v[60:63], v16 offset:29696
    v_mfma_f32_16x16x32_bf16 v[132:135], a[220:223], a[84:87], v[132:135]
    s_barrier
    ds_read_b128 a[28:31], v16 offset:30720
    v_mfma_f32_16x16x32_bf16 v[132:135], a[216:219], a[76:79], v[132:135]
    buffer_load_dwordx4 v5, s[24:27], s69 offen lds
    v_mfma_f32_16x16x32_bf16 v[104:107], a[228:231], a[168:171], v[104:107]
    s_mov_b32 m0, s47
    ds_read_b64_tr_b16 a[216:217], v11 offset:25344
    ds_read_b128 a[36:39], v16 offset:38912
    v_mfma_f32_16x16x32_bf16 v[104:107], a[232:235], a[176:179], v[104:107]
    s_add_u32 s69, s62, 256
    ds_read_b64_tr_b16 a[218:219], v11 offset:27456
    ds_read_b128 a[44:47], v16 offset:47104
    v_mfma_f32_16x16x32_bf16 v[104:107], a[236:239], a[184:187], v[104:107]
    ds_read_b128 a[116:119], v16 offset:48128
    v_mul_f32 v174, s72, v174
    v_mfma_f32_16x16x32_bf16 v[108:111], a[236:239], v[72:75], v[108:111]
    ds_read_b128 a[108:111], v16 offset:39936
    v_mul_f32 v175, s72, v175
    v_mfma_f32_16x16x32_bf16 v[108:111], a[232:235], v[64:67], v[108:111]
    ds_read_b64_tr_b16 a[220:221], v11 offset:29568
    ds_read_b128 a[100:103], v16 offset:31744
    v_mfma_f32_16x16x32_bf16 v[108:111], a[228:231], v[56:59], v[108:111]
    s_waitcnt lgkmcnt(15)
    ds_read_b64_tr_b16 a[222:223], v11 offset:31680
    v_cvt_pk_bf16_f32 v171, v174, v175
    v_mfma_f32_16x16x32_bf16 v[112:115], a[228:231], a[24:27], v[112:115]
    ds_read_b128 a[192:195], v17 offset:8192
    v_mul_f32 v176, s72, v176
    v_mfma_f32_16x16x32_bf16 v[112:115], a[232:235], a[32:35], v[112:115]
    buffer_load_dwordx4 v5, s[24:27], s69 offen lds
    v_mfma_f32_16x16x32_bf16 v[112:115], a[236:239], a[40:43], v[112:115]
    s_add_u32 m0, m0, s43
    ds_read_b64_tr_b16 a[224:225], v11 offset:33792
    ds_read_b128 a[200:203], v17 offset:16384
    v_mfma_f32_16x16x32_bf16 v[116:119], a[236:239], a[112:115], v[116:119]
    s_add_u32 s69, s69, s86
    ds_read_b64_tr_b16 a[226:227], v11 offset:35904
    ds_read_b128 a[208:211], v17 offset:24576
    v_mfma_f32_16x16x32_bf16 v[116:119], a[232:235], a[104:107], v[116:119]
    ds_read_b128 v[96:99], v17 offset:25600
    v_mul_f32 v177, s72, v177
    v_mfma_f32_16x16x32_bf16 v[116:119], a[228:231], a[96:99], v[116:119]
    s_waitcnt lgkmcnt(15)
    ds_read_b128 v[88:91], v17 offset:17408
    v_cvt_pk_bf16_f32 v176, v176, v177
    v_mfma_f32_16x16x32_bf16 v[120:123], a[228:231], a[172:175], v[120:123]
    ds_read_b128 v[80:83], v17 offset:9216
    v_mul_f32 v178, s72, v178
    v_mfma_f32_16x16x32_bf16 v[120:123], a[232:235], a[180:183], v[120:123]
    ds_read_b128 a[48:51], v17 offset:10240
    v_mul_f32 v179, s72, v179
    v_mfma_f32_16x16x32_bf16 v[120:123], a[236:239], a[188:191], v[120:123]
    ds_read_b128 a[56:59], v17 offset:18432
    v_cvt_pk_bf16_f32 v177, v178, v179
    v_mfma_f32_16x16x32_bf16 v[124:127], a[236:239], v[76:79], v[124:127]
    buffer_load_dwordx4 v5, s[24:27], s69 offen lds
    v_mfma_f32_16x16x32_bf16 v[124:127], a[232:235], v[68:71], v[124:127]
    s_add_u32 m0, m0, s43
    ds_read_b128 a[64:67], v17 offset:26624
    v_mul_f32 v180, s72, v180
    v_mfma_f32_16x16x32_bf16 v[124:127], a[228:231], v[60:63], v[124:127]
    s_waitcnt lgkmcnt(15)
    s_add_u32 s69, s69, s86
    ds_read_b128 a[136:139], v17 offset:27648
    v_mfma_f32_16x16x32_bf16 v[128:131], a[228:231], a[28:31], v[128:131]
    ds_read_b128 a[128:131], v17 offset:19456
    v_mul_f32 v181, s72, v181
    v_mfma_f32_16x16x32_bf16 v[128:131], a[232:235], a[36:39], v[128:131]
    ds_read_b128 a[120:123], v17 offset:11264
    v_cvt_pk_bf16_f32 v178, v180, v181
    v_mfma_f32_16x16x32_bf16 v[128:131], a[236:239], a[44:47], v[128:131]
    s_waitcnt lgkmcnt(10)
    ds_read_b128 a[196:199], v17 offset:12288
    v_mul_f32 v182, s72, v182
    v_mfma_f32_16x16x32_bf16 v[132:135], a[236:239], a[116:119], v[132:135]
    s_waitcnt vmcnt(5)
    ds_read_b128 a[204:207], v17 offset:20480
    v_mfma_f32_16x16x32_bf16 v[132:135], a[232:235], a[108:111], v[132:135]
    s_barrier
    v_mfma_f32_16x16x32_bf16 v[132:135], a[228:231], a[100:103], v[132:135]
    buffer_load_dwordx4 v5, s[24:27], s69 offen lds
    v_mfma_f32_16x16x32_bf16 v[104:107], a[216:219], a[192:195], v[104:107]
    s_add_u32 m0, m0, s43
    ds_read_b64_tr_b16 a[228:229], v25 offset:0
    ds_read_b128 a[212:215], v17 offset:28672
    v_mfma_f32_16x16x32_bf16 v[104:107], a[220:223], a[200:203], v[104:107]
    s_waitcnt lgkmcnt(12)
    s_add_u32 s69, s69, s86
    ds_read_b64_tr_b16 a[230:231], v25 offset:2112
    ds_read_b128 v[100:103], v17 offset:29696
    v_mfma_f32_16x16x32_bf16 v[136:139], a[224:227], a[208:211], v[104:107]
    ds_read_b128 v[92:95], v17 offset:21504
    v_mul_f32 v183, s72, v183
    v_mfma_f32_16x16x32_bf16 v[108:111], a[224:227], v[96:99], v[108:111]
    s_waitcnt lgkmcnt(13)
    ds_read_b128 v[84:87], v17 offset:13312
    v_cvt_pk_bf16_f32 v179, v182, v183
    v_mfma_f32_16x16x32_bf16 v[108:111], a[220:223], v[88:91], v[108:111]
    ds_read_b64_tr_b16 a[232:233], v25 offset:4224
    ds_read_b128 a[52:55], v17 offset:14336
    v_mfma_f32_16x16x32_bf16 v[140:143], a[216:219], v[80:83], v[108:111]
    s_waitcnt lgkmcnt(14)
    ds_read_b64_tr_b16 a[234:235], v25 offset:6336
    ds_read_b128 a[60:63], v17 offset:22528
    v_mfma_f32_16x16x32_bf16 v[112:115], a[216:219], a[48:51], v[112:115]
    ds_read_b128 a[68:71], v17 offset:30720
    v_mul_f32 v184, s72, v184
    v_mfma_f32_16x16x32_bf16 v[112:115], a[220:223], a[56:59], v[112:115]
    s_waitcnt lgkmcnt(15)
    buffer_load_dwordx4 v5, s[24:27], s69 offen lds
    v_mfma_f32_16x16x32_bf16 v[144:147], a[224:227], a[64:67], v[112:115]
    s_add_u32 m0, m0, s43
    ds_read_b64_tr_b16 a[236:237], v25 offset:8448
    ds_read_b128 a[140:143], v17 offset:31744
    v_mfma_f32_16x16x32_bf16 v[116:119], a[224:227], a[136:139], v[116:119]
    s_waitcnt lgkmcnt(15)
    s_add_u32 s69, s69, s86
    ds_read_b64_tr_b16 a[238:239], v25 offset:10560
    ds_read_b128 a[132:135], v17 offset:23552
    v_mfma_f32_16x16x32_bf16 v[116:119], a[220:223], a[128:131], v[116:119]
    ds_read_b128 a[124:127], v17 offset:15360
    v_mul_f32 v185, s72, v185
    v_mfma_f32_16x16x32_bf16 v[148:151], a[216:219], a[120:123], v[116:119]
    s_waitcnt lgkmcnt(15)
    v_cvt_pk_bf16_f32 v184, v184, v185
    v_mul_f32 v186, s72, v186
    v_mfma_f32_16x16x32_bf16 v[120:123], a[216:219], a[196:199], v[120:123]
    buffer_store_dwordx4 v[168:171], v20, s[12:15], s76 offen sc1
    v_mfma_f32_16x16x32_bf16 v[120:123], a[220:223], a[204:207], v[120:123]
    s_waitcnt lgkmcnt(12)
    v_cvt_pk_bf16_f32 v232, v136, v137
    v_cvt_pk_bf16_f32 v233, v138, v139
    v_mfma_f32_16x16x32_bf16 v[152:155], a[224:227], a[212:215], v[120:123]
    v_cvt_pk_bf16_f32 v234, v140, v141
    v_cvt_pk_bf16_f32 v235, v142, v143
    v_mfma_f32_16x16x32_bf16 v[124:127], a[224:227], v[100:103], v[124:127]
    s_waitcnt lgkmcnt(10)
    buffer_load_dwordx4 v5, s[24:27], s69 offen lds
    v_mfma_f32_16x16x32_bf16 v[124:127], a[220:223], v[92:95], v[124:127]
    s_add_u32 m0, m0, s43
    v_mul_f32 v187, s72, v187
    v_cvt_pk_bf16_f32 v185, v186, v187
    v_mfma_f32_16x16x32_bf16 v[156:159], a[216:219], v[84:87], v[124:127]
    s_waitcnt lgkmcnt(6)
    s_add_u32 s69, s69, s86
    v_mul_f32 v188, s72, v188
    v_mfma_f32_16x16x32_bf16 v[128:131], a[216:219], a[52:55], v[128:131]
    v_mul_f32 v189, s72, v189
    v_cvt_pk_bf16_f32 v186, v188, v189
    v_mfma_f32_16x16x32_bf16 v[128:131], a[220:223], a[60:63], v[128:131]
    s_waitcnt lgkmcnt(3)
    v_mul_f32 v190, s72, v190
    v_mul_f32 v191, s72, v191
    v_mfma_f32_16x16x32_bf16 v[160:163], a[224:227], a[68:71], v[128:131]
    s_waitcnt lgkmcnt(2)
    v_cvt_pk_bf16_f32 v187, v190, v191
    v_cvt_pk_bf16_f32 v236, v144, v145
    v_mfma_f32_16x16x32_bf16 v[132:135], a[224:227], a[140:143], v[132:135]
    s_waitcnt lgkmcnt(0)
    v_cvt_pk_bf16_f32 v237, v146, v147
    v_cvt_pk_bf16_f32 v238, v148, v149
    v_mfma_f32_16x16x32_bf16 v[132:135], a[220:223], a[132:135], v[132:135]
    v_cvt_pk_bf16_f32 v239, v150, v151
    v_mul_f32 v192, s72, v192
    v_mfma_f32_16x16x32_bf16 v[164:167], a[216:219], a[124:127], v[132:135]
    buffer_load_dwordx4 v5, s[24:27], s69 offen lds
    v_mfma_f32_16x16x32_bf16 v[104:107], a[228:231], a[144:147], 0
    s_add_u32 m0, m0, s43
    ds_read_b64_tr_b16 a[216:217], v25 offset:12672
    v_mul_f32 v193, s72, v193
    v_mfma_f32_16x16x32_bf16 v[104:107], a[232:235], a[152:155], v[104:107]
    s_add_u32 s69, s69, s86
    ds_read_b64_tr_b16 a[218:219], v25 offset:14784
    v_cvt_pk_bf16_f32 v240, v152, v153
    v_mfma_f32_16x16x32_bf16 v[104:107], a[236:239], a[160:163], v[104:107]
    v_cvt_pk_bf16_f32 v241, v154, v155
    v_cvt_pk_bf16_f32 v242, v156, v157
    v_mfma_f32_16x16x32_bf16 v[108:111], a[236:239], v[48:51], 0
    v_cvt_pk_bf16_f32 v243, v158, v159
    v_cvt_pk_bf16_f32 v192, v192, v193
    v_mfma_f32_16x16x32_bf16 v[108:111], a[232:235], v[40:43], v[108:111]
    ds_read_b64_tr_b16 a[220:221], v25 offset:16896
    v_mul_f32 v194, s72, v194
    v_mfma_f32_16x16x32_bf16 v[108:111], a[228:231], v[32:35], v[108:111]
    ds_read_b64_tr_b16 a[222:223], v25 offset:19008
    v_mul_f32 v195, s72, v195
    v_mfma_f32_16x16x32_bf16 v[112:115], a[228:231], a[0:3], 0
    v_cvt_pk_bf16_f32 v193, v194, v195
    v_mul_f32 v196, s72, v196
    v_mfma_f32_16x16x32_bf16 v[112:115], a[232:235], a[8:11], v[112:115]
    buffer_load_dwordx4 v5, s[24:27], s69 offen lds
    v_mfma_f32_16x16x32_bf16 v[112:115], a[236:239], a[16:19], v[112:115]
    s_add_u32 m0, m0, s43
    ds_read_b64_tr_b16 a[224:225], v25 offset:21120
    v_mul_f32 v197, s72, v197
    v_mfma_f32_16x16x32_bf16 v[116:119], a[236:239], a[88:91], 0
    s_add_u32 s69, s69, s86
    ds_read_b64_tr_b16 a[226:227], v25 offset:23232
    v_cvt_pk_bf16_f32 v194, v196, v197
    v_mfma_f32_16x16x32_bf16 v[116:119], a[232:235], a[80:83], v[116:119]
    buffer_store_dwordx4 v[176:179], v20, s[12:15], s77 offen sc1
    v_mfma_f32_16x16x32_bf16 v[116:119], a[228:231], a[72:75], v[116:119]
    v_mul_f32 v198, s72, v198
    v_mul_f32 v199, s72, v199
    v_mfma_f32_16x16x32_bf16 v[120:123], a[228:231], a[148:151], 0
    v_cvt_pk_bf16_f32 v195, v198, v199
    v_cvt_pk_bf16_f32 v172, v160, v161
    v_mfma_f32_16x16x32_bf16 v[120:123], a[232:235], a[156:159], v[120:123]
    v_cvt_pk_bf16_f32 v173, v162, v163
    v_cvt_pk_bf16_f32 v174, v164, v165
    v_mfma_f32_16x16x32_bf16 v[120:123], a[236:239], a[164:167], v[120:123]
    v_cvt_pk_bf16_f32 v175, v166, v167
    v_mul_f32 v200, s72, v200
    v_mfma_f32_16x16x32_bf16 v[124:127], a[236:239], v[52:55], 0
    buffer_load_dwordx4 v5, s[24:27], s69 offen lds
    v_mfma_f32_16x16x32_bf16 v[124:127], a[232:235], v[44:47], v[124:127]
    s_add_u32 m0, m0, s43
    v_mul_f32 v201, s72, v201
    v_cvt_pk_bf16_f32 v200, v200, v201
    v_mfma_f32_16x16x32_bf16 v[124:127], a[228:231], v[36:39], v[124:127]
    s_add_u32 s69, s69, s86
    v_mul_f32 v202, s72, v202
    v_mul_f32 v203, s72, v203
    v_mfma_f32_16x16x32_bf16 v[128:131], a[228:231], a[4:7], 0
    v_cvt_pk_bf16_f32 v201, v202, v203
    v_mul_f32 v204, s72, v204
    v_mfma_f32_16x16x32_bf16 v[128:131], a[232:235], a[12:15], v[128:131]
    v_mul_f32 v205, s72, v205
    v_cvt_pk_bf16_f32 v202, v204, v205
    v_mfma_f32_16x16x32_bf16 v[128:131], a[236:239], a[20:23], v[128:131]
    s_waitcnt lgkmcnt(0)
    buffer_store_dwordx4 v[184:187], v20, s[12:15], s78 offen sc1
    v_mfma_f32_16x16x32_bf16 v[132:135], a[236:239], a[92:95], 0
    s_waitcnt vmcnt(8)
    v_mul_f32 v206, s72, v206
    v_mul_f32 v207, s72, v207
    v_mfma_f32_16x16x32_bf16 v[132:135], a[232:235], a[84:87], v[132:135]
    s_barrier
    v_mfma_f32_16x16x32_bf16 v[132:135], a[228:231], a[76:79], v[132:135]
    buffer_load_dwordx4 v5, s[24:27], s69 offen lds
    v_mfma_f32_16x16x32_bf16 v[104:107], a[216:219], a[168:171], v[104:107]
    s_add_u32 m0, m0, s43
    ds_read_b64_tr_b16 a[228:229], v25 offset:25344
    v_cvt_pk_bf16_f32 v203, v206, v207
    v_mfma_f32_16x16x32_bf16 v[104:107], a[220:223], a[176:179], v[104:107]
    s_add_u32 s69, s62, 384
    ds_read_b64_tr_b16 a[230:231], v25 offset:27456
    v_mul_f32 v208, s72, v208
    v_mfma_f32_16x16x32_bf16 v[104:107], a[224:227], a[184:187], v[104:107]
    v_mul_f32 v209, s72, v209
    v_cvt_pk_bf16_f32 v208, v208, v209
    v_mfma_f32_16x16x32_bf16 v[108:111], a[224:227], v[72:75], v[108:111]
    v_mul_f32 v210, s72, v210
    v_mul_f32 v211, s72, v211
    v_mfma_f32_16x16x32_bf16 v[108:111], a[220:223], v[64:67], v[108:111]
    ds_read_b64_tr_b16 a[232:233], v25 offset:29568
    v_cvt_pk_bf16_f32 v209, v210, v211
    v_mfma_f32_16x16x32_bf16 v[108:111], a[216:219], v[56:59], v[108:111]
    ds_read_b64_tr_b16 a[234:235], v25 offset:31680
    v_mul_f32 v212, s72, v212
    v_mfma_f32_16x16x32_bf16 v[112:115], a[216:219], a[24:27], v[112:115]
    v_mul_f32 v213, s72, v213
    v_cvt_pk_bf16_f32 v210, v212, v213
    v_mfma_f32_16x16x32_bf16 v[112:115], a[220:223], a[32:35], v[112:115]
    buffer_load_dwordx4 v5, s[24:27], s69 offen lds
    v_mfma_f32_16x16x32_bf16 v[112:115], a[224:227], a[40:43], v[112:115]
    s_add_u32 m0, m0, s43
    ds_read_b64_tr_b16 a[236:237], v25 offset:33792
    v_mul_f32 v214, s72, v214
    v_mfma_f32_16x16x32_bf16 v[116:119], a[224:227], a[112:115], v[116:119]
    s_add_u32 s69, s69, s86
    ds_read_b64_tr_b16 a[238:239], v25 offset:35904
    v_mul_f32 v215, s72, v215
    v_mfma_f32_16x16x32_bf16 v[116:119], a[220:223], a[104:107], v[116:119]
    v_cvt_pk_bf16_f32 v211, v214, v215
    v_mul_f32 v216, s72, v216
    v_mfma_f32_16x16x32_bf16 v[116:119], a[216:219], a[96:99], v[116:119]
    v_mul_f32 v217, s72, v217
    v_cvt_pk_bf16_f32 v216, v216, v217
    v_mfma_f32_16x16x32_bf16 v[120:123], a[216:219], a[172:175], v[120:123]
    buffer_store_dwordx4 v[192:195], v20, s[12:15], s79 offen sc1
    v_mfma_f32_16x16x32_bf16 v[120:123], a[220:223], a[180:183], v[120:123]
    v_mul_f32 v218, s72, v218
    v_mul_f32 v219, s72, v219
    v_mfma_f32_16x16x32_bf16 v[120:123], a[224:227], a[188:191], v[120:123]
    v_cvt_pk_bf16_f32 v217, v218, v219
    v_mul_f32 v220, s72, v220
    v_mfma_f32_16x16x32_bf16 v[124:127], a[224:227], v[76:79], v[124:127]
    buffer_load_dwordx4 v5, s[24:27], s69 offen lds
    v_mfma_f32_16x16x32_bf16 v[124:127], a[220:223], v[68:71], v[124:127]
    s_add_u32 m0, m0, s43
    v_mul_f32 v221, s72, v221
    v_cvt_pk_bf16_f32 v218, v220, v221
    v_mfma_f32_16x16x32_bf16 v[124:127], a[216:219], v[60:63], v[124:127]
    s_add_u32 s69, s69, s86
    v_mul_f32 v222, s72, v222
    v_mul_f32 v223, s72, v223
    v_mfma_f32_16x16x32_bf16 v[128:131], a[216:219], a[28:31], v[128:131]
    v_cvt_pk_bf16_f32 v219, v222, v223
    v_mul_f32 v224, s72, v224
    v_mfma_f32_16x16x32_bf16 v[128:131], a[220:223], a[36:39], v[128:131]
    v_mul_f32 v225, s72, v225
    v_cvt_pk_bf16_f32 v224, v224, v225
    v_mfma_f32_16x16x32_bf16 v[128:131], a[224:227], a[44:47], v[128:131]
    s_waitcnt lgkmcnt(0)
    v_mul_f32 v226, s72, v226
    v_mul_f32 v227, s72, v227
    v_mfma_f32_16x16x32_bf16 v[132:135], a[224:227], a[116:119], v[132:135]
    v_cvt_pk_bf16_f32 v225, v226, v227
    v_mul_f32 v228, s72, v228
    v_mfma_f32_16x16x32_bf16 v[132:135], a[220:223], a[108:111], v[132:135]
    v_mul_f32 v229, s72, v229
    v_cvt_pk_bf16_f32 v226, v228, v229
    v_mfma_f32_16x16x32_bf16 v[132:135], a[216:219], a[100:103], v[132:135]
    buffer_load_dwordx4 v5, s[24:27], s69 offen lds
    v_mfma_f32_16x16x32_bf16 v[104:107], a[228:231], a[192:195], v[104:107]
    s_add_u32 m0, m0, s43
    ds_read_b64_tr_b16 a[216:217], v11 offset:0
    v_mul_f32 v230, s72, v230
    v_mfma_f32_16x16x32_bf16 v[104:107], a[232:235], a[200:203], v[104:107]
    s_add_u32 s69, s69, s86
    ds_read_b64_tr_b16 a[218:219], v11 offset:2112
    v_mul_f32 v231, s72, v231
    v_mfma_f32_16x16x32_bf16 v[136:139], a[236:239], a[208:211], v[104:107]
    v_cvt_pk_bf16_f32 v227, v230, v231
    v_mfma_f32_16x16x32_bf16 v[108:111], a[236:239], v[96:99], v[108:111]
    v_mfma_f32_16x16x32_bf16 v[108:111], a[232:235], v[88:91], v[108:111]
    ds_read_b64_tr_b16 a[220:221], v11 offset:4224
    v_mfma_f32_16x16x32_bf16 v[140:143], a[228:231], v[80:83], v[108:111]
    ds_read_b64_tr_b16 a[222:223], v11 offset:6336
    v_mfma_f32_16x16x32_bf16 v[112:115], a[228:231], a[48:51], v[112:115]
    v_mfma_f32_16x16x32_bf16 v[112:115], a[232:235], a[56:59], v[112:115]
    buffer_load_dwordx4 v5, s[24:27], s69 offen lds
    v_mfma_f32_16x16x32_bf16 v[144:147], a[236:239], a[64:67], v[112:115]
    s_add_u32 m0, m0, s43
    ds_read_b64_tr_b16 a[224:225], v11 offset:8448
    v_mfma_f32_16x16x32_bf16 v[116:119], a[236:239], a[136:139], v[116:119]
    s_add_u32 s69, s69, s86
    ds_read_b64_tr_b16 a[226:227], v11 offset:10560
    v_mfma_f32_16x16x32_bf16 v[116:119], a[232:235], a[128:131], v[116:119]
    buffer_store_dwordx4 v[200:203], v20, s[12:15], s80 offen sc1
    v_mfma_f32_16x16x32_bf16 v[148:151], a[228:231], a[120:123], v[116:119]
    v_mfma_f32_16x16x32_bf16 v[120:123], a[228:231], a[196:199], v[120:123]
    v_mfma_f32_16x16x32_bf16 v[120:123], a[232:235], a[204:207], v[120:123]
    v_cvt_pk_bf16_f32 v180, v136, v137
    v_cvt_pk_bf16_f32 v181, v138, v139
    v_mfma_f32_16x16x32_bf16 v[152:155], a[236:239], a[212:215], v[120:123]
    v_cvt_pk_bf16_f32 v182, v140, v141
    v_cvt_pk_bf16_f32 v183, v142, v143
    v_mfma_f32_16x16x32_bf16 v[124:127], a[236:239], v[100:103], v[124:127]
    buffer_load_dwordx4 v5, s[24:27], s69 offen lds
    v_mfma_f32_16x16x32_bf16 v[124:127], a[232:235], v[92:95], v[124:127]
    s_add_u32 m0, m0, s43
    v_mfma_f32_16x16x32_bf16 v[156:159], a[228:231], v[84:87], v[124:127]
    s_add_u32 s69, s69, s86
    v_mfma_f32_16x16x32_bf16 v[128:131], a[228:231], a[52:55], v[128:131]
    v_mfma_f32_16x16x32_bf16 v[128:131], a[232:235], a[60:63], v[128:131]
    v_cvt_pk_bf16_f32 v188, v144, v145
    v_cvt_pk_bf16_f32 v189, v146, v147
    v_mfma_f32_16x16x32_bf16 v[160:163], a[236:239], a[68:71], v[128:131]
    s_waitcnt lgkmcnt(0)
    buffer_store_dwordx4 v[208:211], v20, s[12:15], s81 offen sc1
    v_mfma_f32_16x16x32_bf16 v[132:135], a[236:239], a[140:143], v[132:135]
    s_waitcnt vmcnt(8)
    v_cvt_pk_bf16_f32 v190, v148, v149
    v_cvt_pk_bf16_f32 v191, v150, v151
    v_mfma_f32_16x16x32_bf16 v[132:135], a[232:235], a[132:135], v[132:135]
    s_barrier
    v_mfma_f32_16x16x32_bf16 v[164:167], a[228:231], a[124:127], v[132:135]
    buffer_load_dwordx4 v5, s[24:27], s69 offen lds
    v_mfma_f32_16x16x32_bf16 v[104:107], a[216:219], a[144:147], 0
    s_add_u32 m0, m0, s43
    ds_read_b64_tr_b16 a[228:229], v11 offset:12672
    v_mfma_f32_16x16x32_bf16 v[104:107], a[220:223], a[152:155], v[104:107]
    s_add_u32 s69, s69, s86
    ds_read_b64_tr_b16 a[230:231], v11 offset:14784
    v_cvt_pk_bf16_f32 v196, v152, v153
    v_mfma_f32_16x16x32_bf16 v[104:107], a[224:227], a[160:163], v[104:107]
    v_cvt_pk_bf16_f32 v197, v154, v155
    v_cvt_pk_bf16_f32 v198, v156, v157
    v_mfma_f32_16x16x32_bf16 v[108:111], a[224:227], v[48:51], 0
    v_cvt_pk_bf16_f32 v199, v158, v159
    v_mfma_f32_16x16x32_bf16 v[108:111], a[220:223], v[40:43], v[108:111]
    ds_read_b64_tr_b16 a[232:233], v11 offset:16896
    v_mfma_f32_16x16x32_bf16 v[108:111], a[216:219], v[32:35], v[108:111]
    ds_read_b64_tr_b16 a[234:235], v11 offset:19008
    v_mfma_f32_16x16x32_bf16 v[112:115], a[216:219], a[0:3], 0
    v_mfma_f32_16x16x32_bf16 v[112:115], a[220:223], a[8:11], v[112:115]
    buffer_load_dwordx4 v5, s[24:27], s69 offen lds
    v_mfma_f32_16x16x32_bf16 v[112:115], a[224:227], a[16:19], v[112:115]
    s_add_u32 m0, m0, s43
    ds_read_b64_tr_b16 a[236:237], v11 offset:21120
    v_cvt_pk_bf16_f32 v168, v160, v161
    v_mfma_f32_16x16x32_bf16 v[116:119], a[224:227], a[88:91], 0
    s_add_u32 s69, s69, s86
    ds_read_b64_tr_b16 a[238:239], v11 offset:23232
    v_cvt_pk_bf16_f32 v169, v162, v163
    v_mfma_f32_16x16x32_bf16 v[116:119], a[220:223], a[80:83], v[116:119]
    v_cvt_pk_bf16_f32 v170, v164, v165
    v_cvt_pk_bf16_f32 v171, v166, v167
    v_mfma_f32_16x16x32_bf16 v[116:119], a[216:219], a[72:75], v[116:119]
    v_mfma_f32_16x16x32_bf16 v[120:123], a[216:219], a[148:151], 0
    buffer_store_dwordx4 v[216:219], v20, s[12:15], s82 offen sc1
    v_mfma_f32_16x16x32_bf16 v[120:123], a[220:223], a[156:159], v[120:123]
    v_mfma_f32_16x16x32_bf16 v[120:123], a[224:227], a[164:167], v[120:123]
    v_mfma_f32_16x16x32_bf16 v[124:127], a[224:227], v[52:55], 0
    buffer_load_dwordx4 v5, s[24:27], s69 offen lds
    v_mfma_f32_16x16x32_bf16 v[124:127], a[220:223], v[44:47], v[124:127]
    s_add_u32 m0, m0, s43
    v_mfma_f32_16x16x32_bf16 v[124:127], a[216:219], v[36:39], v[124:127]
    s_add_u32 s69, s69, s86
    buffer_load_dword v244, off, s[92:95], 0 sc1
    v_mfma_f32_16x16x32_bf16 v[128:131], a[216:219], a[4:7], 0
    v_mfma_f32_16x16x32_bf16 v[128:131], a[220:223], a[12:15], v[128:131]
    v_mfma_f32_16x16x32_bf16 v[128:131], a[224:227], a[20:23], v[128:131]
    s_waitcnt lgkmcnt(0)
    v_mfma_f32_16x16x32_bf16 v[132:135], a[224:227], a[92:95], 0
    v_mfma_f32_16x16x32_bf16 v[132:135], a[220:223], a[84:87], v[132:135]
    v_mfma_f32_16x16x32_bf16 v[132:135], a[216:219], a[76:79], v[132:135]
    buffer_load_dwordx4 v5, s[24:27], s69 offen lds
    v_mfma_f32_16x16x32_bf16 v[104:107], a[228:231], a[168:171], v[104:107]
    s_mov_b32 m0, s47
    ds_read_b64_tr_b16 a[216:217], v11 offset:25344
    v_mfma_f32_16x16x32_bf16 v[104:107], a[232:235], a[176:179], v[104:107]
    s_add_u32 s69, s62, 512
    ds_read_b64_tr_b16 a[218:219], v11 offset:27456
    v_mfma_f32_16x16x32_bf16 v[104:107], a[236:239], a[184:187], v[104:107]
    v_mfma_f32_16x16x32_bf16 v[108:111], a[236:239], v[72:75], v[108:111]
    v_mfma_f32_16x16x32_bf16 v[108:111], a[232:235], v[64:67], v[108:111]
    ds_read_b64_tr_b16 a[220:221], v11 offset:29568
    v_mfma_f32_16x16x32_bf16 v[108:111], a[228:231], v[56:59], v[108:111]
    ds_read_b64_tr_b16 a[222:223], v11 offset:31680
    v_mfma_f32_16x16x32_bf16 v[112:115], a[228:231], a[24:27], v[112:115]
    v_mfma_f32_16x16x32_bf16 v[112:115], a[232:235], a[32:35], v[112:115]
    buffer_load_dwordx4 v5, s[24:27], s69 offen lds
    v_mfma_f32_16x16x32_bf16 v[112:115], a[236:239], a[40:43], v[112:115]
    s_add_u32 m0, m0, s43
    ds_read_b64_tr_b16 a[224:225], v11 offset:33792
    v_mfma_f32_16x16x32_bf16 v[116:119], a[236:239], a[112:115], v[116:119]
    s_add_u32 s69, s69, s86
    ds_read_b64_tr_b16 a[226:227], v11 offset:35904
    v_mfma_f32_16x16x32_bf16 v[116:119], a[232:235], a[104:107], v[116:119]
    buffer_store_dwordx4 v[224:227], v20, s[12:15], s83 offen sc1
    v_mfma_f32_16x16x32_bf16 v[116:119], a[228:231], a[96:99], v[116:119]
    v_mfma_f32_16x16x32_bf16 v[120:123], a[228:231], a[172:175], v[120:123]
    v_mfma_f32_16x16x32_bf16 v[120:123], a[232:235], a[180:183], v[120:123]
    v_mfma_f32_16x16x32_bf16 v[120:123], a[236:239], a[188:191], v[120:123]
    v_mfma_f32_16x16x32_bf16 v[124:127], a[236:239], v[76:79], v[124:127]
    buffer_load_dwordx4 v5, s[24:27], s69 offen lds
    v_mfma_f32_16x16x32_bf16 v[124:127], a[232:235], v[68:71], v[124:127]
    s_add_u32 m0, m0, s43
    v_mfma_f32_16x16x32_bf16 v[124:127], a[228:231], v[60:63], v[124:127]
    s_add_u32 s69, s69, s86
    v_mfma_f32_16x16x32_bf16 v[128:131], a[228:231], a[28:31], v[128:131]
    v_mfma_f32_16x16x32_bf16 v[128:131], a[232:235], a[36:39], v[128:131]
    v_mfma_f32_16x16x32_bf16 v[128:131], a[236:239], a[44:47], v[128:131]
    s_waitcnt lgkmcnt(0)
    v_mfma_f32_16x16x32_bf16 v[132:135], a[236:239], a[116:119], v[132:135]
    s_waitcnt vmcnt(8)
    v_mfma_f32_16x16x32_bf16 v[132:135], a[232:235], a[108:111], v[132:135]
    s_barrier
    v_mfma_f32_16x16x32_bf16 v[132:135], a[228:231], a[100:103], v[132:135]
    buffer_load_dwordx4 v5, s[24:27], s69 offen lds
    v_mfma_f32_16x16x32_bf16 v[104:107], a[216:219], a[192:195], v[104:107]
    s_add_u32 m0, m0, s43
    ds_read_b64_tr_b16 a[228:229], v25 offset:0
    v_mfma_f32_16x16x32_bf16 v[104:107], a[220:223], a[200:203], v[104:107]
    s_add_u32 s69, s69, s86
    ds_read_b64_tr_b16 a[230:231], v25 offset:2112
    v_mfma_f32_16x16x32_bf16 v[136:139], a[224:227], a[208:211], v[104:107]
    s_add_u32 s3, s67, 0
    v_mfma_f32_16x16x32_bf16 v[108:111], a[224:227], v[96:99], v[108:111]
    v_mfma_f32_16x16x32_bf16 v[108:111], a[220:223], v[88:91], v[108:111]
    ds_read_b64_tr_b16 a[232:233], v25 offset:4224
    v_mfma_f32_16x16x32_bf16 v[140:143], a[216:219], v[80:83], v[108:111]
    ds_read_b64_tr_b16 a[234:235], v25 offset:6336
    v_mfma_f32_16x16x32_bf16 v[112:115], a[216:219], a[48:51], v[112:115]
    v_mfma_f32_16x16x32_bf16 v[112:115], a[220:223], a[56:59], v[112:115]
    buffer_load_dwordx4 v5, s[24:27], s69 offen lds
    v_mfma_f32_16x16x32_bf16 v[144:147], a[224:227], a[64:67], v[112:115]
    s_add_u32 m0, m0, s43
    ds_read_b64_tr_b16 a[236:237], v25 offset:8448
    v_mfma_f32_16x16x32_bf16 v[116:119], a[224:227], a[136:139], v[116:119]
    s_add_u32 s69, s69, s86
    ds_read_b64_tr_b16 a[238:239], v25 offset:10560
    v_mfma_f32_16x16x32_bf16 v[116:119], a[220:223], a[128:131], v[116:119]
    s_and_b32 s48, s2, 7
    buffer_store_dwordx4 v[232:235], v1, s[12:15], s3 offen sc1
    v_mfma_f32_16x16x32_bf16 v[148:151], a[216:219], a[120:123], v[116:119]
    s_lshl_b32 s48, s48, 2
    v_mfma_f32_16x16x32_bf16 v[120:123], a[216:219], a[196:199], v[120:123]
    s_bfe_u32 s57, s2, 0x20003
    v_mfma_f32_16x16x32_bf16 v[120:123], a[220:223], a[204:207], v[120:123]
    s_add_u32 s48, s48, s57
    v_cvt_pk_bf16_f32 v204, v136, v137
    v_cvt_pk_bf16_f32 v205, v138, v139
    v_mfma_f32_16x16x32_bf16 v[152:155], a[224:227], a[212:215], v[120:123]
    s_lshr_b32 s49, s2, 5
    v_cvt_pk_bf16_f32 v206, v140, v141
    v_cvt_pk_bf16_f32 v207, v142, v143
    v_mfma_f32_16x16x32_bf16 v[124:127], a[224:227], v[100:103], v[124:127]
    s_lshr_b32 s53, s48, 1
    buffer_load_dwordx4 v5, s[24:27], s69 offen lds
    v_mfma_f32_16x16x32_bf16 v[124:127], a[220:223], v[92:95], v[124:127]
    s_add_u32 m0, m0, s43
    v_mfma_f32_16x16x32_bf16 v[156:159], a[216:219], v[84:87], v[124:127]
    s_add_u32 s69, s69, s86
    v_mfma_f32_16x16x32_bf16 v[128:131], a[216:219], a[52:55], v[128:131]
    s_mul_i32 s53, s53, 9
    v_mfma_f32_16x16x32_bf16 v[128:131], a[220:223], a[60:63], v[128:131]
    s_and_b32 s55, s48, 1
    v_cvt_pk_bf16_f32 v176, v144, v145
    v_cvt_pk_bf16_f32 v177, v146, v147
    v_mfma_f32_16x16x32_bf16 v[160:163], a[224:227], a[68:71], v[128:131]
    s_waitcnt lgkmcnt(0)
    v_cvt_pk_bf16_f32 v178, v148, v149
    v_cvt_pk_bf16_f32 v179, v150, v151
    v_mfma_f32_16x16x32_bf16 v[132:135], a[224:227], a[140:143], v[132:135]
    s_mul_i32 s50, s55, 5
    v_mfma_f32_16x16x32_bf16 v[132:135], a[220:223], a[132:135], v[132:135]
    s_add_u32 s50, s50, s53
    v_mfma_f32_16x16x32_bf16 v[164:167], a[216:219], a[124:127], v[132:135]
    s_lshl_b32 s50, s50, 14
    buffer_load_dwordx4 v5, s[24:27], s69 offen lds
    v_mfma_f32_16x16x32_bf16 v[104:107], a[228:231], a[144:147], 0
    s_add_u32 m0, m0, s43
    ds_read_b64_tr_b16 a[216:217], v25 offset:12672
    v_mfma_f32_16x16x32_bf16 v[104:107], a[232:235], a[152:155], v[104:107]
    s_add_u32 s69, s69, s86
    ds_read_b64_tr_b16 a[218:219], v25 offset:14784
    v_cvt_pk_bf16_f32 v212, v152, v153
    v_mfma_f32_16x16x32_bf16 v[104:107], a[236:239], a[160:163], v[104:107]
    s_add_u32 s53, s53, 4
    v_cvt_pk_bf16_f32 v213, v154, v155
    v_cvt_pk_bf16_f32 v214, v156, v157
    v_mfma_f32_16x16x32_bf16 v[108:111], a[236:239], v[48:51], 0
    s_lshl_b32 s53, s53, 14
    v_cvt_pk_bf16_f32 v215, v158, v159
    v_mfma_f32_16x16x32_bf16 v[108:111], a[232:235], v[40:43], v[108:111]
    s_lshl2_add_u32 s53, s55, s53
    ds_read_b64_tr_b16 a[220:221], v25 offset:16896
    v_mfma_f32_16x16x32_bf16 v[108:111], a[228:231], v[32:35], v[108:111]
    s_lshl_b32 s55, s49, 11
    ds_read_b64_tr_b16 a[222:223], v25 offset:19008
    v_mfma_f32_16x16x32_bf16 v[112:115], a[228:231], a[0:3], 0
    s_add_u32 s6, s67, 36864
    v_mfma_f32_16x16x32_bf16 v[112:115], a[232:235], a[8:11], v[112:115]
    s_lshl_b32 s64, s44, 14
    buffer_load_dwordx4 v5, s[24:27], s69 offen lds
    v_mfma_f32_16x16x32_bf16 v[112:115], a[236:239], a[16:19], v[112:115]
    s_add_u32 m0, m0, s43
    ds_read_b64_tr_b16 a[224:225], v25 offset:21120
    v_cvt_pk_bf16_f32 v184, v160, v161
    v_mfma_f32_16x16x32_bf16 v[116:119], a[236:239], a[88:91], 0
    s_add_u32 s69, s69, s86
    ds_read_b64_tr_b16 a[226:227], v25 offset:23232
    v_cvt_pk_bf16_f32 v185, v162, v163
    v_mfma_f32_16x16x32_bf16 v[116:119], a[232:235], a[80:83], v[116:119]
    s_add_u32 s64, s64, s55
    v_cvt_pk_bf16_f32 v186, v164, v165
    v_cvt_pk_bf16_f32 v187, v166, v167
    v_mfma_f32_16x16x32_bf16 v[116:119], a[228:231], a[72:75], v[116:119]
    s_add_u32 s64, s64, s50
    v_mfma_f32_16x16x32_bf16 v[120:123], a[228:231], a[148:151], 0
    s_lshl_b32 s65, s44, 9
    buffer_store_dwordx4 v[236:239], v1, s[12:15], s6 offen sc1
    v_mfma_f32_16x16x32_bf16 v[120:123], a[232:235], a[156:159], v[120:123]
    s_add_u32 s65, s65, s55
    v_mfma_f32_16x16x32_bf16 v[120:123], a[236:239], a[164:167], v[120:123]
    s_add_u32 s65, s65, s53
    v_mfma_f32_16x16x32_bf16 v[124:127], a[236:239], v[52:55], 0
    s_lshl_b32 s55, s44, 12
    buffer_load_dwordx4 v5, s[24:27], s69 offen lds
    v_mfma_f32_16x16x32_bf16 v[124:127], a[232:235], v[44:47], v[124:127]
    s_add_u32 m0, m0, s43
    v_mfma_f32_16x16x32_bf16 v[124:127], a[228:231], v[36:39], v[124:127]
    s_add_u32 s69, s69, s86
    v_mfma_f32_16x16x32_bf16 v[128:131], a[228:231], a[4:7], 0
    s_add_u32 s55, s55, 2359296
    v_mfma_f32_16x16x32_bf16 v[128:131], a[232:235], a[12:15], v[128:131]
    s_add_u32 s50, s50, s55
    v_mfma_f32_16x16x32_bf16 v[128:131], a[236:239], a[20:23], v[128:131]
    s_waitcnt lgkmcnt(0)
    v_mfma_f32_16x16x32_bf16 v[132:135], a[236:239], a[92:95], 0
    s_waitcnt vmcnt(7)
    v_mfma_f32_16x16x32_bf16 v[132:135], a[232:235], a[84:87], v[132:135]
    s_barrier
    v_mfma_f32_16x16x32_bf16 v[132:135], a[228:231], a[76:79], v[132:135]
    s_add_u32 s51, s50, 16384
    buffer_load_dwordx4 v5, s[24:27], s69 offen lds
    v_mfma_f32_16x16x32_bf16 v[104:107], a[216:219], a[168:171], v[104:107]
    s_add_u32 m0, m0, s43
    ds_read_b64_tr_b16 a[228:229], v25 offset:25344
    v_cmp_ne_u32 vcc, 1, v244
    v_mfma_f32_16x16x32_bf16 v[104:107], a[220:223], a[176:179], v[104:107]
    s_add_u32 s69, s62, 640
    ds_read_b64_tr_b16 a[230:231], v25 offset:27456
    v_mfma_f32_16x16x32_bf16 v[104:107], a[224:227], a[184:187], v[104:107]
    s_add_u32 s53, s53, s55
    v_mfma_f32_16x16x32_bf16 v[108:111], a[224:227], v[72:75], v[108:111]
    s_mul_i32 s52, s44, 598016
    v_mfma_f32_16x16x32_bf16 v[108:111], a[220:223], v[64:67], v[108:111]
    s_mul_i32 s22, s48, 288
    ds_read_b64_tr_b16 a[232:233], v25 offset:29568
    v_mfma_f32_16x16x32_bf16 v[108:111], a[216:219], v[56:59], v[108:111]
    s_cbranch_vccnz L_c0_spin
L_c0_ok:
    ds_read_b64_tr_b16 a[234:235], v25 offset:31680
    v_mfma_f32_16x16x32_bf16 v[112:115], a[216:219], a[24:27], v[112:115]
    s_add_u32 s52, s52, s22
    v_mfma_f32_16x16x32_bf16 v[112:115], a[220:223], a[32:35], v[112:115]
    s_add_u32 s52, s52, 5242880
    buffer_load_dwordx4 v5, s[24:27], s69 offen lds
    v_mfma_f32_16x16x32_bf16 v[112:115], a[224:227], a[40:43], v[112:115]
    s_add_u32 m0, m0, s43
    ds_read_b64_tr_b16 a[236:237], v25 offset:33792
    v_mfma_f32_16x16x32_bf16 v[116:119], a[224:227], a[112:115], v[116:119]
    s_add_u32 s69, s69, s86
    ds_read_b64_tr_b16 a[238:239], v25 offset:35904
    v_mfma_f32_16x16x32_bf16 v[116:119], a[220:223], a[104:107], v[116:119]
    s_sub_u32 s22, 9216, s22
    buffer_store_dword v22, v21, s[12:15], s96 offen sc1
    v_mfma_f32_16x16x32_bf16 v[116:119], a[216:219], a[96:99], v[116:119]
    s_lshr_b32 s54, s48, 2
    v_mfma_f32_16x16x32_bf16 v[120:123], a[216:219], a[172:175], v[120:123]
    s_add_u32 s7, s67, 73728
    v_mfma_f32_16x16x32_bf16 v[120:123], a[220:223], a[180:183], v[120:123]
    s_lshl3_add_u32 s56, s49, s54
    v_mfma_f32_16x16x32_bf16 v[120:123], a[224:227], a[188:191], v[120:123]
    s_lshr_b32 s63, s56, 2
    v_mfma_f32_16x16x32_bf16 v[124:127], a[224:227], v[76:79], v[124:127]
    s_lshl_b32 s63, s63, 6
    buffer_load_dwordx4 v5, s[24:27], s69 offen lds
    v_mfma_f32_16x16x32_bf16 v[124:127], a[220:223], v[68:71], v[124:127]
    s_add_u32 m0, m0, s43
    v_mfma_f32_16x16x32_bf16 v[124:127], a[216:219], v[60:63], v[124:127]
    s_add_u32 s69, s69, s86
    v_mfma_f32_16x16x32_bf16 v[128:131], a[216:219], a[28:31], v[128:131]
    s_add_u32 s63, s63, 12583936
    buffer_store_dwordx4 v[240:243], v1, s[12:15], s7 offen sc1
    v_mfma_f32_16x16x32_bf16 v[128:131], a[220:223], a[36:39], v[128:131]
    s_mul_i32 s54, s57, 9
    v_mfma_f32_16x16x32_bf16 v[128:131], a[224:227], a[44:47], v[128:131]
    s_waitcnt lgkmcnt(0)
    v_mfma_f32_16x16x32_bf16 v[132:135], a[224:227], a[116:119], v[132:135]
    s_mul_i32 s61, s56, 36
    v_mfma_f32_16x16x32_bf16 v[132:135], a[220:223], a[108:111], v[132:135]
    s_add_u32 s61, s61, s54
    v_mfma_f32_16x16x32_bf16 v[132:135], a[216:219], a[100:103], v[132:135]
    s_lshl1_add_u32 s60, s44, s61
    buffer_load_dwordx4 v5, s[24:27], s69 offen lds
    v_mfma_f32_16x16x32_bf16 v[104:107], a[228:231], a[192:195], v[104:107]
    s_add_u32 m0, m0, s43
    ds_read_b64_tr_b16 a[216:217], v11 offset:0
    v_mfma_f32_16x16x32_bf16 v[104:107], a[232:235], a[200:203], v[104:107]
    s_add_u32 s69, s69, s86
    ds_read_b64_tr_b16 a[218:219], v11 offset:2112
    v_mfma_f32_16x16x32_bf16 v[136:139], a[236:239], a[208:211], v[104:107]
    s_lshl_b32 s60, s60, 10
    v_mfma_f32_16x16x32_bf16 v[108:111], a[236:239], v[96:99], v[108:111]
    s_add_u32 s60, s60, 16777216
    v_mfma_f32_16x16x32_bf16 v[108:111], a[232:235], v[88:91], v[108:111]
    s_lshl_b32 s61, s61, 10
    ds_read_b64_tr_b16 a[220:221], v11 offset:4224
    v_mfma_f32_16x16x32_bf16 v[140:143], a[228:231], v[80:83], v[108:111]
    s_mul_i32 s58, s44, 9437184
    ds_read_b64_tr_b16 a[222:223], v11 offset:6336
    v_mfma_f32_16x16x32_bf16 v[112:115], a[228:231], a[48:51], v[112:115]
    s_add_u32 s61, s61, s58
    v_mfma_f32_16x16x32_bf16 v[112:115], a[232:235], a[56:59], v[112:115]
    s_add_u32 s61, s61, 16785408
    buffer_load_dwordx4 v5, s[24:27], s69 offen lds
    v_mfma_f32_16x16x32_bf16 v[144:147], a[236:239], a[64:67], v[112:115]
    s_add_u32 m0, m0, s43
    ds_read_b64_tr_b16 a[224:225], v11 offset:8448
    v_mfma_f32_16x16x32_bf16 v[116:119], a[236:239], a[136:139], v[116:119]
    s_add_u32 s69, s69, s86
    ds_read_b64_tr_b16 a[226:227], v11 offset:10560
    v_mfma_f32_16x16x32_bf16 v[116:119], a[232:235], a[128:131], v[116:119]
    s_mul_i32 s74, s54, 18432
    v_mfma_f32_16x16x32_bf16 v[148:151], a[228:231], a[120:123], v[116:119]
    s_mul_i32 s58, s44, 36864
    v_mfma_f32_16x16x32_bf16 v[120:123], a[228:231], a[196:199], v[120:123]
    s_add_u32 s58, s58, s74
    v_mfma_f32_16x16x32_bf16 v[120:123], a[232:235], a[204:207], v[120:123]
    s_add_u32 s58, s58, 11534336
    v_cvt_pk_bf16_f32 v220, v136, v137
    v_cvt_pk_bf16_f32 v221, v138, v139
    v_mfma_f32_16x16x32_bf16 v[152:155], a[236:239], a[212:215], v[120:123]
    s_add_u32 s74, s74, 11681792
    v_cvt_pk_bf16_f32 v222, v140, v141
    v_cvt_pk_bf16_f32 v223, v142, v143
    v_mfma_f32_16x16x32_bf16 v[124:127], a[236:239], v[100:103], v[124:127]
    s_mul_i32 s59, s44, 25600
    buffer_load_dwordx4 v5, s[24:27], s69 offen lds
    v_mfma_f32_16x16x32_bf16 v[124:127], a[232:235], v[92:95], v[124:127]
    s_add_u32 m0, m0, s43
    v_mfma_f32_16x16x32_bf16 v[156:159], a[228:231], v[84:87], v[124:127]
    s_add_u32 s69, s69, s86
    v_mfma_f32_16x16x32_bf16 v[128:131], a[228:231], a[52:55], v[128:131]
    s_add_u32 s75, s67, 110592
    v_mfma_f32_16x16x32_bf16 v[128:131], a[232:235], a[60:63], v[128:131]
    s_add_u32 s54, s44, 3
    v_cvt_pk_bf16_f32 v192, v144, v145
    v_cvt_pk_bf16_f32 v193, v146, v147
    v_mfma_f32_16x16x32_bf16 v[160:163], a[236:239], a[68:71], v[128:131]
    s_waitcnt lgkmcnt(0)
    v_cvt_pk_bf16_f32 v194, v148, v149
    v_cvt_pk_bf16_f32 v195, v150, v151
    v_mfma_f32_16x16x32_bf16 v[132:135], a[236:239], a[140:143], v[132:135]
    s_waitcnt vmcnt(7)
    v_mfma_f32_16x16x32_bf16 v[132:135], a[232:235], a[132:135], v[132:135]
    s_barrier
    v_mfma_f32_16x16x32_bf16 v[164:167], a[228:231], a[124:127], v[132:135]
    s_and_b32 s54, s54, 3
    buffer_load_dwordx4 v5, s[24:27], s69 offen lds
    v_mfma_f32_16x16x32_bf16 v[104:107], a[216:219], a[144:147], 0
    s_add_u32 m0, m0, s43
    ds_read_b64_tr_b16 a[228:229], v11 offset:12672
    v_mfma_f32_16x16x32_bf16 v[104:107], a[220:223], a[152:155], v[104:107]
    s_add_u32 s69, s69, s86
    ds_read_b64_tr_b16 a[230:231], v11 offset:14784
    v_cvt_pk_bf16_f32 v228, v152, v153
    v_mfma_f32_16x16x32_bf16 v[104:107], a[224:227], a[160:163], v[104:107]
    s_lshl2_add_u32 s54, s49, s54
    buffer_store_dwordx4 v[172:175], v1, s[12:15], s75 offen sc1
    v_mfma_f32_16x16x32_bf16 v[108:111], a[224:227], v[48:51], 0
    s_lshl_b32 s68, s54, 6
    v_cvt_pk_bf16_f32 v229, v154, v155
    v_cvt_pk_bf16_f32 v230, v156, v157
    v_mfma_f32_16x16x32_bf16 v[108:111], a[220:223], v[40:43], v[108:111]
    s_add_u32 s66, s68, s68
    ds_read_b64_tr_b16 a[232:233], v11 offset:16896
    v_cvt_pk_bf16_f32 v231, v158, v159
    v_mfma_f32_16x16x32_bf16 v[108:111], a[216:219], v[32:35], v[108:111]
    s_add_u32 s68, s68, s48
    ds_read_b64_tr_b16 a[234:235], v11 offset:19008
    v_mfma_f32_16x16x32_bf16 v[112:115], a[216:219], a[0:3], 0
    s_add_u32 s66, s66, s48
    v_mfma_f32_16x16x32_bf16 v[112:115], a[220:223], a[8:11], v[112:115]
    s_lshl_b32 s68, s68, 7
    buffer_load_dwordx4 v5, s[24:27], s69 offen lds
    v_mfma_f32_16x16x32_bf16 v[112:115], a[224:227], a[16:19], v[112:115]
    s_add_u32 m0, m0, s43
    ds_read_b64_tr_b16 a[236:237], v11 offset:21120
    v_cvt_pk_bf16_f32 v200, v160, v161
    v_mfma_f32_16x16x32_bf16 v[116:119], a[224:227], a[88:91], 0
    s_add_u32 s69, s69, s86
    ds_read_b64_tr_b16 a[238:239], v11 offset:23232
    v_cvt_pk_bf16_f32 v201, v162, v163
    v_mfma_f32_16x16x32_bf16 v[116:119], a[220:223], a[80:83], v[116:119]
    s_lshl_b32 s66, s66, 9
    v_cvt_pk_bf16_f32 v202, v164, v165
    v_cvt_pk_bf16_f32 v203, v166, v167
    v_mfma_f32_16x16x32_bf16 v[116:119], a[216:219], a[72:75], v[116:119]
    s_add_u32 s68, s68, 10485760
    v_mfma_f32_16x16x32_bf16 v[120:123], a[216:219], a[148:151], 0
    s_add_u32 s66, s66, 8388608
    v_mfma_f32_16x16x32_bf16 v[120:123], a[220:223], a[156:159], v[120:123]
    s_lshl3_add_u32 s54, s56, s44
    v_mfma_f32_16x16x32_bf16 v[120:123], a[224:227], a[164:167], v[120:123]
    s_mul_i32 s4, s54, 4608
    v_mfma_f32_16x16x32_bf16 v[124:127], a[224:227], v[52:55], 0
    s_lshl_b32 s5, s54, 12
    buffer_load_dwordx4 v5, s[24:27], s69 offen lds
    v_mfma_f32_16x16x32_bf16 v[124:127], a[220:223], v[44:47], v[124:127]
    s_add_u32 m0, m0, s43
    v_mfma_f32_16x16x32_bf16 v[124:127], a[216:219], v[36:39], v[124:127]
    s_add_u32 s69, s69, s86
    v_mfma_f32_16x16x32_bf16 v[128:131], a[216:219], a[4:7], 0
    s_add_u32 s5, s5, 8388608
    v_mfma_f32_16x16x32_bf16 v[128:131], a[220:223], a[12:15], v[128:131]
    s_mul_i32 s54, s57, 288
    v_mfma_f32_16x16x32_bf16 v[128:131], a[224:227], a[20:23], v[128:131]
    s_waitcnt lgkmcnt(0)
    v_mfma_f32_16x16x32_bf16 v[132:135], a[224:227], a[92:95], 0
    s_add_u32 s4, s4, s54
    v_mfma_f32_16x16x32_bf16 v[132:135], a[220:223], a[84:87], v[132:135]
    s_add_u32 s35, s4, 18432
    v_mfma_f32_16x16x32_bf16 v[132:135], a[216:219], a[76:79], v[132:135]
    s_lshr_b32 s54, s56, 1
    buffer_load_dwordx4 v5, s[24:27], s69 offen lds
    v_mfma_f32_16x16x32_bf16 v[104:107], a[228:231], a[168:171], v[104:107]
    s_mov_b32 m0, s47
    ds_read_b64_tr_b16 a[216:217], v11 offset:25344
    v_mfma_f32_16x16x32_bf16 v[104:107], a[232:235], a[176:179], v[104:107]
    s_add_u32 s69, s62, 768
    ds_read_b64_tr_b16 a[218:219], v11 offset:27456
    v_mfma_f32_16x16x32_bf16 v[104:107], a[236:239], a[184:187], v[104:107]
    s_add_u32 s3, s67, 4096
    v_mfma_f32_16x16x32_bf16 v[108:111], a[236:239], v[72:75], v[108:111]
    s_lshl3_add_u32 s54, s54, s44
    v_mfma_f32_16x16x32_bf16 v[108:111], a[232:235], v[64:67], v[108:111]
    s_lshl_b32 s32, s54, 10
    ds_read_b64_tr_b16 a[220:221], v11 offset:29568
    v_mfma_f32_16x16x32_bf16 v[108:111], a[228:231], v[56:59], v[108:111]
    s_add_u32 s32, s32, 10485760
    ds_read_b64_tr_b16 a[222:223], v11 offset:31680
    v_mfma_f32_16x16x32_bf16 v[112:115], a[228:231], a[24:27], v[112:115]
    s_mov_b32 s16, s88
    v_mfma_f32_16x16x32_bf16 v[112:115], a[232:235], a[32:35], v[112:115]
    s_mov_b32 s17, s89
    buffer_load_dwordx4 v5, s[24:27], s69 offen lds
    v_mfma_f32_16x16x32_bf16 v[112:115], a[236:239], a[40:43], v[112:115]
    s_add_u32 m0, m0, s43
    ds_read_b64_tr_b16 a[224:225], v11 offset:33792
    v_mfma_f32_16x16x32_bf16 v[116:119], a[236:239], a[112:115], v[116:119]
    s_add_u32 s69, s69, s86
    ds_read_b64_tr_b16 a[226:227], v11 offset:35904
    v_mfma_f32_16x16x32_bf16 v[116:119], a[232:235], a[104:107], v[116:119]
    s_mov_b32 s18, 2359296
    buffer_store_dwordx4 v[180:183], v1, s[12:15], s3 offen sc1
    v_mfma_f32_16x16x32_bf16 v[116:119], a[228:231], a[96:99], v[116:119]
    s_mov_b32 s19, 0x00020000
    v_mfma_f32_16x16x32_bf16 v[120:123], a[228:231], a[172:175], v[120:123]
    s_mov_b64 s[20:21], 0
    v_mfma_f32_16x16x32_bf16 v[120:123], a[232:235], a[180:183], v[120:123]
    s_lshl_b32 s33, s44, 12
    v_mfma_f32_16x16x32_bf16 v[120:123], a[236:239], a[188:191], v[120:123]
    s_lshl_b32 s34, s44, 10
    v_mfma_f32_16x16x32_bf16 v[124:127], a[236:239], v[76:79], v[124:127]
    s_add_u32 s36, s74, 16384
    buffer_load_dwordx4 v5, s[24:27], s69 offen lds
    v_mfma_f32_16x16x32_bf16 v[124:127], a[232:235], v[68:71], v[124:127]
    s_add_u32 m0, m0, s43
    v_mfma_f32_16x16x32_bf16 v[124:127], a[228:231], v[60:63], v[124:127]
    s_add_u32 s69, s69, s86
    v_mfma_f32_16x16x32_bf16 v[128:131], a[228:231], a[28:31], v[128:131]
    s_add_u32 s37, s74, 17408
    v_mfma_f32_16x16x32_bf16 v[128:131], a[232:235], a[36:39], v[128:131]
    s_add_u32 s74, s74, s33
    v_mfma_f32_16x16x32_bf16 v[128:131], a[236:239], a[44:47], v[128:131]
    s_waitcnt lgkmcnt(0)
    v_mfma_f32_16x16x32_bf16 v[132:135], a[236:239], a[116:119], v[132:135]
    s_waitcnt vmcnt(7)
    v_mfma_f32_16x16x32_bf16 v[132:135], a[232:235], a[108:111], v[132:135]
    s_barrier
    v_mfma_f32_16x16x32_bf16 v[132:135], a[228:231], a[100:103], v[132:135]
    buffer_load_dwordx4 v5, s[24:27], s69 offen lds
    v_mfma_f32_16x16x32_bf16 v[104:107], a[216:219], a[192:195], v[104:107]
    s_add_u32 m0, m0, s43
    ds_read_b64_tr_b16 a[228:229], v25 offset:0
    v_mfma_f32_16x16x32_bf16 v[104:107], a[220:223], a[200:203], v[104:107]
    s_add_u32 s69, s69, s86
    ds_read_b64_tr_b16 a[230:231], v25 offset:2112
    v_mfma_f32_16x16x32_bf16 v[136:139], a[224:227], a[208:211], v[104:107]
    s_cmp_eq_u32 s44, 0
    s_cselect_b32 s36, s36, 536870912
    v_mfma_f32_16x16x32_bf16 v[108:111], a[224:227], v[96:99], v[108:111]
    s_cmp_eq_u32 s44, 1
    s_cselect_b32 s37, s37, 536870912
    v_mfma_f32_16x16x32_bf16 v[108:111], a[220:223], v[88:91], v[108:111]
    s_mul_i32 s54, s44, 2560
    ds_read_b64_tr_b16 a[232:233], v25 offset:4224
    v_mfma_f32_16x16x32_bf16 v[140:143], a[216:219], v[80:83], v[108:111]
    s_add_u32 s54, s54, 136192
    ds_read_b64_tr_b16 a[234:235], v25 offset:6336
    v_mfma_f32_16x16x32_bf16 v[112:115], a[216:219], a[48:51], v[112:115]
    s_add_u32 s6, s67, 40960
    v_mfma_f32_16x16x32_bf16 v[112:115], a[220:223], a[56:59], v[112:115]
    s_add_u32 s55, s44, 1
    buffer_load_dwordx4 v5, s[24:27], s69 offen lds
    v_mfma_f32_16x16x32_bf16 v[144:147], a[224:227], a[64:67], v[112:115]
    s_add_u32 m0, m0, s43
    ds_read_b64_tr_b16 a[236:237], v25 offset:8448
    v_mfma_f32_16x16x32_bf16 v[116:119], a[224:227], a[136:139], v[116:119]
    s_add_u32 s69, s69, s86
    ds_read_b64_tr_b16 a[238:239], v25 offset:10560
    v_mfma_f32_16x16x32_bf16 v[116:119], a[220:223], a[128:131], v[116:119]
    s_and_b32 s55, s55, 3
    v_mfma_f32_16x16x32_bf16 v[148:151], a[216:219], a[120:123], v[116:119]
    s_mul_i32 s55, s55, 2560
    v_mfma_f32_16x16x32_bf16 v[120:123], a[216:219], a[196:199], v[120:123]
    s_add_u32 s55, s55, 136192
    buffer_store_dwordx4 v[188:191], v1, s[12:15], s6 offen sc1
    v_mfma_f32_16x16x32_bf16 v[120:123], a[220:223], a[204:207], v[120:123]
    v_cvt_pk_bf16_f32 v208, v136, v137
    v_cvt_pk_bf16_f32 v209, v138, v139
    v_mfma_f32_16x16x32_bf16 v[152:155], a[224:227], a[212:215], v[120:123]
    v_cvt_pk_bf16_f32 v210, v140, v141
    v_cvt_pk_bf16_f32 v211, v142, v143
    v_mfma_f32_16x16x32_bf16 v[124:127], a[224:227], v[100:103], v[124:127]
    buffer_load_dwordx4 v5, s[24:27], s69 offen lds
    v_mfma_f32_16x16x32_bf16 v[124:127], a[220:223], v[92:95], v[124:127]
    s_add_u32 m0, m0, s43
    v_add_u32 v10, s54, v1
    v_add_u32 v8, s55, v1
    v_mfma_f32_16x16x32_bf16 v[156:159], a[216:219], v[84:87], v[124:127]
    s_add_u32 s69, s69, s86
    v_lshlrev_b32 v250, 3, v29
    v_add_u32 v18, s54, v250
    v_mfma_f32_16x16x32_bf16 v[128:131], a[216:219], a[52:55], v[128:131]
    v_add_u32 v9, s55, v250
    v_and_b32 v244, 31, v29
    v_mfma_f32_16x16x32_bf16 v[128:131], a[220:223], a[60:63], v[128:131]
    v_cvt_pk_bf16_f32 v216, v144, v145
    v_cvt_pk_bf16_f32 v217, v146, v147
    v_mfma_f32_16x16x32_bf16 v[160:163], a[224:227], a[68:71], v[128:131]
    s_waitcnt lgkmcnt(0)
    v_cvt_pk_bf16_f32 v218, v148, v149
    v_cvt_pk_bf16_f32 v219, v150, v151
    v_mfma_f32_16x16x32_bf16 v[132:135], a[224:227], a[140:143], v[132:135]
    v_lshrrev_b32 v247, 5, v29
    v_lshlrev_b32 v19, 3, v244
    v_mfma_f32_16x16x32_bf16 v[132:135], a[220:223], a[132:135], v[132:135]
    v_add_u32 v19, 134144, v19
    v_lshlrev_b32 v28, 2, v244
    v_mfma_f32_16x16x32_bf16 v[164:167], a[216:219], a[124:127], v[132:135]
    buffer_load_dwordx4 v5, s[24:27], s69 offen lds
    v_mfma_f32_16x16x32_bf16 v[104:107], a[228:231], a[144:147], 0
    s_add_u32 m0, m0, s43
    ds_read_b64_tr_b16 a[216:217], v25 offset:12672
    v_lshl_or_b32 v28, v247, 1, v28
    v_mfma_f32_16x16x32_bf16 v[104:107], a[232:235], a[152:155], v[104:107]
    s_add_u32 s69, s69, s86
    ds_read_b64_tr_b16 a[218:219], v25 offset:14784
    v_cvt_pk_bf16_f32 v224, v152, v153
    v_mfma_f32_16x16x32_bf16 v[104:107], a[236:239], a[160:163], v[104:107]
    v_cvt_pk_bf16_f32 v225, v154, v155
    v_cvt_pk_bf16_f32 v226, v156, v157
    v_mfma_f32_16x16x32_bf16 v[108:111], a[236:239], v[48:51], 0
    v_cvt_pk_bf16_f32 v227, v158, v159
    v_and_b32 v245, 7, v244
    v_mfma_f32_16x16x32_bf16 v[108:111], a[232:235], v[40:43], v[108:111]
    ds_read_b64_tr_b16 a[220:221], v25 offset:16896
    v_lshrrev_b32 v246, 4, v244
    v_mfma_f32_16x16x32_bf16 v[108:111], a[228:231], v[32:35], v[108:111]
    ds_read_b64_tr_b16 a[222:223], v25 offset:19008
    v_lshl_or_b32 v245, v246, 3, v245
    v_mfma_f32_16x16x32_bf16 v[112:115], a[228:231], a[0:3], 0
    v_bfe_u32 v248, v244, 3, 1
    v_lshl_or_b32 v245, v245, 1, v248
    v_mfma_f32_16x16x32_bf16 v[112:115], a[232:235], a[8:11], v[112:115]
    buffer_load_dwordx4 v5, s[24:27], s69 offen lds
    v_mfma_f32_16x16x32_bf16 v[112:115], a[236:239], a[16:19], v[112:115]
    s_add_u32 m0, m0, s43
    ds_read_b64_tr_b16 a[224:225], v25 offset:21120
    v_cvt_pk_bf16_f32 v232, v160, v161
    v_mfma_f32_16x16x32_bf16 v[116:119], a[236:239], a[88:91], 0
    s_add_u32 s69, s69, s86
    ds_read_b64_tr_b16 a[226:227], v25 offset:23232
    v_cvt_pk_bf16_f32 v233, v162, v163
    v_mfma_f32_16x16x32_bf16 v[116:119], a[232:235], a[80:83], v[116:119]
    v_cvt_pk_bf16_f32 v234, v164, v165
    v_cvt_pk_bf16_f32 v235, v166, v167
    v_mfma_f32_16x16x32_bf16 v[116:119], a[228:231], a[72:75], v[116:119]
    v_lshlrev_b32 v245, 3, v245
    v_lshl_or_b32 v2, v247, 15, v245
    v_mfma_f32_16x16x32_bf16 v[120:123], a[228:231], a[148:151], 0
    v_lshl_or_b32 v3, v247, 8, v245
    v_and_b32 v245, 15, v244
    v_mfma_f32_16x16x32_bf16 v[120:123], a[232:235], a[156:159], v[120:123]
    s_add_u32 s7, s67, 77824
    v_lshlrev_b32 v24, 2, v245
    v_lshlrev_b32 v26, 4, v245
    v_mfma_f32_16x16x32_bf16 v[120:123], a[236:239], a[164:167], v[120:123]
    v_lshl_or_b32 v26, v246, 15, v26
    v_lshl_or_b32 v26, v247, 8, v26
    v_mfma_f32_16x16x32_bf16 v[124:127], a[236:239], v[52:55], 0
    buffer_load_dwordx4 v5, s[24:27], s69 offen lds
    v_mfma_f32_16x16x32_bf16 v[124:127], a[232:235], v[44:47], v[124:127]
    s_add_u32 m0, m0, s43
    v_lshlrev_b32 v245, 4, v244
    v_lshl_or_b32 v249, v247, 3, v245
    v_mfma_f32_16x16x32_bf16 v[124:127], a[228:231], v[36:39], v[124:127]
    s_add_u32 s69, s69, s86
    v_lshl_or_b32 v23, v247, 12, v245
    v_add_u32 v23, 125952, v23
    v_mfma_f32_16x16x32_bf16 v[128:131], a[228:231], a[4:7], 0
    s_lshl_b32 s54, s44, 8
    v_lshl_add_u32 v6, s54, 1, v23
    v_add_u32 v7, s54, v19
    v_mfma_f32_16x16x32_bf16 v[128:131], a[232:235], a[12:15], v[128:131]
    buffer_store_dwordx4 v[196:199], v1, s[12:15], s7 offen sc1
    v_mfma_f32_16x16x32_bf16 v[128:131], a[236:239], a[20:23], v[128:131]
    s_waitcnt lgkmcnt(0)
    v_lshl_add_u32 v250, v247, 10, v7
    v_and_b32 v245, 3, v244
    v_mfma_f32_16x16x32_bf16 v[132:135], a[236:239], a[92:95], 0
    s_waitcnt vmcnt(7)
    v_and_b32 v246, 4, v244
    v_lshl_or_b32 v245, v246, 1, v245
    v_mfma_f32_16x16x32_bf16 v[132:135], a[232:235], a[84:87], v[132:135]
    s_barrier
    v_mfma_f32_16x16x32_bf16 v[132:135], a[228:231], a[76:79], v[132:135]
    buffer_load_dwordx4 v5, s[24:27], s69 offen lds
    v_mfma_f32_16x16x32_bf16 v[104:107], a[216:219], a[168:171], v[104:107]
    s_add_u32 m0, m0, s43
    ds_read_b64_tr_b16 a[228:229], v25 offset:25344
    v_and_b32 v246, 8, v244
    v_mfma_f32_16x16x32_bf16 v[104:107], a[220:223], a[176:179], v[104:107]
    s_add_u32 s69, s62, 896
    ds_read_b64_tr_b16 a[230:231], v25 offset:27456
    v_lshrrev_b32 v246, 1, v246
    v_mfma_f32_16x16x32_bf16 v[104:107], a[224:227], a[184:187], v[104:107]
    v_or_b32 v245, v245, v246
    v_cmp_gt_u32 vcc, 16, v244
    v_mfma_f32_16x16x32_bf16 v[108:111], a[224:227], v[72:75], v[108:111]
    v_bfe_u32 v246, v244, 2, 1
    v_add_u32 v246, 16, v246
    v_mfma_f32_16x16x32_bf16 v[108:111], a[220:223], v[64:67], v[108:111]
    ds_read_b64_tr_b16 a[232:233], v25 offset:29568
    v_mul_u32_u24 v248, 9344, v247
    v_mfma_f32_16x16x32_bf16 v[108:111], a[216:219], v[56:59], v[108:111]
    ds_read_b64_tr_b16 a[234:235], v25 offset:31680
    v_cndmask_b32 v245, v246, v245, vcc
    v_mfma_f32_16x16x32_bf16 v[112:115], a[216:219], a[24:27], v[112:115]
    v_lshl_add_u32 v4, v245, 4, v248
    v_and_b32 v246, 27, v244
    v_mfma_f32_16x16x32_bf16 v[112:115], a[220:223], a[32:35], v[112:115]
    buffer_load_dwordx4 v5, s[24:27], s69 offen lds
    v_mfma_f32_16x16x32_bf16 v[112:115], a[224:227], a[40:43], v[112:115]
    s_add_u32 m0, m0, s43
    ds_read_b64_tr_b16 a[236:237], v25 offset:33792
    v_cmp_lt_u32 vcc, 17, v246
    v_mfma_f32_16x16x32_bf16 v[116:119], a[224:227], a[112:115], v[116:119]
    s_add_u32 s69, s69, s86
    ds_read_b64_tr_b16 a[238:239], v25 offset:35904
    v_mov_b32 v248, 536870912
    v_mfma_f32_16x16x32_bf16 v[116:119], a[220:223], a[104:107], v[116:119]
    v_mov_b32 v254, 1065369472
    v_cndmask_b32 v4, v4, v248, vcc
    v_mfma_f32_16x16x32_bf16 v[116:119], a[216:219], a[96:99], v[116:119]
    v_cmp_eq_u32 vcc, 17, v246
    v_mov_b32 v248, s22
    v_mfma_f32_16x16x32_bf16 v[120:123], a[216:219], a[172:175], v[120:123]
    v_mfma_f32_16x16x32_bf16 v[120:123], a[220:223], a[180:183], v[120:123]
    v_cndmask_b32 v4, v4, v248, vcc
    v_add_u32 v0, 18688, v4
    v_mfma_f32_16x16x32_bf16 v[120:123], a[224:227], a[188:191], v[120:123]
    v_bfe_u32 v245, v29, 2, 2
    v_lshrrev_b32 v246, 4, v29
    v_mfma_f32_16x16x32_bf16 v[124:127], a[224:227], v[76:79], v[124:127]
    buffer_load_dwordx4 v5, s[24:27], s69 offen lds
    v_mfma_f32_16x16x32_bf16 v[124:127], a[220:223], v[68:71], v[124:127]
    s_add_u32 m0, m0, s43
    v_cmp_eq_u32 vcc, v245, v246
    v_and_b32 v247, 1, v29
    v_mfma_f32_16x16x32_bf16 v[124:127], a[216:219], v[60:63], v[124:127]
    s_add_u32 s69, s69, s86
    v_lshlrev_b32 v247, 4, v247
    v_mov_b32 v248, 0x3f80
    v_mfma_f32_16x16x32_bf16 v[128:131], a[216:219], a[28:31], v[128:131]
    v_lshlrev_b32 v247, v247, v248
    v_cndmask_b32 v247, 0, v247, vcc
    v_mfma_f32_16x16x32_bf16 v[128:131], a[220:223], a[36:39], v[128:131]
    s_add_u32 s75, s67, 114688
    v_bfe_u32 v248, v29, 1, 1
    v_cmp_eq_u32 vcc, 1, v248
    v_mfma_f32_16x16x32_bf16 v[128:131], a[224:227], a[44:47], v[128:131]
    s_waitcnt lgkmcnt(0)
    v_mov_b32 v253, 0
    v_mov_b32 v245, 162816
    v_mfma_f32_16x16x32_bf16 v[132:135], a[224:227], a[116:119], v[132:135]
    v_cndmask_b32 v248, 0, v247, vcc
    v_sub_u32 v247, v247, v248
    v_mfma_f32_16x16x32_bf16 v[132:135], a[220:223], a[108:111], v[132:135]
    v_accvgpr_write_b32 a254, v247
    v_accvgpr_write_b32 a255, v248
    v_mfma_f32_16x16x32_bf16 v[132:135], a[216:219], a[100:103], v[132:135]
    buffer_load_dwordx4 v5, s[24:27], s69 offen lds
    v_mfma_f32_16x16x32_bf16 v[104:107], a[228:231], a[192:195], v[104:107]
    s_add_u32 m0, m0, s43
    ds_read_b64_tr_b16 a[216:217], v11 offset:0
    v_mfma_f32_16x16x32_bf16 v[104:107], a[232:235], a[200:203], v[104:107]
    s_add_u32 s69, s69, s86
    ds_read_b64_tr_b16 a[218:219], v11 offset:2112
    v_mfma_f32_16x16x32_bf16 v[136:139], a[236:239], a[208:211], v[104:107]
    buffer_store_dwordx4 v[168:171], v1, s[12:15], s75 offen sc1
    v_mfma_f32_16x16x32_bf16 v[108:111], a[236:239], v[96:99], v[108:111]
    ds_write_b32 v245, v253
    v_mfma_f32_16x16x32_bf16 v[108:111], a[232:235], v[88:91], v[108:111]
    s_mov_b32 s54, 12582912
    ds_read_b64_tr_b16 a[220:221], v11 offset:4224
    v_mfma_f32_16x16x32_bf16 v[140:143], a[228:231], v[80:83], v[108:111]
    s_lshl_b32 s55, s44, 11
    ds_read_b64_tr_b16 a[222:223], v11 offset:6336
    v_mfma_f32_16x16x32_bf16 v[112:115], a[228:231], a[48:51], v[112:115]
    v_mfma_f32_16x16x32_bf16 v[112:115], a[232:235], a[56:59], v[112:115]
    buffer_load_dwordx4 v5, s[24:27], s69 offen lds
    v_mfma_f32_16x16x32_bf16 v[144:147], a[236:239], a[64:67], v[112:115]
    s_add_u32 m0, m0, s43
    ds_read_b64_tr_b16 a[224:225], v11 offset:8448
    v_mfma_f32_16x16x32_bf16 v[116:119], a[236:239], a[136:139], v[116:119]
    s_add_u32 s69, s69, s86
    ds_read_b64_tr_b16 a[226:227], v11 offset:10560
    v_mfma_f32_16x16x32_bf16 v[116:119], a[232:235], a[128:131], v[116:119]
    v_mfma_f32_16x16x32_bf16 v[148:151], a[228:231], a[120:123], v[116:119]
    v_mfma_f32_16x16x32_bf16 v[120:123], a[228:231], a[196:199], v[120:123]
    v_mfma_f32_16x16x32_bf16 v[120:123], a[232:235], a[204:207], v[120:123]
    v_cvt_pk_bf16_f32 v236, v136, v137
    v_cvt_pk_bf16_f32 v237, v138, v139
    v_mfma_f32_16x16x32_bf16 v[152:155], a[236:239], a[212:215], v[120:123]
    v_cvt_pk_bf16_f32 v238, v140, v141
    v_cvt_pk_bf16_f32 v239, v142, v143
    v_mfma_f32_16x16x32_bf16 v[124:127], a[236:239], v[100:103], v[124:127]
    buffer_load_dwordx4 v5, s[24:27], s69 offen lds
    v_mfma_f32_16x16x32_bf16 v[124:127], a[232:235], v[92:95], v[124:127]
    s_add_u32 m0, m0, s43
    v_mfma_f32_16x16x32_bf16 v[156:159], a[228:231], v[84:87], v[124:127]
    s_add_u32 s69, s69, s86
    v_mfma_f32_16x16x32_bf16 v[128:131], a[228:231], a[52:55], v[128:131]
    v_mfma_f32_16x16x32_bf16 v[128:131], a[232:235], a[60:63], v[128:131]
    v_cvt_pk_bf16_f32 v240, v144, v145
    v_cvt_pk_bf16_f32 v241, v146, v147
    v_mfma_f32_16x16x32_bf16 v[160:163], a[236:239], a[68:71], v[128:131]
    s_waitcnt lgkmcnt(0)
    v_cvt_pk_bf16_f32 v242, v148, v149
    v_cvt_pk_bf16_f32 v243, v150, v151
    v_mfma_f32_16x16x32_bf16 v[132:135], a[236:239], a[140:143], v[132:135]
    s_waitcnt vmcnt(6)
    v_mfma_f32_16x16x32_bf16 v[132:135], a[232:235], a[132:135], v[132:135]
    s_barrier
    v_mfma_f32_16x16x32_bf16 v[164:167], a[228:231], a[124:127], v[132:135]
    buffer_load_dwordx4 v5, s[24:27], s69 offen lds
    v_mfma_f32_16x16x32_bf16 v[104:107], a[216:219], a[144:147], 0
    s_add_u32 m0, m0, s43
    ds_read_b64_tr_b16 a[228:229], v11 offset:12672
    v_mfma_f32_16x16x32_bf16 v[104:107], a[220:223], a[152:155], v[104:107]
    s_add_u32 s69, s69, s86
    ds_read_b64_tr_b16 a[230:231], v11 offset:14784
    v_cvt_pk_bf16_f32 v172, v152, v153
    v_mfma_f32_16x16x32_bf16 v[104:107], a[224:227], a[160:163], v[104:107]
    s_add_u32 s3, s67, 8192
    v_cvt_pk_bf16_f32 v173, v154, v155
    v_cvt_pk_bf16_f32 v174, v156, v157
    v_mfma_f32_16x16x32_bf16 v[108:111], a[224:227], v[48:51], 0
    v_cvt_pk_bf16_f32 v175, v158, v159
    v_mfma_f32_16x16x32_bf16 v[108:111], a[220:223], v[40:43], v[108:111]
    ds_read_b64_tr_b16 a[232:233], v11 offset:16896
    v_mfma_f32_16x16x32_bf16 v[108:111], a[216:219], v[32:35], v[108:111]
    ds_read_b64_tr_b16 a[234:235], v11 offset:19008
    v_mfma_f32_16x16x32_bf16 v[112:115], a[216:219], a[0:3], 0
    v_mfma_f32_16x16x32_bf16 v[112:115], a[220:223], a[8:11], v[112:115]
    buffer_load_dwordx4 v5, s[24:27], s69 offen lds
    v_mfma_f32_16x16x32_bf16 v[112:115], a[224:227], a[16:19], v[112:115]
    s_add_u32 m0, m0, s43
    ds_read_b64_tr_b16 a[236:237], v11 offset:21120
    v_cvt_pk_bf16_f32 v180, v160, v161
    v_mfma_f32_16x16x32_bf16 v[116:119], a[224:227], a[88:91], 0
    s_add_u32 s69, s69, s86
    ds_read_b64_tr_b16 a[238:239], v11 offset:23232
    v_cvt_pk_bf16_f32 v181, v162, v163
    v_mfma_f32_16x16x32_bf16 v[116:119], a[220:223], a[80:83], v[116:119]
    buffer_store_dwordx4 v[204:207], v1, s[12:15], s3 offen sc1
    v_mfma_f32_16x16x32_bf16 v[116:119], a[216:219], a[72:75], v[116:119]
    v_cvt_pk_bf16_f32 v182, v164, v165
    v_cvt_pk_bf16_f32 v183, v166, v167
    v_mfma_f32_16x16x32_bf16 v[120:123], a[216:219], a[148:151], 0
    v_mfma_f32_16x16x32_bf16 v[120:123], a[220:223], a[156:159], v[120:123]
    v_mfma_f32_16x16x32_bf16 v[120:123], a[224:227], a[164:167], v[120:123]
    v_mfma_f32_16x16x32_bf16 v[124:127], a[224:227], v[52:55], 0
    buffer_load_dwordx4 v5, s[24:27], s69 offen lds
    v_mfma_f32_16x16x32_bf16 v[124:127], a[220:223], v[44:47], v[124:127]
    s_add_u32 m0, m0, s43
    v_mfma_f32_16x16x32_bf16 v[124:127], a[216:219], v[36:39], v[124:127]
    s_add_u32 s69, s69, s86
    v_mfma_f32_16x16x32_bf16 v[128:131], a[216:219], a[4:7], 0
    v_mfma_f32_16x16x32_bf16 v[128:131], a[220:223], a[12:15], v[128:131]
    v_mfma_f32_16x16x32_bf16 v[128:131], a[224:227], a[20:23], v[128:131]
    s_waitcnt lgkmcnt(0)
    v_mfma_f32_16x16x32_bf16 v[132:135], a[224:227], a[92:95], 0
    v_mfma_f32_16x16x32_bf16 v[132:135], a[220:223], a[84:87], v[132:135]
    v_mfma_f32_16x16x32_bf16 v[132:135], a[216:219], a[76:79], v[132:135]
    buffer_load_dwordx4 v5, s[24:27], s69 offen lds
    v_mfma_f32_16x16x32_bf16 v[104:107], a[228:231], a[168:171], v[104:107]
    s_mov_b32 m0, s47
    ds_read_b64_tr_b16 a[216:217], v11 offset:25344
    v_mfma_f32_16x16x32_bf16 v[104:107], a[232:235], a[176:179], v[104:107]
    s_add_u32 s69, s62, 1024
    ds_read_b64_tr_b16 a[218:219], v11 offset:27456
    v_mfma_f32_16x16x32_bf16 v[104:107], a[236:239], a[184:187], v[104:107]
    v_mfma_f32_16x16x32_bf16 v[108:111], a[236:239], v[72:75], v[108:111]
    v_mfma_f32_16x16x32_bf16 v[108:111], a[232:235], v[64:67], v[108:111]
    ds_read_b64_tr_b16 a[220:221], v11 offset:29568
    v_mfma_f32_16x16x32_bf16 v[108:111], a[228:231], v[56:59], v[108:111]
    ds_read_b64_tr_b16 a[222:223], v11 offset:31680
    v_mfma_f32_16x16x32_bf16 v[112:115], a[228:231], a[24:27], v[112:115]
    v_mfma_f32_16x16x32_bf16 v[112:115], a[232:235], a[32:35], v[112:115]
    s_add_u32 s6, s67, 45056
    buffer_load_dwordx4 v5, s[24:27], s69 offen lds
    v_mfma_f32_16x16x32_bf16 v[112:115], a[236:239], a[40:43], v[112:115]
    s_add_u32 m0, m0, s43
    ds_read_b64_tr_b16 a[224:225], v11 offset:33792
    v_mfma_f32_16x16x32_bf16 v[116:119], a[236:239], a[112:115], v[116:119]
    s_add_u32 s69, s69, s86
    ds_read_b64_tr_b16 a[226:227], v11 offset:35904
    v_mfma_f32_16x16x32_bf16 v[116:119], a[232:235], a[104:107], v[116:119]
    v_mfma_f32_16x16x32_bf16 v[116:119], a[228:231], a[96:99], v[116:119]
    v_mfma_f32_16x16x32_bf16 v[120:123], a[228:231], a[172:175], v[120:123]
    v_mfma_f32_16x16x32_bf16 v[120:123], a[232:235], a[180:183], v[120:123]
    buffer_store_dwordx4 v[176:179], v1, s[12:15], s6 offen sc1
    v_mfma_f32_16x16x32_bf16 v[120:123], a[236:239], a[188:191], v[120:123]
    v_mfma_f32_16x16x32_bf16 v[124:127], a[236:239], v[76:79], v[124:127]
    buffer_load_dwordx4 v5, s[24:27], s69 offen lds
    v_mfma_f32_16x16x32_bf16 v[124:127], a[232:235], v[68:71], v[124:127]
    s_add_u32 m0, m0, s43
    v_mfma_f32_16x16x32_bf16 v[124:127], a[228:231], v[60:63], v[124:127]
    s_add_u32 s69, s69, s86
    v_mfma_f32_16x16x32_bf16 v[128:131], a[228:231], a[28:31], v[128:131]
    v_mfma_f32_16x16x32_bf16 v[128:131], a[232:235], a[36:39], v[128:131]
    v_mfma_f32_16x16x32_bf16 v[128:131], a[236:239], a[44:47], v[128:131]
    s_waitcnt lgkmcnt(0)
    v_mfma_f32_16x16x32_bf16 v[132:135], a[236:239], a[116:119], v[132:135]
    s_waitcnt vmcnt(7)
    v_mfma_f32_16x16x32_bf16 v[132:135], a[232:235], a[108:111], v[132:135]
    s_barrier
    v_mfma_f32_16x16x32_bf16 v[132:135], a[228:231], a[100:103], v[132:135]
    buffer_load_dwordx4 v5, s[24:27], s69 offen lds
    v_mfma_f32_16x16x32_bf16 v[104:107], a[216:219], a[192:195], v[104:107]
    s_add_u32 m0, m0, s43
    ds_read_b64_tr_b16 a[228:229], v25 offset:0
    v_mfma_f32_16x16x32_bf16 v[104:107], a[220:223], a[200:203], v[104:107]
    s_add_u32 s69, s69, s86
    ds_read_b64_tr_b16 a[230:231], v25 offset:2112
    v_mfma_f32_16x16x32_bf16 v[136:139], a[224:227], a[208:211], v[104:107]
    v_mfma_f32_16x16x32_bf16 v[108:111], a[224:227], v[96:99], v[108:111]
    v_mfma_f32_16x16x32_bf16 v[108:111], a[220:223], v[88:91], v[108:111]
    ds_read_b64_tr_b16 a[232:233], v25 offset:4224
    v_mfma_f32_16x16x32_bf16 v[140:143], a[216:219], v[80:83], v[108:111]
    ds_read_b64_tr_b16 a[234:235], v25 offset:6336
    v_mfma_f32_16x16x32_bf16 v[112:115], a[216:219], a[48:51], v[112:115]
    v_mfma_f32_16x16x32_bf16 v[112:115], a[220:223], a[56:59], v[112:115]
    buffer_load_dwordx4 v5, s[24:27], s69 offen lds
    v_mfma_f32_16x16x32_bf16 v[144:147], a[224:227], a[64:67], v[112:115]
    s_add_u32 m0, m0, s43
    ds_read_b64_tr_b16 a[236:237], v25 offset:8448
    v_mfma_f32_16x16x32_bf16 v[116:119], a[224:227], a[136:139], v[116:119]
    s_add_u32 s69, s69, s86
    ds_read_b64_tr_b16 a[238:239], v25 offset:10560
    v_mfma_f32_16x16x32_bf16 v[116:119], a[220:223], a[128:131], v[116:119]
    buffer_load_dwordx4 v[244:247], v1, s[12:15], s54 offen sc1
    v_mfma_f32_16x16x32_bf16 v[148:151], a[216:219], a[120:123], v[116:119]
    v_mfma_f32_16x16x32_bf16 v[120:123], a[216:219], a[196:199], v[120:123]
    v_mfma_f32_16x16x32_bf16 v[120:123], a[220:223], a[204:207], v[120:123]
    s_add_u32 s7, s67, 81920
    v_cvt_pk_bf16_f32 v188, v136, v137
    v_cvt_pk_bf16_f32 v189, v138, v139
    v_mfma_f32_16x16x32_bf16 v[152:155], a[224:227], a[212:215], v[120:123]
    v_cvt_pk_bf16_f32 v190, v140, v141
    v_cvt_pk_bf16_f32 v191, v142, v143
    v_mfma_f32_16x16x32_bf16 v[124:127], a[224:227], v[100:103], v[124:127]
    buffer_load_dwordx4 v5, s[24:27], s69 offen lds
    v_mfma_f32_16x16x32_bf16 v[124:127], a[220:223], v[92:95], v[124:127]
    s_add_u32 m0, m0, s43
    v_mfma_f32_16x16x32_bf16 v[156:159], a[216:219], v[84:87], v[124:127]
    s_add_u32 s69, s69, s86
    v_mfma_f32_16x16x32_bf16 v[128:131], a[216:219], a[52:55], v[128:131]
    v_mfma_f32_16x16x32_bf16 v[128:131], a[220:223], a[60:63], v[128:131]
    buffer_store_dwordx4 v[212:215], v1, s[12:15], s7 offen sc1
    v_mfma_f32_16x16x32_bf16 v[160:163], a[224:227], a[68:71], v[128:131]
    s_waitcnt lgkmcnt(0)
    v_cvt_pk_bf16_f32 v196, v144, v145
    v_cvt_pk_bf16_f32 v197, v146, v147
    v_mfma_f32_16x16x32_bf16 v[132:135], a[224:227], a[140:143], v[132:135]
    v_cvt_pk_bf16_f32 v198, v148, v149
    v_cvt_pk_bf16_f32 v199, v150, v151
    v_mfma_f32_16x16x32_bf16 v[132:135], a[220:223], a[132:135], v[132:135]
    v_mfma_f32_16x16x32_bf16 v[164:167], a[216:219], a[124:127], v[132:135]
    buffer_load_dwordx4 v5, s[24:27], s69 offen lds
    v_mfma_f32_16x16x32_bf16 v[104:107], a[228:231], a[144:147], 0
    s_add_u32 m0, m0, s43
    ds_read_b64_tr_b16 a[216:217], v25 offset:12672
    v_mfma_f32_16x16x32_bf16 v[104:107], a[232:235], a[152:155], v[104:107]
    s_add_u32 s69, s69, s86
    ds_read_b64_tr_b16 a[218:219], v25 offset:14784
    v_cvt_pk_bf16_f32 v168, v152, v153
    v_mfma_f32_16x16x32_bf16 v[104:107], a[236:239], a[160:163], v[104:107]
    v_cvt_pk_bf16_f32 v169, v154, v155
    v_cvt_pk_bf16_f32 v170, v156, v157
    v_mfma_f32_16x16x32_bf16 v[108:111], a[236:239], v[48:51], 0
    v_cvt_pk_bf16_f32 v171, v158, v159
    v_mfma_f32_16x16x32_bf16 v[108:111], a[232:235], v[40:43], v[108:111]
    ds_read_b64_tr_b16 a[220:221], v25 offset:16896
    v_mfma_f32_16x16x32_bf16 v[108:111], a[228:231], v[32:35], v[108:111]
    ds_read_b64_tr_b16 a[222:223], v25 offset:19008
    v_mfma_f32_16x16x32_bf16 v[112:115], a[228:231], a[0:3], 0
    v_mfma_f32_16x16x32_bf16 v[112:115], a[232:235], a[8:11], v[112:115]
    buffer_load_dwordx4 v5, s[24:27], s69 offen lds
    v_mfma_f32_16x16x32_bf16 v[112:115], a[236:239], a[16:19], v[112:115]
    s_add_u32 m0, m0, s43
    ds_read_b64_tr_b16 a[224:225], v25 offset:21120
    v_cvt_pk_bf16_f32 v204, v160, v161
    v_mfma_f32_16x16x32_bf16 v[116:119], a[236:239], a[88:91], 0
    s_add_u32 s69, s69, s86
    ds_read_b64_tr_b16 a[226:227], v25 offset:23232
    v_cvt_pk_bf16_f32 v205, v162, v163
    v_mfma_f32_16x16x32_bf16 v[116:119], a[232:235], a[80:83], v[116:119]
    v_cvt_pk_bf16_f32 v206, v164, v165
    v_cvt_pk_bf16_f32 v207, v166, v167
    v_mfma_f32_16x16x32_bf16 v[116:119], a[228:231], a[72:75], v[116:119]
    v_mfma_f32_16x16x32_bf16 v[120:123], a[228:231], a[148:151], 0
    v_mfma_f32_16x16x32_bf16 v[120:123], a[232:235], a[156:159], v[120:123]
    v_mfma_f32_16x16x32_bf16 v[120:123], a[236:239], a[164:167], v[120:123]
    v_mfma_f32_16x16x32_bf16 v[124:127], a[236:239], v[52:55], 0
    buffer_load_dwordx4 v5, s[24:27], s69 offen lds
    v_mfma_f32_16x16x32_bf16 v[124:127], a[232:235], v[44:47], v[124:127]
    s_add_u32 m0, m0, s43
    v_mfma_f32_16x16x32_bf16 v[124:127], a[228:231], v[36:39], v[124:127]
    s_add_u32 s69, s69, s86
    v_mfma_f32_16x16x32_bf16 v[128:131], a[228:231], a[4:7], 0
    v_mfma_f32_16x16x32_bf16 v[128:131], a[232:235], a[12:15], v[128:131]
    s_add_u32 s75, s67, 118784
    v_mfma_f32_16x16x32_bf16 v[128:131], a[236:239], a[20:23], v[128:131]
    s_waitcnt lgkmcnt(0)
    v_mfma_f32_16x16x32_bf16 v[132:135], a[236:239], a[92:95], 0
    s_waitcnt vmcnt(7)
    v_mfma_f32_16x16x32_bf16 v[132:135], a[232:235], a[84:87], v[132:135]
    s_barrier
    v_mfma_f32_16x16x32_bf16 v[132:135], a[228:231], a[76:79], v[132:135]
    buffer_load_dwordx4 v5, s[24:27], s69 offen lds
    v_mfma_f32_16x16x32_bf16 v[104:107], a[216:219], a[168:171], v[104:107]
    s_waitcnt vmcnt(6)
    ds_read_b64_tr_b16 a[228:229], v25 offset:25344
    v_and_b32 v244, v244, v245
    v_mfma_f32_16x16x32_bf16 v[104:107], a[220:223], a[176:179], v[104:107]
    ds_read_b64_tr_b16 a[230:231], v25 offset:27456
    v_and_b32 v246, v246, v247
    v_mfma_f32_16x16x32_bf16 v[104:107], a[224:227], a[184:187], v[104:107]
    buffer_store_dwordx4 v[184:187], v1, s[12:15], s75 offen sc1
    v_mfma_f32_16x16x32_bf16 v[108:111], a[224:227], v[72:75], v[108:111]
    v_and_b32 v244, v244, v246
    v_cmp_ne_u32 vcc, 1, v244
    v_mfma_f32_16x16x32_bf16 v[108:111], a[220:223], v[64:67], v[108:111]
    ds_read_b64_tr_b16 a[232:233], v25 offset:29568
    v_mfma_f32_16x16x32_bf16 v[108:111], a[216:219], v[56:59], v[108:111]
    ds_read_b64_tr_b16 a[234:235], v25 offset:31680
    v_mfma_f32_16x16x32_bf16 v[112:115], a[216:219], a[24:27], v[112:115]
    v_mfma_f32_16x16x32_bf16 v[112:115], a[220:223], a[32:35], v[112:115]
    v_mfma_f32_16x16x32_bf16 v[112:115], a[224:227], a[40:43], v[112:115]
    s_cbranch_vccnz L_f1_spin
L_f1_ok:
    ds_read_b64_tr_b16 a[236:237], v25 offset:33792
    v_mfma_f32_16x16x32_bf16 v[116:119], a[224:227], a[112:115], v[116:119]
    s_add_u32 m0, s55, 125952
    ds_read_b64_tr_b16 a[238:239], v25 offset:35904
    v_mfma_f32_16x16x32_bf16 v[116:119], a[220:223], a[104:107], v[116:119]
    buffer_load_dword v252, v249, s[12:15], s65 offen sc1
    v_mfma_f32_16x16x32_bf16 v[116:119], a[216:219], a[96:99], v[116:119]
    buffer_load_dwordx4 v1, s[12:15], s64 offen sc1 lds
    v_mfma_f32_16x16x32_bf16 v[120:123], a[216:219], a[172:175], v[120:123]
    buffer_load_dwordx4 v1, s[12:15], s64 offen offset:1024 sc1 lds
    v_mfma_f32_16x16x32_bf16 v[120:123], a[220:223], a[180:183], v[120:123]
    buffer_load_dword a252, v3, s[12:15], s53 offen offset:0 sc1
    v_mfma_f32_16x16x32_bf16 v[120:123], a[224:227], a[188:191], v[120:123]
    v_accvgpr_write_b32 a253, v254
    v_mfma_f32_16x16x32_bf16 v[124:127], a[224:227], v[76:79], v[124:127]
    v_mfma_f32_16x16x32_bf16 v[124:127], a[220:223], v[68:71], v[124:127]
    buffer_load_dwordx2 a[240:241], v2, s[12:15], s50 offen offset:0 sc1
    v_mfma_f32_16x16x32_bf16 v[124:127], a[216:219], v[60:63], v[124:127]
    v_mfma_f32_16x16x32_bf16 v[128:131], a[216:219], a[28:31], v[128:131]
    v_mfma_f32_16x16x32_bf16 v[128:131], a[220:223], a[36:39], v[128:131]
    buffer_load_dwordx2 a[242:243], v2, s[12:15], s51 offen offset:0 sc1
    v_mfma_f32_16x16x32_bf16 v[128:131], a[224:227], a[44:47], v[128:131]
    s_waitcnt lgkmcnt(0)
    v_mfma_f32_16x16x32_bf16 v[132:135], a[224:227], a[116:119], v[132:135]
    v_mfma_f32_16x16x32_bf16 v[132:135], a[220:223], a[108:111], v[132:135]
    buffer_load_dwordx2 a[244:245], v2, s[12:15], s50 offen offset:256 sc1
    v_mfma_f32_16x16x32_bf16 v[132:135], a[216:219], a[100:103], v[132:135]
    v_mfma_f32_16x16x32_bf16 v[104:107], a[228:231], a[192:195], v[104:107]
    ds_read_b64_tr_b16 a[216:217], v11 offset:0
    v_mfma_f32_16x16x32_bf16 v[104:107], a[232:235], a[200:203], v[104:107]
    ds_read_b64_tr_b16 a[218:219], v11 offset:2112
    v_mfma_f32_16x16x32_bf16 v[136:139], a[236:239], a[208:211], v[104:107]
    s_add_u32 s3, s67, 12288
    buffer_load_dwordx2 a[246:247], v2, s[12:15], s51 offen offset:256 sc1
    v_mfma_f32_16x16x32_bf16 v[108:111], a[236:239], v[96:99], v[108:111]
    s_add_u32 s70, s52, 0
    v_mfma_f32_16x16x32_bf16 v[108:111], a[232:235], v[88:91], v[108:111]
    ds_read_b64_tr_b16 a[220:221], v11 offset:4224
    v_mfma_f32_16x16x32_bf16 v[140:143], a[228:231], v[80:83], v[108:111]
    ds_read_b64_tr_b16 a[222:223], v11 offset:6336
    v_mfma_f32_16x16x32_bf16 v[112:115], a[228:231], a[48:51], v[112:115]
    buffer_load_dwordx4 a[248:251], v4, s[12:15], s70 offen sc1
    v_mfma_f32_16x16x32_bf16 v[112:115], a[232:235], a[56:59], v[112:115]
    v_mfma_f32_16x16x32_bf16 v[144:147], a[236:239], a[64:67], v[112:115]
    ds_read_b64_tr_b16 a[224:225], v11 offset:8448
    v_mfma_f32_16x16x32_bf16 v[116:119], a[236:239], a[136:139], v[116:119]
    ds_read_b64_tr_b16 a[226:227], v11 offset:10560
    v_mfma_f32_16x16x32_bf16 v[116:119], a[232:235], a[128:131], v[116:119]
    buffer_store_dwordx4 v[220:223], v1, s[12:15], s3 offen sc1
    v_mfma_f32_16x16x32_bf16 v[148:151], a[228:231], a[120:123], v[116:119]
    v_mfma_f32_16x16x32_bf16 v[120:123], a[228:231], a[196:199], v[120:123]
    v_mfma_f32_16x16x32_bf16 v[120:123], a[232:235], a[204:207], v[120:123]
    v_cvt_pk_bf16_f32 v176, v136, v137
    v_cvt_pk_bf16_f32 v177, v138, v139
    v_mfma_f32_16x16x32_bf16 v[152:155], a[236:239], a[212:215], v[120:123]
    v_cvt_pk_bf16_f32 v178, v140, v141
    v_cvt_pk_bf16_f32 v179, v142, v143
    v_mfma_f32_16x16x32_bf16 v[124:127], a[236:239], v[100:103], v[124:127]
    v_mfma_f32_16x16x32_bf16 v[124:127], a[232:235], v[92:95], v[124:127]
    v_mfma_f32_16x16x32_bf16 v[156:159], a[228:231], v[84:87], v[124:127]
    v_mfma_f32_16x16x32_bf16 v[128:131], a[228:231], a[52:55], v[128:131]
    v_mfma_f32_16x16x32_bf16 v[128:131], a[232:235], a[60:63], v[128:131]
    v_cvt_pk_bf16_f32 v212, v144, v145
    v_cvt_pk_bf16_f32 v213, v146, v147
    v_mfma_f32_16x16x32_bf16 v[160:163], a[236:239], a[68:71], v[128:131]
    s_waitcnt lgkmcnt(0)
    v_cvt_pk_bf16_f32 v214, v148, v149
    v_cvt_pk_bf16_f32 v215, v150, v151
    v_mfma_f32_16x16x32_bf16 v[132:135], a[236:239], a[140:143], v[132:135]
    s_waitcnt vmcnt(11)
    v_mfma_f32_16x16x32_bf16 v[132:135], a[232:235], a[132:135], v[132:135]
    s_barrier
    v_mfma_f32_16x16x32_bf16 v[164:167], a[228:231], a[124:127], v[132:135]
    v_mfma_f32_16x16x32_bf16 v[104:107], a[216:219], a[144:147], 0
    ds_read_b64_tr_b16 a[228:229], v11 offset:12672
    v_mfma_f32_16x16x32_bf16 v[104:107], a[220:223], a[152:155], v[104:107]
    ds_read_b64_tr_b16 a[230:231], v11 offset:14784
    v_cvt_pk_bf16_f32 v184, v152, v153
    v_mfma_f32_16x16x32_bf16 v[104:107], a[224:227], a[160:163], v[104:107]
    buffer_load_dwordx4 a[144:147], v0, s[12:15], s70 offen sc1
    v_mfma_f32_16x16x32_bf16 v[108:111], a[224:227], v[48:51], 0
    s_add_u32 s71, s52, 37376
    v_cvt_pk_bf16_f32 v185, v154, v155
    v_cvt_pk_bf16_f32 v186, v156, v157
    v_mfma_f32_16x16x32_bf16 v[108:111], a[220:223], v[40:43], v[108:111]
    ds_read_b64_tr_b16 a[232:233], v11 offset:16896
    v_cvt_pk_bf16_f32 v187, v158, v159
    v_mfma_f32_16x16x32_bf16 v[108:111], a[216:219], v[32:35], v[108:111]
    ds_read_b64_tr_b16 a[234:235], v11 offset:19008
    v_mfma_f32_16x16x32_bf16 v[112:115], a[216:219], a[0:3], 0
    buffer_load_dwordx4 a[152:155], v4, s[12:15], s71 offen sc1
    v_mfma_f32_16x16x32_bf16 v[112:115], a[220:223], a[8:11], v[112:115]
    v_cvt_pk_bf16_f32 v220, v160, v161
    v_cvt_pk_bf16_f32 v221, v162, v163
    v_mfma_f32_16x16x32_bf16 v[112:115], a[224:227], a[16:19], v[112:115]
    ds_read_b64_tr_b16 a[236:237], v11 offset:21120
    v_cvt_pk_bf16_f32 v222, v164, v165
    v_mfma_f32_16x16x32_bf16 v[116:119], a[224:227], a[88:91], 0
    ds_read_b64_tr_b16 a[238:239], v11 offset:23232
    v_cvt_pk_bf16_f32 v223, v166, v167
    v_mfma_f32_16x16x32_bf16 v[116:119], a[220:223], a[80:83], v[116:119]
    buffer_load_dwordx4 a[160:163], v0, s[12:15], s71 offen sc1
    v_mfma_f32_16x16x32_bf16 v[116:119], a[216:219], a[72:75], v[116:119]
    v_mfma_f32_16x16x32_bf16 v[120:123], a[216:219], a[148:151], 0
    v_mfma_f32_16x16x32_bf16 v[120:123], a[220:223], a[156:159], v[120:123]
    buffer_load_dword v34, v3, s[12:15], s53 offen offset:512 sc1
    v_mfma_f32_16x16x32_bf16 v[120:123], a[224:227], a[164:167], v[120:123]
    v_mov_b32 v35, 1065369472
    v_mfma_f32_16x16x32_bf16 v[124:127], a[224:227], v[52:55], 0
    v_mfma_f32_16x16x32_bf16 v[124:127], a[220:223], v[44:47], v[124:127]
    s_waitcnt vmcnt(11)
    ds_write_b64 v250, v[252:253]
    v_mfma_f32_16x16x32_bf16 v[124:127], a[216:219], v[36:39], v[124:127]
    buffer_load_dwordx2 a[0:1], v2, s[12:15], s50 offen offset:512 sc1
    v_mfma_f32_16x16x32_bf16 v[128:131], a[216:219], a[4:7], 0
    v_mfma_f32_16x16x32_bf16 v[128:131], a[220:223], a[12:15], v[128:131]
    v_mfma_f32_16x16x32_bf16 v[128:131], a[224:227], a[20:23], v[128:131]
    s_waitcnt lgkmcnt(1)
    buffer_load_dwordx2 a[2:3], v2, s[12:15], s51 offen offset:512 sc1
    v_mfma_f32_16x16x32_bf16 v[132:135], a[224:227], a[92:95], 0
    v_mfma_f32_16x16x32_bf16 v[132:135], a[220:223], a[84:87], v[132:135]
    v_mfma_f32_16x16x32_bf16 v[132:135], a[216:219], a[76:79], v[132:135]
    buffer_load_dwordx2 a[8:9], v2, s[12:15], s50 offen offset:768 sc1
    v_mfma_f32_16x16x32_bf16 v[104:107], a[228:231], a[168:171], v[104:107]
    ds_read_b64_tr_b16 a[216:217], v11 offset:25344
    v_mfma_f32_16x16x32_bf16 v[104:107], a[232:235], a[176:179], v[104:107]
    ds_read_b64_tr_b16 a[218:219], v11 offset:27456
    v_mfma_f32_16x16x32_bf16 v[104:107], a[236:239], a[184:187], v[104:107]
    buffer_load_dwordx2 a[10:11], v2, s[12:15], s51 offen offset:768 sc1
    v_mfma_f32_16x16x32_bf16 v[108:111], a[236:239], v[72:75], v[108:111]
    s_add_u32 s70, s52, 74752
    v_mfma_f32_16x16x32_bf16 v[108:111], a[232:235], v[64:67], v[108:111]
    ds_read_b64_tr_b16 a[220:221], v11 offset:29568
    v_mfma_f32_16x16x32_bf16 v[108:111], a[228:231], v[56:59], v[108:111]
    ds_read_b64_tr_b16 a[222:223], v11 offset:31680
    v_mfma_f32_16x16x32_bf16 v[112:115], a[228:231], a[24:27], v[112:115]
    buffer_load_dwordx4 a[16:19], v4, s[12:15], s70 offen sc1
    v_mfma_f32_16x16x32_bf16 v[112:115], a[232:235], a[32:35], v[112:115]
    v_mfma_f32_16x16x32_bf16 v[112:115], a[236:239], a[40:43], v[112:115]
    ds_read_b64_tr_b16 a[224:225], v11 offset:33792
    v_mfma_f32_16x16x32_bf16 v[116:119], a[236:239], a[112:115], v[116:119]
    ds_read_b64_tr_b16 a[226:227], v11 offset:35904
    v_mfma_f32_16x16x32_bf16 v[116:119], a[232:235], a[104:107], v[116:119]
    buffer_load_dwordx4 a[88:91], v0, s[12:15], s70 offen sc1
    v_mfma_f32_16x16x32_bf16 v[116:119], a[228:231], a[96:99], v[116:119]
    s_add_u32 s71, s52, 112128
    v_mfma_f32_16x16x32_bf16 v[120:123], a[228:231], a[172:175], v[120:123]
    v_mfma_f32_16x16x32_bf16 v[120:123], a[232:235], a[180:183], v[120:123]
    buffer_load_dwordx4 a[80:83], v4, s[12:15], s71 offen sc1
    v_mfma_f32_16x16x32_bf16 v[120:123], a[236:239], a[188:191], v[120:123]
    s_waitcnt lgkmcnt(0)
    v_mfma_f32_16x16x32_bf16 v[124:127], a[236:239], v[76:79], v[124:127]
    s_barrier
    ds_read_b64 v[16:17], v7
    v_mfma_f32_16x16x32_bf16 v[124:127], a[232:235], v[68:71], v[124:127]
    ds_read2st64_b64 v[12:15], v6 offset0:0 offset1:4
    v_mfma_f32_16x16x32_bf16 v[124:127], a[228:231], v[60:63], v[124:127]
    buffer_load_dwordx4 a[72:75], v0, s[12:15], s71 offen sc1
    v_mfma_f32_16x16x32_bf16 v[128:131], a[228:231], a[28:31], v[128:131]
    v_mfma_f32_16x16x32_bf16 v[128:131], a[232:235], a[36:39], v[128:131]
    v_mfma_f32_16x16x32_bf16 v[128:131], a[236:239], a[44:47], v[128:131]
    s_waitcnt lgkmcnt(2)
    buffer_load_dword v36, v3, s[12:15], s53 offen offset:1024 sc1
    v_mfma_f32_16x16x32_bf16 v[132:135], a[236:239], a[116:119], v[132:135]
    v_mov_b32 v37, 1065369472
    v_mfma_f32_16x16x32_bf16 v[132:135], a[232:235], a[108:111], v[132:135]
    v_mfma_f32_16x16x32_bf16 v[132:135], a[228:231], a[100:103], v[132:135]
    buffer_load_dwordx2 a[148:149], v2, s[12:15], s50 offen offset:1024 sc1
    v_mfma_f32_16x16x32_bf16 v[104:107], a[216:219], a[192:195], v[104:107]
    v_mfma_f32_16x16x32_bf16 v[104:107], a[220:223], a[200:203], v[104:107]
    v_mfma_f32_16x16x32_bf16 v[136:139], a[224:227], a[208:211], v[104:107]
    buffer_load_dwordx2 a[150:151], v2, s[12:15], s51 offen offset:1024 sc1
    s_waitcnt vmcnt(17) lgkmcnt(0)
    v_mfma_f32_32x32x4_2b_bf16 v[48:79], a[252:253], v[16:17], 0
    v_lshrrev_b32 v246, 4, v29
    v_mul_u32_u24 v247, 1152, v246
    v_lshl_add_u32 v247, v24, 2, v247
    v_bfe_u32 v248, v29, 1, 2
    v_and_b32 v245, 1, v29
    v_mul_u32_u24 v250, 1152, v248
    v_lshl_add_u32 v250, v245, 4, v250
    v_cmp_gt_u32 vcc, 8, v29
    v_add_u32 v250, 256, v250
    v_mov_b32 v251, 536870912
    v_cndmask_b32 v250, v251, v250, vcc
    v_and_b32 v252, -4, v28
    v_add_u32 v254, s59, v1
    v_add_u32 v6, 8, v6
    v_mfma_f32_16x16x32_bf16 v[108:111], a[224:227], v[96:99], v[108:111]
    v_mfma_f32_16x16x32_bf16 v[108:111], a[220:223], v[88:91], v[108:111]
    v_mfma_f32_16x16x32_bf16 v[140:143], a[216:219], v[80:83], v[108:111]
    buffer_load_dwordx2 a[156:157], v2, s[12:15], s50 offen offset:1280 sc1
    v_mfma_f32_16x16x32_bf16 v[112:115], a[216:219], a[48:51], v[112:115]
    v_mfma_f32_16x16x32_bf16 v[112:115], a[220:223], a[56:59], v[112:115]
    v_mfma_f32_16x16x32_bf16 v[144:147], a[224:227], a[64:67], v[112:115]
    buffer_load_dwordx2 a[158:159], v2, s[12:15], s51 offen offset:1280 sc1
    v_mfma_f32_16x16x32_bf16 v[116:119], a[224:227], a[136:139], v[116:119]
    s_add_u32 s70, s52, 149504
    v_mfma_f32_16x16x32_bf16 v[116:119], a[220:223], a[128:131], v[116:119]
    v_mfma_f32_32x32x16_bf16 v[48:63], a[240:243], v[12:15], v[48:63]
    s_nop 1
    v_cvt_pk_bf16_f32 v136, v136, v137
    v_cvt_pk_bf16_f32 v137, v138, v139
    v_cvt_pk_bf16_f32 v138, v140, v141
    v_cvt_pk_bf16_f32 v139, v142, v143
    v_mfma_f32_16x16x32_bf16 v[148:151], a[216:219], a[120:123], v[116:119]
    buffer_load_dwordx4 a[164:167], v4, s[12:15], s70 offen sc1
    v_mfma_f32_16x16x32_bf16 v[120:123], a[216:219], a[196:199], v[120:123]
    v_mfma_f32_16x16x32_bf16 v[120:123], a[220:223], a[204:207], v[120:123]
    v_mfma_f32_16x16x32_bf16 v[152:155], a[224:227], a[212:215], v[120:123]
    buffer_load_dwordx4 a[4:7], v0, s[12:15], s70 offen sc1
    v_mfma_f32_16x16x32_bf16 v[124:127], a[224:227], v[100:103], v[124:127]
    s_add_u32 s71, s52, 186880
    v_mfma_f32_16x16x32_bf16 v[124:127], a[220:223], v[92:95], v[124:127]
    v_mfma_f32_16x16x32_bf16 v[156:159], a[216:219], v[84:87], v[124:127]
    buffer_load_dwordx4 a[12:15], v4, s[12:15], s71 offen sc1
    v_mfma_f32_32x32x16_bf16 v[64:79], a[244:247], v[12:15], v[64:79]
    s_nop 0
    v_cvt_pk_bf16_f32 v140, v144, v145
    v_cvt_pk_bf16_f32 v141, v146, v147
    v_cvt_pk_bf16_f32 v142, v148, v149
    v_cvt_pk_bf16_f32 v143, v150, v151
    v_mfma_f32_16x16x32_bf16 v[128:131], a[216:219], a[52:55], v[128:131]
    v_mfma_f32_16x16x32_bf16 v[128:131], a[220:223], a[60:63], v[128:131]
    v_mfma_f32_16x16x32_bf16 v[160:163], a[224:227], a[68:71], v[128:131]
    buffer_load_dwordx4 a[20:23], v0, s[12:15], s71 offen sc1
    v_mfma_f32_16x16x32_bf16 v[132:135], a[224:227], a[140:143], v[132:135]
    v_mfma_f32_16x16x32_bf16 v[132:135], a[220:223], a[132:135], v[132:135]
    v_mfma_f32_16x16x32_bf16 v[164:167], a[216:219], a[124:127], v[132:135]
    buffer_load_dword v38, v3, s[12:15], s53 offen offset:1536 sc1
    s_waitcnt vmcnt(14)
    v_mfma_f32_32x32x4_2b_bf16 v[80:111], v[34:35], v[16:17], 0
    v_cvt_pk_bf16_f32 v144, v152, v153
    v_cvt_pk_bf16_f32 v145, v154, v155
    v_cvt_pk_bf16_f32 v146, v156, v157
    v_cvt_pk_bf16_f32 v147, v158, v159
    v_exp_f32 v48, v48
    v_exp_f32 v49, v49
    v_exp_f32 v50, v50
    v_exp_f32 v51, v51
    v_cvt_pk_bf16_f32 v112, v48, v49
    v_cvt_pk_bf16_f32 v113, v50, v51
    v_exp_f32 v52, v52
    v_exp_f32 v53, v53
    v_exp_f32 v54, v54
    v_exp_f32 v55, v55
    v_cvt_pk_bf16_f32 v148, v160, v161
    v_cvt_pk_bf16_f32 v149, v162, v163
    v_cvt_pk_bf16_f32 v150, v164, v165
    v_cvt_pk_bf16_f32 v151, v166, v167
    v_cvt_pk_bf16_f32 v114, v52, v53
    v_cvt_pk_bf16_f32 v115, v54, v55
    v_exp_f32 v56, v56
    v_exp_f32 v57, v57
    v_mfma_f32_32x32x16_bf16 a[192:207], a[248:251], v[112:115], 0
    ds_read_b64 v[164:165], v7 offset:1024
    v_exp_f32 v58, v58
    v_exp_f32 v59, v59
    v_cvt_pk_bf16_f32 v116, v56, v57
    v_cvt_pk_bf16_f32 v117, v58, v59
    v_mfma_f32_32x32x16_bf16 v[80:95], a[0:3], v[12:15], v[80:95]
    s_add_u32 s3, s52, 224256
    ds_read2st64_b64 v[160:163], v6 offset0:0 offset1:4
    v_exp_f32 v60, v60
    v_exp_f32 v61, v61
    v_exp_f32 v62, v62
    v_exp_f32 v63, v63
    v_mfma_f32_32x32x16_bf16 v[96:111], a[8:11], v[12:15], v[96:111]
    buffer_load_dwordx2 a[92:93], v2, s[12:15], s50 offen offset:1536 sc1
    buffer_load_dwordx2 a[94:95], v2, s[12:15], s51 offen offset:1536 sc1
    buffer_load_dwordx2 a[84:85], v2, s[12:15], s50 offen offset:1792 sc1
    v_mov_b32 v39, 1065369472
    v_cvt_pk_bf16_f32 v118, v60, v61
    v_cvt_pk_bf16_f32 v119, v62, v63
    v_exp_f32 v64, v64
    v_exp_f32 v65, v65
    v_exp_f32 v66, v66
    v_exp_f32 v67, v67
    v_cvt_pk_bf16_f32 v120, v64, v65
    v_cvt_pk_bf16_f32 v121, v66, v67
    v_exp_f32 v68, v68
    v_exp_f32 v69, v69
    v_exp_f32 v70, v70
    v_exp_f32 v71, v71
    v_mfma_f32_32x32x16_bf16 a[192:207], a[144:147], v[116:119], a[192:207]
    s_waitcnt lgkmcnt(0)
    v_cvt_pk_bf16_f32 v122, v68, v69
    v_cvt_pk_bf16_f32 v123, v70, v71
    v_exp_f32 v72, v72
    v_exp_f32 v73, v73
    v_mfma_f32_32x32x16_bf16 a[192:207], a[152:155], v[120:123], a[192:207]
    s_waitcnt vmcnt(13)
    v_exp_f32 v74, v74
    v_exp_f32 v75, v75
    v_cvt_pk_bf16_f32 v124, v72, v73
    v_cvt_pk_bf16_f32 v125, v74, v75
    v_exp_f32 v76, v76
    v_exp_f32 v77, v77
    v_exp_f32 v78, v78
    v_exp_f32 v79, v79
    v_cvt_pk_bf16_f32 v126, v76, v77
    v_cvt_pk_bf16_f32 v127, v78, v79
    v_mfma_f32_32x32x4_2b_bf16 v[48:79], a[252:253], v[164:165], 0
    v_exp_f32 v80, v80
    v_exp_f32 v81, v81
    v_exp_f32 v82, v82
    v_exp_f32 v83, v83
    v_cvt_pk_bf16_f32 v112, v80, v81
    v_cvt_pk_bf16_f32 v113, v82, v83
    v_exp_f32 v84, v84
    v_exp_f32 v85, v85
    v_exp_f32 v86, v86
    v_exp_f32 v87, v87
    v_mfma_f32_32x32x16_bf16 a[192:207], a[160:163], v[124:127], a[192:207]
    buffer_load_dwordx2 a[86:87], v2, s[12:15], s51 offen offset:1792 sc1
    buffer_load_dwordx4 a[76:79], v4, s[12:15], s3 offen sc1
    buffer_load_dwordx4 a[168:171], v0, s[12:15], s3 offen sc1
    v_cvt_pk_bf16_f32 v114, v84, v85
    v_cvt_pk_bf16_f32 v115, v86, v87
    v_exp_f32 v88, v88
    v_exp_f32 v89, v89
    v_mfma_f32_32x32x16_bf16 a[192:207], a[16:19], v[112:115], a[192:207]
    v_exp_f32 v90, v90
    v_exp_f32 v91, v91
    v_cvt_pk_bf16_f32 v116, v88, v89
    v_cvt_pk_bf16_f32 v117, v90, v91
    v_mfma_f32_32x32x16_bf16 v[48:63], a[240:243], v[160:163], v[48:63]
    s_add_u32 s6, s52, 261632
    v_exp_f32 v92, v92
    v_exp_f32 v93, v93
    v_exp_f32 v94, v94
    v_exp_f32 v95, v95
    v_mfma_f32_32x32x16_bf16 v[64:79], a[244:247], v[160:163], v[64:79]
    buffer_load_dwordx4 a[176:179], v4, s[12:15], s6 offen sc1
    buffer_load_dwordx4 a[184:187], v0, s[12:15], s6 offen sc1
    buffer_load_dword v40, v3, s[12:15], s53 offen offset:2048 sc1
    v_mov_b32 v41, 1065369472
    v_cvt_pk_bf16_f32 v118, v92, v93
    v_cvt_pk_bf16_f32 v119, v94, v95
    v_exp_f32 v96, v96
    v_exp_f32 v97, v97
    v_exp_f32 v98, v98
    v_exp_f32 v99, v99
    v_cvt_pk_bf16_f32 v120, v96, v97
    v_cvt_pk_bf16_f32 v121, v98, v99
    v_exp_f32 v100, v100
    v_exp_f32 v101, v101
    v_exp_f32 v102, v102
    v_exp_f32 v103, v103
    v_mfma_f32_32x32x16_bf16 a[192:207], a[88:91], v[116:119], a[192:207]
    v_cvt_pk_bf16_f32 v122, v100, v101
    v_cvt_pk_bf16_f32 v123, v102, v103
    v_exp_f32 v104, v104
    v_exp_f32 v105, v105
    v_mfma_f32_32x32x16_bf16 a[192:207], a[80:83], v[120:123], a[192:207]
    v_exp_f32 v106, v106
    v_exp_f32 v107, v107
    v_cvt_pk_bf16_f32 v124, v104, v105
    v_cvt_pk_bf16_f32 v125, v106, v107
    v_exp_f32 v108, v108
    v_exp_f32 v109, v109
    v_exp_f32 v110, v110
    v_exp_f32 v111, v111
    v_cvt_pk_bf16_f32 v126, v108, v109
    v_cvt_pk_bf16_f32 v127, v110, v111
    v_mfma_f32_32x32x4_2b_bf16 v[80:111], v[34:35], v[164:165], 0
    v_exp_f32 v48, v48
    v_exp_f32 v49, v49
    v_exp_f32 v50, v50
    v_exp_f32 v51, v51
    v_cvt_pk_bf16_f32 v112, v48, v49
    v_cvt_pk_bf16_f32 v113, v50, v51
    v_exp_f32 v52, v52
    v_exp_f32 v53, v53
    v_exp_f32 v54, v54
    v_exp_f32 v55, v55
    v_mfma_f32_32x32x16_bf16 a[192:207], a[72:75], v[124:127], a[192:207]
    buffer_load_dwordx2 a[24:25], v2, s[12:15], s50 offen offset:2048 sc1
    buffer_load_dwordx2 a[26:27], v2, s[12:15], s51 offen offset:2048 sc1
    buffer_load_dwordx2 a[32:33], v2, s[12:15], s50 offen offset:2304 sc1
    v_cvt_pk_bf16_f32 v114, v52, v53
    v_cvt_pk_bf16_f32 v115, v54, v55
    v_exp_f32 v56, v56
    v_exp_f32 v57, v57
    v_mfma_f32_32x32x16_bf16 a[208:223], a[248:251], v[112:115], 0
    v_exp_f32 v58, v58
    v_exp_f32 v59, v59
    v_cvt_pk_bf16_f32 v116, v56, v57
    v_cvt_pk_bf16_f32 v117, v58, v59
    v_mfma_f32_32x32x16_bf16 v[80:95], a[0:3], v[160:163], v[80:95]
    s_add_u32 s7, s52, 299008
    v_exp_f32 v60, v60
    v_exp_f32 v61, v61
    v_exp_f32 v62, v62
    v_exp_f32 v63, v63
    v_mfma_f32_32x32x16_bf16 v[96:111], a[8:11], v[160:163], v[96:111]
    buffer_load_dwordx2 a[34:35], v2, s[12:15], s51 offen offset:2304 sc1
    buffer_load_dwordx4 a[40:43], v4, s[12:15], s7 offen sc1
    buffer_load_dwordx4 a[112:115], v0, s[12:15], s7 offen sc1
    v_cvt_pk_bf16_f32 v118, v60, v61
    v_cvt_pk_bf16_f32 v119, v62, v63
    v_exp_f32 v64, v64
    v_exp_f32 v65, v65
    v_exp_f32 v66, v66
    v_exp_f32 v67, v67
    v_cvt_pk_bf16_f32 v120, v64, v65
    v_cvt_pk_bf16_f32 v121, v66, v67
    v_exp_f32 v68, v68
    v_exp_f32 v69, v69
    v_exp_f32 v70, v70
    v_exp_f32 v71, v71
    v_mfma_f32_32x32x16_bf16 a[208:223], a[144:147], v[116:119], a[208:223]
    s_add_u32 s75, s52, 336384
    v_cvt_pk_bf16_f32 v122, v68, v69
    v_cvt_pk_bf16_f32 v123, v70, v71
    v_exp_f32 v72, v72
    v_exp_f32 v73, v73
    v_mfma_f32_32x32x16_bf16 a[208:223], a[152:155], v[120:123], a[208:223]
    s_waitcnt vmcnt(20)
    v_exp_f32 v74, v74
    v_exp_f32 v75, v75
    v_cvt_pk_bf16_f32 v124, v72, v73
    v_cvt_pk_bf16_f32 v125, v74, v75
    v_exp_f32 v76, v76
    v_exp_f32 v77, v77
    v_exp_f32 v78, v78
    v_exp_f32 v79, v79
    v_cvt_pk_bf16_f32 v126, v76, v77
    v_cvt_pk_bf16_f32 v127, v78, v79
    v_mfma_f32_32x32x4_2b_bf16 v[48:79], v[36:37], v[16:17], 0
    v_exp_f32 v80, v80
    v_exp_f32 v81, v81
    v_exp_f32 v82, v82
    v_exp_f32 v83, v83
    v_cvt_pk_bf16_f32 v112, v80, v81
    v_cvt_pk_bf16_f32 v113, v82, v83
    v_exp_f32 v84, v84
    v_exp_f32 v85, v85
    v_exp_f32 v86, v86
    v_exp_f32 v87, v87
    v_mfma_f32_32x32x16_bf16 a[208:223], a[160:163], v[124:127], a[208:223]
    buffer_load_dwordx4 a[104:107], v4, s[12:15], s75 offen sc1
    buffer_load_dwordx4 a[96:99], v0, s[12:15], s75 offen sc1
    buffer_load_dword v42, v3, s[12:15], s53 offen offset:2560 sc1
    v_mov_b32 v43, 1065369472
    v_cvt_pk_bf16_f32 v114, v84, v85
    v_cvt_pk_bf16_f32 v115, v86, v87
    v_exp_f32 v88, v88
    v_exp_f32 v89, v89
    v_mfma_f32_32x32x16_bf16 a[208:223], a[16:19], v[112:115], a[208:223]
    v_exp_f32 v90, v90
    v_exp_f32 v91, v91
    v_cvt_pk_bf16_f32 v116, v88, v89
    v_cvt_pk_bf16_f32 v117, v90, v91
    v_mfma_f32_32x32x16_bf16 v[48:63], a[148:151], v[12:15], v[48:63]
    v_exp_f32 v92, v92
    v_exp_f32 v93, v93
    v_exp_f32 v94, v94
    v_exp_f32 v95, v95
    v_mfma_f32_32x32x16_bf16 v[64:79], a[156:159], v[12:15], v[64:79]
    buffer_load_dwordx2 a[172:173], v2, s[12:15], s50 offen offset:2560 sc1
    buffer_load_dwordx2 a[174:175], v2, s[12:15], s51 offen offset:2560 sc1
    buffer_load_dwordx2 a[180:181], v2, s[12:15], s50 offen offset:2816 sc1
    v_cvt_pk_bf16_f32 v118, v92, v93
    v_cvt_pk_bf16_f32 v119, v94, v95
    v_exp_f32 v96, v96
    v_exp_f32 v97, v97
    v_exp_f32 v98, v98
    v_exp_f32 v99, v99
    v_cvt_pk_bf16_f32 v120, v96, v97
    v_cvt_pk_bf16_f32 v121, v98, v99
    v_exp_f32 v100, v100
    v_exp_f32 v101, v101
    v_exp_f32 v102, v102
    v_exp_f32 v103, v103
    v_mfma_f32_32x32x16_bf16 a[208:223], a[88:91], v[116:119], a[208:223]
    s_add_u32 s28, s52, 373760
    v_cvt_pk_bf16_f32 v122, v100, v101
    v_cvt_pk_bf16_f32 v123, v102, v103
    v_exp_f32 v104, v104
    v_exp_f32 v105, v105
    v_mfma_f32_32x32x16_bf16 a[208:223], a[80:83], v[120:123], a[208:223]
    s_waitcnt vmcnt(22)
    v_exp_f32 v106, v106
    v_exp_f32 v107, v107
    v_cvt_pk_bf16_f32 v124, v104, v105
    v_cvt_pk_bf16_f32 v125, v106, v107
    v_exp_f32 v108, v108
    v_exp_f32 v109, v109
    v_exp_f32 v110, v110
    v_exp_f32 v111, v111
    v_cvt_pk_bf16_f32 v126, v108, v109
    v_cvt_pk_bf16_f32 v127, v110, v111
    v_mfma_f32_32x32x4_2b_bf16 v[80:111], v[36:37], v[164:165], 0
    v_exp_f32 v48, v48
    v_exp_f32 v49, v49
    v_exp_f32 v50, v50
    v_exp_f32 v51, v51
    v_cvt_pk_bf16_f32 v112, v48, v49
    v_cvt_pk_bf16_f32 v113, v50, v51
    v_exp_f32 v52, v52
    v_exp_f32 v53, v53
    v_exp_f32 v54, v54
    v_exp_f32 v55, v55
    v_mfma_f32_32x32x16_bf16 a[208:223], a[72:75], v[124:127], a[208:223]
    buffer_load_dwordx2 a[182:183], v2, s[12:15], s51 offen offset:2816 sc1
    buffer_load_dwordx4 a[188:191], v4, s[12:15], s28 offen sc1
    buffer_load_dwordx4 a[28:31], v0, s[12:15], s28 offen sc1
    v_cvt_pk_bf16_f32 v114, v52, v53
    v_cvt_pk_bf16_f32 v115, v54, v55
    v_exp_f32 v56, v56
    v_exp_f32 v57, v57
    v_mfma_f32_32x32x16_bf16 a[192:207], a[164:167], v[112:115], a[192:207]
    v_exp_f32 v58, v58
    v_exp_f32 v59, v59
    v_cvt_pk_bf16_f32 v116, v56, v57
    v_cvt_pk_bf16_f32 v117, v58, v59
    v_mfma_f32_32x32x16_bf16 v[80:95], a[148:151], v[160:163], v[80:95]
    s_add_u32 s29, s52, 411136
    v_exp_f32 v60, v60
    v_exp_f32 v61, v61
    v_exp_f32 v62, v62
    v_exp_f32 v63, v63
    v_mfma_f32_32x32x16_bf16 v[96:111], a[156:159], v[160:163], v[96:111]
    buffer_load_dwordx4 a[36:39], v4, s[12:15], s29 offen sc1
    buffer_load_dwordx4 a[44:47], v0, s[12:15], s29 offen sc1
    buffer_load_dword v44, v3, s[12:15], s53 offen offset:3072 sc1
    v_mov_b32 v45, 1065369472
    v_cvt_pk_bf16_f32 v118, v60, v61
    v_cvt_pk_bf16_f32 v119, v62, v63
    v_exp_f32 v64, v64
    v_exp_f32 v65, v65
    v_exp_f32 v66, v66
    v_exp_f32 v67, v67
    v_cvt_pk_bf16_f32 v120, v64, v65
    v_cvt_pk_bf16_f32 v121, v66, v67
    v_exp_f32 v68, v68
    v_exp_f32 v69, v69
    v_exp_f32 v70, v70
    v_exp_f32 v71, v71
    v_mfma_f32_32x32x16_bf16 a[192:207], a[4:7], v[116:119], a[192:207]
    v_cvt_pk_bf16_f32 v122, v68, v69
    v_cvt_pk_bf16_f32 v123, v70, v71
    v_exp_f32 v72, v72
    v_exp_f32 v73, v73
    v_mfma_f32_32x32x16_bf16 a[192:207], a[12:15], v[120:123], a[192:207]
    s_waitcnt vmcnt(23)
    v_exp_f32 v74, v74
    v_exp_f32 v75, v75
    v_cvt_pk_bf16_f32 v124, v72, v73
    v_cvt_pk_bf16_f32 v125, v74, v75
    v_exp_f32 v76, v76
    v_exp_f32 v77, v77
    v_exp_f32 v78, v78
    v_exp_f32 v79, v79
    v_cvt_pk_bf16_f32 v126, v76, v77
    v_cvt_pk_bf16_f32 v127, v78, v79
    v_mfma_f32_32x32x4_2b_bf16 v[48:79], v[38:39], v[16:17], 0
    v_exp_f32 v80, v80
    v_exp_f32 v81, v81
    v_exp_f32 v82, v82
    v_exp_f32 v83, v83
    v_cvt_pk_bf16_f32 v112, v80, v81
    v_cvt_pk_bf16_f32 v113, v82, v83
    v_exp_f32 v84, v84
    v_exp_f32 v85, v85
    v_exp_f32 v86, v86
    v_exp_f32 v87, v87
    v_mfma_f32_32x32x16_bf16 a[192:207], a[20:23], v[124:127], a[192:207]
    buffer_load_dwordx2 a[116:117], v2, s[12:15], s50 offen offset:3072 sc1
    buffer_load_dwordx2 a[118:119], v2, s[12:15], s51 offen offset:3072 sc1
    buffer_load_dwordx2 a[108:109], v2, s[12:15], s50 offen offset:3328 sc1
    v_cvt_pk_bf16_f32 v114, v84, v85
    v_cvt_pk_bf16_f32 v115, v86, v87
    v_exp_f32 v88, v88
    v_exp_f32 v89, v89
    v_mfma_f32_32x32x16_bf16 a[208:223], a[164:167], v[112:115], a[208:223]
    v_exp_f32 v90, v90
    v_exp_f32 v91, v91
    v_cvt_pk_bf16_f32 v116, v88, v89
    v_cvt_pk_bf16_f32 v117, v90, v91
    v_mfma_f32_32x32x16_bf16 v[48:63], a[92:95], v[12:15], v[48:63]
    s_add_u32 s30, s52, 448512
    v_exp_f32 v92, v92
    v_exp_f32 v93, v93
    v_exp_f32 v94, v94
    v_exp_f32 v95, v95
    v_mfma_f32_32x32x16_bf16 v[64:79], a[84:87], v[12:15], v[64:79]
    buffer_load_dwordx2 a[110:111], v2, s[12:15], s51 offen offset:3328 sc1
    buffer_load_dwordx4 a[100:103], v4, s[12:15], s30 offen sc1
    buffer_load_dwordx4 a[48:51], v0, s[12:15], s30 offen sc1
    v_cvt_pk_bf16_f32 v118, v92, v93
    v_cvt_pk_bf16_f32 v119, v94, v95
    v_exp_f32 v96, v96
    v_exp_f32 v97, v97
    v_exp_f32 v98, v98
    v_exp_f32 v99, v99
    v_cvt_pk_bf16_f32 v120, v96, v97
    v_cvt_pk_bf16_f32 v121, v98, v99
    v_exp_f32 v100, v100
    v_exp_f32 v101, v101
    v_exp_f32 v102, v102
    v_exp_f32 v103, v103
    v_mfma_f32_32x32x16_bf16 a[208:223], a[4:7], v[116:119], a[208:223]
    s_add_u32 s31, s52, 485888
    v_cvt_pk_bf16_f32 v122, v100, v101
    v_cvt_pk_bf16_f32 v123, v102, v103
    v_exp_f32 v104, v104
    v_exp_f32 v105, v105
    v_mfma_f32_32x32x16_bf16 a[208:223], a[12:15], v[120:123], a[208:223]
    s_waitcnt vmcnt(25)
    v_exp_f32 v106, v106
    v_exp_f32 v107, v107
    v_cvt_pk_bf16_f32 v124, v104, v105
    v_cvt_pk_bf16_f32 v125, v106, v107
    v_exp_f32 v108, v108
    v_exp_f32 v109, v109
    v_exp_f32 v110, v110
    v_exp_f32 v111, v111
    v_cvt_pk_bf16_f32 v126, v108, v109
    v_cvt_pk_bf16_f32 v127, v110, v111
    v_mfma_f32_32x32x4_2b_bf16 v[80:111], v[38:39], v[164:165], 0
    v_exp_f32 v48, v48
    v_exp_f32 v49, v49
    v_exp_f32 v50, v50
    v_exp_f32 v51, v51
    v_cvt_pk_bf16_f32 v112, v48, v49
    v_cvt_pk_bf16_f32 v113, v50, v51
    v_exp_f32 v52, v52
    v_exp_f32 v53, v53
    v_exp_f32 v54, v54
    v_exp_f32 v55, v55
    v_mfma_f32_32x32x16_bf16 a[208:223], a[20:23], v[124:127], a[208:223]
    buffer_load_dwordx4 a[56:59], v4, s[12:15], s31 offen sc1
    buffer_load_dwordx4 a[64:67], v0, s[12:15], s31 offen sc1
    buffer_load_dword v46, v3, s[12:15], s53 offen offset:3584 sc1
    v_mov_b32 v47, 1065369472
    v_cvt_pk_bf16_f32 v114, v52, v53
    v_cvt_pk_bf16_f32 v115, v54, v55
    v_exp_f32 v56, v56
    v_exp_f32 v57, v57
    v_mfma_f32_32x32x16_bf16 a[192:207], a[76:79], v[112:115], a[192:207]
    v_exp_f32 v58, v58
    v_exp_f32 v59, v59
    v_cvt_pk_bf16_f32 v116, v56, v57
    v_cvt_pk_bf16_f32 v117, v58, v59
    v_mfma_f32_32x32x16_bf16 v[80:95], a[92:95], v[160:163], v[80:95]
    v_exp_f32 v60, v60
    v_exp_f32 v61, v61
    v_exp_f32 v62, v62
    v_exp_f32 v63, v63
    v_mfma_f32_32x32x16_bf16 v[96:111], a[84:87], v[160:163], v[96:111]
    buffer_load_dwordx2 a[136:137], v2, s[12:15], s50 offen offset:3584 sc1
    buffer_load_dwordx2 a[138:139], v2, s[12:15], s51 offen offset:3584 sc1
    buffer_load_dwordx2 a[128:129], v2, s[12:15], s50 offen offset:3840 sc1
    v_cvt_pk_bf16_f32 v118, v60, v61
    v_cvt_pk_bf16_f32 v119, v62, v63
    v_exp_f32 v64, v64
    v_exp_f32 v65, v65
    v_exp_f32 v66, v66
    v_exp_f32 v67, v67
    v_cvt_pk_bf16_f32 v120, v64, v65
    v_cvt_pk_bf16_f32 v121, v66, v67
    v_exp_f32 v68, v68
    v_exp_f32 v69, v69
    v_exp_f32 v70, v70
    v_exp_f32 v71, v71
    v_mfma_f32_32x32x16_bf16 a[192:207], a[168:171], v[116:119], a[192:207]
    s_add_u32 s38, s52, 523264
    v_cvt_pk_bf16_f32 v122, v68, v69
    v_cvt_pk_bf16_f32 v123, v70, v71
    v_exp_f32 v72, v72
    v_exp_f32 v73, v73
    v_mfma_f32_32x32x16_bf16 a[192:207], a[176:179], v[120:123], a[192:207]
    s_waitcnt vmcnt(26)
    v_exp_f32 v74, v74
    v_exp_f32 v75, v75
    v_cvt_pk_bf16_f32 v124, v72, v73
    v_cvt_pk_bf16_f32 v125, v74, v75
    v_exp_f32 v76, v76
    v_exp_f32 v77, v77
    v_exp_f32 v78, v78
    v_exp_f32 v79, v79
    v_cvt_pk_bf16_f32 v126, v76, v77
    v_cvt_pk_bf16_f32 v127, v78, v79
    v_mfma_f32_32x32x4_2b_bf16 v[48:79], v[40:41], v[16:17], 0
    v_exp_f32 v80, v80
    v_exp_f32 v81, v81
    v_exp_f32 v82, v82
    v_exp_f32 v83, v83
    v_cvt_pk_bf16_f32 v112, v80, v81
    v_cvt_pk_bf16_f32 v113, v82, v83
    v_exp_f32 v84, v84
    v_exp_f32 v85, v85
    v_exp_f32 v86, v86
    v_exp_f32 v87, v87
    v_mfma_f32_32x32x16_bf16 a[192:207], a[184:187], v[124:127], a[192:207]
    buffer_load_dwordx2 a[130:131], v2, s[12:15], s51 offen offset:3840 sc1
    buffer_load_dwordx4 a[120:123], v4, s[12:15], s38 offen sc1
    buffer_load_dwordx4 a[52:55], v0, s[12:15], s38 offen sc1
    v_cvt_pk_bf16_f32 v114, v84, v85
    v_cvt_pk_bf16_f32 v115, v86, v87
    v_exp_f32 v88, v88
    v_exp_f32 v89, v89
    v_mfma_f32_32x32x16_bf16 a[208:223], a[76:79], v[112:115], a[208:223]
    s_add_u32 m0, s59, 0
    v_exp_f32 v90, v90
    v_exp_f32 v91, v91
    v_cvt_pk_bf16_f32 v116, v88, v89
    v_cvt_pk_bf16_f32 v117, v90, v91
    v_mfma_f32_32x32x16_bf16 v[48:63], a[24:27], v[12:15], v[48:63]
    s_add_u32 s39, s52, 560640
    v_exp_f32 v92, v92
    v_exp_f32 v93, v93
    v_exp_f32 v94, v94
    v_exp_f32 v95, v95
    v_mfma_f32_32x32x16_bf16 v[64:79], a[32:35], v[12:15], v[64:79]
    buffer_load_dwordx4 a[60:63], v4, s[12:15], s39 offen sc1
    buffer_load_dwordx4 a[68:71], v0, s[12:15], s39 offen sc1
    v_cvt_pk_bf16_f32 v118, v92, v93
    v_cvt_pk_bf16_f32 v119, v94, v95
    v_exp_f32 v96, v96
    v_exp_f32 v97, v97
    v_exp_f32 v98, v98
    v_exp_f32 v99, v99
    v_cvt_pk_bf16_f32 v120, v96, v97
    v_cvt_pk_bf16_f32 v121, v98, v99
    v_exp_f32 v100, v100
    v_exp_f32 v101, v101
    v_exp_f32 v102, v102
    v_exp_f32 v103, v103
    v_mfma_f32_32x32x16_bf16 a[208:223], a[168:171], v[116:119], a[208:223]
    s_add_u32 s40, s58, 0
    v_cvt_pk_bf16_f32 v122, v100, v101
    v_cvt_pk_bf16_f32 v123, v102, v103
    v_exp_f32 v104, v104
    v_exp_f32 v105, v105
    v_mfma_f32_32x32x16_bf16 a[208:223], a[176:179], v[120:123], a[208:223]
    s_waitcnt vmcnt(27)
    v_exp_f32 v106, v106
    v_exp_f32 v107, v107
    v_cvt_pk_bf16_f32 v124, v104, v105
    v_cvt_pk_bf16_f32 v125, v106, v107
    v_exp_f32 v108, v108
    v_exp_f32 v109, v109
    v_exp_f32 v110, v110
    v_exp_f32 v111, v111
    v_cvt_pk_bf16_f32 v126, v108, v109
    v_cvt_pk_bf16_f32 v127, v110, v111
    v_mfma_f32_32x32x4_2b_bf16 v[80:111], v[40:41], v[164:165], 0
    s_add_u32 s3, s67, 69632
    s_add_u32 s41, s67, 32768
    v_exp_f32 v48, v48
    v_exp_f32 v49, v49
    v_exp_f32 v50, v50
    v_exp_f32 v51, v51
    v_cvt_pk_bf16_f32 v112, v48, v49
    v_cvt_pk_bf16_f32 v113, v50, v51
    v_exp_f32 v52, v52
    v_exp_f32 v53, v53
    v_exp_f32 v54, v54
    v_exp_f32 v55, v55
    v_mfma_f32_32x32x16_bf16 a[208:223], a[184:187], v[124:127], a[208:223]
    buffer_load_dwordx4 v1, s[12:15], s40 offen offset:0 sc1 lds
    buffer_load_dwordx4 v1, s[12:15], s40 offen offset:1024 sc1 lds
    buffer_store_dwordx4 v[136:139], v1, s[12:15], s41 offen sc1
    buffer_store_dwordx4 v[140:143], v1, s[12:15], s3 offen sc1
    v_cvt_pk_bf16_f32 v114, v52, v53
    v_cvt_pk_bf16_f32 v115, v54, v55
    v_exp_f32 v56, v56
    v_exp_f32 v57, v57
    v_mfma_f32_32x32x16_bf16 a[192:207], a[40:43], v[112:115], a[192:207]
    v_exp_f32 v58, v58
    v_exp_f32 v59, v59
    v_cvt_pk_bf16_f32 v116, v56, v57
    v_cvt_pk_bf16_f32 v117, v58, v59
    v_mfma_f32_32x32x16_bf16 v[80:95], a[24:27], v[160:163], v[80:95]
    v_exp_f32 v60, v60
    v_exp_f32 v61, v61
    v_exp_f32 v62, v62
    v_exp_f32 v63, v63
    v_mfma_f32_32x32x16_bf16 v[96:111], a[32:35], v[160:163], v[96:111]
    s_add_u32 s7, s67, 143360
    v_cvt_pk_bf16_f32 v118, v60, v61
    v_cvt_pk_bf16_f32 v119, v62, v63
    v_exp_f32 v64, v64
    v_exp_f32 v65, v65
    v_exp_f32 v66, v66
    v_exp_f32 v67, v67
    v_cvt_pk_bf16_f32 v120, v64, v65
    v_cvt_pk_bf16_f32 v121, v66, v67
    v_exp_f32 v68, v68
    v_exp_f32 v69, v69
    v_exp_f32 v70, v70
    v_exp_f32 v71, v71
    v_mfma_f32_32x32x16_bf16 a[192:207], a[112:115], v[116:119], a[192:207]
    s_add_u32 s6, s67, 106496
    v_cvt_pk_bf16_f32 v122, v68, v69
    v_cvt_pk_bf16_f32 v123, v70, v71
    v_exp_f32 v72, v72
    v_exp_f32 v73, v73
    v_mfma_f32_32x32x16_bf16 a[192:207], a[104:107], v[120:123], a[192:207]
    s_waitcnt vmcnt(26)
    v_exp_f32 v74, v74
    v_exp_f32 v75, v75
    v_cvt_pk_bf16_f32 v124, v72, v73
    v_cvt_pk_bf16_f32 v125, v74, v75
    v_exp_f32 v76, v76
    v_exp_f32 v77, v77
    v_exp_f32 v78, v78
    v_exp_f32 v79, v79
    v_cvt_pk_bf16_f32 v126, v76, v77
    v_cvt_pk_bf16_f32 v127, v78, v79
    v_mfma_f32_32x32x4_2b_bf16 v[48:79], v[42:43], v[16:17], 0
    v_exp_f32 v80, v80
    v_exp_f32 v81, v81
    v_exp_f32 v82, v82
    v_exp_f32 v83, v83
    v_cvt_pk_bf16_f32 v112, v80, v81
    v_cvt_pk_bf16_f32 v113, v82, v83
    v_exp_f32 v84, v84
    v_exp_f32 v85, v85
    v_exp_f32 v86, v86
    v_exp_f32 v87, v87
    v_mfma_f32_32x32x16_bf16 a[192:207], a[96:99], v[124:127], a[192:207]
    buffer_load_dwordx4 v1, s[12:15], s40 offen offset:2048 sc1 lds
    buffer_load_dwordx4 v1, s[12:15], s40 offen offset:3072 sc1 lds
    buffer_store_dwordx4 v[144:147], v1, s[12:15], s6 offen sc1
    buffer_store_dwordx4 v[148:151], v1, s[12:15], s7 offen sc1
    v_cvt_pk_bf16_f32 v114, v84, v85
    v_cvt_pk_bf16_f32 v115, v86, v87
    v_exp_f32 v88, v88
    v_exp_f32 v89, v89
    v_mfma_f32_32x32x16_bf16 a[208:223], a[40:43], v[112:115], a[208:223]
    v_exp_f32 v90, v90
    v_exp_f32 v91, v91
    v_cvt_pk_bf16_f32 v116, v88, v89
    v_cvt_pk_bf16_f32 v117, v90, v91
    v_mfma_f32_32x32x16_bf16 v[48:63], a[172:175], v[12:15], v[48:63]
    s_add_u32 s29, s67, 86016
    v_exp_f32 v92, v92
    v_exp_f32 v93, v93
    v_exp_f32 v94, v94
    v_exp_f32 v95, v95
    v_mfma_f32_32x32x16_bf16 v[64:79], a[180:183], v[12:15], v[64:79]
    s_add_u32 s28, s67, 49152
    v_cvt_pk_bf16_f32 v118, v92, v93
    v_cvt_pk_bf16_f32 v119, v94, v95
    v_exp_f32 v96, v96
    v_exp_f32 v97, v97
    v_exp_f32 v98, v98
    v_exp_f32 v99, v99
    v_cvt_pk_bf16_f32 v120, v96, v97
    v_cvt_pk_bf16_f32 v121, v98, v99
    v_exp_f32 v100, v100
    v_exp_f32 v101, v101
    v_exp_f32 v102, v102
    v_exp_f32 v103, v103
    v_mfma_f32_32x32x16_bf16 a[208:223], a[112:115], v[116:119], a[208:223]
    s_add_u32 m0, s59, 4096
    v_cvt_pk_bf16_f32 v122, v100, v101
    v_cvt_pk_bf16_f32 v123, v102, v103
    v_exp_f32 v104, v104
    v_exp_f32 v105, v105
    v_mfma_f32_32x32x16_bf16 a[208:223], a[104:107], v[120:123], a[208:223]
    s_waitcnt vmcnt(21)
    v_exp_f32 v106, v106
    v_exp_f32 v107, v107
    v_cvt_pk_bf16_f32 v124, v104, v105
    v_cvt_pk_bf16_f32 v125, v106, v107
    v_exp_f32 v108, v108
    v_exp_f32 v109, v109
    v_exp_f32 v110, v110
    v_exp_f32 v111, v111
    v_cvt_pk_bf16_f32 v126, v108, v109
    v_cvt_pk_bf16_f32 v127, v110, v111
    v_mfma_f32_32x32x4_2b_bf16 v[80:111], v[44:45], v[16:17], 0
    v_exp_f32 v48, v48
    v_exp_f32 v49, v49
    v_exp_f32 v50, v50
    v_exp_f32 v51, v51
    v_cvt_pk_bf16_f32 v112, v48, v49
    v_cvt_pk_bf16_f32 v113, v50, v51
    v_exp_f32 v52, v52
    v_exp_f32 v53, v53
    v_exp_f32 v54, v54
    v_exp_f32 v55, v55
    v_mfma_f32_32x32x16_bf16 a[208:223], a[96:99], v[124:127], a[208:223]
    s_add_u32 s54, s44, 1
    v_cvt_pk_bf16_f32 v114, v52, v53
    v_cvt_pk_bf16_f32 v115, v54, v55
    v_exp_f32 v56, v56
    v_exp_f32 v57, v57
    v_mfma_f32_32x32x16_bf16 a[192:207], a[188:191], v[112:115], a[192:207]
    s_and_b32 s54, s54, 3
    v_exp_f32 v58, v58
    v_exp_f32 v59, v59
    v_cvt_pk_bf16_f32 v116, v56, v57
    v_cvt_pk_bf16_f32 v117, v58, v59
    v_mfma_f32_32x32x16_bf16 v[80:95], a[116:119], v[12:15], v[80:95]
    s_lshl_b32 s54, s54, 8
    v_lshl_add_u32 v6, s54, 1, v23
    v_add_u32 v7, s54, v19
    v_exp_f32 v60, v60
    v_exp_f32 v61, v61
    v_exp_f32 v62, v62
    v_exp_f32 v63, v63
    v_mfma_f32_32x32x16_bf16 v[96:111], a[108:111], v[12:15], v[96:111]
    s_add_u32 s75, s58, 4096
    v_cvt_pk_bf16_f32 v118, v60, v61
    v_cvt_pk_bf16_f32 v119, v62, v63
    v_exp_f32 v64, v64
    v_exp_f32 v65, v65
    v_exp_f32 v66, v66
    v_exp_f32 v67, v67
    v_cvt_pk_bf16_f32 v120, v64, v65
    v_cvt_pk_bf16_f32 v121, v66, v67
    v_exp_f32 v68, v68
    v_exp_f32 v69, v69
    v_exp_f32 v70, v70
    v_exp_f32 v71, v71
    v_mfma_f32_32x32x16_bf16 a[192:207], a[28:31], v[116:119], a[192:207]
    buffer_load_dwordx4 v1, s[12:15], s75 offen offset:0 sc1 lds
    buffer_load_dwordx4 v1, s[12:15], s75 offen offset:1024 sc1 lds
    buffer_store_dwordx4 v[192:195], v1, s[12:15], s28 offen sc1
    buffer_store_dwordx4 v[228:231], v1, s[12:15], s29 offen sc1
    v_cvt_pk_bf16_f32 v122, v68, v69
    v_cvt_pk_bf16_f32 v123, v70, v71
    v_exp_f32 v72, v72
    v_exp_f32 v73, v73
    v_mfma_f32_32x32x16_bf16 a[192:207], a[36:39], v[120:123], a[192:207]
    s_waitcnt vmcnt(16)
    v_exp_f32 v74, v74
    v_exp_f32 v75, v75
    v_cvt_pk_bf16_f32 v124, v72, v73
    v_cvt_pk_bf16_f32 v125, v74, v75
    v_exp_f32 v76, v76
    v_exp_f32 v77, v77
    v_exp_f32 v78, v78
    v_exp_f32 v79, v79
    v_cvt_pk_bf16_f32 v126, v76, v77
    v_cvt_pk_bf16_f32 v127, v78, v79
    v_mfma_f32_32x32x4_2b_bf16 v[48:79], v[46:47], v[16:17], 0
    v_exp_f32 v80, v80
    v_exp_f32 v81, v81
    v_exp_f32 v82, v82
    v_exp_f32 v83, v83
    v_cvt_pk_bf16_f32 v112, v80, v81
    v_cvt_pk_bf16_f32 v113, v82, v83
    v_exp_f32 v84, v84
    v_exp_f32 v85, v85
    v_exp_f32 v86, v86
    v_exp_f32 v87, v87
    v_mfma_f32_32x32x16_bf16 a[192:207], a[44:47], v[124:127], a[192:207]
    v_cvt_pk_bf16_f32 v114, v84, v85
    v_cvt_pk_bf16_f32 v115, v86, v87
    v_exp_f32 v88, v88
    v_exp_f32 v89, v89
    v_mfma_f32_32x32x16_bf16 a[192:207], a[100:103], v[112:115], a[192:207]
    v_exp_f32 v90, v90
    v_exp_f32 v91, v91
    v_cvt_pk_bf16_f32 v116, v88, v89
    v_cvt_pk_bf16_f32 v117, v90, v91
    v_mfma_f32_32x32x16_bf16 v[48:63], a[136:139], v[12:15], v[48:63]
    v_exp_f32 v92, v92
    v_exp_f32 v93, v93
    v_exp_f32 v94, v94
    v_exp_f32 v95, v95
    v_mfma_f32_32x32x16_bf16 v[64:79], a[128:131], v[12:15], v[64:79]
    s_add_u32 s31, s67, 16384
    v_cvt_pk_bf16_f32 v118, v92, v93
    v_cvt_pk_bf16_f32 v119, v94, v95
    v_exp_f32 v96, v96
    v_exp_f32 v97, v97
    v_exp_f32 v98, v98
    v_exp_f32 v99, v99
    v_cvt_pk_bf16_f32 v120, v96, v97
    v_cvt_pk_bf16_f32 v121, v98, v99
    v_exp_f32 v100, v100
    v_exp_f32 v101, v101
    v_exp_f32 v102, v102
    v_exp_f32 v103, v103
    v_mfma_f32_32x32x16_bf16 a[192:207], a[48:51], v[116:119], a[192:207]
    s_add_u32 s30, s67, 122880
    v_cvt_pk_bf16_f32 v122, v100, v101
    v_cvt_pk_bf16_f32 v123, v102, v103
    v_exp_f32 v104, v104
    v_exp_f32 v105, v105
    v_mfma_f32_32x32x16_bf16 a[192:207], a[56:59], v[120:123], a[192:207]
    s_waitcnt vmcnt(12)
    v_exp_f32 v106, v106
    v_exp_f32 v107, v107
    v_cvt_pk_bf16_f32 v124, v104, v105
    v_cvt_pk_bf16_f32 v125, v106, v107
    v_exp_f32 v108, v108
    v_exp_f32 v109, v109
    v_exp_f32 v110, v110
    v_exp_f32 v111, v111
    v_cvt_pk_bf16_f32 v126, v108, v109
    v_cvt_pk_bf16_f32 v127, v110, v111
    v_mfma_f32_32x32x4_2b_bf16 v[80:111], v[42:43], v[164:165], 0
    v_exp_f32 v48, v48
    v_exp_f32 v49, v49
    v_exp_f32 v50, v50
    v_exp_f32 v51, v51
    v_cvt_pk_bf16_f32 v112, v48, v49
    v_cvt_pk_bf16_f32 v113, v50, v51
    v_exp_f32 v52, v52
    v_exp_f32 v53, v53
    v_exp_f32 v54, v54
    v_exp_f32 v55, v55
    v_mfma_f32_32x32x16_bf16 a[192:207], a[64:67], v[124:127], a[192:207]
    buffer_load_dwordx4 v1, s[12:15], s75 offen offset:2048 sc1 lds
    buffer_load_dwordx4 v1, s[12:15], s75 offen offset:3072 sc1 lds
    buffer_store_dwordx4 v[200:203], v1, s[12:15], s30 offen sc1
    buffer_store_dwordx4 v[208:211], v1, s[12:15], s31 offen sc1
    ds_read_b64 v[16:17], v7
    v_cvt_pk_bf16_f32 v114, v52, v53
    v_cvt_pk_bf16_f32 v115, v54, v55
    v_exp_f32 v56, v56
    v_exp_f32 v57, v57
    v_mfma_f32_32x32x16_bf16 a[192:207], a[120:123], v[112:115], a[192:207]
    ds_read2st64_b64 v[12:15], v6 offset0:0 offset1:4
    v_exp_f32 v58, v58
    v_exp_f32 v59, v59
    v_cvt_pk_bf16_f32 v116, v56, v57
    v_cvt_pk_bf16_f32 v117, v58, v59
    v_mfma_f32_32x32x16_bf16 v[80:95], a[172:175], v[160:163], v[80:95]
    s_add_u32 s3, s67, 90112
    v_exp_f32 v60, v60
    v_exp_f32 v61, v61
    v_exp_f32 v62, v62
    v_exp_f32 v63, v63
    v_mfma_f32_32x32x16_bf16 v[96:111], a[180:183], v[160:163], v[96:111]
    s_add_u32 s39, s67, 53248
    v_cvt_pk_bf16_f32 v118, v60, v61
    v_cvt_pk_bf16_f32 v119, v62, v63
    v_exp_f32 v64, v64
    v_exp_f32 v65, v65
    v_exp_f32 v66, v66
    v_exp_f32 v67, v67
    v_cvt_pk_bf16_f32 v120, v64, v65
    v_cvt_pk_bf16_f32 v121, v66, v67
    v_exp_f32 v68, v68
    v_exp_f32 v69, v69
    v_exp_f32 v70, v70
    v_exp_f32 v71, v71
    v_mfma_f32_32x32x16_bf16 a[192:207], a[52:55], v[116:119], a[192:207]
    s_add_u32 m0, s59, 8192
    v_cvt_pk_bf16_f32 v122, v68, v69
    v_cvt_pk_bf16_f32 v123, v70, v71
    v_exp_f32 v72, v72
    v_exp_f32 v73, v73
    v_mfma_f32_32x32x16_bf16 a[192:207], a[60:63], v[120:123], a[192:207]
    s_add_u32 s38, s58, 8192
    v_exp_f32 v74, v74
    v_exp_f32 v75, v75
    v_cvt_pk_bf16_f32 v124, v72, v73
    v_cvt_pk_bf16_f32 v125, v74, v75
    v_exp_f32 v76, v76
    v_exp_f32 v77, v77
    v_exp_f32 v78, v78
    v_exp_f32 v79, v79
    v_cvt_pk_bf16_f32 v126, v76, v77
    v_cvt_pk_bf16_f32 v127, v78, v79
    v_mfma_f32_32x32x4_2b_bf16 v[48:79], v[44:45], v[164:165], 0
    v_exp_f32 v80, v80
    v_exp_f32 v81, v81
    v_exp_f32 v82, v82
    v_exp_f32 v83, v83
    v_cvt_pk_bf16_f32 v112, v80, v81
    v_cvt_pk_bf16_f32 v113, v82, v83
    v_exp_f32 v84, v84
    v_exp_f32 v85, v85
    v_exp_f32 v86, v86
    v_exp_f32 v87, v87
    v_mfma_f32_32x32x16_bf16 a[192:207], a[68:71], v[124:127], a[192:207]
    buffer_load_dwordx4 v1, s[12:15], s38 offen offset:0 sc1 lds
    buffer_load_dwordx4 v1, s[12:15], s38 offen offset:1024 sc1 lds
    buffer_store_dwordx4 v[216:219], v1, s[12:15], s39 offen sc1
    buffer_store_dwordx4 v[224:227], v1, s[12:15], s3 offen sc1
    v_cvt_pk_bf16_f32 v114, v84, v85
    v_cvt_pk_bf16_f32 v115, v86, v87
    v_exp_f32 v88, v88
    v_exp_f32 v89, v89
    v_mfma_f32_32x32x16_bf16 a[208:223], a[188:191], v[112:115], a[208:223]
    v_exp_f32 v90, v90
    v_exp_f32 v91, v91
    v_cvt_pk_bf16_f32 v116, v88, v89
    v_cvt_pk_bf16_f32 v117, v90, v91
    v_mfma_f32_32x32x16_bf16 v[48:63], a[116:119], v[160:163], v[48:63]
    v_exp_f32 v92, v92
    v_exp_f32 v93, v93
    v_exp_f32 v94, v94
    v_exp_f32 v95, v95
    v_mfma_f32_32x32x16_bf16 v[64:79], a[108:111], v[160:163], v[64:79]
    ds_write_b128 v10, a[192:195] offset:0
    v_cvt_pk_bf16_f32 v118, v92, v93
    v_cvt_pk_bf16_f32 v119, v94, v95
    v_exp_f32 v96, v96
    v_exp_f32 v97, v97
    v_exp_f32 v98, v98
    v_exp_f32 v99, v99
    v_cvt_pk_bf16_f32 v120, v96, v97
    v_cvt_pk_bf16_f32 v121, v98, v99
    v_exp_f32 v100, v100
    v_exp_f32 v101, v101
    v_exp_f32 v102, v102
    v_exp_f32 v103, v103
    v_mfma_f32_32x32x16_bf16 a[208:223], a[28:31], v[116:119], a[208:223]
    ds_write_b128 v10, a[196:199] offset:1024
    v_cvt_pk_bf16_f32 v122, v100, v101
    v_cvt_pk_bf16_f32 v123, v102, v103
    v_exp_f32 v104, v104
    v_exp_f32 v105, v105
    v_mfma_f32_32x32x16_bf16 a[208:223], a[36:39], v[120:123], a[208:223]
    ds_write_b64 v18, a[200:201] offset:2048
    v_exp_f32 v106, v106
    v_exp_f32 v107, v107
    v_cvt_pk_bf16_f32 v124, v104, v105
    v_cvt_pk_bf16_f32 v125, v106, v107
    v_exp_f32 v108, v108
    v_exp_f32 v109, v109
    v_exp_f32 v110, v110
    v_exp_f32 v111, v111
    v_cvt_pk_bf16_f32 v126, v108, v109
    v_cvt_pk_bf16_f32 v127, v110, v111
    v_mfma_f32_32x32x4_2b_bf16 v[80:111], v[46:47], v[164:165], 0
    v_exp_f32 v48, v48
    v_exp_f32 v49, v49
    v_exp_f32 v50, v50
    v_exp_f32 v51, v51
    v_cvt_pk_bf16_f32 v112, v48, v49
    v_cvt_pk_bf16_f32 v113, v50, v51
    v_exp_f32 v52, v52
    v_exp_f32 v53, v53
    v_exp_f32 v54, v54
    v_exp_f32 v55, v55
    v_mfma_f32_32x32x16_bf16 a[208:223], a[44:47], v[124:127], a[208:223]
    v_cvt_pk_bf16_f32 v114, v52, v53
    v_cvt_pk_bf16_f32 v115, v54, v55
    v_exp_f32 v56, v56
    v_exp_f32 v57, v57
    v_mfma_f32_32x32x16_bf16 a[208:223], a[100:103], v[112:115], a[208:223]
    s_waitcnt lgkmcnt(0)
    v_exp_f32 v58, v58
    v_exp_f32 v59, v59
    v_cvt_pk_bf16_f32 v116, v56, v57
    v_cvt_pk_bf16_f32 v117, v58, v59
    v_mfma_f32_32x32x16_bf16 v[80:95], a[136:139], v[160:163], v[80:95]
    s_barrier
    v_exp_f32 v60, v60
    v_exp_f32 v61, v61
    v_exp_f32 v62, v62
    v_exp_f32 v63, v63
    v_mfma_f32_32x32x16_bf16 v[96:111], a[128:131], v[160:163], v[96:111]
    v_cvt_pk_bf16_f32 v118, v60, v61
    v_cvt_pk_bf16_f32 v119, v62, v63
    v_exp_f32 v64, v64
    v_exp_f32 v65, v65
    v_exp_f32 v66, v66
    v_exp_f32 v67, v67
    v_cvt_pk_bf16_f32 v120, v64, v65
    v_cvt_pk_bf16_f32 v121, v66, v67
    v_exp_f32 v68, v68
    v_exp_f32 v69, v69
    v_exp_f32 v70, v70
    v_exp_f32 v71, v71
    v_mfma_f32_32x32x16_bf16 a[208:223], a[48:51], v[116:119], a[208:223]
    s_add_u32 s6, s67, 20480
    v_cvt_pk_bf16_f32 v122, v68, v69
    v_cvt_pk_bf16_f32 v123, v70, v71
    v_exp_f32 v72, v72
    v_exp_f32 v73, v73
    v_mfma_f32_32x32x16_bf16 a[208:223], a[56:59], v[120:123], a[208:223]
    s_add_u32 s41, s67, 126976
    v_exp_f32 v74, v74
    v_exp_f32 v75, v75
    v_cvt_pk_bf16_f32 v124, v72, v73
    v_cvt_pk_bf16_f32 v125, v74, v75
    v_exp_f32 v76, v76
    v_exp_f32 v77, v77
    v_exp_f32 v78, v78
    v_exp_f32 v79, v79
    v_cvt_pk_bf16_f32 v126, v76, v77
    v_cvt_pk_bf16_f32 v127, v78, v79
    v_mfma_f32_32x32x4_2b_bf16 v[48:79], a[252:253], v[16:17], 0
    v_exp_f32 v80, v80
    v_exp_f32 v81, v81
    v_exp_f32 v82, v82
    v_exp_f32 v83, v83
    v_cvt_pk_bf16_f32 v112, v80, v81
    v_cvt_pk_bf16_f32 v113, v82, v83
    v_exp_f32 v84, v84
    v_exp_f32 v85, v85
    v_exp_f32 v86, v86
    v_exp_f32 v87, v87
    v_mfma_f32_32x32x16_bf16 a[208:223], a[64:67], v[124:127], a[208:223]
    buffer_load_dwordx4 v1, s[12:15], s38 offen offset:2048 sc1 lds
    buffer_load_dwordx4 v1, s[12:15], s38 offen offset:3072 sc1 lds
    buffer_store_dwordx4 v[232:235], v1, s[12:15], s41 offen sc1
    buffer_store_dwordx4 v[236:239], v1, s[12:15], s6 offen sc1
    v_cvt_pk_bf16_f32 v114, v84, v85
    v_cvt_pk_bf16_f32 v115, v86, v87
    v_exp_f32 v88, v88
    v_exp_f32 v89, v89
    v_mfma_f32_32x32x16_bf16 a[208:223], a[120:123], v[112:115], a[208:223]
    ds_read_b128 a[192:195], v8 offset:0
    v_exp_f32 v90, v90
    v_exp_f32 v91, v91
    v_cvt_pk_bf16_f32 v116, v88, v89
    v_cvt_pk_bf16_f32 v117, v90, v91
    v_mfma_f32_32x32x16_bf16 v[48:63], a[240:243], v[12:15], v[48:63]
    s_add_u32 s28, s67, 94208
    ds_read_b128 a[196:199], v8 offset:1024
    v_exp_f32 v92, v92
    v_exp_f32 v93, v93
    v_exp_f32 v94, v94
    v_exp_f32 v95, v95
    v_mfma_f32_32x32x16_bf16 v[64:79], a[244:247], v[12:15], v[64:79]
    s_add_u32 s40, s67, 57344
    ds_read_b64 a[200:201], v9 offset:2048
    v_cvt_pk_bf16_f32 v118, v92, v93
    v_cvt_pk_bf16_f32 v119, v94, v95
    v_exp_f32 v96, v96
    v_exp_f32 v97, v97
    v_exp_f32 v98, v98
    v_exp_f32 v99, v99
    v_cvt_pk_bf16_f32 v120, v96, v97
    v_cvt_pk_bf16_f32 v121, v98, v99
    v_exp_f32 v100, v100
    v_exp_f32 v101, v101
    v_exp_f32 v102, v102
    v_exp_f32 v103, v103
    v_mfma_f32_32x32x16_bf16 a[208:223], a[52:55], v[116:119], a[208:223]
    s_add_u32 m0, s59, 12288
    v_cvt_pk_bf16_f32 v122, v100, v101
    v_cvt_pk_bf16_f32 v123, v102, v103
    v_exp_f32 v104, v104
    v_exp_f32 v105, v105
    v_mfma_f32_32x32x16_bf16 a[208:223], a[60:63], v[120:123], a[208:223]
    s_add_u32 s7, s58, 12288
    v_exp_f32 v106, v106
    v_exp_f32 v107, v107
    v_cvt_pk_bf16_f32 v124, v104, v105
    v_cvt_pk_bf16_f32 v125, v106, v107
    v_exp_f32 v108, v108
    v_exp_f32 v109, v109
    v_exp_f32 v110, v110
    v_exp_f32 v111, v111
    v_cvt_pk_bf16_f32 v126, v108, v109
    v_cvt_pk_bf16_f32 v127, v110, v111
    v_mfma_f32_32x32x4_2b_bf16 v[80:111], v[34:35], v[16:17], 0
    v_exp_f32 v48, v48
    v_exp_f32 v49, v49
    v_exp_f32 v50, v50
    v_exp_f32 v51, v51
    v_cvt_pk_bf16_f32 v112, v48, v49
    v_cvt_pk_bf16_f32 v113, v50, v51
    v_exp_f32 v52, v52
    v_exp_f32 v53, v53
    v_exp_f32 v54, v54
    v_exp_f32 v55, v55
    v_mfma_f32_32x32x16_bf16 a[208:223], a[68:71], v[124:127], a[208:223]
    s_waitcnt lgkmcnt(0)
    v_cvt_pk_bf16_f32 v114, v52, v53
    v_cvt_pk_bf16_f32 v115, v54, v55
    v_exp_f32 v56, v56
    v_exp_f32 v57, v57
    v_mfma_f32_32x32x16_bf16 a[192:207], a[248:251], v[112:115], a[192:207]
    buffer_load_dwordx4 v1, s[12:15], s7 offen offset:0 sc1 lds
    buffer_load_dwordx4 v1, s[12:15], s7 offen offset:1024 sc1 lds
    buffer_store_dwordx4 v[240:243], v1, s[12:15], s40 offen sc1
    buffer_store_dwordx4 v[172:175], v1, s[12:15], s28 offen sc1
    v_exp_f32 v58, v58
    v_exp_f32 v59, v59
    v_cvt_pk_bf16_f32 v116, v56, v57
    v_cvt_pk_bf16_f32 v117, v58, v59
    v_mfma_f32_32x32x16_bf16 v[80:95], a[0:3], v[12:15], v[80:95]
    v_exp_f32 v60, v60
    v_exp_f32 v61, v61
    v_exp_f32 v62, v62
    v_exp_f32 v63, v63
    v_mfma_f32_32x32x16_bf16 v[96:111], a[8:11], v[12:15], v[96:111]
    ds_write_b128 v10, a[208:211] offset:10240
    v_cvt_pk_bf16_f32 v118, v60, v61
    v_cvt_pk_bf16_f32 v119, v62, v63
    v_exp_f32 v64, v64
    v_exp_f32 v65, v65
    v_exp_f32 v66, v66
    v_exp_f32 v67, v67
    v_cvt_pk_bf16_f32 v120, v64, v65
    v_cvt_pk_bf16_f32 v121, v66, v67
    v_exp_f32 v68, v68
    v_exp_f32 v69, v69
    v_exp_f32 v70, v70
    v_exp_f32 v71, v71
    v_mfma_f32_32x32x16_bf16 a[192:207], a[144:147], v[116:119], a[192:207]
    ds_write_b128 v10, a[212:215] offset:11264
    v_cvt_pk_bf16_f32 v122, v68, v69
    v_cvt_pk_bf16_f32 v123, v70, v71
    v_exp_f32 v72, v72
    v_exp_f32 v73, v73
    v_mfma_f32_32x32x16_bf16 a[192:207], a[152:155], v[120:123], a[192:207]
    ds_write_b64 v18, a[216:217] offset:12288
    v_exp_f32 v74, v74
    v_exp_f32 v75, v75
    v_cvt_pk_bf16_f32 v124, v72, v73
    v_cvt_pk_bf16_f32 v125, v74, v75
    v_exp_f32 v76, v76
    v_exp_f32 v77, v77
    v_exp_f32 v78, v78
    v_exp_f32 v79, v79
    v_cvt_pk_bf16_f32 v126, v76, v77
    v_cvt_pk_bf16_f32 v127, v78, v79
    v_mfma_f32_32x32x4_2b_bf16 v[48:79], v[36:37], v[16:17], 0
    v_exp_f32 v80, v80
    v_exp_f32 v81, v81
    v_exp_f32 v82, v82
    v_exp_f32 v83, v83
    v_cvt_pk_bf16_f32 v112, v80, v81
    v_cvt_pk_bf16_f32 v113, v82, v83
    v_exp_f32 v84, v84
    v_exp_f32 v85, v85
    v_exp_f32 v86, v86
    v_exp_f32 v87, v87
    v_mfma_f32_32x32x16_bf16 a[192:207], a[160:163], v[124:127], a[192:207]
    v_cvt_pk_bf16_f32 v114, v84, v85
    v_cvt_pk_bf16_f32 v115, v86, v87
    v_exp_f32 v88, v88
    v_exp_f32 v89, v89
    v_mfma_f32_32x32x16_bf16 a[192:207], a[16:19], v[112:115], a[192:207]
    v_exp_f32 v90, v90
    v_exp_f32 v91, v91
    v_cvt_pk_bf16_f32 v116, v88, v89
    v_cvt_pk_bf16_f32 v117, v90, v91
    v_mfma_f32_32x32x16_bf16 v[48:63], a[148:151], v[12:15], v[48:63]
    v_exp_f32 v92, v92
    v_exp_f32 v93, v93
    v_exp_f32 v94, v94
    v_exp_f32 v95, v95
    v_mfma_f32_32x32x16_bf16 v[64:79], a[156:159], v[12:15], v[64:79]
    v_cvt_pk_bf16_f32 v118, v92, v93
    v_cvt_pk_bf16_f32 v119, v94, v95
    v_exp_f32 v96, v96
    v_exp_f32 v97, v97
    v_exp_f32 v98, v98
    v_exp_f32 v99, v99
    v_cvt_pk_bf16_f32 v120, v96, v97
    v_cvt_pk_bf16_f32 v121, v98, v99
    v_exp_f32 v100, v100
    v_exp_f32 v101, v101
    v_exp_f32 v102, v102
    v_exp_f32 v103, v103
    v_mfma_f32_32x32x16_bf16 a[192:207], a[88:91], v[116:119], a[192:207]
    s_add_u32 s75, s67, 24576
    v_cvt_pk_bf16_f32 v122, v100, v101
    v_cvt_pk_bf16_f32 v123, v102, v103
    v_exp_f32 v104, v104
    v_exp_f32 v105, v105
    v_mfma_f32_32x32x16_bf16 a[192:207], a[80:83], v[120:123], a[192:207]
    s_add_u32 s29, s67, 131072
    v_exp_f32 v106, v106
    v_exp_f32 v107, v107
    v_cvt_pk_bf16_f32 v124, v104, v105
    v_cvt_pk_bf16_f32 v125, v106, v107
    v_exp_f32 v108, v108
    v_exp_f32 v109, v109
    v_exp_f32 v110, v110
    v_exp_f32 v111, v111
    v_cvt_pk_bf16_f32 v126, v108, v109
    v_cvt_pk_bf16_f32 v127, v110, v111
    v_mfma_f32_32x32x4_2b_bf16 v[80:111], v[38:39], v[16:17], 0
    v_exp_f32 v48, v48
    v_exp_f32 v49, v49
    v_exp_f32 v50, v50
    v_exp_f32 v51, v51
    v_cvt_pk_bf16_f32 v112, v48, v49
    v_cvt_pk_bf16_f32 v113, v50, v51
    v_exp_f32 v52, v52
    v_exp_f32 v53, v53
    v_exp_f32 v54, v54
    v_exp_f32 v55, v55
    v_mfma_f32_32x32x16_bf16 a[192:207], a[72:75], v[124:127], a[192:207]
    buffer_load_dwordx4 v1, s[12:15], s7 offen offset:2048 sc1 lds
    buffer_load_dwordx4 v1, s[12:15], s7 offen offset:3072 sc1 lds
    buffer_store_dwordx4 v[180:183], v1, s[12:15], s29 offen sc1
    buffer_store_dwordx4 v[188:191], v1, s[12:15], s75 offen sc1
    v_cvt_pk_bf16_f32 v114, v52, v53
    v_cvt_pk_bf16_f32 v115, v54, v55
    v_exp_f32 v56, v56
    v_exp_f32 v57, v57
    v_mfma_f32_32x32x16_bf16 a[192:207], a[164:167], v[112:115], a[192:207]
    v_exp_f32 v58, v58
    v_exp_f32 v59, v59
    v_cvt_pk_bf16_f32 v116, v56, v57
    v_cvt_pk_bf16_f32 v117, v58, v59
    v_mfma_f32_32x32x16_bf16 v[80:95], a[92:95], v[12:15], v[80:95]
    s_add_u32 s3, s67, 98304
    v_exp_f32 v60, v60
    v_exp_f32 v61, v61
    v_exp_f32 v62, v62
    v_exp_f32 v63, v63
    v_mfma_f32_32x32x16_bf16 v[96:111], a[84:87], v[12:15], v[96:111]
    s_add_u32 s31, s67, 61440
    v_cvt_pk_bf16_f32 v118, v60, v61
    v_cvt_pk_bf16_f32 v119, v62, v63
    v_exp_f32 v64, v64
    v_exp_f32 v65, v65
    v_exp_f32 v66, v66
    v_exp_f32 v67, v67
    v_cvt_pk_bf16_f32 v120, v64, v65
    v_cvt_pk_bf16_f32 v121, v66, v67
    v_exp_f32 v68, v68
    v_exp_f32 v69, v69
    v_exp_f32 v70, v70
    v_exp_f32 v71, v71
    v_mfma_f32_32x32x16_bf16 a[192:207], a[4:7], v[116:119], a[192:207]
    s_add_u32 m0, s59, 16384
    v_cvt_pk_bf16_f32 v122, v68, v69
    v_cvt_pk_bf16_f32 v123, v70, v71
    v_exp_f32 v72, v72
    v_exp_f32 v73, v73
    v_mfma_f32_32x32x16_bf16 a[192:207], a[12:15], v[120:123], a[192:207]
    s_add_u32 s30, s58, 16384
    v_exp_f32 v74, v74
    v_exp_f32 v75, v75
    v_cvt_pk_bf16_f32 v124, v72, v73
    v_cvt_pk_bf16_f32 v125, v74, v75
    v_exp_f32 v76, v76
    v_exp_f32 v77, v77
    v_exp_f32 v78, v78
    v_exp_f32 v79, v79
    v_cvt_pk_bf16_f32 v126, v76, v77
    v_cvt_pk_bf16_f32 v127, v78, v79
    v_mfma_f32_32x32x4_2b_bf16 v[48:79], v[40:41], v[16:17], 0
    v_exp_f32 v80, v80
    v_exp_f32 v81, v81
    v_exp_f32 v82, v82
    v_exp_f32 v83, v83
    v_cvt_pk_bf16_f32 v112, v80, v81
    v_cvt_pk_bf16_f32 v113, v82, v83
    v_exp_f32 v84, v84
    v_exp_f32 v85, v85
    v_exp_f32 v86, v86
    v_exp_f32 v87, v87
    v_mfma_f32_32x32x16_bf16 a[192:207], a[20:23], v[124:127], a[192:207]
    buffer_load_dwordx4 v1, s[12:15], s30 offen offset:0 sc1 lds
    buffer_load_dwordx4 v1, s[12:15], s30 offen offset:1024 sc1 lds
    buffer_store_dwordx4 v[196:199], v1, s[12:15], s31 offen sc1
    buffer_store_dwordx4 v[168:171], v1, s[12:15], s3 offen sc1
    v_cvt_pk_bf16_f32 v114, v84, v85
    v_cvt_pk_bf16_f32 v115, v86, v87
    v_exp_f32 v88, v88
    v_exp_f32 v89, v89
    v_mfma_f32_32x32x16_bf16 a[192:207], a[76:79], v[112:115], a[192:207]
    s_waitcnt lgkmcnt(0)
    v_exp_f32 v90, v90
    v_exp_f32 v91, v91
    v_cvt_pk_bf16_f32 v116, v88, v89
    v_cvt_pk_bf16_f32 v117, v90, v91
    v_mfma_f32_32x32x16_bf16 v[48:63], a[24:27], v[12:15], v[48:63]
    s_barrier
    v_exp_f32 v92, v92
    v_exp_f32 v93, v93
    v_exp_f32 v94, v94
    v_exp_f32 v95, v95
    v_mfma_f32_32x32x16_bf16 v[64:79], a[32:35], v[12:15], v[64:79]
    v_cvt_pk_bf16_f32 v118, v92, v93
    v_cvt_pk_bf16_f32 v119, v94, v95
    v_exp_f32 v96, v96
    v_exp_f32 v97, v97
    v_exp_f32 v98, v98
    v_exp_f32 v99, v99
    v_cvt_pk_bf16_f32 v120, v96, v97
    v_cvt_pk_bf16_f32 v121, v98, v99
    v_exp_f32 v100, v100
    v_exp_f32 v101, v101
    v_exp_f32 v102, v102
    v_exp_f32 v103, v103
    v_mfma_f32_32x32x16_bf16 a[192:207], a[168:171], v[116:119], a[192:207]
    v_cvt_pk_bf16_f32 v122, v100, v101
    v_cvt_pk_bf16_f32 v123, v102, v103
    v_exp_f32 v104, v104
    v_exp_f32 v105, v105
    v_mfma_f32_32x32x16_bf16 a[192:207], a[176:179], v[120:123], a[192:207]
    v_exp_f32 v106, v106
    v_exp_f32 v107, v107
    v_cvt_pk_bf16_f32 v124, v104, v105
    v_cvt_pk_bf16_f32 v125, v106, v107
    v_exp_f32 v108, v108
    v_exp_f32 v109, v109
    v_exp_f32 v110, v110
    v_exp_f32 v111, v111
    v_cvt_pk_bf16_f32 v126, v108, v109
    v_cvt_pk_bf16_f32 v127, v110, v111
    v_mfma_f32_32x32x4_2b_bf16 v[80:111], v[42:43], v[16:17], 0
    v_exp_f32 v48, v48
    v_exp_f32 v49, v49
    v_exp_f32 v50, v50
    v_exp_f32 v51, v51
    v_cvt_pk_bf16_f32 v112, v48, v49
    v_cvt_pk_bf16_f32 v113, v50, v51
    v_exp_f32 v52, v52
    v_exp_f32 v53, v53
    v_exp_f32 v54, v54
    v_exp_f32 v55, v55
    v_mfma_f32_32x32x16_bf16 a[192:207], a[184:187], v[124:127], a[192:207]
    v_cvt_pk_bf16_f32 v114, v52, v53
    v_cvt_pk_bf16_f32 v115, v54, v55
    v_exp_f32 v56, v56
    v_exp_f32 v57, v57
    v_mfma_f32_32x32x16_bf16 a[192:207], a[40:43], v[112:115], a[192:207]
    ds_read_b128 a[208:211], v8 offset:10240
    v_exp_f32 v58, v58
    v_exp_f32 v59, v59
    v_cvt_pk_bf16_f32 v116, v56, v57
    v_cvt_pk_bf16_f32 v117, v58, v59
    v_mfma_f32_32x32x16_bf16 v[80:95], a[172:175], v[12:15], v[80:95]
    ds_read_b128 a[212:215], v8 offset:11264
    v_exp_f32 v60, v60
    v_exp_f32 v61, v61
    v_exp_f32 v62, v62
    v_exp_f32 v63, v63
    v_mfma_f32_32x32x16_bf16 v[96:111], a[180:183], v[12:15], v[96:111]
    ds_read_b64 a[216:217], v9 offset:12288
    v_cvt_pk_bf16_f32 v118, v60, v61
    v_cvt_pk_bf16_f32 v119, v62, v63
    v_exp_f32 v64, v64
    v_exp_f32 v65, v65
    v_exp_f32 v66, v66
    v_exp_f32 v67, v67
    v_cvt_pk_bf16_f32 v120, v64, v65
    v_cvt_pk_bf16_f32 v121, v66, v67
    v_exp_f32 v68, v68
    v_exp_f32 v69, v69
    v_exp_f32 v70, v70
    v_exp_f32 v71, v71
    v_mfma_f32_32x32x16_bf16 a[192:207], a[112:115], v[116:119], a[192:207]
    s_add_u32 s6, s67, 28672
    v_cvt_pk_bf16_f32 v122, v68, v69
    v_cvt_pk_bf16_f32 v123, v70, v71
    v_exp_f32 v72, v72
    v_exp_f32 v73, v73
    v_mfma_f32_32x32x16_bf16 a[192:207], a[104:107], v[120:123], a[192:207]
    s_add_u32 s39, s67, 135168
    v_exp_f32 v74, v74
    v_exp_f32 v75, v75
    v_cvt_pk_bf16_f32 v124, v72, v73
    v_cvt_pk_bf16_f32 v125, v74, v75
    v_exp_f32 v76, v76
    v_exp_f32 v77, v77
    v_exp_f32 v78, v78
    v_exp_f32 v79, v79
    v_cvt_pk_bf16_f32 v126, v76, v77
    v_cvt_pk_bf16_f32 v127, v78, v79
    v_mfma_f32_32x32x4_2b_bf16 v[48:79], v[44:45], v[16:17], 0
    v_add_u32 v6, 8, v6
    v_exp_f32 v80, v80
    v_exp_f32 v81, v81
    v_exp_f32 v82, v82
    v_exp_f32 v83, v83
    v_cvt_pk_bf16_f32 v112, v80, v81
    v_cvt_pk_bf16_f32 v113, v82, v83
    v_exp_f32 v84, v84
    v_exp_f32 v85, v85
    v_exp_f32 v86, v86
    v_exp_f32 v87, v87
    v_mfma_f32_32x32x16_bf16 a[192:207], a[96:99], v[124:127], a[192:207]
    buffer_load_dwordx4 v1, s[12:15], s30 offen offset:2048 sc1 lds
    buffer_load_dwordx4 v1, s[12:15], s30 offen offset:3072 sc1 lds
    buffer_store_dwordx4 v[204:207], v1, s[12:15], s39 offen sc1
    buffer_store_dwordx4 v[176:179], v1, s[12:15], s6 offen sc1
    v_cvt_pk_bf16_f32 v114, v84, v85
    v_cvt_pk_bf16_f32 v115, v86, v87
    v_exp_f32 v88, v88
    v_exp_f32 v89, v89
    v_mfma_f32_32x32x16_bf16 a[192:207], a[188:191], v[112:115], a[192:207]
    v_exp_f32 v90, v90
    v_exp_f32 v91, v91
    v_cvt_pk_bf16_f32 v116, v88, v89
    v_cvt_pk_bf16_f32 v117, v90, v91
    v_mfma_f32_32x32x16_bf16 v[48:63], a[116:119], v[12:15], v[48:63]
    s_add_u32 s28, s67, 102400
    v_exp_f32 v92, v92
    v_exp_f32 v93, v93
    v_exp_f32 v94, v94
    v_exp_f32 v95, v95
    v_mfma_f32_32x32x16_bf16 v[64:79], a[108:111], v[12:15], v[64:79]
    s_add_u32 s41, s67, 65536
    v_cvt_pk_bf16_f32 v118, v92, v93
    v_cvt_pk_bf16_f32 v119, v94, v95
    v_exp_f32 v96, v96
    v_exp_f32 v97, v97
    v_exp_f32 v98, v98
    v_exp_f32 v99, v99
    v_cvt_pk_bf16_f32 v120, v96, v97
    v_cvt_pk_bf16_f32 v121, v98, v99
    v_exp_f32 v100, v100
    v_exp_f32 v101, v101
    v_exp_f32 v102, v102
    v_exp_f32 v103, v103
    v_mfma_f32_32x32x16_bf16 a[192:207], a[28:31], v[116:119], a[192:207]
    s_add_u32 m0, s59, 20480
    v_cvt_pk_bf16_f32 v122, v100, v101
    v_cvt_pk_bf16_f32 v123, v102, v103
    v_exp_f32 v104, v104
    v_exp_f32 v105, v105
    v_mfma_f32_32x32x16_bf16 a[192:207], a[36:39], v[120:123], a[192:207]
    s_add_u32 s38, s58, 20480
    v_exp_f32 v106, v106
    v_exp_f32 v107, v107
    v_cvt_pk_bf16_f32 v124, v104, v105
    v_cvt_pk_bf16_f32 v125, v106, v107
    v_exp_f32 v108, v108
    v_exp_f32 v109, v109
    v_exp_f32 v110, v110
    v_exp_f32 v111, v111
    v_cvt_pk_bf16_f32 v126, v108, v109
    v_cvt_pk_bf16_f32 v127, v110, v111
    v_mfma_f32_32x32x4_2b_bf16 v[80:111], v[46:47], v[16:17], 0
    v_exp_f32 v48, v48
    v_exp_f32 v49, v49
    v_exp_f32 v50, v50
    v_exp_f32 v51, v51
    v_cvt_pk_bf16_f32 v112, v48, v49
    v_cvt_pk_bf16_f32 v113, v50, v51
    v_exp_f32 v52, v52
    v_exp_f32 v53, v53
    v_exp_f32 v54, v54
    v_exp_f32 v55, v55
    v_mfma_f32_32x32x16_bf16 a[192:207], a[44:47], v[124:127], a[192:207]
    buffer_load_dwordx4 v1, s[12:15], s38 offen offset:0 sc1 lds
    buffer_load_dwordx4 v1, s[12:15], s38 offen offset:1024 sc1 lds
    buffer_store_dwordx4 v[212:215], v1, s[12:15], s41 offen sc1
    buffer_store_dwordx4 v[184:187], v1, s[12:15], s28 offen sc1
    ds_read_b64 v[16:17], v7 offset:1024
    v_cvt_pk_bf16_f32 v114, v52, v53
    v_cvt_pk_bf16_f32 v115, v54, v55
    v_exp_f32 v56, v56
    v_exp_f32 v57, v57
    v_mfma_f32_32x32x16_bf16 a[192:207], a[100:103], v[112:115], a[192:207]
    v_exp_f32 v58, v58
    v_exp_f32 v59, v59
    v_cvt_pk_bf16_f32 v116, v56, v57
    v_cvt_pk_bf16_f32 v117, v58, v59
    v_mfma_f32_32x32x16_bf16 v[80:95], a[136:139], v[12:15], v[80:95]
    v_exp_f32 v60, v60
    v_exp_f32 v61, v61
    v_exp_f32 v62, v62
    v_exp_f32 v63, v63
    v_mfma_f32_32x32x16_bf16 v[96:111], a[128:131], v[12:15], v[96:111]
    v_cvt_pk_bf16_f32 v118, v60, v61
    v_cvt_pk_bf16_f32 v119, v62, v63
    v_exp_f32 v64, v64
    v_exp_f32 v65, v65
    v_exp_f32 v66, v66
    v_exp_f32 v67, v67
    v_cvt_pk_bf16_f32 v120, v64, v65
    v_cvt_pk_bf16_f32 v121, v66, v67
    v_exp_f32 v68, v68
    v_exp_f32 v69, v69
    v_exp_f32 v70, v70
    v_exp_f32 v71, v71
    v_mfma_f32_32x32x16_bf16 a[192:207], a[48:51], v[116:119], a[192:207]
    ds_read2st64_b64 v[12:15], v6 offset0:0 offset1:4
    v_cvt_pk_bf16_f32 v122, v68, v69
    v_cvt_pk_bf16_f32 v123, v70, v71
    v_exp_f32 v72, v72
    v_exp_f32 v73, v73
    v_mfma_f32_32x32x16_bf16 a[192:207], a[56:59], v[120:123], a[192:207]
    s_waitcnt lgkmcnt(1)
    v_exp_f32 v74, v74
    v_exp_f32 v75, v75
    v_cvt_pk_bf16_f32 v124, v72, v73
    v_cvt_pk_bf16_f32 v125, v74, v75
    v_exp_f32 v76, v76
    v_exp_f32 v77, v77
    v_exp_f32 v78, v78
    v_exp_f32 v79, v79
    v_cvt_pk_bf16_f32 v126, v76, v77
    v_cvt_pk_bf16_f32 v127, v78, v79
    v_mfma_f32_32x32x4_2b_bf16 v[48:79], a[252:253], v[16:17], 0
    v_exp_f32 v80, v80
    v_exp_f32 v81, v81
    v_exp_f32 v82, v82
    v_exp_f32 v83, v83
    v_cvt_pk_bf16_f32 v112, v80, v81
    v_cvt_pk_bf16_f32 v113, v82, v83
    v_exp_f32 v84, v84
    v_exp_f32 v85, v85
    v_exp_f32 v86, v86
    v_exp_f32 v87, v87
    v_mfma_f32_32x32x16_bf16 a[192:207], a[64:67], v[124:127], a[192:207]
    v_cvt_pk_bf16_f32 v114, v84, v85
    v_cvt_pk_bf16_f32 v115, v86, v87
    v_exp_f32 v88, v88
    v_exp_f32 v89, v89
    v_mfma_f32_32x32x16_bf16 a[192:207], a[120:123], v[112:115], a[192:207]
    s_waitcnt lgkmcnt(0)
    v_exp_f32 v90, v90
    v_exp_f32 v91, v91
    v_cvt_pk_bf16_f32 v116, v88, v89
    v_cvt_pk_bf16_f32 v117, v90, v91
    v_mfma_f32_32x32x16_bf16 v[48:63], a[240:243], v[12:15], v[48:63]
    v_exp_f32 v92, v92
    v_exp_f32 v93, v93
    v_exp_f32 v94, v94
    v_exp_f32 v95, v95
    v_mfma_f32_32x32x16_bf16 v[64:79], a[244:247], v[12:15], v[64:79]
    v_cvt_pk_bf16_f32 v118, v92, v93
    v_cvt_pk_bf16_f32 v119, v94, v95
    v_exp_f32 v96, v96
    v_exp_f32 v97, v97
    v_exp_f32 v98, v98
    v_exp_f32 v99, v99
    v_cvt_pk_bf16_f32 v120, v96, v97
    v_cvt_pk_bf16_f32 v121, v98, v99
    v_exp_f32 v100, v100
    v_exp_f32 v101, v101
    v_exp_f32 v102, v102
    v_exp_f32 v103, v103
    v_mfma_f32_32x32x16_bf16 a[192:207], a[52:55], v[116:119], a[192:207]
    v_cvt_pk_bf16_f32 v122, v100, v101
    v_cvt_pk_bf16_f32 v123, v102, v103
    v_exp_f32 v104, v104
    v_exp_f32 v105, v105
    v_mfma_f32_32x32x16_bf16 a[192:207], a[60:63], v[120:123], a[192:207]
    s_add_u32 s40, s67, 139264
    v_exp_f32 v106, v106
    v_exp_f32 v107, v107
    v_cvt_pk_bf16_f32 v124, v104, v105
    v_cvt_pk_bf16_f32 v125, v106, v107
    v_exp_f32 v108, v108
    v_exp_f32 v109, v109
    v_exp_f32 v110, v110
    v_exp_f32 v111, v111
    v_cvt_pk_bf16_f32 v126, v108, v109
    v_cvt_pk_bf16_f32 v127, v110, v111
    v_mfma_f32_32x32x4_2b_bf16 v[80:111], v[34:35], v[16:17], 0
    v_exp_f32 v48, v48
    v_exp_f32 v49, v49
    v_exp_f32 v50, v50
    v_exp_f32 v51, v51
    v_cvt_pk_bf16_f32 v112, v48, v49
    v_cvt_pk_bf16_f32 v113, v50, v51
    v_exp_f32 v52, v52
    v_exp_f32 v53, v53
    v_exp_f32 v54, v54
    v_exp_f32 v55, v55
    v_mfma_f32_32x32x16_bf16 a[192:207], a[68:71], v[124:127], a[192:207]
    buffer_load_dwordx4 v1, s[12:15], s38 offen offset:2048 sc1 lds
    buffer_load_dwordx4 v1, s[12:15], s38 offen offset:3072 sc1 lds
    buffer_store_dwordx4 v[220:223], v1, s[12:15], s40 offen sc1
    v_cvt_pk_bf16_f32 v114, v52, v53
    v_cvt_pk_bf16_f32 v115, v54, v55
    v_exp_f32 v56, v56
    v_exp_f32 v57, v57
    v_mfma_f32_32x32x16_bf16 a[208:223], a[248:251], v[112:115], a[208:223]
    s_add_u32 m0, s59, 24576
    s_add_u32 s7, s58, 24576
    v_exp_f32 v58, v58
    v_exp_f32 v59, v59
    v_cvt_pk_bf16_f32 v116, v56, v57
    v_cvt_pk_bf16_f32 v117, v58, v59
    v_mfma_f32_32x32x16_bf16 v[80:95], a[0:3], v[12:15], v[80:95]
    buffer_load_dwordx4 v1, s[12:15], s7 offen offset:0 sc1 lds
    global_load_dword v253, v[30:31], off
    v_exp_f32 v60, v60
    v_exp_f32 v61, v61
    v_exp_f32 v62, v62
    v_exp_f32 v63, v63
    v_mfma_f32_32x32x16_bf16 v[96:111], a[8:11], v[12:15], v[96:111]
    ds_write_b128 v10, a[192:195] offset:0
    v_cvt_pk_bf16_f32 v118, v60, v61
    v_cvt_pk_bf16_f32 v119, v62, v63
    v_exp_f32 v64, v64
    v_exp_f32 v65, v65
    v_exp_f32 v66, v66
    v_exp_f32 v67, v67
    v_cvt_pk_bf16_f32 v120, v64, v65
    v_cvt_pk_bf16_f32 v121, v66, v67
    v_exp_f32 v68, v68
    v_exp_f32 v69, v69
    v_exp_f32 v70, v70
    v_exp_f32 v71, v71
    v_mfma_f32_32x32x16_bf16 a[208:223], a[144:147], v[116:119], a[208:223]
    ds_write_b128 v10, a[196:199] offset:1024
    v_cvt_pk_bf16_f32 v122, v68, v69
    v_cvt_pk_bf16_f32 v123, v70, v71
    v_exp_f32 v72, v72
    v_exp_f32 v73, v73
    v_mfma_f32_32x32x16_bf16 a[208:223], a[152:155], v[120:123], a[208:223]
    ds_write_b64 v18, a[200:201] offset:2048
    v_exp_f32 v74, v74
    v_exp_f32 v75, v75
    v_cvt_pk_bf16_f32 v124, v72, v73
    v_cvt_pk_bf16_f32 v125, v74, v75
    v_exp_f32 v76, v76
    v_exp_f32 v77, v77
    v_exp_f32 v78, v78
    v_exp_f32 v79, v79
    v_cvt_pk_bf16_f32 v126, v76, v77
    v_cvt_pk_bf16_f32 v127, v78, v79
    v_mfma_f32_32x32x4_2b_bf16 v[48:79], v[36:37], v[16:17], 0
    v_exp_f32 v80, v80
    v_exp_f32 v81, v81
    v_exp_f32 v82, v82
    v_exp_f32 v83, v83
    v_cvt_pk_bf16_f32 v112, v80, v81
    v_cvt_pk_bf16_f32 v113, v82, v83
    v_exp_f32 v84, v84
    v_exp_f32 v85, v85
    v_exp_f32 v86, v86
    v_exp_f32 v87, v87
    v_mfma_f32_32x32x16_bf16 a[208:223], a[160:163], v[124:127], a[208:223]
    v_cvt_pk_bf16_f32 v114, v84, v85
    v_cvt_pk_bf16_f32 v115, v86, v87
    v_exp_f32 v88, v88
    v_exp_f32 v89, v89
    v_mfma_f32_32x32x16_bf16 a[208:223], a[16:19], v[112:115], a[208:223]
    v_exp_f32 v90, v90
    v_exp_f32 v91, v91
    v_cvt_pk_bf16_f32 v116, v88, v89
    v_cvt_pk_bf16_f32 v117, v90, v91
    v_mfma_f32_32x32x16_bf16 v[48:63], a[148:151], v[12:15], v[48:63]
    v_exp_f32 v92, v92
    v_exp_f32 v93, v93
    v_exp_f32 v94, v94
    v_exp_f32 v95, v95
    v_mfma_f32_32x32x16_bf16 v[64:79], a[156:159], v[12:15], v[64:79]
    v_cvt_pk_bf16_f32 v118, v92, v93
    v_cvt_pk_bf16_f32 v119, v94, v95
    v_exp_f32 v96, v96
    v_exp_f32 v97, v97
    v_exp_f32 v98, v98
    v_exp_f32 v99, v99
    v_cvt_pk_bf16_f32 v120, v96, v97
    v_cvt_pk_bf16_f32 v121, v98, v99
    v_exp_f32 v100, v100
    v_exp_f32 v101, v101
    v_exp_f32 v102, v102
    v_exp_f32 v103, v103
    v_mfma_f32_32x32x16_bf16 a[208:223], a[88:91], v[116:119], a[208:223]
    v_cvt_pk_bf16_f32 v122, v100, v101
    v_cvt_pk_bf16_f32 v123, v102, v103
    v_exp_f32 v104, v104
    v_exp_f32 v105, v105
    v_mfma_f32_32x32x16_bf16 a[208:223], a[80:83], v[120:123], a[208:223]
    v_exp_f32 v106, v106
    v_exp_f32 v107, v107
    v_cvt_pk_bf16_f32 v124, v104, v105
    v_cvt_pk_bf16_f32 v125, v106, v107
    v_exp_f32 v108, v108
    v_exp_f32 v109, v109
    v_exp_f32 v110, v110
    v_exp_f32 v111, v111
    v_cvt_pk_bf16_f32 v126, v108, v109
    v_cvt_pk_bf16_f32 v127, v110, v111
    v_mfma_f32_32x32x4_2b_bf16 v[80:111], v[38:39], v[16:17], 0
    v_exp_f32 v48, v48
    v_exp_f32 v49, v49
    v_exp_f32 v50, v50
    v_exp_f32 v51, v51
    v_cvt_pk_bf16_f32 v112, v48, v49
    v_cvt_pk_bf16_f32 v113, v50, v51
    v_exp_f32 v52, v52
    v_exp_f32 v53, v53
    v_exp_f32 v54, v54
    v_exp_f32 v55, v55
    v_mfma_f32_32x32x16_bf16 a[208:223], a[72:75], v[124:127], a[208:223]
    s_add_u32 s54, s44, 2
    v_cvt_pk_bf16_f32 v114, v52, v53
    v_cvt_pk_bf16_f32 v115, v54, v55
    v_exp_f32 v56, v56
    v_exp_f32 v57, v57
    v_mfma_f32_32x32x16_bf16 a[208:223], a[164:167], v[112:115], a[208:223]
    s_and_b32 s54, s54, 3
    v_exp_f32 v58, v58
    v_exp_f32 v59, v59
    v_cvt_pk_bf16_f32 v116, v56, v57
    v_cvt_pk_bf16_f32 v117, v58, v59
    v_mfma_f32_32x32x16_bf16 v[80:95], a[92:95], v[12:15], v[80:95]
    s_lshl_b32 s54, s54, 8
    v_lshl_add_u32 v6, s54, 1, v23
    v_add_u32 v7, s54, v19
    v_exp_f32 v60, v60
    v_exp_f32 v61, v61
    v_exp_f32 v62, v62
    v_exp_f32 v63, v63
    v_mfma_f32_32x32x16_bf16 v[96:111], a[84:87], v[12:15], v[96:111]
    v_cvt_pk_bf16_f32 v118, v60, v61
    v_cvt_pk_bf16_f32 v119, v62, v63
    v_exp_f32 v64, v64
    v_exp_f32 v65, v65
    v_exp_f32 v66, v66
    v_exp_f32 v67, v67
    v_cvt_pk_bf16_f32 v120, v64, v65
    v_cvt_pk_bf16_f32 v121, v66, v67
    v_exp_f32 v68, v68
    v_exp_f32 v69, v69
    v_exp_f32 v70, v70
    v_exp_f32 v71, v71
    v_mfma_f32_32x32x16_bf16 a[208:223], a[4:7], v[116:119], a[208:223]
    v_cvt_pk_bf16_f32 v122, v68, v69
    v_cvt_pk_bf16_f32 v123, v70, v71
    v_exp_f32 v72, v72
    v_exp_f32 v73, v73
    v_mfma_f32_32x32x16_bf16 a[208:223], a[12:15], v[120:123], a[208:223]
    v_exp_f32 v74, v74
    v_exp_f32 v75, v75
    v_cvt_pk_bf16_f32 v124, v72, v73
    v_cvt_pk_bf16_f32 v125, v74, v75
    v_exp_f32 v76, v76
    v_exp_f32 v77, v77
    v_exp_f32 v78, v78
    v_exp_f32 v79, v79
    v_cvt_pk_bf16_f32 v126, v76, v77
    v_cvt_pk_bf16_f32 v127, v78, v79
    v_mfma_f32_32x32x4_2b_bf16 v[48:79], v[40:41], v[16:17], 0
    v_exp_f32 v80, v80
    v_exp_f32 v81, v81
    v_exp_f32 v82, v82
    v_exp_f32 v83, v83
    v_cvt_pk_bf16_f32 v112, v80, v81
    v_cvt_pk_bf16_f32 v113, v82, v83
    v_exp_f32 v84, v84
    v_exp_f32 v85, v85
    v_exp_f32 v86, v86
    v_exp_f32 v87, v87
    v_mfma_f32_32x32x16_bf16 a[208:223], a[20:23], v[124:127], a[208:223]
    v_cvt_pk_bf16_f32 v114, v84, v85
    v_cvt_pk_bf16_f32 v115, v86, v87
    v_exp_f32 v88, v88
    v_exp_f32 v89, v89
    v_mfma_f32_32x32x16_bf16 a[208:223], a[76:79], v[112:115], a[208:223]
    s_waitcnt vmcnt(2) lgkmcnt(0)
    v_exp_f32 v90, v90
    v_exp_f32 v91, v91
    v_cvt_pk_bf16_f32 v116, v88, v89
    v_cvt_pk_bf16_f32 v117, v90, v91
    v_mfma_f32_32x32x16_bf16 v[48:63], a[24:27], v[12:15], v[48:63]
    s_barrier
    v_exp_f32 v92, v92
    v_exp_f32 v93, v93
    v_exp_f32 v94, v94
    v_exp_f32 v95, v95
    v_mfma_f32_32x32x16_bf16 v[64:79], a[32:35], v[12:15], v[64:79]
    buffer_store_dword v22, v21, s[12:15], s96 offen offset:1024 sc1
    buffer_load_dwordx4 v[168:171], v1, s[12:15], s7 offen offset:1024 sc1
    buffer_load_dwordx4 v[172:175], v1, s[12:15], s7 offen offset:2048 sc1
    v_cvt_pk_bf16_f32 v118, v92, v93
    v_cvt_pk_bf16_f32 v119, v94, v95
    v_exp_f32 v96, v96
    v_exp_f32 v97, v97
    v_exp_f32 v98, v98
    v_exp_f32 v99, v99
    v_cvt_pk_bf16_f32 v120, v96, v97
    v_cvt_pk_bf16_f32 v121, v98, v99
    v_exp_f32 v100, v100
    v_exp_f32 v101, v101
    v_exp_f32 v102, v102
    v_exp_f32 v103, v103
    v_mfma_f32_32x32x16_bf16 a[208:223], a[168:171], v[116:119], a[208:223]
    v_cvt_pk_bf16_f32 v122, v100, v101
    v_cvt_pk_bf16_f32 v123, v102, v103
    v_exp_f32 v104, v104
    v_exp_f32 v105, v105
    v_mfma_f32_32x32x16_bf16 a[208:223], a[176:179], v[120:123], a[208:223]
    s_add_u32 s75, s58, 28672
    v_exp_f32 v106, v106
    v_exp_f32 v107, v107
    v_cvt_pk_bf16_f32 v124, v104, v105
    v_cvt_pk_bf16_f32 v125, v106, v107
    v_exp_f32 v108, v108
    v_exp_f32 v109, v109
    v_exp_f32 v110, v110
    v_exp_f32 v111, v111
    v_cvt_pk_bf16_f32 v126, v108, v109
    v_cvt_pk_bf16_f32 v127, v110, v111
    v_mfma_f32_32x32x4_2b_bf16 v[80:111], v[42:43], v[16:17], 0
    v_exp_f32 v48, v48
    v_exp_f32 v49, v49
    v_exp_f32 v50, v50
    v_exp_f32 v51, v51
    v_cvt_pk_bf16_f32 v112, v48, v49
    v_cvt_pk_bf16_f32 v113, v50, v51
    v_exp_f32 v52, v52
    v_exp_f32 v53, v53
    v_exp_f32 v54, v54
    v_exp_f32 v55, v55
    v_mfma_f32_32x32x16_bf16 a[208:223], a[184:187], v[124:127], a[208:223]
    buffer_load_dwordx4 v[176:179], v1, s[12:15], s7 offen offset:3072 sc1
    buffer_load_dwordx4 v[180:183], v1, s[12:15], s75 offen offset:0 sc1
    v_cvt_pk_bf16_f32 v114, v52, v53
    v_cvt_pk_bf16_f32 v115, v54, v55
    v_exp_f32 v56, v56
    v_exp_f32 v57, v57
    v_mfma_f32_32x32x16_bf16 a[208:223], a[40:43], v[112:115], a[208:223]
    ds_read_b128 v[128:131], v8 offset:0
    v_exp_f32 v58, v58
    v_exp_f32 v59, v59
    v_cvt_pk_bf16_f32 v116, v56, v57
    v_cvt_pk_bf16_f32 v117, v58, v59
    v_mfma_f32_32x32x16_bf16 v[80:95], a[172:175], v[12:15], v[80:95]
    ds_read_b128 v[132:135], v8 offset:1024
    v_exp_f32 v60, v60
    v_exp_f32 v61, v61
    v_exp_f32 v62, v62
    v_exp_f32 v63, v63
    v_mfma_f32_32x32x16_bf16 v[96:111], a[180:183], v[12:15], v[96:111]
    ds_read_b64 v[136:137], v9 offset:2048
    v_cvt_pk_bf16_f32 v118, v60, v61
    v_cvt_pk_bf16_f32 v119, v62, v63
    v_exp_f32 v64, v64
    v_exp_f32 v65, v65
    v_exp_f32 v66, v66
    v_exp_f32 v67, v67
    v_cvt_pk_bf16_f32 v120, v64, v65
    v_cvt_pk_bf16_f32 v121, v66, v67
    v_exp_f32 v68, v68
    v_exp_f32 v69, v69
    v_exp_f32 v70, v70
    v_exp_f32 v71, v71
    v_mfma_f32_32x32x16_bf16 a[208:223], a[112:115], v[116:119], a[208:223]
    v_cvt_pk_bf16_f32 v122, v68, v69
    v_cvt_pk_bf16_f32 v123, v70, v71
    v_exp_f32 v72, v72
    v_exp_f32 v73, v73
    v_mfma_f32_32x32x16_bf16 a[208:223], a[104:107], v[120:123], a[208:223]
    v_exp_f32 v74, v74
    v_exp_f32 v75, v75
    v_cvt_pk_bf16_f32 v124, v72, v73
    v_cvt_pk_bf16_f32 v125, v74, v75
    v_exp_f32 v76, v76
    v_exp_f32 v77, v77
    v_exp_f32 v78, v78
    v_exp_f32 v79, v79
    v_cvt_pk_bf16_f32 v126, v76, v77
    v_cvt_pk_bf16_f32 v127, v78, v79
    v_mfma_f32_32x32x4_2b_bf16 v[48:79], v[44:45], v[16:17], 0
    v_exp_f32 v80, v80
    v_exp_f32 v81, v81
    v_exp_f32 v82, v82
    v_exp_f32 v83, v83
    v_cvt_pk_bf16_f32 v112, v80, v81
    v_cvt_pk_bf16_f32 v113, v82, v83
    v_exp_f32 v84, v84
    v_exp_f32 v85, v85
    v_exp_f32 v86, v86
    v_exp_f32 v87, v87
    v_mfma_f32_32x32x16_bf16 a[208:223], a[96:99], v[124:127], a[208:223]
    buffer_load_dwordx4 v[184:187], v1, s[12:15], s75 offen offset:1024 sc1
    buffer_load_dwordx4 v[188:191], v1, s[12:15], s75 offen offset:2048 sc1
    v_cvt_pk_bf16_f32 v114, v84, v85
    v_cvt_pk_bf16_f32 v115, v86, v87
    v_exp_f32 v88, v88
    v_exp_f32 v89, v89
    v_mfma_f32_32x32x16_bf16 a[208:223], a[188:191], v[112:115], a[208:223]
    v_exp_f32 v90, v90
    v_exp_f32 v91, v91
    v_cvt_pk_bf16_f32 v116, v88, v89
    v_cvt_pk_bf16_f32 v117, v90, v91
    v_mfma_f32_32x32x16_bf16 v[48:63], a[116:119], v[12:15], v[48:63]
    v_exp_f32 v92, v92
    v_exp_f32 v93, v93
    v_exp_f32 v94, v94
    v_exp_f32 v95, v95
    v_mfma_f32_32x32x16_bf16 v[64:79], a[108:111], v[12:15], v[64:79]
    v_cvt_pk_bf16_f32 v118, v92, v93
    v_cvt_pk_bf16_f32 v119, v94, v95
    v_exp_f32 v96, v96
    v_exp_f32 v97, v97
    v_exp_f32 v98, v98
    v_exp_f32 v99, v99
    v_cvt_pk_bf16_f32 v120, v96, v97
    v_cvt_pk_bf16_f32 v121, v98, v99
    v_exp_f32 v100, v100
    v_exp_f32 v101, v101
    v_exp_f32 v102, v102
    v_exp_f32 v103, v103
    v_mfma_f32_32x32x16_bf16 a[208:223], a[28:31], v[116:119], a[208:223]
    v_cvt_pk_bf16_f32 v122, v100, v101
    v_cvt_pk_bf16_f32 v123, v102, v103
    v_exp_f32 v104, v104
    v_exp_f32 v105, v105
    v_mfma_f32_32x32x16_bf16 a[208:223], a[36:39], v[120:123], a[208:223]
    s_add_u32 s29, s58, 32768
    v_exp_f32 v106, v106
    v_exp_f32 v107, v107
    v_cvt_pk_bf16_f32 v124, v104, v105
    v_cvt_pk_bf16_f32 v125, v106, v107
    v_exp_f32 v108, v108
    v_exp_f32 v109, v109
    v_exp_f32 v110, v110
    v_exp_f32 v111, v111
    v_cvt_pk_bf16_f32 v126, v108, v109
    v_cvt_pk_bf16_f32 v127, v110, v111
    v_mfma_f32_32x32x4_2b_bf16 v[80:111], v[46:47], v[16:17], 0
    v_exp_f32 v48, v48
    v_exp_f32 v49, v49
    v_exp_f32 v50, v50
    v_exp_f32 v51, v51
    v_cvt_pk_bf16_f32 v112, v48, v49
    v_cvt_pk_bf16_f32 v113, v50, v51
    v_exp_f32 v52, v52
    v_exp_f32 v53, v53
    v_exp_f32 v54, v54
    v_exp_f32 v55, v55
    v_mfma_f32_32x32x16_bf16 a[208:223], a[44:47], v[124:127], a[208:223]
    buffer_load_dwordx4 v[192:195], v1, s[12:15], s75 offen offset:3072 sc1
    buffer_load_dwordx4 v[196:199], v1, s[12:15], s29 offen offset:0 sc1
    ds_read_b64 v[16:17], v7 offset:0
    v_cvt_pk_bf16_f32 v114, v52, v53
    v_cvt_pk_bf16_f32 v115, v54, v55
    v_exp_f32 v56, v56
    v_exp_f32 v57, v57
    v_mfma_f32_32x32x16_bf16 a[208:223], a[100:103], v[112:115], a[208:223]
    v_exp_f32 v58, v58
    v_exp_f32 v59, v59
    v_cvt_pk_bf16_f32 v116, v56, v57
    v_cvt_pk_bf16_f32 v117, v58, v59
    v_mfma_f32_32x32x16_bf16 v[80:95], a[136:139], v[12:15], v[80:95]
    v_exp_f32 v60, v60
    v_exp_f32 v61, v61
    v_exp_f32 v62, v62
    v_exp_f32 v63, v63
    v_mfma_f32_32x32x16_bf16 v[96:111], a[128:131], v[12:15], v[96:111]
    v_cvt_pk_bf16_f32 v118, v60, v61
    v_cvt_pk_bf16_f32 v119, v62, v63
    v_exp_f32 v64, v64
    v_exp_f32 v65, v65
    v_exp_f32 v66, v66
    v_exp_f32 v67, v67
    v_cvt_pk_bf16_f32 v120, v64, v65
    v_cvt_pk_bf16_f32 v121, v66, v67
    v_exp_f32 v68, v68
    v_exp_f32 v69, v69
    v_exp_f32 v70, v70
    v_exp_f32 v71, v71
    v_mfma_f32_32x32x16_bf16 a[208:223], a[48:51], v[116:119], a[208:223]
    ds_read2st64_b64 v[12:15], v6 offset0:0 offset1:4
    v_cvt_pk_bf16_f32 v122, v68, v69
    v_cvt_pk_bf16_f32 v123, v70, v71
    v_exp_f32 v72, v72
    v_exp_f32 v73, v73
    v_mfma_f32_32x32x16_bf16 a[208:223], a[56:59], v[120:123], a[208:223]
    s_waitcnt lgkmcnt(1)
    v_exp_f32 v74, v74
    v_exp_f32 v75, v75
    v_cvt_pk_bf16_f32 v124, v72, v73
    v_cvt_pk_bf16_f32 v125, v74, v75
    v_exp_f32 v76, v76
    v_exp_f32 v77, v77
    v_exp_f32 v78, v78
    v_exp_f32 v79, v79
    v_cvt_pk_bf16_f32 v126, v76, v77
    v_cvt_pk_bf16_f32 v127, v78, v79
    v_mfma_f32_32x32x4_2b_bf16 v[48:79], a[252:253], v[16:17], 0
    v_exp_f32 v80, v80
    v_exp_f32 v81, v81
    v_exp_f32 v82, v82
    v_exp_f32 v83, v83
    v_cvt_pk_bf16_f32 v112, v80, v81
    v_cvt_pk_bf16_f32 v113, v82, v83
    v_exp_f32 v84, v84
    v_exp_f32 v85, v85
    v_exp_f32 v86, v86
    v_exp_f32 v87, v87
    v_mfma_f32_32x32x16_bf16 a[208:223], a[64:67], v[124:127], a[208:223]
    buffer_load_dwordx4 v[200:203], v1, s[12:15], s29 offen offset:1024 sc1
    buffer_load_dwordx4 v[204:207], v1, s[12:15], s29 offen offset:2048 sc1
    v_cvt_pk_bf16_f32 v114, v84, v85
    v_cvt_pk_bf16_f32 v115, v86, v87
    v_exp_f32 v88, v88
    v_exp_f32 v89, v89
    v_mfma_f32_32x32x16_bf16 a[208:223], a[120:123], v[112:115], a[208:223]
    s_waitcnt lgkmcnt(0)
    v_exp_f32 v90, v90
    v_exp_f32 v91, v91
    v_cvt_pk_bf16_f32 v116, v88, v89
    v_cvt_pk_bf16_f32 v117, v90, v91
    v_mfma_f32_32x32x16_bf16 v[48:63], a[240:243], v[12:15], v[48:63]
    v_exp_f32 v92, v92
    v_exp_f32 v93, v93
    v_exp_f32 v94, v94
    v_exp_f32 v95, v95
    v_mfma_f32_32x32x16_bf16 v[64:79], a[244:247], v[12:15], v[64:79]
    v_cvt_pk_bf16_f32 v118, v92, v93
    v_cvt_pk_bf16_f32 v119, v94, v95
    v_exp_f32 v96, v96
    v_exp_f32 v97, v97
    v_exp_f32 v98, v98
    v_exp_f32 v99, v99
    v_cvt_pk_bf16_f32 v120, v96, v97
    v_cvt_pk_bf16_f32 v121, v98, v99
    v_exp_f32 v100, v100
    v_exp_f32 v101, v101
    v_exp_f32 v102, v102
    v_exp_f32 v103, v103
    v_mfma_f32_32x32x16_bf16 a[208:223], a[52:55], v[116:119], a[208:223]
    v_cvt_pk_bf16_f32 v122, v100, v101
    v_cvt_pk_bf16_f32 v123, v102, v103
    v_exp_f32 v104, v104
    v_exp_f32 v105, v105
    v_mfma_f32_32x32x16_bf16 a[208:223], a[60:63], v[120:123], a[208:223]
    v_exp_f32 v106, v106
    v_exp_f32 v107, v107
    v_cvt_pk_bf16_f32 v124, v104, v105
    v_cvt_pk_bf16_f32 v125, v106, v107
    v_exp_f32 v108, v108
    v_exp_f32 v109, v109
    v_exp_f32 v110, v110
    v_exp_f32 v111, v111
    v_cvt_pk_bf16_f32 v126, v108, v109
    v_cvt_pk_bf16_f32 v127, v110, v111
    v_mfma_f32_32x32x4_2b_bf16 v[80:111], v[34:35], v[16:17], 0
    v_exp_f32 v48, v48
    v_exp_f32 v49, v49
    v_exp_f32 v50, v50
    v_exp_f32 v51, v51
    v_cvt_pk_bf16_f32 v112, v48, v49
    v_cvt_pk_bf16_f32 v113, v50, v51
    v_exp_f32 v52, v52
    v_exp_f32 v53, v53
    v_exp_f32 v54, v54
    v_exp_f32 v55, v55
    v_mfma_f32_32x32x16_bf16 a[208:223], a[68:71], v[124:127], a[208:223]
    buffer_load_dwordx4 v[208:211], v1, s[12:15], s29 offen offset:3072 sc1
    buffer_load_dwordx4 v[212:215], v1, s[12:15], s74 offen offset:0 sc1
    v_cvt_pk_bf16_f32 v114, v52, v53
    v_cvt_pk_bf16_f32 v115, v54, v55
    v_exp_f32 v56, v56
    v_exp_f32 v57, v57
    v_mfma_f32_32x32x16_bf16 v[128:143], a[248:251], v[112:115], v[128:143]
    v_exp_f32 v58, v58
    v_exp_f32 v59, v59
    v_cvt_pk_bf16_f32 v116, v56, v57
    v_cvt_pk_bf16_f32 v117, v58, v59
    v_mfma_f32_32x32x16_bf16 v[80:95], a[0:3], v[12:15], v[80:95]
    v_exp_f32 v60, v60
    v_exp_f32 v61, v61
    v_exp_f32 v62, v62
    v_exp_f32 v63, v63
    v_mfma_f32_32x32x16_bf16 v[96:111], a[8:11], v[12:15], v[96:111]
    ds_write_b128 v10, a[208:211] offset:10240
    v_cvt_pk_bf16_f32 v118, v60, v61
    v_cvt_pk_bf16_f32 v119, v62, v63
    v_exp_f32 v64, v64
    v_exp_f32 v65, v65
    v_exp_f32 v66, v66
    v_exp_f32 v67, v67
    v_cvt_pk_bf16_f32 v120, v64, v65
    v_cvt_pk_bf16_f32 v121, v66, v67
    v_exp_f32 v68, v68
    v_exp_f32 v69, v69
    v_exp_f32 v70, v70
    v_exp_f32 v71, v71
    v_mfma_f32_32x32x16_bf16 v[128:143], a[144:147], v[116:119], v[128:143]
    ds_write_b128 v10, a[212:215] offset:11264
    v_cvt_pk_bf16_f32 v122, v68, v69
    v_cvt_pk_bf16_f32 v123, v70, v71
    v_exp_f32 v72, v72
    v_exp_f32 v73, v73
    v_mfma_f32_32x32x16_bf16 v[128:143], a[152:155], v[120:123], v[128:143]
    ds_write_b64 v18, a[216:217] offset:12288
    v_exp_f32 v74, v74
    v_exp_f32 v75, v75
    v_cvt_pk_bf16_f32 v124, v72, v73
    v_cvt_pk_bf16_f32 v125, v74, v75
    v_exp_f32 v76, v76
    v_exp_f32 v77, v77
    v_exp_f32 v78, v78
    v_exp_f32 v79, v79
    v_cvt_pk_bf16_f32 v126, v76, v77
    v_cvt_pk_bf16_f32 v127, v78, v79
    v_mfma_f32_32x32x4_2b_bf16 v[48:79], v[36:37], v[16:17], 0
    v_exp_f32 v80, v80
    v_exp_f32 v81, v81
    v_exp_f32 v82, v82
    v_exp_f32 v83, v83
    v_cvt_pk_bf16_f32 v112, v80, v81
    v_cvt_pk_bf16_f32 v113, v82, v83
    v_exp_f32 v84, v84
    v_exp_f32 v85, v85
    v_exp_f32 v86, v86
    v_exp_f32 v87, v87
    v_mfma_f32_32x32x16_bf16 v[128:143], a[160:163], v[124:127], v[128:143]
    buffer_load_dwordx4 v[216:219], v1, s[12:15], s74 offen offset:1024 sc1
    buffer_load_dwordx4 v[220:223], v1, s[12:15], s74 offen offset:2048 sc1
    v_cvt_pk_bf16_f32 v114, v84, v85
    v_cvt_pk_bf16_f32 v115, v86, v87
    v_exp_f32 v88, v88
    v_exp_f32 v89, v89
    v_mfma_f32_32x32x16_bf16 v[128:143], a[16:19], v[112:115], v[128:143]
    v_exp_f32 v90, v90
    v_exp_f32 v91, v91
    v_cvt_pk_bf16_f32 v116, v88, v89
    v_cvt_pk_bf16_f32 v117, v90, v91
    v_mfma_f32_32x32x16_bf16 v[48:63], a[148:151], v[12:15], v[48:63]
    v_exp_f32 v92, v92
    v_exp_f32 v93, v93
    v_exp_f32 v94, v94
    v_exp_f32 v95, v95
    v_mfma_f32_32x32x16_bf16 v[64:79], a[156:159], v[12:15], v[64:79]
    v_cvt_pk_bf16_f32 v118, v92, v93
    v_cvt_pk_bf16_f32 v119, v94, v95
    v_exp_f32 v96, v96
    v_exp_f32 v97, v97
    v_exp_f32 v98, v98
    v_exp_f32 v99, v99
    v_cvt_pk_bf16_f32 v120, v96, v97
    v_cvt_pk_bf16_f32 v121, v98, v99
    v_exp_f32 v100, v100
    v_exp_f32 v101, v101
    v_exp_f32 v102, v102
    v_exp_f32 v103, v103
    v_mfma_f32_32x32x16_bf16 v[128:143], a[88:91], v[116:119], v[128:143]
    v_cvt_pk_bf16_f32 v122, v100, v101
    v_cvt_pk_bf16_f32 v123, v102, v103
    v_exp_f32 v104, v104
    v_exp_f32 v105, v105
    v_mfma_f32_32x32x16_bf16 v[128:143], a[80:83], v[120:123], v[128:143]
    v_exp_f32 v106, v106
    v_exp_f32 v107, v107
    v_cvt_pk_bf16_f32 v124, v104, v105
    v_cvt_pk_bf16_f32 v125, v106, v107
    v_exp_f32 v108, v108
    v_exp_f32 v109, v109
    v_exp_f32 v110, v110
    v_exp_f32 v111, v111
    v_cvt_pk_bf16_f32 v126, v108, v109
    v_cvt_pk_bf16_f32 v127, v110, v111
    v_mfma_f32_32x32x4_2b_bf16 v[80:111], v[38:39], v[16:17], 0
    v_exp_f32 v48, v48
    v_exp_f32 v49, v49
    v_exp_f32 v50, v50
    v_exp_f32 v51, v51
    v_cvt_pk_bf16_f32 v112, v48, v49
    v_cvt_pk_bf16_f32 v113, v50, v51
    v_exp_f32 v52, v52
    v_exp_f32 v53, v53
    v_exp_f32 v54, v54
    v_exp_f32 v55, v55
    v_mfma_f32_32x32x16_bf16 v[128:143], a[72:75], v[124:127], v[128:143]
    buffer_load_dword v255, v24, s[12:15], s63 offen sc1
    buffer_load_dwordx4 v[224:227], v1, s[12:15], s74 offen offset:3072 sc1
    v_cvt_pk_bf16_f32 v114, v52, v53
    v_cvt_pk_bf16_f32 v115, v54, v55
    v_exp_f32 v56, v56
    v_exp_f32 v57, v57
    v_mfma_f32_32x32x16_bf16 v[128:143], a[164:167], v[112:115], v[128:143]
    v_exp_f32 v58, v58
    v_exp_f32 v59, v59
    v_cvt_pk_bf16_f32 v116, v56, v57
    v_cvt_pk_bf16_f32 v117, v58, v59
    v_mfma_f32_32x32x16_bf16 v[80:95], a[92:95], v[12:15], v[80:95]
    v_exp_f32 v60, v60
    v_exp_f32 v61, v61
    v_exp_f32 v62, v62
    v_exp_f32 v63, v63
    v_mfma_f32_32x32x16_bf16 v[96:111], a[84:87], v[12:15], v[96:111]
    v_cvt_pk_bf16_f32 v118, v60, v61
    v_cvt_pk_bf16_f32 v119, v62, v63
    v_exp_f32 v64, v64
    v_exp_f32 v65, v65
    v_exp_f32 v66, v66
    v_exp_f32 v67, v67
    v_cvt_pk_bf16_f32 v120, v64, v65
    v_cvt_pk_bf16_f32 v121, v66, v67
    v_exp_f32 v68, v68
    v_exp_f32 v69, v69
    v_exp_f32 v70, v70
    v_exp_f32 v71, v71
    v_mfma_f32_32x32x16_bf16 v[128:143], a[4:7], v[116:119], v[128:143]
    v_cvt_pk_bf16_f32 v122, v68, v69
    v_cvt_pk_bf16_f32 v123, v70, v71
    v_exp_f32 v72, v72
    v_exp_f32 v73, v73
    v_mfma_f32_32x32x16_bf16 v[128:143], a[12:15], v[120:123], v[128:143]
    v_exp_f32 v74, v74
    v_exp_f32 v75, v75
    v_cvt_pk_bf16_f32 v124, v72, v73
    v_cvt_pk_bf16_f32 v125, v74, v75
    v_exp_f32 v76, v76
    v_exp_f32 v77, v77
    v_exp_f32 v78, v78
    v_exp_f32 v79, v79
    v_cvt_pk_bf16_f32 v126, v76, v77
    v_cvt_pk_bf16_f32 v127, v78, v79
    v_mfma_f32_32x32x4_2b_bf16 v[48:79], v[40:41], v[16:17], 0
    v_exp_f32 v80, v80
    v_exp_f32 v81, v81
    v_exp_f32 v82, v82
    v_exp_f32 v83, v83
    v_cvt_pk_bf16_f32 v112, v80, v81
    v_cvt_pk_bf16_f32 v113, v82, v83
    v_exp_f32 v84, v84
    v_exp_f32 v85, v85
    v_exp_f32 v86, v86
    v_exp_f32 v87, v87
    v_mfma_f32_32x32x16_bf16 v[128:143], a[20:23], v[124:127], v[128:143]
    buffer_load_dwordx4 v[228:231], v1, s[12:15], s36 offen sc1
    buffer_load_dwordx4 v[160:163], v1, s[12:15], s37 offen sc1
    v_cvt_pk_bf16_f32 v114, v84, v85
    v_cvt_pk_bf16_f32 v115, v86, v87
    v_exp_f32 v88, v88
    v_exp_f32 v89, v89
    v_mfma_f32_32x32x16_bf16 v[128:143], a[76:79], v[112:115], v[128:143]
    s_waitcnt lgkmcnt(0)
    v_exp_f32 v90, v90
    v_exp_f32 v91, v91
    v_cvt_pk_bf16_f32 v116, v88, v89
    v_cvt_pk_bf16_f32 v117, v90, v91
    v_mfma_f32_32x32x16_bf16 v[48:63], a[24:27], v[12:15], v[48:63]
    s_barrier
    v_exp_f32 v92, v92
    v_exp_f32 v93, v93
    v_exp_f32 v94, v94
    v_exp_f32 v95, v95
    v_mfma_f32_32x32x16_bf16 v[64:79], a[32:35], v[12:15], v[64:79]
    v_cvt_pk_bf16_f32 v118, v92, v93
    v_cvt_pk_bf16_f32 v119, v94, v95
    v_exp_f32 v96, v96
    v_exp_f32 v97, v97
    v_exp_f32 v98, v98
    v_exp_f32 v99, v99
    v_cvt_pk_bf16_f32 v120, v96, v97
    v_cvt_pk_bf16_f32 v121, v98, v99
    v_exp_f32 v100, v100
    v_exp_f32 v101, v101
    v_exp_f32 v102, v102
    v_exp_f32 v103, v103
    v_mfma_f32_32x32x16_bf16 v[128:143], a[168:171], v[116:119], v[128:143]
    v_cvt_pk_bf16_f32 v122, v100, v101
    v_cvt_pk_bf16_f32 v123, v102, v103
    v_exp_f32 v104, v104
    v_exp_f32 v105, v105
    v_mfma_f32_32x32x16_bf16 v[128:143], a[176:179], v[120:123], v[128:143]
    v_exp_f32 v106, v106
    v_exp_f32 v107, v107
    v_cvt_pk_bf16_f32 v124, v104, v105
    v_cvt_pk_bf16_f32 v125, v106, v107
    v_exp_f32 v108, v108
    v_exp_f32 v109, v109
    v_exp_f32 v110, v110
    v_exp_f32 v111, v111
    v_cvt_pk_bf16_f32 v126, v108, v109
    v_cvt_pk_bf16_f32 v127, v110, v111
    v_mfma_f32_32x32x4_2b_bf16 v[80:111], v[42:43], v[16:17], 0
    v_exp_f32 v48, v48
    v_exp_f32 v49, v49
    v_exp_f32 v50, v50
    v_exp_f32 v51, v51
    v_cvt_pk_bf16_f32 v112, v48, v49
    v_cvt_pk_bf16_f32 v113, v50, v51
    v_exp_f32 v52, v52
    v_exp_f32 v53, v53
    v_exp_f32 v54, v54
    v_exp_f32 v55, v55
    v_mfma_f32_32x32x16_bf16 v[128:143], a[184:187], v[124:127], v[128:143]
    v_cvt_pk_bf16_f32 v114, v52, v53
    v_cvt_pk_bf16_f32 v115, v54, v55
    v_exp_f32 v56, v56
    v_exp_f32 v57, v57
    v_mfma_f32_32x32x16_bf16 v[128:143], a[40:43], v[112:115], v[128:143]
    ds_read_b128 v[144:147], v8 offset:10240
    v_exp_f32 v58, v58
    v_exp_f32 v59, v59
    v_cvt_pk_bf16_f32 v116, v56, v57
    v_cvt_pk_bf16_f32 v117, v58, v59
    v_mfma_f32_32x32x16_bf16 v[80:95], a[172:175], v[12:15], v[80:95]
    ds_read_b128 v[148:151], v8 offset:11264
    v_exp_f32 v60, v60
    v_exp_f32 v61, v61
    v_exp_f32 v62, v62
    v_exp_f32 v63, v63
    v_mfma_f32_32x32x16_bf16 v[96:111], a[180:183], v[12:15], v[96:111]
    s_add_u32 s3, s60, 0
    ds_read_b64 v[152:153], v9 offset:12288
    v_cvt_pk_bf16_f32 v118, v60, v61
    v_cvt_pk_bf16_f32 v119, v62, v63
    v_exp_f32 v64, v64
    v_exp_f32 v65, v65
    v_exp_f32 v66, v66
    v_exp_f32 v67, v67
    v_cvt_pk_bf16_f32 v120, v64, v65
    v_cvt_pk_bf16_f32 v121, v66, v67
    v_exp_f32 v68, v68
    v_exp_f32 v69, v69
    v_exp_f32 v70, v70
    v_exp_f32 v71, v71
    v_mfma_f32_32x32x16_bf16 v[128:143], a[112:115], v[116:119], v[128:143]
    s_waitcnt vmcnt(3)
    v_cmp_ne_u32 vcc, 1, v255
    v_cvt_pk_bf16_f32 v122, v68, v69
    v_cvt_pk_bf16_f32 v123, v70, v71
    v_exp_f32 v72, v72
    v_exp_f32 v73, v73
    v_mfma_f32_32x32x16_bf16 v[128:143], a[104:107], v[120:123], v[128:143]
    s_cbranch_vccnz L_f2_spin
L_f2_ok:
    v_exp_f32 v74, v74
    v_exp_f32 v75, v75
    v_cvt_pk_bf16_f32 v124, v72, v73
    v_cvt_pk_bf16_f32 v125, v74, v75
    v_exp_f32 v76, v76
    v_exp_f32 v77, v77
    v_exp_f32 v78, v78
    v_exp_f32 v79, v79
    v_cvt_pk_bf16_f32 v126, v76, v77
    v_cvt_pk_bf16_f32 v127, v78, v79
    v_mfma_f32_32x32x4_2b_bf16 v[48:79], v[44:45], v[16:17], 0
    v_add_u32 v6, 8, v6
    v_exp_f32 v80, v80
    v_exp_f32 v81, v81
    v_exp_f32 v82, v82
    v_exp_f32 v83, v83
    v_cvt_pk_bf16_f32 v112, v80, v81
    v_cvt_pk_bf16_f32 v113, v82, v83
    v_exp_f32 v84, v84
    v_exp_f32 v85, v85
    v_exp_f32 v86, v86
    v_exp_f32 v87, v87
    v_mfma_f32_32x32x16_bf16 v[128:143], a[96:99], v[124:127], v[128:143]
    buffer_load_dwordx4 a[140:143], v1, s[12:15], s3 offen offset:0 sc1
    buffer_load_dwordx4 a[132:135], v1, s[12:15], s3 offen offset:1024 sc1
    buffer_load_dwordx4 v[232:235], v247, s[8:11], s4 offen
    v_cvt_pk_bf16_f32 v114, v84, v85
    v_cvt_pk_bf16_f32 v115, v86, v87
    v_exp_f32 v88, v88
    v_exp_f32 v89, v89
    v_mfma_f32_32x32x16_bf16 v[128:143], a[188:191], v[112:115], v[128:143]
    v_exp_f32 v90, v90
    v_exp_f32 v91, v91
    v_cvt_pk_bf16_f32 v116, v88, v89
    v_cvt_pk_bf16_f32 v117, v90, v91
    v_mfma_f32_32x32x16_bf16 v[48:63], a[116:119], v[12:15], v[48:63]
    v_exp_f32 v92, v92
    v_exp_f32 v93, v93
    v_exp_f32 v94, v94
    v_exp_f32 v95, v95
    v_mfma_f32_32x32x16_bf16 v[64:79], a[108:111], v[12:15], v[64:79]
    v_cvt_pk_bf16_f32 v118, v92, v93
    v_cvt_pk_bf16_f32 v119, v94, v95
    v_exp_f32 v96, v96
    v_exp_f32 v97, v97
    v_exp_f32 v98, v98
    v_exp_f32 v99, v99
    v_cvt_pk_bf16_f32 v120, v96, v97
    v_cvt_pk_bf16_f32 v121, v98, v99
    v_exp_f32 v100, v100
    v_exp_f32 v101, v101
    v_exp_f32 v102, v102
    v_exp_f32 v103, v103
    v_mfma_f32_32x32x16_bf16 v[128:143], a[28:31], v[116:119], v[128:143]
    v_cvt_pk_bf16_f32 v122, v100, v101
    v_cvt_pk_bf16_f32 v123, v102, v103
    v_exp_f32 v104, v104
    v_exp_f32 v105, v105
    v_mfma_f32_32x32x16_bf16 v[128:143], a[36:39], v[120:123], v[128:143]
    s_add_u32 s31, s60, 2359296
    v_exp_f32 v106, v106
    v_exp_f32 v107, v107
    v_cvt_pk_bf16_f32 v124, v104, v105
    v_cvt_pk_bf16_f32 v125, v106, v107
    v_exp_f32 v108, v108
    v_exp_f32 v109, v109
    v_exp_f32 v110, v110
    v_exp_f32 v111, v111
    v_cvt_pk_bf16_f32 v126, v108, v109
    v_cvt_pk_bf16_f32 v127, v110, v111
    v_mfma_f32_32x32x4_2b_bf16 v[80:111], v[46:47], v[16:17], 0
    v_exp_f32 v48, v48
    v_exp_f32 v49, v49
    v_exp_f32 v50, v50
    v_exp_f32 v51, v51
    v_cvt_pk_bf16_f32 v112, v48, v49
    v_cvt_pk_bf16_f32 v113, v50, v51
    v_exp_f32 v52, v52
    v_exp_f32 v53, v53
    v_exp_f32 v54, v54
    v_exp_f32 v55, v55
    v_mfma_f32_32x32x16_bf16 v[128:143], a[44:47], v[124:127], v[128:143]
    buffer_load_dwordx4 a[124:127], v1, s[12:15], s31 offen offset:0 sc1
    buffer_load_dwordx4 a[224:227], v1, s[12:15], s31 offen offset:1024 sc1
    buffer_load_dwordx4 v[236:239], v250, s[8:11], s4 offen
    ds_read_b64 v[16:17], v7 offset:1024
    v_cvt_pk_bf16_f32 v114, v52, v53
    v_cvt_pk_bf16_f32 v115, v54, v55
    v_exp_f32 v56, v56
    v_exp_f32 v57, v57
    v_mfma_f32_32x32x16_bf16 v[128:143], a[100:103], v[112:115], v[128:143]
    v_exp_f32 v58, v58
    v_exp_f32 v59, v59
    v_cvt_pk_bf16_f32 v116, v56, v57
    v_cvt_pk_bf16_f32 v117, v58, v59
    v_mfma_f32_32x32x16_bf16 v[80:95], a[136:139], v[12:15], v[80:95]
    v_exp_f32 v60, v60
    v_exp_f32 v61, v61
    v_exp_f32 v62, v62
    v_exp_f32 v63, v63
    v_mfma_f32_32x32x16_bf16 v[96:111], a[128:131], v[12:15], v[96:111]
    v_cvt_pk_bf16_f32 v118, v60, v61
    v_cvt_pk_bf16_f32 v119, v62, v63
    v_exp_f32 v64, v64
    v_exp_f32 v65, v65
    v_exp_f32 v66, v66
    v_exp_f32 v67, v67
    v_cvt_pk_bf16_f32 v120, v64, v65
    v_cvt_pk_bf16_f32 v121, v66, v67
    v_exp_f32 v68, v68
    v_exp_f32 v69, v69
    v_exp_f32 v70, v70
    v_exp_f32 v71, v71
    v_mfma_f32_32x32x16_bf16 v[128:143], a[48:51], v[116:119], v[128:143]
    s_add_u32 s6, s60, 4718592
    ds_read2st64_b64 v[12:15], v6 offset0:0 offset1:4
    v_cvt_pk_bf16_f32 v122, v68, v69
    v_cvt_pk_bf16_f32 v123, v70, v71
    v_exp_f32 v72, v72
    v_exp_f32 v73, v73
    v_mfma_f32_32x32x16_bf16 v[128:143], a[56:59], v[120:123], v[128:143]
    s_waitcnt lgkmcnt(1)
    v_exp_f32 v74, v74
    v_exp_f32 v75, v75
    v_cvt_pk_bf16_f32 v124, v72, v73
    v_cvt_pk_bf16_f32 v125, v74, v75
    v_exp_f32 v76, v76
    v_exp_f32 v77, v77
    v_exp_f32 v78, v78
    v_exp_f32 v79, v79
    v_cvt_pk_bf16_f32 v126, v76, v77
    v_cvt_pk_bf16_f32 v127, v78, v79
    v_mfma_f32_32x32x4_2b_bf16 v[48:79], a[252:253], v[16:17], 0
    v_exp_f32 v80, v80
    v_exp_f32 v81, v81
    v_exp_f32 v82, v82
    v_exp_f32 v83, v83
    v_cvt_pk_bf16_f32 v112, v80, v81
    v_cvt_pk_bf16_f32 v113, v82, v83
    v_exp_f32 v84, v84
    v_exp_f32 v85, v85
    v_exp_f32 v86, v86
    v_exp_f32 v87, v87
    v_mfma_f32_32x32x16_bf16 v[128:143], a[64:67], v[124:127], v[128:143]
    buffer_load_dwordx4 a[228:231], v1, s[12:15], s6 offen offset:0 sc1
    buffer_load_dwordx4 a[232:235], v1, s[12:15], s6 offen offset:1024 sc1
    buffer_load_dwordx4 v[240:243], v247, s[8:11], s35 offen
    v_cvt_pk_bf16_f32 v114, v84, v85
    v_cvt_pk_bf16_f32 v115, v86, v87
    v_exp_f32 v88, v88
    v_exp_f32 v89, v89
    v_mfma_f32_32x32x16_bf16 v[128:143], a[120:123], v[112:115], v[128:143]
    s_waitcnt lgkmcnt(0)
    v_exp_f32 v90, v90
    v_exp_f32 v91, v91
    v_cvt_pk_bf16_f32 v116, v88, v89
    v_cvt_pk_bf16_f32 v117, v90, v91
    v_mfma_f32_32x32x16_bf16 v[48:63], a[240:243], v[12:15], v[48:63]
    v_exp_f32 v92, v92
    v_exp_f32 v93, v93
    v_exp_f32 v94, v94
    v_exp_f32 v95, v95
    v_mfma_f32_32x32x16_bf16 v[64:79], a[244:247], v[12:15], v[64:79]
    v_cvt_pk_bf16_f32 v118, v92, v93
    v_cvt_pk_bf16_f32 v119, v94, v95
    v_exp_f32 v96, v96
    v_exp_f32 v97, v97
    v_exp_f32 v98, v98
    v_exp_f32 v99, v99
    v_cvt_pk_bf16_f32 v120, v96, v97
    v_cvt_pk_bf16_f32 v121, v98, v99
    v_exp_f32 v100, v100
    v_exp_f32 v101, v101
    v_exp_f32 v102, v102
    v_exp_f32 v103, v103
    v_mfma_f32_32x32x16_bf16 v[128:143], a[52:55], v[116:119], v[128:143]
    s_add_u32 s39, s61, 0
    v_cvt_pk_bf16_f32 v122, v100, v101
    v_cvt_pk_bf16_f32 v123, v102, v103
    v_exp_f32 v104, v104
    v_exp_f32 v105, v105
    v_mfma_f32_32x32x16_bf16 v[128:143], a[60:63], v[120:123], v[128:143]
    s_add_u32 s30, s60, 7077888
    v_exp_f32 v106, v106
    v_exp_f32 v107, v107
    v_cvt_pk_bf16_f32 v124, v104, v105
    v_cvt_pk_bf16_f32 v125, v106, v107
    v_exp_f32 v108, v108
    v_exp_f32 v109, v109
    v_exp_f32 v110, v110
    v_exp_f32 v111, v111
    v_cvt_pk_bf16_f32 v126, v108, v109
    v_cvt_pk_bf16_f32 v127, v110, v111
    v_mfma_f32_32x32x4_2b_bf16 v[80:111], v[34:35], v[16:17], 0
    v_exp_f32 v48, v48
    v_exp_f32 v49, v49
    v_exp_f32 v50, v50
    v_exp_f32 v51, v51
    v_cvt_pk_bf16_f32 v112, v48, v49
    v_cvt_pk_bf16_f32 v113, v50, v51
    v_exp_f32 v52, v52
    v_exp_f32 v53, v53
    v_exp_f32 v54, v54
    v_exp_f32 v55, v55
    v_mfma_f32_32x32x16_bf16 v[128:143], a[68:71], v[124:127], v[128:143]
    buffer_load_dwordx4 a[236:239], v1, s[12:15], s30 offen offset:0 sc1
    buffer_load_dwordx4 a[192:195], v1, s[12:15], s30 offen offset:1024 sc1
    buffer_load_dwordx4 a[196:199], v1, s[12:15], s39 offen offset:0 sc1
    v_cvt_pk_bf16_f32 v114, v52, v53
    v_cvt_pk_bf16_f32 v115, v54, v55
    v_exp_f32 v56, v56
    v_exp_f32 v57, v57
    v_mfma_f32_32x32x16_bf16 v[144:159], a[248:251], v[112:115], v[144:159]
    v_exp_f32 v58, v58
    v_exp_f32 v59, v59
    v_cvt_pk_bf16_f32 v116, v56, v57
    v_cvt_pk_bf16_f32 v117, v58, v59
    v_mfma_f32_32x32x16_bf16 v[80:95], a[0:3], v[12:15], v[80:95]
    v_exp_f32 v60, v60
    v_exp_f32 v61, v61
    v_exp_f32 v62, v62
    v_exp_f32 v63, v63
    v_mfma_f32_32x32x16_bf16 v[96:111], a[8:11], v[12:15], v[96:111]
    ds_write_b128 v10, v[128:131] offset:0
    v_cvt_pk_bf16_f32 v118, v60, v61
    v_cvt_pk_bf16_f32 v119, v62, v63
    v_exp_f32 v64, v64
    v_exp_f32 v65, v65
    v_exp_f32 v66, v66
    v_exp_f32 v67, v67
    v_cvt_pk_bf16_f32 v120, v64, v65
    v_cvt_pk_bf16_f32 v121, v66, v67
    v_exp_f32 v68, v68
    v_exp_f32 v69, v69
    v_exp_f32 v70, v70
    v_exp_f32 v71, v71
    v_mfma_f32_32x32x16_bf16 v[144:159], a[144:147], v[116:119], v[144:159]
    ds_write_b128 v10, v[132:135] offset:1024
    v_cvt_pk_bf16_f32 v122, v68, v69
    v_cvt_pk_bf16_f32 v123, v70, v71
    v_exp_f32 v72, v72
    v_exp_f32 v73, v73
    v_mfma_f32_32x32x16_bf16 v[144:159], a[152:155], v[120:123], v[144:159]
    ds_write_b64 v18, v[136:137] offset:2048
    v_exp_f32 v74, v74
    v_exp_f32 v75, v75
    v_cvt_pk_bf16_f32 v124, v72, v73
    v_cvt_pk_bf16_f32 v125, v74, v75
    v_exp_f32 v76, v76
    v_exp_f32 v77, v77
    v_exp_f32 v78, v78
    v_exp_f32 v79, v79
    v_cvt_pk_bf16_f32 v126, v76, v77
    v_cvt_pk_bf16_f32 v127, v78, v79
    v_mfma_f32_32x32x4_2b_bf16 v[48:79], v[36:37], v[16:17], 0
    v_exp_f32 v80, v80
    v_exp_f32 v81, v81
    v_exp_f32 v82, v82
    v_exp_f32 v83, v83
    v_cvt_pk_bf16_f32 v112, v80, v81
    v_cvt_pk_bf16_f32 v113, v82, v83
    v_exp_f32 v84, v84
    v_exp_f32 v85, v85
    v_exp_f32 v86, v86
    v_exp_f32 v87, v87
    v_mfma_f32_32x32x16_bf16 v[144:159], a[160:163], v[124:127], v[144:159]
    v_cvt_pk_bf16_f32 v114, v84, v85
    v_cvt_pk_bf16_f32 v115, v86, v87
    v_exp_f32 v88, v88
    v_exp_f32 v89, v89
    v_mfma_f32_32x32x16_bf16 v[144:159], a[16:19], v[112:115], v[144:159]
    v_exp_f32 v90, v90
    v_exp_f32 v91, v91
    v_cvt_pk_bf16_f32 v116, v88, v89
    v_cvt_pk_bf16_f32 v117, v90, v91
    v_mfma_f32_32x32x16_bf16 v[48:63], a[148:151], v[12:15], v[48:63]
    v_exp_f32 v92, v92
    v_exp_f32 v93, v93
    v_exp_f32 v94, v94
    v_exp_f32 v95, v95
    v_mfma_f32_32x32x16_bf16 v[64:79], a[156:159], v[12:15], v[64:79]
    v_cvt_pk_bf16_f32 v118, v92, v93
    v_cvt_pk_bf16_f32 v119, v94, v95
    v_exp_f32 v96, v96
    v_exp_f32 v97, v97
    v_exp_f32 v98, v98
    v_exp_f32 v99, v99
    v_cvt_pk_bf16_f32 v120, v96, v97
    v_cvt_pk_bf16_f32 v121, v98, v99
    v_exp_f32 v100, v100
    v_exp_f32 v101, v101
    v_exp_f32 v102, v102
    v_exp_f32 v103, v103
    v_mfma_f32_32x32x16_bf16 v[144:159], a[88:91], v[116:119], v[144:159]
    v_cvt_pk_bf16_f32 v122, v100, v101
    v_cvt_pk_bf16_f32 v123, v102, v103
    v_exp_f32 v104, v104
    v_exp_f32 v105, v105
    v_mfma_f32_32x32x16_bf16 v[144:159], a[80:83], v[120:123], v[144:159]
    s_waitcnt vmcnt(10)
    v_exp_f32 v106, v106
    v_exp_f32 v107, v107
    v_cvt_pk_bf16_f32 v124, v104, v105
    v_cvt_pk_bf16_f32 v125, v106, v107
    v_exp_f32 v108, v108
    v_exp_f32 v109, v109
    v_exp_f32 v110, v110
    v_exp_f32 v111, v111
    v_cvt_pk_bf16_f32 v126, v108, v109
    v_cvt_pk_bf16_f32 v127, v110, v111
    v_mfma_f32_32x32x4_2b_bf16 v[80:111], v[38:39], v[16:17], 0
    v_exp_f32 v48, v48
    v_exp_f32 v49, v49
    v_exp_f32 v50, v50
    v_exp_f32 v51, v51
    v_cvt_pk_bf16_f32 v112, v48, v49
    v_cvt_pk_bf16_f32 v113, v50, v51
    v_exp_f32 v52, v52
    v_exp_f32 v53, v53
    v_exp_f32 v54, v54
    v_exp_f32 v55, v55
    v_mfma_f32_32x32x16_bf16 v[144:159], a[72:75], v[124:127], v[144:159]
    s_add_u32 s54, s44, 3
    v_cvt_pk_bf16_f32 v114, v52, v53
    v_cvt_pk_bf16_f32 v115, v54, v55
    v_exp_f32 v56, v56
    v_exp_f32 v57, v57
    v_mfma_f32_32x32x16_bf16 v[144:159], a[164:167], v[112:115], v[144:159]
    s_and_b32 s54, s54, 3
    v_exp_f32 v58, v58
    v_exp_f32 v59, v59
    v_cvt_pk_bf16_f32 v116, v56, v57
    v_cvt_pk_bf16_f32 v117, v58, v59
    v_mfma_f32_32x32x16_bf16 v[80:95], a[92:95], v[12:15], v[80:95]
    s_lshl_b32 s54, s54, 8
    v_lshl_add_u32 v6, s54, 1, v23
    v_add_u32 v7, s54, v19
    v_exp_f32 v60, v60
    v_exp_f32 v61, v61
    v_exp_f32 v62, v62
    v_exp_f32 v63, v63
    v_mfma_f32_32x32x16_bf16 v[96:111], a[84:87], v[12:15], v[96:111]
    v_cvt_pk_bf16_f32 v118, v60, v61
    v_cvt_pk_bf16_f32 v119, v62, v63
    v_exp_f32 v64, v64
    v_exp_f32 v65, v65
    v_mfma_f32_16x16x16_bf16 a[200:203], a[254:255], a[140:141], 0
    v_exp_f32 v66, v66
    v_exp_f32 v67, v67
    v_mfma_f32_16x16x16_bf16 a[204:207], a[254:255], a[142:143], 0
    v_cvt_pk_bf16_f32 v120, v64, v65
    v_cvt_pk_bf16_f32 v121, v66, v67
    v_exp_f32 v68, v68
    v_mfma_f32_16x16x16_bf16 a[208:211], a[254:255], a[132:133], 0
    v_exp_f32 v69, v69
    v_exp_f32 v70, v70
    v_exp_f32 v71, v71
    v_mfma_f32_32x32x16_bf16 v[144:159], a[4:7], v[116:119], v[144:159]
    s_add_u32 s28, s60, 9437184
    v_cvt_pk_bf16_f32 v122, v68, v69
    v_cvt_pk_bf16_f32 v123, v70, v71
    v_exp_f32 v72, v72
    v_exp_f32 v73, v73
    v_mfma_f32_32x32x16_bf16 v[144:159], a[12:15], v[120:123], v[144:159]
    s_waitcnt vmcnt(7)
    v_exp_f32 v74, v74
    v_exp_f32 v75, v75
    v_cvt_pk_bf16_f32 v124, v72, v73
    v_cvt_pk_bf16_f32 v125, v74, v75
    v_mfma_f32_16x16x16_bf16 a[212:215], a[254:255], a[134:135], 0
    v_exp_f32 v76, v76
    v_exp_f32 v77, v77
    v_exp_f32 v78, v78
    v_exp_f32 v79, v79
    v_cvt_pk_bf16_f32 v126, v76, v77
    v_cvt_pk_bf16_f32 v127, v78, v79
    v_mfma_f32_32x32x4_2b_bf16 v[48:79], v[40:41], v[16:17], 0
    v_exp_f32 v80, v80
    v_exp_f32 v81, v81
    v_exp_f32 v82, v82
    v_exp_f32 v83, v83
    v_cvt_pk_bf16_f32 v112, v80, v81
    v_cvt_pk_bf16_f32 v113, v82, v83
    v_exp_f32 v84, v84
    v_exp_f32 v85, v85
    v_exp_f32 v86, v86
    v_exp_f32 v87, v87
    v_mfma_f32_32x32x16_bf16 v[144:159], a[20:23], v[124:127], v[144:159]
    buffer_load_dwordx4 a[140:143], v1, s[12:15], s28 offen offset:0 sc1
    buffer_load_dwordx4 a[132:135], v1, s[12:15], s28 offen offset:1024 sc1
    buffer_load_dwordx4 v[164:167], v250, s[8:11], s35 offen
    v_cvt_pk_bf16_f32 v114, v84, v85
    v_cvt_pk_bf16_f32 v115, v86, v87
    v_exp_f32 v88, v88
    v_exp_f32 v89, v89
    v_mfma_f32_32x32x16_bf16 v[144:159], a[76:79], v[112:115], v[144:159]
    s_waitcnt lgkmcnt(0)
    v_exp_f32 v90, v90
    v_exp_f32 v91, v91
    v_cvt_pk_bf16_f32 v116, v88, v89
    v_cvt_pk_bf16_f32 v117, v90, v91
    v_mfma_f32_32x32x16_bf16 v[48:63], a[24:27], v[12:15], v[48:63]
    s_barrier
    v_exp_f32 v92, v92
    v_exp_f32 v93, v93
    v_exp_f32 v94, v94
    v_exp_f32 v95, v95
    v_mfma_f32_32x32x16_bf16 v[64:79], a[32:35], v[12:15], v[64:79]
    v_cvt_pk_bf16_f32 v118, v92, v93
    v_cvt_pk_bf16_f32 v119, v94, v95
    v_exp_f32 v96, v96
    v_exp_f32 v97, v97
    v_mfma_f32_16x16x16_bf16 a[200:203], a[254:255], a[124:125], a[200:203]
    v_exp_f32 v98, v98
    v_exp_f32 v99, v99
    v_mfma_f32_16x16x16_bf16 a[204:207], a[254:255], a[126:127], a[204:207]
    v_cvt_pk_bf16_f32 v120, v96, v97
    v_cvt_pk_bf16_f32 v121, v98, v99
    v_exp_f32 v100, v100
    v_mfma_f32_16x16x16_bf16 a[208:211], a[254:255], a[224:225], a[208:211]
    v_exp_f32 v101, v101
    v_exp_f32 v102, v102
    v_exp_f32 v103, v103
    v_mfma_f32_32x32x16_bf16 v[144:159], a[168:171], v[116:119], v[144:159]
    v_cvt_pk_bf16_f32 v122, v100, v101
    v_cvt_pk_bf16_f32 v123, v102, v103
    v_exp_f32 v104, v104
    v_exp_f32 v105, v105
    v_mfma_f32_32x32x16_bf16 v[144:159], a[176:179], v[120:123], v[144:159]
    s_add_u32 s41, s60, 11796480
    v_exp_f32 v106, v106
    v_exp_f32 v107, v107
    v_cvt_pk_bf16_f32 v124, v104, v105
    v_cvt_pk_bf16_f32 v125, v106, v107
    v_mfma_f32_16x16x16_bf16 a[212:215], a[254:255], a[226:227], a[212:215]
    v_exp_f32 v108, v108
    v_exp_f32 v109, v109
    v_exp_f32 v110, v110
    v_exp_f32 v111, v111
    v_cvt_pk_bf16_f32 v126, v108, v109
    v_cvt_pk_bf16_f32 v127, v110, v111
    v_mfma_f32_32x32x4_2b_bf16 v[80:111], v[42:43], v[16:17], 0
    v_exp_f32 v48, v48
    v_exp_f32 v49, v49
    v_exp_f32 v50, v50
    v_exp_f32 v51, v51
    v_cvt_pk_bf16_f32 v112, v48, v49
    v_cvt_pk_bf16_f32 v113, v50, v51
    v_exp_f32 v52, v52
    v_exp_f32 v53, v53
    v_exp_f32 v54, v54
    v_exp_f32 v55, v55
    v_mfma_f32_32x32x16_bf16 v[144:159], a[184:187], v[124:127], v[144:159]
    buffer_load_dwordx4 a[124:127], v1, s[12:15], s41 offen offset:0 sc1
    buffer_load_dwordx4 a[224:227], v1, s[12:15], s41 offen offset:1024 sc1
    global_load_dword v253, v[30:31], off
    v_cvt_pk_bf16_f32 v114, v52, v53
    v_cvt_pk_bf16_f32 v115, v54, v55
    v_exp_f32 v56, v56
    v_exp_f32 v57, v57
    v_mfma_f32_32x32x16_bf16 v[144:159], a[40:43], v[112:115], v[144:159]
    ds_read_b128 v[128:131], v8 offset:0
    v_exp_f32 v58, v58
    v_exp_f32 v59, v59
    v_cvt_pk_bf16_f32 v116, v56, v57
    v_cvt_pk_bf16_f32 v117, v58, v59
    v_mfma_f32_32x32x16_bf16 v[80:95], a[172:175], v[12:15], v[80:95]
    s_waitcnt vmcnt(10)
    ds_read_b128 v[132:135], v8 offset:1024
    v_exp_f32 v60, v60
    v_exp_f32 v61, v61
    v_exp_f32 v62, v62
    v_exp_f32 v63, v63
    v_mfma_f32_32x32x16_bf16 v[96:111], a[180:183], v[12:15], v[96:111]
    ds_read_b64 v[136:137], v9 offset:2048
    v_cvt_pk_bf16_f32 v118, v60, v61
    v_cvt_pk_bf16_f32 v119, v62, v63
    v_exp_f32 v64, v64
    v_exp_f32 v65, v65
    v_mfma_f32_16x16x16_bf16 a[200:203], a[254:255], a[228:229], a[200:203]
    v_exp_f32 v66, v66
    v_exp_f32 v67, v67
    v_mfma_f32_16x16x16_bf16 a[204:207], a[254:255], a[230:231], a[204:207]
    v_cvt_pk_bf16_f32 v120, v64, v65
    v_cvt_pk_bf16_f32 v121, v66, v67
    v_exp_f32 v68, v68
    v_mfma_f32_16x16x16_bf16 a[208:211], a[254:255], a[232:233], a[208:211]
    v_exp_f32 v69, v69
    v_exp_f32 v70, v70
    v_exp_f32 v71, v71
    v_mfma_f32_32x32x16_bf16 v[144:159], a[112:115], v[116:119], v[144:159]
    v_cvt_pk_bf16_f32 v122, v68, v69
    v_cvt_pk_bf16_f32 v123, v70, v71
    v_exp_f32 v72, v72
    v_exp_f32 v73, v73
    v_mfma_f32_32x32x16_bf16 v[144:159], a[104:107], v[120:123], v[144:159]
    v_exp_f32 v74, v74
    v_exp_f32 v75, v75
    v_cvt_pk_bf16_f32 v124, v72, v73
    v_cvt_pk_bf16_f32 v125, v74, v75
    v_mfma_f32_16x16x16_bf16 a[212:215], a[254:255], a[234:235], a[212:215]
    v_exp_f32 v76, v76
    v_exp_f32 v77, v77
    v_exp_f32 v78, v78
    v_exp_f32 v79, v79
    v_cvt_pk_bf16_f32 v126, v76, v77
    v_cvt_pk_bf16_f32 v127, v78, v79
    v_mfma_f32_32x32x4_2b_bf16 v[48:79], v[44:45], v[16:17], 0
    v_exp_f32 v80, v80
    v_exp_f32 v81, v81
    v_exp_f32 v82, v82
    v_exp_f32 v83, v83
    v_cvt_pk_bf16_f32 v112, v80, v81
    v_cvt_pk_bf16_f32 v113, v82, v83
    v_exp_f32 v84, v84
    v_exp_f32 v85, v85
    v_exp_f32 v86, v86
    v_exp_f32 v87, v87
    v_mfma_f32_32x32x16_bf16 v[144:159], a[96:99], v[124:127], v[144:159]
    v_cvt_pk_bf16_f32 v114, v84, v85
    v_cvt_pk_bf16_f32 v115, v86, v87
    v_exp_f32 v88, v88
    v_exp_f32 v89, v89
    v_mfma_f32_32x32x16_bf16 v[144:159], a[188:191], v[112:115], v[144:159]
    v_exp_f32 v90, v90
    v_exp_f32 v91, v91
    v_cvt_pk_bf16_f32 v116, v88, v89
    v_cvt_pk_bf16_f32 v117, v90, v91
    v_mfma_f32_32x32x16_bf16 v[48:63], a[116:119], v[12:15], v[48:63]
    s_waitcnt vmcnt(8)
    v_exp_f32 v92, v92
    v_exp_f32 v93, v93
    v_exp_f32 v94, v94
    v_exp_f32 v95, v95
    v_mfma_f32_32x32x16_bf16 v[64:79], a[108:111], v[12:15], v[64:79]
    v_cvt_pk_bf16_f32 v118, v92, v93
    v_cvt_pk_bf16_f32 v119, v94, v95
    v_exp_f32 v96, v96
    v_exp_f32 v97, v97
    v_mfma_f32_16x16x16_bf16 a[200:203], a[254:255], a[236:237], a[200:203]
    v_exp_f32 v98, v98
    v_exp_f32 v99, v99
    v_mfma_f32_16x16x16_bf16 a[204:207], a[254:255], a[238:239], a[204:207]
    v_cvt_pk_bf16_f32 v120, v96, v97
    v_cvt_pk_bf16_f32 v121, v98, v99
    v_exp_f32 v100, v100
    v_exp_f32 v101, v101
    v_exp_f32 v102, v102
    v_exp_f32 v103, v103
    v_mfma_f32_32x32x16_bf16 v[144:159], a[28:31], v[116:119], v[144:159]
    v_cvt_pk_bf16_f32 v122, v100, v101
    v_cvt_pk_bf16_f32 v123, v102, v103
    v_exp_f32 v104, v104
    v_exp_f32 v105, v105
    v_mfma_f32_32x32x16_bf16 v[144:159], a[36:39], v[120:123], v[144:159]
    s_add_u32 s38, s60, 14155776
    v_exp_f32 v106, v106
    v_exp_f32 v107, v107
    v_cvt_pk_bf16_f32 v124, v104, v105
    v_cvt_pk_bf16_f32 v125, v106, v107
    v_exp_f32 v108, v108
    v_exp_f32 v109, v109
    v_exp_f32 v110, v110
    v_exp_f32 v111, v111
    v_cvt_pk_bf16_f32 v126, v108, v109
    v_cvt_pk_bf16_f32 v127, v110, v111
    v_mfma_f32_32x32x4_2b_bf16 v[80:111], v[46:47], v[16:17], 0
    v_exp_f32 v48, v48
    v_exp_f32 v49, v49
    v_exp_f32 v50, v50
    v_exp_f32 v51, v51
    v_cvt_pk_bf16_f32 v112, v48, v49
    v_cvt_pk_bf16_f32 v113, v50, v51
    v_exp_f32 v52, v52
    v_exp_f32 v53, v53
    v_exp_f32 v54, v54
    v_exp_f32 v55, v55
    v_mfma_f32_32x32x16_bf16 v[144:159], a[44:47], v[124:127], v[144:159]
    buffer_load_dwordx4 a[228:231], v1, s[12:15], s38 offen offset:0 sc1
    buffer_load_dwordx4 a[232:235], v1, s[12:15], s38 offen offset:1024 sc1
    ds_read_b64 v[16:17], v7 offset:0
    v_cvt_pk_bf16_f32 v114, v52, v53
    v_cvt_pk_bf16_f32 v115, v54, v55
    v_exp_f32 v56, v56
    v_exp_f32 v57, v57
    v_mfma_f32_32x32x16_bf16 v[144:159], a[100:103], v[112:115], v[144:159]
    v_exp_f32 v58, v58
    v_exp_f32 v59, v59
    v_cvt_pk_bf16_f32 v116, v56, v57
    v_cvt_pk_bf16_f32 v117, v58, v59
    v_mfma_f32_32x32x16_bf16 v[80:95], a[136:139], v[12:15], v[80:95]
    s_waitcnt vmcnt(9)
    v_exp_f32 v60, v60
    v_exp_f32 v61, v61
    v_exp_f32 v62, v62
    v_exp_f32 v63, v63
    v_mfma_f32_32x32x16_bf16 v[96:111], a[128:131], v[12:15], v[96:111]
    v_cvt_pk_bf16_f32 v118, v60, v61
    v_cvt_pk_bf16_f32 v119, v62, v63
    v_exp_f32 v64, v64
    v_exp_f32 v65, v65
    v_mfma_f32_16x16x16_bf16 a[208:211], a[254:255], a[192:193], a[208:211]
    v_exp_f32 v66, v66
    v_exp_f32 v67, v67
    v_mfma_f32_16x16x16_bf16 a[212:215], a[254:255], a[194:195], a[212:215]
    v_cvt_pk_bf16_f32 v120, v64, v65
    v_cvt_pk_bf16_f32 v121, v66, v67
    v_exp_f32 v68, v68
    v_exp_f32 v69, v69
    v_exp_f32 v70, v70
    v_exp_f32 v71, v71
    v_mfma_f32_32x32x16_bf16 v[144:159], a[48:51], v[116:119], v[144:159]
    ds_read2st64_b64 v[12:15], v6 offset0:0 offset1:4
    v_cvt_pk_bf16_f32 v122, v68, v69
    v_cvt_pk_bf16_f32 v123, v70, v71
    v_exp_f32 v72, v72
    v_exp_f32 v73, v73
    v_mfma_f32_32x32x16_bf16 v[144:159], a[56:59], v[120:123], v[144:159]
    s_waitcnt lgkmcnt(1)
    v_exp_f32 v74, v74
    v_exp_f32 v75, v75
    v_cvt_pk_bf16_f32 v124, v72, v73
    v_cvt_pk_bf16_f32 v125, v74, v75
    v_exp_f32 v76, v76
    v_exp_f32 v77, v77
    v_exp_f32 v78, v78
    v_exp_f32 v79, v79
    v_cvt_pk_bf16_f32 v126, v76, v77
    v_cvt_pk_bf16_f32 v127, v78, v79
    v_mfma_f32_32x32x4_2b_bf16 v[48:79], a[252:253], v[16:17], 0
    v_exp_f32 v80, v80
    v_exp_f32 v81, v81
    v_exp_f32 v82, v82
    v_exp_f32 v83, v83
    v_cvt_pk_bf16_f32 v112, v80, v81
    v_cvt_pk_bf16_f32 v113, v82, v83
    v_exp_f32 v84, v84
    v_exp_f32 v85, v85
    v_exp_f32 v86, v86
    v_exp_f32 v87, v87
    v_mfma_f32_32x32x16_bf16 v[144:159], a[64:67], v[124:127], v[144:159]
    v_cvt_pk_bf16_f32 v114, v84, v85
    v_cvt_pk_bf16_f32 v115, v86, v87
    v_exp_f32 v88, v88
    v_exp_f32 v89, v89
    v_mfma_f32_32x32x16_bf16 v[144:159], a[120:123], v[112:115], v[144:159]
    s_waitcnt lgkmcnt(0)
    v_exp_f32 v90, v90
    v_exp_f32 v91, v91
    v_cvt_pk_bf16_f32 v116, v88, v89
    v_cvt_pk_bf16_f32 v117, v90, v91
    v_mfma_f32_32x32x16_bf16 v[48:63], a[240:243], v[12:15], v[48:63]
    s_waitcnt vmcnt(8)
    v_exp_f32 v92, v92
    v_exp_f32 v93, v93
    v_exp_f32 v94, v94
    v_exp_f32 v95, v95
    v_mfma_f32_32x32x16_bf16 v[64:79], a[244:247], v[12:15], v[64:79]
    v_cvt_pk_bf16_f32 v118, v92, v93
    v_cvt_pk_bf16_f32 v119, v94, v95
    v_exp_f32 v96, v96
    v_exp_f32 v97, v97
    v_mfma_f32_16x16x16_bf16 a[216:219], a[254:255], a[196:197], 0
    v_exp_f32 v98, v98
    v_exp_f32 v99, v99
    v_mfma_f32_16x16x16_bf16 a[220:223], a[254:255], a[198:199], 0
    v_cvt_pk_bf16_f32 v120, v96, v97
    v_cvt_pk_bf16_f32 v121, v98, v99
    v_exp_f32 v100, v100
    v_exp_f32 v101, v101
    v_exp_f32 v102, v102
    v_exp_f32 v103, v103
    v_mfma_f32_32x32x16_bf16 v[144:159], a[52:55], v[116:119], v[144:159]
    s_add_u32 s7, s61, 2359296
    v_cvt_pk_bf16_f32 v122, v100, v101
    v_cvt_pk_bf16_f32 v123, v102, v103
    v_exp_f32 v104, v104
    v_exp_f32 v105, v105
    v_mfma_f32_32x32x16_bf16 v[144:159], a[60:63], v[120:123], v[144:159]
    s_add_u32 s40, s60, 16515072
    v_exp_f32 v106, v106
    v_exp_f32 v107, v107
    v_cvt_pk_bf16_f32 v124, v104, v105
    v_cvt_pk_bf16_f32 v125, v106, v107
    v_exp_f32 v108, v108
    v_exp_f32 v109, v109
    v_exp_f32 v110, v110
    v_exp_f32 v111, v111
    v_cvt_pk_bf16_f32 v126, v108, v109
    v_cvt_pk_bf16_f32 v127, v110, v111
    v_mfma_f32_32x32x4_2b_bf16 v[80:111], v[34:35], v[16:17], 0
    v_exp_f32 v48, v48
    v_exp_f32 v49, v49
    v_exp_f32 v50, v50
    v_exp_f32 v51, v51
    v_cvt_pk_bf16_f32 v112, v48, v49
    v_cvt_pk_bf16_f32 v113, v50, v51
    v_exp_f32 v52, v52
    v_exp_f32 v53, v53
    v_exp_f32 v54, v54
    v_exp_f32 v55, v55
    v_mfma_f32_32x32x16_bf16 v[144:159], a[68:71], v[124:127], v[144:159]
    buffer_load_dwordx4 a[236:239], v1, s[12:15], s40 offen offset:0 sc1
    buffer_load_dwordx4 a[192:195], v1, s[12:15], s40 offen offset:1024 sc1
    buffer_load_dwordx4 a[196:199], v1, s[12:15], s7 offen offset:0 sc1
    v_cvt_pk_bf16_f32 v114, v52, v53
    v_cvt_pk_bf16_f32 v115, v54, v55
    v_exp_f32 v56, v56
    v_exp_f32 v57, v57
    v_mfma_f32_32x32x16_bf16 v[128:143], a[248:251], v[112:115], v[128:143]
    v_exp_f32 v58, v58
    v_exp_f32 v59, v59
    v_cvt_pk_bf16_f32 v116, v56, v57
    v_cvt_pk_bf16_f32 v117, v58, v59
    v_mfma_f32_32x32x16_bf16 v[80:95], a[0:3], v[12:15], v[80:95]
    s_waitcnt vmcnt(9)
    v_exp_f32 v60, v60
    v_exp_f32 v61, v61
    v_exp_f32 v62, v62
    v_exp_f32 v63, v63
    v_mfma_f32_32x32x16_bf16 v[96:111], a[8:11], v[12:15], v[96:111]
    ds_write_b128 v10, v[144:147] offset:10240
    v_cvt_pk_bf16_f32 v118, v60, v61
    v_cvt_pk_bf16_f32 v119, v62, v63
    v_exp_f32 v64, v64
    v_exp_f32 v65, v65
    v_mfma_f32_16x16x16_bf16 a[200:203], a[254:255], a[140:141], a[200:203]
    v_exp_f32 v66, v66
    v_exp_f32 v67, v67
    v_mfma_f32_16x16x16_bf16 a[204:207], a[254:255], a[142:143], a[204:207]
    v_cvt_pk_bf16_f32 v120, v64, v65
    v_cvt_pk_bf16_f32 v121, v66, v67
    v_exp_f32 v68, v68
    v_mfma_f32_16x16x16_bf16 a[208:211], a[254:255], a[132:133], a[208:211]
    v_exp_f32 v69, v69
    v_exp_f32 v70, v70
    v_exp_f32 v71, v71
    v_mfma_f32_32x32x16_bf16 v[128:143], a[144:147], v[116:119], v[128:143]
    ds_write_b128 v10, v[148:151] offset:11264
    v_cvt_pk_bf16_f32 v122, v68, v69
    v_cvt_pk_bf16_f32 v123, v70, v71
    v_exp_f32 v72, v72
    v_exp_f32 v73, v73
    v_mfma_f32_32x32x16_bf16 v[128:143], a[152:155], v[120:123], v[128:143]
    s_add_u32 s75, s60, 18874368
    ds_write_b64 v18, v[152:153] offset:12288
    v_exp_f32 v74, v74
    v_exp_f32 v75, v75
    v_cvt_pk_bf16_f32 v124, v72, v73
    v_cvt_pk_bf16_f32 v125, v74, v75
    v_mfma_f32_16x16x16_bf16 a[212:215], a[254:255], a[134:135], a[212:215]
    v_exp_f32 v76, v76
    v_exp_f32 v77, v77
    v_exp_f32 v78, v78
    v_exp_f32 v79, v79
    v_cvt_pk_bf16_f32 v126, v76, v77
    v_cvt_pk_bf16_f32 v127, v78, v79
    v_mfma_f32_32x32x4_2b_bf16 v[48:79], v[36:37], v[16:17], 0
    v_exp_f32 v80, v80
    v_exp_f32 v81, v81
    v_exp_f32 v82, v82
    v_exp_f32 v83, v83
    v_cvt_pk_bf16_f32 v112, v80, v81
    v_cvt_pk_bf16_f32 v113, v82, v83
    v_exp_f32 v84, v84
    v_exp_f32 v85, v85
    v_exp_f32 v86, v86
    v_exp_f32 v87, v87
    v_mfma_f32_32x32x16_bf16 v[128:143], a[160:163], v[124:127], v[128:143]
    buffer_load_dwordx4 a[140:143], v1, s[12:15], s75 offen offset:0 sc1
    buffer_load_dwordx4 a[132:135], v1, s[12:15], s75 offen offset:1024 sc1
    v_cvt_pk_bf16_f32 v114, v84, v85
    v_cvt_pk_bf16_f32 v115, v86, v87
    v_exp_f32 v88, v88
    v_exp_f32 v89, v89
    v_mfma_f32_32x32x16_bf16 v[128:143], a[16:19], v[112:115], v[128:143]
    v_exp_f32 v90, v90
    v_exp_f32 v91, v91
    v_cvt_pk_bf16_f32 v116, v88, v89
    v_cvt_pk_bf16_f32 v117, v90, v91
    v_mfma_f32_32x32x16_bf16 v[48:63], a[148:151], v[12:15], v[48:63]
    s_waitcnt vmcnt(9)
    v_exp_f32 v92, v92
    v_exp_f32 v93, v93
    v_exp_f32 v94, v94
    v_exp_f32 v95, v95
    v_mfma_f32_32x32x16_bf16 v[64:79], a[156:159], v[12:15], v[64:79]
    v_cvt_pk_bf16_f32 v118, v92, v93
    v_cvt_pk_bf16_f32 v119, v94, v95
    v_exp_f32 v96, v96
    v_exp_f32 v97, v97
    v_mfma_f32_16x16x16_bf16 a[200:203], a[254:255], a[124:125], a[200:203]
    v_exp_f32 v98, v98
    v_exp_f32 v99, v99
    v_mfma_f32_16x16x16_bf16 a[204:207], a[254:255], a[126:127], a[204:207]
    v_cvt_pk_bf16_f32 v120, v96, v97
    v_cvt_pk_bf16_f32 v121, v98, v99
    v_exp_f32 v100, v100
    v_exp_f32 v101, v101
    v_exp_f32 v102, v102
    v_exp_f32 v103, v103
    v_mfma_f32_32x32x16_bf16 v[128:143], a[88:91], v[116:119], v[128:143]
    v_cvt_pk_bf16_f32 v122, v100, v101
    v_cvt_pk_bf16_f32 v123, v102, v103
    v_exp_f32 v104, v104
    v_exp_f32 v105, v105
    v_mfma_f32_32x32x16_bf16 v[128:143], a[80:83], v[120:123], v[128:143]
    v_exp_f32 v106, v106
    v_exp_f32 v107, v107
    v_cvt_pk_bf16_f32 v124, v104, v105
    v_cvt_pk_bf16_f32 v125, v106, v107
    v_exp_f32 v108, v108
    v_exp_f32 v109, v109
    v_exp_f32 v110, v110
    v_exp_f32 v111, v111
    v_cvt_pk_bf16_f32 v126, v108, v109
    v_cvt_pk_bf16_f32 v127, v110, v111
    v_mfma_f32_32x32x4_2b_bf16 v[80:111], v[38:39], v[16:17], 0
    v_exp_f32 v48, v48
    v_exp_f32 v49, v49
    v_exp_f32 v50, v50
    v_exp_f32 v51, v51
    v_cvt_pk_bf16_f32 v112, v48, v49
    v_cvt_pk_bf16_f32 v113, v50, v51
    v_exp_f32 v52, v52
    v_exp_f32 v53, v53
    v_exp_f32 v54, v54
    v_exp_f32 v55, v55
    v_mfma_f32_32x32x16_bf16 v[128:143], a[72:75], v[124:127], v[128:143]
    v_cvt_pk_bf16_f32 v114, v52, v53
    v_cvt_pk_bf16_f32 v115, v54, v55
    v_exp_f32 v56, v56
    v_exp_f32 v57, v57
    v_mfma_f32_32x32x16_bf16 v[128:143], a[164:167], v[112:115], v[128:143]
    v_exp_f32 v58, v58
    v_exp_f32 v59, v59
    v_cvt_pk_bf16_f32 v116, v56, v57
    v_cvt_pk_bf16_f32 v117, v58, v59
    v_mfma_f32_32x32x16_bf16 v[80:95], a[92:95], v[12:15], v[80:95]
    s_waitcnt vmcnt(8)
    v_exp_f32 v60, v60
    v_exp_f32 v61, v61
    v_exp_f32 v62, v62
    v_exp_f32 v63, v63
    v_mfma_f32_32x32x16_bf16 v[96:111], a[84:87], v[12:15], v[96:111]
    v_cvt_pk_bf16_f32 v118, v60, v61
    v_cvt_pk_bf16_f32 v119, v62, v63
    v_exp_f32 v64, v64
    v_exp_f32 v65, v65
    v_mfma_f32_16x16x16_bf16 a[208:211], a[254:255], a[224:225], a[208:211]
    v_exp_f32 v66, v66
    v_exp_f32 v67, v67
    v_mfma_f32_16x16x16_bf16 a[212:215], a[254:255], a[226:227], a[212:215]
    v_cvt_pk_bf16_f32 v120, v64, v65
    v_cvt_pk_bf16_f32 v121, v66, v67
    v_exp_f32 v68, v68
    v_exp_f32 v69, v69
    v_exp_f32 v70, v70
    v_exp_f32 v71, v71
    v_mfma_f32_32x32x16_bf16 v[128:143], a[4:7], v[116:119], v[128:143]
    s_add_u32 s29, s60, 21233664
    v_cvt_pk_bf16_f32 v122, v68, v69
    v_cvt_pk_bf16_f32 v123, v70, v71
    v_exp_f32 v72, v72
    v_exp_f32 v73, v73
    v_mfma_f32_32x32x16_bf16 v[128:143], a[12:15], v[120:123], v[128:143]
    s_waitcnt vmcnt(5)
    v_exp_f32 v74, v74
    v_exp_f32 v75, v75
    v_cvt_pk_bf16_f32 v124, v72, v73
    v_cvt_pk_bf16_f32 v125, v74, v75
    v_exp_f32 v76, v76
    v_exp_f32 v77, v77
    v_exp_f32 v78, v78
    v_exp_f32 v79, v79
    v_cvt_pk_bf16_f32 v126, v76, v77
    v_cvt_pk_bf16_f32 v127, v78, v79
    v_mfma_f32_32x32x4_2b_bf16 v[48:79], v[40:41], v[16:17], 0
    v_exp_f32 v80, v80
    v_exp_f32 v81, v81
    v_exp_f32 v82, v82
    v_exp_f32 v83, v83
    v_cvt_pk_bf16_f32 v112, v80, v81
    v_cvt_pk_bf16_f32 v113, v82, v83
    v_exp_f32 v84, v84
    v_exp_f32 v85, v85
    v_exp_f32 v86, v86
    v_exp_f32 v87, v87
    v_mfma_f32_32x32x16_bf16 v[128:143], a[20:23], v[124:127], v[128:143]
    buffer_load_dwordx4 a[124:127], v1, s[12:15], s29 offen offset:0 sc1
    buffer_load_dwordx4 a[224:227], v1, s[12:15], s29 offen offset:1024 sc1
    v_cvt_pk_bf16_f32 v114, v84, v85
    v_cvt_pk_bf16_f32 v115, v86, v87
    v_exp_f32 v88, v88
    v_exp_f32 v89, v89
    v_mfma_f32_32x32x16_bf16 v[128:143], a[76:79], v[112:115], v[128:143]
    s_waitcnt lgkmcnt(0)
    v_exp_f32 v90, v90
    v_exp_f32 v91, v91
    v_cvt_pk_bf16_f32 v116, v88, v89
    v_cvt_pk_bf16_f32 v117, v90, v91
    v_mfma_f32_32x32x16_bf16 v[48:63], a[24:27], v[12:15], v[48:63]
    s_barrier
    v_exp_f32 v92, v92
    v_exp_f32 v93, v93
    v_exp_f32 v94, v94
    v_exp_f32 v95, v95
    v_mfma_f32_32x32x16_bf16 v[64:79], a[32:35], v[12:15], v[64:79]
    v_cvt_pk_bf16_f32 v118, v92, v93
    v_cvt_pk_bf16_f32 v119, v94, v95
    v_exp_f32 v96, v96
    v_exp_f32 v97, v97
    v_mfma_f32_16x16x16_bf16 a[200:203], a[254:255], a[228:229], a[200:203]
    v_exp_f32 v98, v98
    v_exp_f32 v99, v99
    v_mfma_f32_16x16x16_bf16 a[204:207], a[254:255], a[230:231], a[204:207]
    v_cvt_pk_bf16_f32 v120, v96, v97
    v_cvt_pk_bf16_f32 v121, v98, v99
    v_exp_f32 v100, v100
    v_mfma_f32_16x16x16_bf16 a[208:211], a[254:255], a[232:233], a[208:211]
    v_exp_f32 v101, v101
    v_exp_f32 v102, v102
    v_exp_f32 v103, v103
    v_mfma_f32_32x32x16_bf16 v[128:143], a[168:171], v[116:119], v[128:143]
    v_cvt_pk_bf16_f32 v122, v100, v101
    v_cvt_pk_bf16_f32 v123, v102, v103
    v_exp_f32 v104, v104
    v_exp_f32 v105, v105
    v_mfma_f32_32x32x16_bf16 v[128:143], a[176:179], v[120:123], v[128:143]
    v_exp_f32 v106, v106
    v_exp_f32 v107, v107
    v_cvt_pk_bf16_f32 v124, v104, v105
    v_cvt_pk_bf16_f32 v125, v106, v107
    v_mfma_f32_16x16x16_bf16 a[212:215], a[254:255], a[234:235], a[212:215]
    v_exp_f32 v108, v108
    v_exp_f32 v109, v109
    v_exp_f32 v110, v110
    v_exp_f32 v111, v111
    v_cvt_pk_bf16_f32 v126, v108, v109
    v_cvt_pk_bf16_f32 v127, v110, v111
    v_mfma_f32_32x32x4_2b_bf16 v[80:111], v[42:43], v[16:17], 0
    v_exp_f32 v48, v48
    v_exp_f32 v49, v49
    v_exp_f32 v50, v50
    v_exp_f32 v51, v51
    v_cvt_pk_bf16_f32 v112, v48, v49
    v_cvt_pk_bf16_f32 v113, v50, v51
    v_exp_f32 v52, v52
    v_exp_f32 v53, v53
    v_exp_f32 v54, v54
    v_exp_f32 v55, v55
    v_mfma_f32_32x32x16_bf16 v[128:143], a[184:187], v[124:127], v[128:143]
    v_cvt_pk_bf16_f32 v114, v52, v53
    v_cvt_pk_bf16_f32 v115, v54, v55
    v_exp_f32 v56, v56
    v_exp_f32 v57, v57
    v_mfma_f32_32x32x16_bf16 v[128:143], a[40:43], v[112:115], v[128:143]
    ds_read_b128 v[144:147], v8 offset:10240
    v_exp_f32 v58, v58
    v_exp_f32 v59, v59
    v_cvt_pk_bf16_f32 v116, v56, v57
    v_cvt_pk_bf16_f32 v117, v58, v59
    v_mfma_f32_32x32x16_bf16 v[80:95], a[172:175], v[12:15], v[80:95]
    s_waitcnt vmcnt(6)
    ds_read_b128 v[148:151], v8 offset:11264
    v_exp_f32 v60, v60
    v_exp_f32 v61, v61
    v_exp_f32 v62, v62
    v_exp_f32 v63, v63
    v_mfma_f32_32x32x16_bf16 v[96:111], a[180:183], v[12:15], v[96:111]
    ds_read_b64 v[152:153], v9 offset:12288
    v_cvt_pk_bf16_f32 v118, v60, v61
    v_cvt_pk_bf16_f32 v119, v62, v63
    v_exp_f32 v64, v64
    v_exp_f32 v65, v65
    v_mfma_f32_16x16x16_bf16 a[200:203], a[254:255], a[236:237], a[200:203]
    v_exp_f32 v66, v66
    v_exp_f32 v67, v67
    v_mfma_f32_16x16x16_bf16 a[204:207], a[254:255], a[238:239], a[204:207]
    v_cvt_pk_bf16_f32 v120, v64, v65
    v_cvt_pk_bf16_f32 v121, v66, v67
    v_exp_f32 v68, v68
    v_exp_f32 v69, v69
    v_exp_f32 v70, v70
    v_exp_f32 v71, v71
    v_mfma_f32_32x32x16_bf16 v[128:143], a[112:115], v[116:119], v[128:143]
    v_cvt_pk_bf16_f32 v122, v68, v69
    v_cvt_pk_bf16_f32 v123, v70, v71
    v_exp_f32 v72, v72
    v_exp_f32 v73, v73
    v_mfma_f32_32x32x16_bf16 v[128:143], a[104:107], v[120:123], v[128:143]
    s_add_u32 s3, s60, 23592960
    v_exp_f32 v74, v74
    v_exp_f32 v75, v75
    v_cvt_pk_bf16_f32 v124, v72, v73
    v_cvt_pk_bf16_f32 v125, v74, v75
    v_exp_f32 v76, v76
    v_exp_f32 v77, v77
    v_exp_f32 v78, v78
    v_exp_f32 v79, v79
    v_cvt_pk_bf16_f32 v126, v76, v77
    v_cvt_pk_bf16_f32 v127, v78, v79
    v_mfma_f32_32x32x4_2b_bf16 v[48:79], v[44:45], v[16:17], 0
    v_add_u32 v6, 8, v6
    v_exp_f32 v80, v80
    v_exp_f32 v81, v81
    v_exp_f32 v82, v82
    v_exp_f32 v83, v83
    v_cvt_pk_bf16_f32 v112, v80, v81
    v_cvt_pk_bf16_f32 v113, v82, v83
    v_exp_f32 v84, v84
    v_exp_f32 v85, v85
    v_exp_f32 v86, v86
    v_exp_f32 v87, v87
    v_mfma_f32_32x32x16_bf16 v[128:143], a[96:99], v[124:127], v[128:143]
    buffer_load_dwordx4 a[228:231], v1, s[12:15], s3 offen offset:0 sc1
    buffer_load_dwordx4 a[232:235], v1, s[12:15], s3 offen offset:1024 sc1
    v_cvt_pk_bf16_f32 v114, v84, v85
    v_cvt_pk_bf16_f32 v115, v86, v87
    v_exp_f32 v88, v88
    v_exp_f32 v89, v89
    v_mfma_f32_32x32x16_bf16 v[128:143], a[188:191], v[112:115], v[128:143]
    v_exp_f32 v90, v90
    v_exp_f32 v91, v91
    v_cvt_pk_bf16_f32 v116, v88, v89
    v_cvt_pk_bf16_f32 v117, v90, v91
    v_mfma_f32_32x32x16_bf16 v[48:63], a[116:119], v[12:15], v[48:63]
    s_waitcnt vmcnt(6)
    v_exp_f32 v92, v92
    v_exp_f32 v93, v93
    v_exp_f32 v94, v94
    v_exp_f32 v95, v95
    v_mfma_f32_32x32x16_bf16 v[64:79], a[108:111], v[12:15], v[64:79]
    v_cvt_pk_bf16_f32 v118, v92, v93
    v_cvt_pk_bf16_f32 v119, v94, v95
    v_exp_f32 v96, v96
    v_exp_f32 v97, v97
    v_mfma_f32_16x16x16_bf16 a[208:211], a[254:255], a[192:193], a[208:211]
    v_exp_f32 v98, v98
    v_exp_f32 v99, v99
    v_mfma_f32_16x16x16_bf16 a[212:215], a[254:255], a[194:195], a[212:215]
    v_cvt_pk_bf16_f32 v120, v96, v97
    v_cvt_pk_bf16_f32 v121, v98, v99
    v_exp_f32 v100, v100
    v_mfma_f32_16x16x16_bf16 a[216:219], a[254:255], a[196:197], a[216:219]
    v_exp_f32 v101, v101
    v_exp_f32 v102, v102
    v_exp_f32 v103, v103
    v_mfma_f32_32x32x16_bf16 v[128:143], a[28:31], v[116:119], v[128:143]
    v_cvt_pk_bf16_f32 v122, v100, v101
    v_cvt_pk_bf16_f32 v123, v102, v103
    v_exp_f32 v104, v104
    v_exp_f32 v105, v105
    v_mfma_f32_32x32x16_bf16 v[128:143], a[36:39], v[120:123], v[128:143]
    v_exp_f32 v106, v106
    v_exp_f32 v107, v107
    v_cvt_pk_bf16_f32 v124, v104, v105
    v_cvt_pk_bf16_f32 v125, v106, v107
    v_mfma_f32_16x16x16_bf16 a[220:223], a[254:255], a[198:199], a[220:223]
    v_exp_f32 v108, v108
    v_exp_f32 v109, v109
    v_exp_f32 v110, v110
    v_exp_f32 v111, v111
    v_cvt_pk_bf16_f32 v126, v108, v109
    v_cvt_pk_bf16_f32 v127, v110, v111
    v_mfma_f32_32x32x4_2b_bf16 v[80:111], v[46:47], v[16:17], 0
    v_exp_f32 v48, v48
    v_exp_f32 v49, v49
    v_exp_f32 v50, v50
    v_exp_f32 v51, v51
    v_cvt_pk_bf16_f32 v112, v48, v49
    v_cvt_pk_bf16_f32 v113, v50, v51
    v_exp_f32 v52, v52
    v_exp_f32 v53, v53
    v_exp_f32 v54, v54
    v_exp_f32 v55, v55
    v_mfma_f32_32x32x16_bf16 v[128:143], a[44:47], v[124:127], v[128:143]
    ds_read_b64 v[16:17], v7 offset:1024
    v_cvt_pk_bf16_f32 v114, v52, v53
    v_cvt_pk_bf16_f32 v115, v54, v55
    v_exp_f32 v56, v56
    v_exp_f32 v57, v57
    v_mfma_f32_32x32x16_bf16 v[128:143], a[100:103], v[112:115], v[128:143]
    v_exp_f32 v58, v58
    v_exp_f32 v59, v59
    v_cvt_pk_bf16_f32 v116, v56, v57
    v_cvt_pk_bf16_f32 v117, v58, v59
    v_mfma_f32_32x32x16_bf16 v[80:95], a[136:139], v[12:15], v[80:95]
    s_waitcnt vmcnt(5)
    v_exp_f32 v60, v60
    v_exp_f32 v61, v61
    v_exp_f32 v62, v62
    v_exp_f32 v63, v63
    v_mfma_f32_32x32x16_bf16 v[96:111], a[128:131], v[12:15], v[96:111]
    s_add_u32 s6, s61, 4718592
    v_cvt_pk_bf16_f32 v118, v60, v61
    v_cvt_pk_bf16_f32 v119, v62, v63
    v_exp_f32 v64, v64
    v_exp_f32 v65, v65
    v_mfma_f32_16x16x16_bf16 a[200:203], a[254:255], a[140:141], a[200:203]
    v_exp_f32 v66, v66
    v_exp_f32 v67, v67
    v_mfma_f32_16x16x16_bf16 a[204:207], a[254:255], a[142:143], a[204:207]
    v_cvt_pk_bf16_f32 v120, v64, v65
    v_cvt_pk_bf16_f32 v121, v66, v67
    v_exp_f32 v68, v68
    v_exp_f32 v69, v69
    v_exp_f32 v70, v70
    v_exp_f32 v71, v71
    v_mfma_f32_32x32x16_bf16 v[128:143], a[48:51], v[116:119], v[128:143]
    s_add_u32 s31, s60, 25952256
    ds_read2st64_b64 v[12:15], v6 offset0:0 offset1:4
    v_cvt_pk_bf16_f32 v122, v68, v69
    v_cvt_pk_bf16_f32 v123, v70, v71
    v_exp_f32 v72, v72
    v_exp_f32 v73, v73
    v_mfma_f32_32x32x16_bf16 v[128:143], a[56:59], v[120:123], v[128:143]
    s_waitcnt lgkmcnt(1)
    v_exp_f32 v74, v74
    v_exp_f32 v75, v75
    v_cvt_pk_bf16_f32 v124, v72, v73
    v_cvt_pk_bf16_f32 v125, v74, v75
    v_exp_f32 v76, v76
    v_exp_f32 v77, v77
    v_exp_f32 v78, v78
    v_exp_f32 v79, v79
    v_cvt_pk_bf16_f32 v126, v76, v77
    v_cvt_pk_bf16_f32 v127, v78, v79
    v_mfma_f32_32x32x4_2b_bf16 v[48:79], a[252:253], v[16:17], 0
    v_exp_f32 v80, v80
    v_exp_f32 v81, v81
    v_exp_f32 v82, v82
    v_exp_f32 v83, v83
    v_cvt_pk_bf16_f32 v112, v80, v81
    v_cvt_pk_bf16_f32 v113, v82, v83
    v_exp_f32 v84, v84
    v_exp_f32 v85, v85
    v_exp_f32 v86, v86
    v_exp_f32 v87, v87
    v_mfma_f32_32x32x16_bf16 v[128:143], a[64:67], v[124:127], v[128:143]
    buffer_load_dwordx4 a[236:239], v1, s[12:15], s31 offen offset:0 sc1
    buffer_load_dwordx4 a[192:195], v1, s[12:15], s31 offen offset:1024 sc1
    buffer_load_dwordx4 a[196:199], v1, s[12:15], s6 offen offset:0 sc1
    v_cvt_pk_bf16_f32 v114, v84, v85
    v_cvt_pk_bf16_f32 v115, v86, v87
    v_exp_f32 v88, v88
    v_exp_f32 v89, v89
    v_mfma_f32_32x32x16_bf16 v[128:143], a[120:123], v[112:115], v[128:143]
    s_waitcnt lgkmcnt(0)
    v_exp_f32 v90, v90
    v_exp_f32 v91, v91
    v_cvt_pk_bf16_f32 v116, v88, v89
    v_cvt_pk_bf16_f32 v117, v90, v91
    v_mfma_f32_32x32x16_bf16 v[48:63], a[240:243], v[12:15], v[48:63]
    s_waitcnt vmcnt(7)
    v_exp_f32 v92, v92
    v_exp_f32 v93, v93
    v_exp_f32 v94, v94
    v_exp_f32 v95, v95
    v_mfma_f32_32x32x16_bf16 v[64:79], a[244:247], v[12:15], v[64:79]
    v_cvt_pk_bf16_f32 v118, v92, v93
    v_cvt_pk_bf16_f32 v119, v94, v95
    v_exp_f32 v96, v96
    v_exp_f32 v97, v97
    v_mfma_f32_16x16x16_bf16 a[208:211], a[254:255], a[132:133], a[208:211]
    v_exp_f32 v98, v98
    v_exp_f32 v99, v99
    v_mfma_f32_16x16x16_bf16 a[212:215], a[254:255], a[134:135], a[212:215]
    v_cvt_pk_bf16_f32 v120, v96, v97
    v_cvt_pk_bf16_f32 v121, v98, v99
    v_exp_f32 v100, v100
    v_exp_f32 v101, v101
    v_exp_f32 v102, v102
    v_exp_f32 v103, v103
    v_mfma_f32_32x32x16_bf16 v[128:143], a[52:55], v[116:119], v[128:143]
    v_cvt_pk_bf16_f32 v122, v100, v101
    v_cvt_pk_bf16_f32 v123, v102, v103
    v_exp_f32 v104, v104
    v_exp_f32 v105, v105
    v_mfma_f32_32x32x16_bf16 v[128:143], a[60:63], v[120:123], v[128:143]
    s_add_u32 s30, s60, 28311552
    v_exp_f32 v106, v106
    v_exp_f32 v107, v107
    v_cvt_pk_bf16_f32 v124, v104, v105
    v_cvt_pk_bf16_f32 v125, v106, v107
    v_exp_f32 v108, v108
    v_exp_f32 v109, v109
    v_exp_f32 v110, v110
    v_exp_f32 v111, v111
    v_cvt_pk_bf16_f32 v126, v108, v109
    v_cvt_pk_bf16_f32 v127, v110, v111
    v_mfma_f32_32x32x4_2b_bf16 v[80:111], v[34:35], v[16:17], 0
    v_exp_f32 v48, v48
    v_exp_f32 v49, v49
    v_exp_f32 v50, v50
    v_exp_f32 v51, v51
    v_cvt_pk_bf16_f32 v112, v48, v49
    v_cvt_pk_bf16_f32 v113, v50, v51
    v_exp_f32 v52, v52
    v_exp_f32 v53, v53
    v_exp_f32 v54, v54
    v_exp_f32 v55, v55
    v_mfma_f32_32x32x16_bf16 v[128:143], a[68:71], v[124:127], v[128:143]
    buffer_load_dwordx4 a[140:143], v1, s[12:15], s30 offen offset:0 sc1
    buffer_load_dwordx4 a[132:135], v1, s[12:15], s30 offen offset:1024 sc1
    v_cvt_pk_bf16_f32 v114, v52, v53
    v_cvt_pk_bf16_f32 v115, v54, v55
    v_exp_f32 v56, v56
    v_exp_f32 v57, v57
    v_mfma_f32_32x32x16_bf16 v[144:159], a[248:251], v[112:115], v[144:159]
    v_exp_f32 v58, v58
    v_exp_f32 v59, v59
    v_cvt_pk_bf16_f32 v116, v56, v57
    v_cvt_pk_bf16_f32 v117, v58, v59
    v_mfma_f32_32x32x16_bf16 v[80:95], a[0:3], v[12:15], v[80:95]
    s_waitcnt vmcnt(8)
    v_exp_f32 v60, v60
    v_exp_f32 v61, v61
    v_exp_f32 v62, v62
    v_exp_f32 v63, v63
    v_mfma_f32_32x32x16_bf16 v[96:111], a[8:11], v[12:15], v[96:111]
    v_cvt_pk_bf16_f32 v118, v60, v61
    v_cvt_pk_bf16_f32 v119, v62, v63
    v_exp_f32 v64, v64
    v_exp_f32 v65, v65
    v_mfma_f32_16x16x16_bf16 a[200:203], a[254:255], a[124:125], a[200:203]
    v_exp_f32 v66, v66
    v_exp_f32 v67, v67
    v_mfma_f32_16x16x16_bf16 a[204:207], a[254:255], a[126:127], a[204:207]
    v_cvt_pk_bf16_f32 v120, v64, v65
    v_cvt_pk_bf16_f32 v121, v66, v67
    v_exp_f32 v68, v68
    v_exp_f32 v69, v69
    v_exp_f32 v70, v70
    v_exp_f32 v71, v71
    v_mfma_f32_32x32x16_bf16 v[144:159], a[144:147], v[116:119], v[144:159]
    s_waitcnt vmcnt(7)
    v_cvt_pk_bf16_f32 v122, v68, v69
    v_cvt_pk_bf16_f32 v123, v70, v71
    v_exp_f32 v72, v72
    v_exp_f32 v73, v73
    v_mfma_f32_32x32x16_bf16 v[144:159], a[152:155], v[120:123], v[144:159]
    v_cmp_nle_f32 vcc, 0x2b800000, v137
    v_rcp_f32 v249, v137
    s_or_b64 s[20:21], s[20:21], vcc
    v_cmp_nge_f32 vcc, 0x53800000, v137
    v_mul_f32 v128, v128, v249
    v_mul_f32 v129, v129, v249
    v_mul_f32 v130, v130, v249
    v_mul_f32 v131, v131, v249
    v_mul_f32 v132, v132, v249
    v_mul_f32 v133, v133, v249
    v_mul_f32 v134, v134, v249
    v_mul_f32 v135, v135, v249
    v_mul_f32 v136, v136, v249
    s_or_b64 s[20:21], s[20:21], vcc
    v_cvt_pk_bf16_f32 v128, v128, v129
    v_cvt_pk_bf16_f32 v129, v130, v131
    v_cvt_pk_bf16_f32 v130, v132, v133
    v_cvt_pk_bf16_f32 v131, v134, v135
    v_cvt_pk_bf16_f32 v132, v136, v136
    v_exp_f32 v74, v74
    v_exp_f32 v75, v75
    v_cvt_pk_bf16_f32 v124, v72, v73
    v_cvt_pk_bf16_f32 v125, v74, v75
    v_exp_f32 v76, v76
    v_exp_f32 v77, v77
    v_exp_f32 v78, v78
    v_exp_f32 v79, v79
    v_cvt_pk_bf16_f32 v126, v76, v77
    v_cvt_pk_bf16_f32 v127, v78, v79
    v_mfma_f32_32x32x4_2b_bf16 v[48:79], v[36:37], v[16:17], 0
    v_exp_f32 v80, v80
    v_exp_f32 v81, v81
    v_exp_f32 v82, v82
    v_exp_f32 v83, v83
    v_cvt_pk_bf16_f32 v112, v80, v81
    v_cvt_pk_bf16_f32 v113, v82, v83
    v_exp_f32 v84, v84
    v_exp_f32 v85, v85
    v_exp_f32 v86, v86
    v_exp_f32 v87, v87
    v_mfma_f32_32x32x16_bf16 v[144:159], a[160:163], v[124:127], v[144:159]
    s_cmp_eq_u64 s[20:21], 0
    s_cselect_b32 s55, 0, 536870912
    v_cvt_pk_bf16_f32 v114, v84, v85
    v_cvt_pk_bf16_f32 v115, v86, v87
    v_exp_f32 v88, v88
    v_exp_f32 v89, v89
    v_mfma_f32_32x32x16_bf16 v[144:159], a[16:19], v[112:115], v[144:159]
    s_or_b32 s54, s66, s55
    v_exp_f32 v90, v90
    v_exp_f32 v91, v91
    v_cvt_pk_bf16_f32 v116, v88, v89
    v_cvt_pk_bf16_f32 v117, v90, v91
    v_mfma_f32_32x32x16_bf16 v[48:63], a[148:151], v[12:15], v[48:63]
    s_or_b32 s55, s68, s55
    v_exp_f32 v92, v92
    v_exp_f32 v93, v93
    v_exp_f32 v94, v94
    v_exp_f32 v95, v95
    v_mfma_f32_32x32x16_bf16 v[64:79], a[156:159], v[12:15], v[64:79]
    buffer_store_short v132, v28, s[12:15], s55 offen sc1
    buffer_store_dwordx4 v[128:131], v26, s[12:15], s54 offen sc1
    v_cvt_pk_bf16_f32 v118, v92, v93
    v_mfma_f32_16x16x16_bf16 a[208:211], a[254:255], a[224:225], a[208:211]
    v_cvt_pk_bf16_f32 v119, v94, v95
    v_exp_f32 v96, v96
    v_mfma_f32_16x16x16_bf16 a[212:215], a[254:255], a[226:227], a[212:215]
    v_exp_f32 v97, v97
    v_exp_f32 v98, v98
    v_exp_f32 v99, v99
    v_cvt_pk_bf16_f32 v120, v96, v97
    v_cvt_pk_bf16_f32 v121, v98, v99
    v_exp_f32 v100, v100
    v_exp_f32 v101, v101
    v_exp_f32 v102, v102
    v_exp_f32 v103, v103
    v_mfma_f32_32x32x16_bf16 v[144:159], a[88:91], v[116:119], v[144:159]
    v_cvt_pk_bf16_f32 v122, v100, v101
    v_cvt_pk_bf16_f32 v123, v102, v103
    v_exp_f32 v104, v104
    v_exp_f32 v105, v105
    v_mfma_f32_32x32x16_bf16 v[144:159], a[80:83], v[120:123], v[144:159]
    s_add_u32 s39, s60, 30670848
    v_exp_f32 v106, v106
    v_exp_f32 v107, v107
    v_cvt_pk_bf16_f32 v124, v104, v105
    v_cvt_pk_bf16_f32 v125, v106, v107
    v_exp_f32 v108, v108
    v_exp_f32 v109, v109
    v_exp_f32 v110, v110
    v_exp_f32 v111, v111
    v_cvt_pk_bf16_f32 v126, v108, v109
    v_cvt_pk_bf16_f32 v127, v110, v111
    v_mfma_f32_32x32x4_2b_bf16 v[80:111], v[38:39], v[16:17], 0
    v_exp_f32 v48, v48
    v_exp_f32 v49, v49
    v_exp_f32 v50, v50
    v_exp_f32 v51, v51
    v_cvt_pk_bf16_f32 v112, v48, v49
    v_cvt_pk_bf16_f32 v113, v50, v51
    v_exp_f32 v52, v52
    v_exp_f32 v53, v53
    v_exp_f32 v54, v54
    v_exp_f32 v55, v55
    v_mfma_f32_32x32x16_bf16 v[144:159], a[72:75], v[124:127], v[144:159]
    buffer_load_dwordx4 a[124:127], v1, s[12:15], s39 offen offset:0 sc1
    buffer_load_dwordx4 a[224:227], v1, s[12:15], s39 offen offset:1024 sc1
    v_cvt_pk_bf16_f32 v114, v52, v53
    v_cvt_pk_bf16_f32 v115, v54, v55
    v_exp_f32 v56, v56
    v_exp_f32 v57, v57
    v_mfma_f32_32x32x16_bf16 v[144:159], a[164:167], v[112:115], v[144:159]
    v_exp_f32 v58, v58
    v_exp_f32 v59, v59
    v_cvt_pk_bf16_f32 v116, v56, v57
    v_cvt_pk_bf16_f32 v117, v58, v59
    v_mfma_f32_32x32x16_bf16 v[80:95], a[92:95], v[12:15], v[80:95]
    s_waitcnt vmcnt(10)
    v_exp_f32 v60, v60
    v_exp_f32 v61, v61
    v_exp_f32 v62, v62
    v_exp_f32 v63, v63
    v_mfma_f32_32x32x16_bf16 v[96:111], a[84:87], v[12:15], v[96:111]
    v_cvt_pk_bf16_f32 v118, v60, v61
    v_cvt_pk_bf16_f32 v119, v62, v63
    v_exp_f32 v64, v64
    v_exp_f32 v65, v65
    v_mfma_f32_16x16x16_bf16 a[200:203], a[254:255], a[228:229], a[200:203]
    v_exp_f32 v66, v66
    v_exp_f32 v67, v67
    v_mfma_f32_16x16x16_bf16 a[204:207], a[254:255], a[230:231], a[204:207]
    v_cvt_pk_bf16_f32 v120, v64, v65
    v_cvt_pk_bf16_f32 v121, v66, v67
    v_exp_f32 v68, v68
    v_exp_f32 v69, v69
    v_exp_f32 v70, v70
    v_exp_f32 v71, v71
    v_mfma_f32_32x32x16_bf16 v[144:159], a[4:7], v[116:119], v[144:159]
    v_cvt_pk_bf16_f32 v122, v68, v69
    v_cvt_pk_bf16_f32 v123, v70, v71
    v_exp_f32 v72, v72
    v_exp_f32 v73, v73
    v_mfma_f32_32x32x16_bf16 v[144:159], a[12:15], v[120:123], v[144:159]
    v_exp_f32 v74, v74
    v_exp_f32 v75, v75
    v_cvt_pk_bf16_f32 v124, v72, v73
    v_cvt_pk_bf16_f32 v125, v74, v75
    v_exp_f32 v76, v76
    v_exp_f32 v77, v77
    v_exp_f32 v78, v78
    v_exp_f32 v79, v79
    v_cvt_pk_bf16_f32 v126, v76, v77
    v_cvt_pk_bf16_f32 v127, v78, v79
    v_mfma_f32_32x32x4_2b_bf16 v[48:79], v[40:41], v[16:17], 0
    v_exp_f32 v80, v80
    v_exp_f32 v81, v81
    v_exp_f32 v82, v82
    v_exp_f32 v83, v83
    v_cvt_pk_bf16_f32 v112, v80, v81
    v_cvt_pk_bf16_f32 v113, v82, v83
    v_exp_f32 v84, v84
    v_exp_f32 v85, v85
    v_exp_f32 v86, v86
    v_exp_f32 v87, v87
    v_mfma_f32_32x32x16_bf16 v[144:159], a[20:23], v[124:127], v[144:159]
    v_cvt_pk_bf16_f32 v114, v84, v85
    v_cvt_pk_bf16_f32 v115, v86, v87
    v_exp_f32 v88, v88
    v_exp_f32 v89, v89
    v_mfma_f32_32x32x16_bf16 v[144:159], a[76:79], v[112:115], v[144:159]
    v_exp_f32 v90, v90
    v_exp_f32 v91, v91
    v_cvt_pk_bf16_f32 v116, v88, v89
    v_cvt_pk_bf16_f32 v117, v90, v91
    v_mfma_f32_32x32x16_bf16 v[48:63], a[24:27], v[12:15], v[48:63]
    s_waitcnt vmcnt(9)
    v_exp_f32 v92, v92
    v_exp_f32 v93, v93
    v_exp_f32 v94, v94
    v_exp_f32 v95, v95
    v_mfma_f32_32x32x16_bf16 v[64:79], a[32:35], v[12:15], v[64:79]
    v_cvt_pk_bf16_f32 v118, v92, v93
    v_cvt_pk_bf16_f32 v119, v94, v95
    v_exp_f32 v96, v96
    v_exp_f32 v97, v97
    v_mfma_f32_16x16x16_bf16 a[208:211], a[254:255], a[232:233], a[208:211]
    v_exp_f32 v98, v98
    v_exp_f32 v99, v99
    v_mfma_f32_16x16x16_bf16 a[212:215], a[254:255], a[234:235], a[212:215]
    v_cvt_pk_bf16_f32 v120, v96, v97
    v_cvt_pk_bf16_f32 v121, v98, v99
    v_exp_f32 v100, v100
    v_exp_f32 v101, v101
    v_exp_f32 v102, v102
    v_exp_f32 v103, v103
    v_mfma_f32_32x32x16_bf16 v[144:159], a[168:171], v[116:119], v[144:159]
    v_cvt_pk_bf16_f32 v122, v100, v101
    v_cvt_pk_bf16_f32 v123, v102, v103
    v_exp_f32 v104, v104
    v_exp_f32 v105, v105
    v_mfma_f32_32x32x16_bf16 v[144:159], a[176:179], v[120:123], v[144:159]
    s_add_u32 s28, s60, 33030144
    v_exp_f32 v106, v106
    v_exp_f32 v107, v107
    v_cvt_pk_bf16_f32 v124, v104, v105
    v_cvt_pk_bf16_f32 v125, v106, v107
    v_exp_f32 v108, v108
    v_exp_f32 v109, v109
    v_exp_f32 v110, v110
    v_exp_f32 v111, v111
    v_cvt_pk_bf16_f32 v126, v108, v109
    v_cvt_pk_bf16_f32 v127, v110, v111
    v_mfma_f32_32x32x4_2b_bf16 v[80:111], v[42:43], v[16:17], 0
    v_exp_f32 v48, v48
    v_exp_f32 v49, v49
    v_exp_f32 v50, v50
    v_exp_f32 v51, v51
    v_cvt_pk_bf16_f32 v112, v48, v49
    v_cvt_pk_bf16_f32 v113, v50, v51
    v_exp_f32 v52, v52
    v_exp_f32 v53, v53
    v_exp_f32 v54, v54
    v_exp_f32 v55, v55
    v_mfma_f32_32x32x16_bf16 v[144:159], a[184:187], v[124:127], v[144:159]
    buffer_load_dwordx4 a[228:231], v1, s[12:15], s28 offen offset:0 sc1
    buffer_load_dwordx4 a[232:235], v1, s[12:15], s28 offen offset:1024 sc1
    v_cvt_pk_bf16_f32 v114, v52, v53
    v_cvt_pk_bf16_f32 v115, v54, v55
    v_exp_f32 v56, v56
    v_exp_f32 v57, v57
    v_mfma_f32_32x32x16_bf16 v[144:159], a[40:43], v[112:115], v[144:159]
    v_exp_f32 v58, v58
    v_exp_f32 v59, v59
    v_cvt_pk_bf16_f32 v116, v56, v57
    v_cvt_pk_bf16_f32 v117, v58, v59
    v_mfma_f32_32x32x16_bf16 v[80:95], a[172:175], v[12:15], v[80:95]
    s_waitcnt vmcnt(9)
    v_exp_f32 v60, v60
    v_exp_f32 v61, v61
    v_exp_f32 v62, v62
    v_exp_f32 v63, v63
    v_mfma_f32_32x32x16_bf16 v[96:111], a[180:183], v[12:15], v[96:111]
    v_cvt_pk_bf16_f32 v118, v60, v61
    v_cvt_pk_bf16_f32 v119, v62, v63
    v_exp_f32 v64, v64
    v_exp_f32 v65, v65
    v_mfma_f32_16x16x16_bf16 a[200:203], a[254:255], a[236:237], a[200:203]
    v_exp_f32 v66, v66
    v_exp_f32 v67, v67
    v_mfma_f32_16x16x16_bf16 a[204:207], a[254:255], a[238:239], a[204:207]
    v_cvt_pk_bf16_f32 v120, v64, v65
    v_cvt_pk_bf16_f32 v121, v66, v67
    v_exp_f32 v68, v68
    v_mfma_f32_16x16x16_bf16 a[208:211], a[254:255], a[192:193], a[208:211]
    v_exp_f32 v69, v69
    v_exp_f32 v70, v70
    v_exp_f32 v71, v71
    v_mfma_f32_32x32x16_bf16 v[144:159], a[112:115], v[116:119], v[144:159]
    v_cvt_pk_bf16_f32 v122, v68, v69
    v_cvt_pk_bf16_f32 v123, v70, v71
    v_exp_f32 v72, v72
    v_exp_f32 v73, v73
    v_mfma_f32_32x32x16_bf16 v[144:159], a[104:107], v[120:123], v[144:159]
    v_exp_f32 v74, v74
    v_exp_f32 v75, v75
    v_cvt_pk_bf16_f32 v124, v72, v73
    v_cvt_pk_bf16_f32 v125, v74, v75
    v_mfma_f32_16x16x16_bf16 a[212:215], a[254:255], a[194:195], a[212:215]
    v_exp_f32 v76, v76
    v_exp_f32 v77, v77
    v_exp_f32 v78, v78
    v_exp_f32 v79, v79
    v_cvt_pk_bf16_f32 v126, v76, v77
    v_cvt_pk_bf16_f32 v127, v78, v79
    v_mfma_f32_32x32x4_2b_bf16 v[48:79], v[44:45], v[16:17], 0
    v_exp_f32 v80, v80
    v_exp_f32 v81, v81
    v_exp_f32 v82, v82
    v_exp_f32 v83, v83
    v_cvt_pk_bf16_f32 v112, v80, v81
    v_cvt_pk_bf16_f32 v113, v82, v83
    v_exp_f32 v84, v84
    v_exp_f32 v85, v85
    v_exp_f32 v86, v86
    v_exp_f32 v87, v87
    v_mfma_f32_32x32x16_bf16 v[144:159], a[96:99], v[124:127], v[144:159]
    v_cvt_pk_bf16_f32 v114, v84, v85
    v_cvt_pk_bf16_f32 v115, v86, v87
    v_exp_f32 v88, v88
    v_exp_f32 v89, v89
    v_mfma_f32_32x32x16_bf16 v[144:159], a[188:191], v[112:115], v[144:159]
    s_add_u32 m0, s34, 118784
    v_exp_f32 v90, v90
    v_exp_f32 v91, v91
    v_cvt_pk_bf16_f32 v116, v88, v89
    v_cvt_pk_bf16_f32 v117, v90, v91
    v_mfma_f32_32x32x16_bf16 v[48:63], a[116:119], v[12:15], v[48:63]
    s_waitcnt vmcnt(8)
    v_exp_f32 v92, v92
    v_exp_f32 v93, v93
    v_exp_f32 v94, v94
    v_exp_f32 v95, v95
    v_mfma_f32_32x32x16_bf16 v[64:79], a[108:111], v[12:15], v[64:79]
    s_add_u32 s7, s32, 0
    v_cvt_pk_bf16_f32 v118, v92, v93
    v_cvt_pk_bf16_f32 v119, v94, v95
    v_exp_f32 v96, v96
    v_exp_f32 v97, v97
    v_mfma_f32_16x16x16_bf16 a[216:219], a[254:255], a[196:197], a[216:219]
    v_exp_f32 v98, v98
    v_exp_f32 v99, v99
    v_mfma_f32_16x16x16_bf16 a[220:223], a[254:255], a[198:199], a[220:223]
    v_cvt_pk_bf16_f32 v120, v96, v97
    v_cvt_pk_bf16_f32 v121, v98, v99
    v_exp_f32 v100, v100
    v_exp_f32 v101, v101
    v_exp_f32 v102, v102
    v_exp_f32 v103, v103
    v_mfma_f32_32x32x16_bf16 v[144:159], a[28:31], v[116:119], v[144:159]
    s_add_u32 s38, s61, 7077888
    v_cvt_pk_bf16_f32 v122, v100, v101
    v_cvt_pk_bf16_f32 v123, v102, v103
    v_exp_f32 v104, v104
    v_exp_f32 v105, v105
    v_mfma_f32_32x32x16_bf16 v[144:159], a[36:39], v[120:123], v[144:159]
    s_add_u32 s41, s60, 35389440
    v_exp_f32 v106, v106
    v_exp_f32 v107, v107
    v_cvt_pk_bf16_f32 v124, v104, v105
    v_cvt_pk_bf16_f32 v125, v106, v107
    v_exp_f32 v108, v108
    v_exp_f32 v109, v109
    v_exp_f32 v110, v110
    v_exp_f32 v111, v111
    v_cvt_pk_bf16_f32 v126, v108, v109
    v_cvt_pk_bf16_f32 v127, v110, v111
    v_mfma_f32_32x32x4_2b_bf16 v[80:111], v[46:47], v[16:17], 0
    v_exp_f32 v48, v48
    v_exp_f32 v49, v49
    v_exp_f32 v50, v50
    v_exp_f32 v51, v51
    v_cvt_pk_bf16_f32 v112, v48, v49
    v_cvt_pk_bf16_f32 v113, v50, v51
    v_exp_f32 v52, v52
    v_exp_f32 v53, v53
    v_exp_f32 v54, v54
    v_exp_f32 v55, v55
    v_mfma_f32_32x32x16_bf16 v[144:159], a[44:47], v[124:127], v[144:159]
    buffer_load_dwordx4 a[236:239], v1, s[12:15], s41 offen offset:0 sc1
    buffer_load_dwordx4 a[192:195], v1, s[12:15], s41 offen offset:1024 sc1
    buffer_load_dwordx4 a[196:199], v1, s[12:15], s38 offen offset:0 sc1
    buffer_load_dwordx4 v1, s[12:15], s7 offen sc1 lds
    v_cvt_pk_bf16_f32 v114, v52, v53
    v_cvt_pk_bf16_f32 v115, v54, v55
    v_exp_f32 v56, v56
    v_exp_f32 v57, v57
    v_mfma_f32_32x32x16_bf16 v[144:159], a[100:103], v[112:115], v[144:159]
    v_exp_f32 v58, v58
    v_exp_f32 v59, v59
    v_cvt_pk_bf16_f32 v116, v56, v57
    v_cvt_pk_bf16_f32 v117, v58, v59
    v_mfma_f32_32x32x16_bf16 v[80:95], a[136:139], v[12:15], v[80:95]
    s_add_u32 m0, s33, 102400
    v_exp_f32 v60, v60
    v_exp_f32 v61, v61
    v_exp_f32 v62, v62
    v_exp_f32 v63, v63
    v_mfma_f32_32x32x16_bf16 v[96:111], a[128:131], v[12:15], v[96:111]
    s_add_u32 s40, s5, 0
    v_cvt_pk_bf16_f32 v118, v60, v61
    v_cvt_pk_bf16_f32 v119, v62, v63
    v_exp_f32 v64, v64
    v_exp_f32 v65, v65
    v_exp_f32 v66, v66
    v_exp_f32 v67, v67
    v_cvt_pk_bf16_f32 v120, v64, v65
    v_cvt_pk_bf16_f32 v121, v66, v67
    v_exp_f32 v68, v68
    v_exp_f32 v69, v69
    v_exp_f32 v70, v70
    v_exp_f32 v71, v71
    v_mfma_f32_32x32x16_bf16 v[144:159], a[48:51], v[116:119], v[144:159]
    buffer_load_dwordx4 v1, s[12:15], s40 offen sc1 lds
    buffer_load_dwordx4 v1, s[12:15], s40 offen offset:1024 sc1 lds
    buffer_load_dwordx4 v1, s[12:15], s40 offen offset:2048 sc1 lds
    buffer_load_dwordx4 v1, s[12:15], s40 offen offset:3072 sc1 lds
    v_cvt_pk_bf16_f32 v122, v68, v69
    v_cvt_pk_bf16_f32 v123, v70, v71
    v_exp_f32 v72, v72
    v_exp_f32 v73, v73
    v_mfma_f32_32x32x16_bf16 v[144:159], a[56:59], v[120:123], v[144:159]
    v_exp_f32 v74, v74
    v_exp_f32 v75, v75
    v_cvt_pk_bf16_f32 v124, v72, v73
    v_cvt_pk_bf16_f32 v125, v74, v75
    v_exp_f32 v76, v76
    v_exp_f32 v77, v77
    v_exp_f32 v78, v78
    v_exp_f32 v79, v79
    v_cvt_pk_bf16_f32 v126, v76, v77
    v_cvt_pk_bf16_f32 v127, v78, v79
    v_exp_f32 v80, v80
    v_exp_f32 v81, v81
    v_exp_f32 v82, v82
    v_exp_f32 v83, v83
    v_cvt_pk_bf16_f32 v112, v80, v81
    v_cvt_pk_bf16_f32 v113, v82, v83
    v_exp_f32 v84, v84
    v_exp_f32 v85, v85
    v_exp_f32 v86, v86
    v_exp_f32 v87, v87
    v_mfma_f32_32x32x16_bf16 v[144:159], a[64:67], v[124:127], v[144:159]
    v_cvt_pk_bf16_f32 v114, v84, v85
    v_cvt_pk_bf16_f32 v115, v86, v87
    v_exp_f32 v88, v88
    v_exp_f32 v89, v89
    v_mfma_f32_32x32x16_bf16 v[144:159], a[120:123], v[112:115], v[144:159]
    v_exp_f32 v90, v90
    v_exp_f32 v91, v91
    v_cvt_pk_bf16_f32 v116, v88, v89
    v_cvt_pk_bf16_f32 v117, v90, v91
    v_exp_f32 v92, v92
    v_exp_f32 v93, v93
    v_exp_f32 v94, v94
    v_exp_f32 v95, v95
    v_cvt_pk_bf16_f32 v118, v92, v93
    v_cvt_pk_bf16_f32 v119, v94, v95
    v_exp_f32 v96, v96
    v_exp_f32 v97, v97
    v_exp_f32 v98, v98
    v_exp_f32 v99, v99
    v_cvt_pk_bf16_f32 v120, v96, v97
    v_cvt_pk_bf16_f32 v121, v98, v99
    v_exp_f32 v100, v100
    v_exp_f32 v101, v101
    v_exp_f32 v102, v102
    v_exp_f32 v103, v103
    v_mfma_f32_32x32x16_bf16 v[144:159], a[52:55], v[116:119], v[144:159]
    v_cvt_pk_bf16_f32 v122, v100, v101
    v_cvt_pk_bf16_f32 v123, v102, v103
    v_exp_f32 v104, v104
    v_exp_f32 v105, v105
    v_mfma_f32_32x32x16_bf16 v[144:159], a[60:63], v[120:123], v[144:159]
    v_exp_f32 v106, v106
    v_exp_f32 v107, v107
    v_cvt_pk_bf16_f32 v124, v104, v105
    v_cvt_pk_bf16_f32 v125, v106, v107
    v_exp_f32 v108, v108
    v_exp_f32 v109, v109
    v_exp_f32 v110, v110
    v_exp_f32 v111, v111
    v_cvt_pk_bf16_f32 v126, v108, v109
    v_cvt_pk_bf16_f32 v127, v110, v111
    s_nop 1
    v_mfma_f32_32x32x16_bf16 v[144:159], a[68:71], v[124:127], v[144:159]
    v_mov_b32 v244, 162816
    v_add_u32 v2, s33, v1
    v_add_u32 v3, s34, v1
    v_add_u32 v2, 102400, v2
    v_add_u32 v3, 102400, v3
    v_add_u32 v4, 102400, v1
    s_and_b32 s54, s56, 1
    s_lshl_b32 s54, s54, 6
    s_add_u32 s54, s54, 118784
    v_lshl_add_u32 v251, v246, 9, v24
    v_add_u32 v251, s54, v251
    v_add_u32 v253, 2048, v251
    v_cmp_nle_f32 vcc, 0x2b800000, v153
    v_rcp_f32 v249, v153
    s_or_b64 s[20:21], s[20:21], vcc
    v_cmp_nge_f32 vcc, 0x53800000, v153
    v_mul_f32 v144, v144, v249
    v_mul_f32 v145, v145, v249
    v_mul_f32 v146, v146, v249
    v_mul_f32 v147, v147, v249
    v_mul_f32 v148, v148, v249
    v_mul_f32 v149, v149, v249
    v_mul_f32 v150, v150, v249
    v_mul_f32 v151, v151, v249
    v_mul_f32 v152, v152, v249
    s_or_b64 s[20:21], s[20:21], vcc
    v_cvt_pk_bf16_f32 v144, v144, v145
    v_cvt_pk_bf16_f32 v145, v146, v147
    v_cvt_pk_bf16_f32 v146, v148, v149
    v_cvt_pk_bf16_f32 v147, v150, v151
    v_cvt_pk_bf16_f32 v148, v152, v152
    s_add_u32 s54, s66, 16384
    s_cmp_eq_u64 s[20:21], 0
    s_cselect_b32 s54, s54, 536870912
    buffer_store_dwordx4 v[144:147], v26, s[12:15], s54 offen sc1
    s_add_u32 s55, s68, 4096
    s_cmp_eq_u64 s[20:21], 0
    s_cselect_b32 s55, s55, 536870912
    buffer_store_short v148, v28, s[12:15], s55 offen sc1
    s_cbranch_scc0 L_at_flag
L_at_noflag:
    s_barrier
    ds_read_b32 v249, v244
    s_waitcnt vmcnt(2)
    v_mfma_f32_16x16x16_bf16 a[200:203], a[254:255], a[140:141], a[200:203]
    ds_read_b128 v[128:131], v2 offset:0
    v_mfma_f32_16x16x16_bf16 a[204:207], a[254:255], a[142:143], a[204:207]
    ds_read_b128 v[132:135], v2 offset:1024
    v_mfma_f32_16x16x16_bf16 a[208:211], a[254:255], a[132:133], a[208:211]
    ds_read_b128 v[136:139], v2 offset:2048
    v_mfma_f32_16x16x16_bf16 a[212:215], a[254:255], a[134:135], a[212:215]
    ds_read_b128 v[140:143], v2 offset:3072
    v_mfma_f32_16x16x16_bf16 a[200:203], a[254:255], a[124:125], a[200:203]
    ds_read_b128 v[152:155], v3 offset:16384
    v_mfma_f32_16x16x16_bf16 a[204:207], a[254:255], a[126:127], a[204:207]
    v_mfma_f32_16x16x16_bf16 a[208:211], a[254:255], a[224:225], a[208:211]
    s_waitcnt lgkmcnt(5)
    v_readfirstlane_b32 s54, v249
    v_mfma_f32_16x16x16_bf16 a[212:215], a[254:255], a[226:227], a[212:215]
    v_mfma_f32_16x16x16_bf16 a[200:203], a[254:255], a[228:229], a[200:203]
    v_mfma_f32_16x16x16_bf16 a[204:207], a[254:255], a[230:231], a[204:207]
    v_mfma_f32_16x16x16_bf16 a[208:211], a[254:255], a[232:233], a[208:211]
    v_mfma_f32_16x16x16_bf16 a[212:215], a[254:255], a[234:235], a[212:215]
    v_mfma_f32_16x16x16_bf16 a[200:203], a[254:255], a[236:237], a[200:203]
    v_mfma_f32_16x16x16_bf16 a[204:207], a[254:255], a[238:239], a[204:207]
    v_mfma_f32_16x16x16_bf16 a[208:211], a[254:255], a[192:193], a[208:211]
    v_mfma_f32_16x16x16_bf16 a[212:215], a[254:255], a[194:195], a[212:215]
    v_mfma_f32_16x16x16_bf16 a[216:219], a[254:255], a[196:197], a[216:219]
    v_mfma_f32_16x16x16_bf16 a[220:223], a[254:255], a[198:199], a[220:223]
    s_cmp_lg_u32 s54, 0
    s_cbranch_scc1 L_at_fallback
    s_mov_b32 s98, 0
L_o0_chk:
    s_waitcnt lgkmcnt(4)
    v_max3_u32 v156, v128, v129, 0
    v_max3_u32 v156, v130, v131, v156
    s_waitcnt lgkmcnt(3)
    v_max3_u32 v156, v132, v133, v156
    v_max3_u32 v156, v134, v135, v156
    s_waitcnt lgkmcnt(2)
    v_max3_u32 v156, v136, v137, v156
    v_max3_u32 v156, v138, v139, v156
    s_waitcnt lgkmcnt(1)
    v_max3_u32 v156, v140, v141, v156
    v_max3_u32 v156, v142, v143, v156
    s_waitcnt lgkmcnt(0)
    v_pk_max_u16 v152, v152, v153
    v_pk_max_u16 v154, v154, v155
    v_pk_max_u16 v152, v152, v154
    v_pk_max_u16 v152, v152, v152 op_sel:[0,1] op_sel_hi:[1,0]
    v_max_u32 v156, v156, v152
    v_cmp_eq_u32 vcc, -1, v156
    s_nop 4
    s_cbranch_vccnz L_o0_again
L_o0_ok:
    s_barrier
    ds_read_b128 v[84:87], v4 offset:7168
    ds_read_b128 a[8:11], v254 offset:7168
    ds_read_b128 v[88:91], v4 offset:8192
    ds_read_b128 a[16:19], v254 offset:8192
    v_mfma_f32_16x16x32_bf16 a[216:219], v[212:215], v[128:131], a[216:219]
    ds_read_b128 v[56:59], v4 offset:0
    ds_read_b128 a[240:243], v254 offset:0
    ds_read_b128 a[92:95], v254 offset:18432
    v_mfma_f32_16x16x32_bf16 a[216:219], v[216:219], v[132:135], a[216:219]
    ds_read_b128 v[92:95], v4 offset:9216
    ds_read_b128 a[88:91], v254 offset:9216
    v_mfma_f32_16x16x32_bf16 a[216:219], v[220:223], v[136:139], a[216:219]
    ds_read_b128 v[96:99], v4 offset:10240
    ds_read_b128 a[80:83], v254 offset:10240
    v_mfma_f32_16x16x32_bf16 a[216:219], v[224:227], v[140:143], a[216:219]
    s_waitcnt lgkmcnt(9)
    ds_read_b128 v[60:63], v4 offset:1024
    ds_read_b128 a[244:247], v254 offset:1024
    ds_read_b128 a[84:87], v254 offset:19456
    v_mfma_f32_16x16x32_bf16 a[200:203], a[8:11], v[84:87], a[200:203]
    ds_read_b128 v[100:103], v4 offset:11264
    ds_read_b128 a[72:75], v254 offset:11264
    v_mfma_f32_16x16x32_bf16 a[208:211], v[168:171], v[84:87], a[208:211]
    s_waitcnt lgkmcnt(12)
    v_lshlrev_b32 v32, 16, v232
    v_and_b32 v33, 0xffff0000, v232
    v_mfma_f32_16x16x32_bf16 a[208:211], v[172:175], v[88:91], a[208:211]
    ds_read_b128 v[64:67], v4 offset:2048
    ds_read_b128 a[248:251], v254 offset:2048
    ds_read_b128 a[76:79], v254 offset:20480
    v_mfma_f32_16x16x32_bf16 a[200:203], a[16:19], v[88:91], a[200:203]
    s_waitcnt lgkmcnt(12)
    v_lshlrev_b32 v34, 16, v233
    v_and_b32 v35, 0xffff0000, v233
    v_mfma_f32_16x16x32_bf16 a[200:203], a[240:243], v[56:59], a[200:203]
    ds_read_b128 v[104:107], v4 offset:12288
    ds_read_b128 a[148:151], v254 offset:12288
    v_mfma_f32_16x16x32_bf16 a[208:211], a[92:95], v[56:59], a[208:211]
    s_waitcnt lgkmcnt(12)
    v_lshlrev_b32 v36, 16, v234
    v_and_b32 v37, 0xffff0000, v234
    v_mfma_f32_16x16x32_bf16 a[208:211], v[176:179], v[92:95], a[208:211]
    ds_read_b128 v[68:71], v4 offset:3072
    ds_read_b128 a[144:147], v254 offset:3072
    ds_read_b128 a[168:171], v254 offset:21504
    v_mfma_f32_16x16x32_bf16 a[200:203], a[88:91], v[92:95], a[200:203]
    s_waitcnt lgkmcnt(13)
    v_lshlrev_b32 v38, 16, v235
    v_and_b32 v39, 0xffff0000, v235
    v_mfma_f32_16x16x32_bf16 a[200:203], a[80:83], v[96:99], a[200:203]
    ds_read_b128 v[108:111], v4 offset:13312
    ds_read_b128 a[156:159], v254 offset:13312
    v_mfma_f32_16x16x32_bf16 a[208:211], v[180:183], v[96:99], a[208:211]
    s_waitcnt lgkmcnt(12)
    v_lshlrev_b32 v40, 16, v236
    v_and_b32 v41, 0xffff0000, v236
    v_mfma_f32_16x16x32_bf16 a[208:211], a[84:87], v[60:63], a[208:211]
    ds_read_b128 v[72:75], v4 offset:4096
    ds_read_b128 a[152:155], v254 offset:4096
    ds_read_b128 a[176:179], v254 offset:22528
    v_mfma_f32_16x16x32_bf16 a[200:203], a[244:247], v[60:63], a[200:203]
    s_waitcnt lgkmcnt(13)
    v_lshlrev_b32 v42, 16, v237
    v_and_b32 v43, 0xffff0000, v237
    v_mfma_f32_16x16x32_bf16 a[200:203], a[72:75], v[100:103], a[200:203]
    ds_read_b128 v[112:115], v4 offset:14336
    ds_read_b128 a[164:167], v254 offset:14336
    v_mfma_f32_16x16x32_bf16 a[208:211], v[184:187], v[100:103], a[208:211]
    s_waitcnt lgkmcnt(12)
    v_lshlrev_b32 v44, 16, v238
    v_and_b32 v45, 0xffff0000, v238
    v_mfma_f32_16x16x32_bf16 a[208:211], a[76:79], v[64:67], a[208:211]
    ds_read_b128 v[76:79], v4 offset:5120
    ds_read_b128 a[160:163], v254 offset:5120
    ds_read_b128 a[184:187], v254 offset:23552
    v_mfma_f32_16x16x32_bf16 a[200:203], a[248:251], v[64:67], a[200:203]
    s_waitcnt lgkmcnt(13)
    v_lshlrev_b32 v46, 16, v239
    v_and_b32 v47, 0xffff0000, v239
    v_mfma_f32_16x16x32_bf16 a[200:203], a[148:151], v[104:107], a[200:203]
    ds_read_b128 v[116:119], v4 offset:15360
    ds_read_b128 a[4:7], v254 offset:15360
    v_mfma_f32_16x16x32_bf16 a[208:211], v[188:191], v[104:107], a[208:211]
    s_waitcnt lgkmcnt(12)
    s_add_u32 m0, s33, 125952
    s_add_u32 s22, s5, 16384
    buffer_load_dwordx4 v1, s[12:15], s22 offen sc1 lds
    v_mfma_f32_16x16x32_bf16 a[208:211], a[168:171], v[68:71], a[208:211]
    ds_read_b128 v[80:83], v4 offset:6144
    ds_read_b128 a[0:3], v254 offset:6144
    ds_read_b128 a[24:27], v254 offset:24576
    v_mfma_f32_16x16x32_bf16 a[200:203], a[144:147], v[68:71], a[200:203]
    s_waitcnt lgkmcnt(13)
    buffer_load_dwordx4 v1, s[12:15], s22 offen offset:1024 sc1 lds
    v_mfma_f32_16x16x32_bf16 a[200:203], a[156:159], v[108:111], a[200:203]
    ds_read2_b32 v[120:121], v251 offset0:0 offset1:32
    ds_read2_b32 v[122:123], v251 offset0:64 offset1:96
    ds_read_b128 a[12:15], v254 offset:16384
    v_mfma_f32_16x16x32_bf16 a[208:211], v[192:195], v[108:111], a[208:211]
    s_waitcnt lgkmcnt(13)
    buffer_load_dwordx4 v1, s[12:15], s22 offen offset:2048 sc1 lds
    v_mfma_f32_16x16x32_bf16 a[208:211], a[176:179], v[72:75], a[208:211]
    ds_read2_b32 v[124:125], v253 offset0:0 offset1:32
    ds_read2_b32 v[126:127], v253 offset0:64 offset1:96
    ds_read_b128 a[20:23], v254 offset:17408
    v_mfma_f32_16x16x32_bf16 a[200:203], a[152:155], v[72:75], a[200:203]
    s_waitcnt lgkmcnt(14)
    buffer_load_dwordx4 v1, s[12:15], s22 offen offset:3072 sc1 lds
    v_mfma_f32_16x16x32_bf16 a[200:203], a[164:167], v[112:115], a[200:203]
    v_mul_u32_u24 v48, 196, v24
    v_lshl_add_u32 v48, v246, 4, v48
    v_mfma_f32_16x16x32_bf16 a[208:211], v[196:199], v[112:115], a[208:211]
    s_waitcnt lgkmcnt(11)
    s_add_u32 m0, s34, 142336
    s_add_u32 s22, s32, 4096
    buffer_load_dwordx4 v1, s[12:15], s22 offen sc1 lds
    v_mfma_f32_16x16x32_bf16 a[208:211], a[184:187], v[76:79], a[208:211]
    v_lshl_add_u32 v49, s44, 6, v48
    v_lshl_add_u32 v48, s44, 7, v48
    v_mfma_f32_16x16x32_bf16 a[200:203], a[160:163], v[76:79], a[200:203]
    s_waitcnt lgkmcnt(9)
    v_lshl_add_u32 v50, s44, 2, v246
    v_lshl_add_u32 v51, s44, 2, v248
    v_mfma_f32_16x16x32_bf16 a[200:203], a[4:7], v[116:119], a[200:203]
    v_mul_u32_u24 v50, 784, v50
    v_lshl_add_u32 v50, v24, 3, v50
    v_mfma_f32_16x16x32_bf16 a[208:211], v[200:203], v[116:119], a[208:211]
    s_waitcnt lgkmcnt(6)
    v_mul_u32_u24 v51, 784, v51
    v_lshl_add_u32 v51, v245, 5, v51
    v_mfma_f32_16x16x32_bf16 a[208:211], a[24:27], v[80:83], a[208:211]
    v_add_u32 v52, 146432, v48
    v_add_u32 v53, 146432, v49
    v_mfma_f32_16x16x32_bf16 a[200:203], a[0:3], v[80:83], a[200:203]
    s_waitcnt lgkmcnt(3)
    v_add_u32 v54, 146432, v50
    v_add_u32 v55, 146432, v51
    v_mfma_f32_16x16x32_bf16 a[200:203], a[12:15], v[120:123], a[200:203]
    v_mfma_f32_16x16x32_bf16 a[208:211], v[204:207], v[120:123], a[208:211]
    v_mfma_f32_16x16x32_bf16 a[216:219], v[228:231], v[120:123], a[216:219]
    s_waitcnt lgkmcnt(0)
    v_mfma_f32_16x16x32_bf16 a[216:219], v[160:163], v[124:127], a[216:219]
    v_mfma_f32_16x16x32_bf16 a[208:211], v[208:211], v[124:127], a[208:211]
    v_mfma_f32_16x16x32_bf16 a[200:203], a[20:23], v[124:127], a[200:203]
    v_add_u32 v251, 23552, v251
    v_add_u32 v253, 23552, v253
    s_nop 3
    ds_write_b128 v53, a[216:219] offset:512
    ds_write_b128 v52, a[208:211] offset:64
    ds_write_b128 v52, a[200:203] offset:0
    s_waitcnt lgkmcnt(0)
    s_barrier
    ds_read_b128 v[56:59], v54 offset:0
    ds_read_b128 v[60:63], v54 offset:16
    ds_read_b128 v[64:67], v55 offset:512
    ds_read_b128 v[68:71], v55 offset:528
    ds_read_b128 v[72:75], v55 offset:576
    ds_read_b128 v[76:79], v55 offset:592
    ds_read_b128 v[80:83], v55 offset:640
    ds_read_b128 v[84:87], v55 offset:656
    ds_read_b128 v[88:91], v55 offset:704
    ds_read_b128 v[92:95], v55 offset:720
    s_waitcnt lgkmcnt(8)
    v_pk_add_f32 v[32:33], v[32:33], v[56:57]
    v_pk_add_f32 v[34:35], v[34:35], v[58:59]
    v_pk_add_f32 v[36:37], v[36:37], v[60:61]
    v_pk_add_f32 v[38:39], v[38:39], v[62:63]
    v_cvt_pk_bf16_f32 v232, v32, v33
    v_cvt_pk_bf16_f32 v233, v34, v35
    v_cvt_pk_bf16_f32 v234, v36, v37
    v_cvt_pk_bf16_f32 v235, v38, v39
    buffer_store_dwordx4 v[232:235], v247, s[16:19], s4 offen
    s_waitcnt lgkmcnt(6)
    v_pk_add_f32 v[40:41], v[40:41], v[64:65]
    v_pk_add_f32 v[42:43], v[42:43], v[66:67]
    v_pk_add_f32 v[44:45], v[44:45], v[68:69]
    v_pk_add_f32 v[46:47], v[46:47], v[70:71]
    s_waitcnt lgkmcnt(4)
    v_pk_add_f32 v[40:41], v[40:41], v[72:73]
    v_pk_add_f32 v[42:43], v[42:43], v[74:75]
    v_pk_add_f32 v[44:45], v[44:45], v[76:77]
    v_pk_add_f32 v[46:47], v[46:47], v[78:79]
    s_waitcnt lgkmcnt(2)
    v_pk_add_f32 v[40:41], v[40:41], v[80:81]
    v_pk_add_f32 v[42:43], v[42:43], v[82:83]
    v_pk_add_f32 v[44:45], v[44:45], v[84:85]
    v_pk_add_f32 v[46:47], v[46:47], v[86:87]
    s_waitcnt lgkmcnt(0)
    v_pk_add_f32 v[40:41], v[40:41], v[88:89]
    v_pk_add_f32 v[42:43], v[42:43], v[90:91]
    v_pk_add_f32 v[44:45], v[44:45], v[92:93]
    v_pk_add_f32 v[46:47], v[46:47], v[94:95]
    v_cvt_pk_bf16_f32 v236, v40, v41
    v_cvt_pk_bf16_f32 v237, v42, v43
    v_cvt_pk_bf16_f32 v238, v44, v45
    v_cvt_pk_bf16_f32 v239, v46, v47
    buffer_store_dwordx4 v[236:239], v250, s[16:19], s4 offen
    s_mov_b32 s98, 0
    s_waitcnt vmcnt(2)
    ds_read_b128 v[128:131], v2 offset:23552
    ds_read_b128 v[132:135], v2 offset:24576
    ds_read_b128 v[136:139], v2 offset:25600
    ds_read_b128 v[140:143], v2 offset:26624
    ds_read_b128 v[152:155], v3 offset:39936
L_o1_chk:
    s_waitcnt lgkmcnt(4)
    v_max3_u32 v156, v128, v129, 0
    v_max3_u32 v156, v130, v131, v156
    s_waitcnt lgkmcnt(3)
    v_max3_u32 v156, v132, v133, v156
    v_max3_u32 v156, v134, v135, v156
    s_waitcnt lgkmcnt(2)
    v_max3_u32 v156, v136, v137, v156
    v_max3_u32 v156, v138, v139, v156
    s_waitcnt lgkmcnt(1)
    v_max3_u32 v156, v140, v141, v156
    v_max3_u32 v156, v142, v143, v156
    s_waitcnt lgkmcnt(0)
    v_pk_max_u16 v152, v152, v153
    v_pk_max_u16 v154, v154, v155
    v_pk_max_u16 v152, v152, v154
    v_pk_max_u16 v152, v152, v152 op_sel:[0,1] op_sel_hi:[1,0]
    v_max_u32 v156, v156, v152
    v_cmp_eq_u32 vcc, -1, v156
    s_nop 4
    s_cbranch_vccnz L_o1_again
L_o1_ok:
    s_barrier
    ds_read_b128 v[56:59], v4 offset:23552
    ds_read_b128 v[60:63], v4 offset:24576
    ds_read_b128 v[64:67], v4 offset:25600
    ds_read_b128 v[68:71], v4 offset:26624
    v_mfma_f32_16x16x32_bf16 a[220:223], v[212:215], v[128:131], a[220:223]
    ds_read_b128 v[72:75], v4 offset:27648
    v_mfma_f32_16x16x32_bf16 a[220:223], v[216:219], v[132:135], a[220:223]
    ds_read_b128 v[76:79], v4 offset:28672
    v_mfma_f32_16x16x32_bf16 a[220:223], v[220:223], v[136:139], a[220:223]
    ds_read_b128 v[80:83], v4 offset:29696
    v_mfma_f32_16x16x32_bf16 a[220:223], v[224:227], v[140:143], a[220:223]
    s_waitcnt lgkmcnt(6)
    ds_read_b128 v[84:87], v4 offset:30720
    v_mfma_f32_16x16x32_bf16 a[204:207], a[240:243], v[56:59], a[204:207]
    ds_read_b128 v[88:91], v4 offset:31744
    v_mfma_f32_16x16x32_bf16 a[212:215], a[92:95], v[56:59], a[212:215]
    s_waitcnt lgkmcnt(7)
    v_lshlrev_b32 v32, 16, v240
    v_and_b32 v33, 0xffff0000, v240
    v_mfma_f32_16x16x32_bf16 a[212:215], a[84:87], v[60:63], a[212:215]
    ds_read_b128 v[92:95], v4 offset:32768
    v_mfma_f32_16x16x32_bf16 a[204:207], a[244:247], v[60:63], a[204:207]
    s_waitcnt lgkmcnt(7)
    v_lshlrev_b32 v34, 16, v241
    v_and_b32 v35, 0xffff0000, v241
    v_mfma_f32_16x16x32_bf16 a[204:207], a[248:251], v[64:67], a[204:207]
    ds_read_b128 v[96:99], v4 offset:33792
    v_mfma_f32_16x16x32_bf16 a[212:215], a[76:79], v[64:67], a[212:215]
    s_waitcnt lgkmcnt(7)
    v_lshlrev_b32 v36, 16, v242
    v_and_b32 v37, 0xffff0000, v242
    v_mfma_f32_16x16x32_bf16 a[212:215], a[168:171], v[68:71], a[212:215]
    ds_read_b128 v[100:103], v4 offset:34816
    v_mfma_f32_16x16x32_bf16 a[204:207], a[144:147], v[68:71], a[204:207]
    s_waitcnt lgkmcnt(7)
    v_lshlrev_b32 v38, 16, v243
    v_and_b32 v39, 0xffff0000, v243
    v_mfma_f32_16x16x32_bf16 a[204:207], a[152:155], v[72:75], a[204:207]
    ds_read_b128 v[104:107], v4 offset:35840
    v_mfma_f32_16x16x32_bf16 a[212:215], a[176:179], v[72:75], a[212:215]
    s_waitcnt lgkmcnt(7)
    v_lshlrev_b32 v40, 16, v164
    v_and_b32 v41, 0xffff0000, v164
    v_mfma_f32_16x16x32_bf16 a[212:215], a[184:187], v[76:79], a[212:215]
    ds_read_b128 v[108:111], v4 offset:36864
    v_mfma_f32_16x16x32_bf16 a[204:207], a[160:163], v[76:79], a[204:207]
    s_waitcnt lgkmcnt(7)
    v_lshlrev_b32 v42, 16, v165
    v_and_b32 v43, 0xffff0000, v165
    v_mfma_f32_16x16x32_bf16 a[204:207], a[0:3], v[80:83], a[204:207]
    ds_read_b128 v[112:115], v4 offset:37888
    v_mfma_f32_16x16x32_bf16 a[212:215], a[24:27], v[80:83], a[212:215]
    s_waitcnt lgkmcnt(7)
    v_lshlrev_b32 v44, 16, v166
    v_and_b32 v45, 0xffff0000, v166
    v_mfma_f32_16x16x32_bf16 a[212:215], v[168:171], v[84:87], a[212:215]
    ds_read_b128 v[116:119], v4 offset:38912
    v_mfma_f32_16x16x32_bf16 a[204:207], a[8:11], v[84:87], a[204:207]
    s_waitcnt lgkmcnt(7)
    v_lshlrev_b32 v46, 16, v167
    v_and_b32 v47, 0xffff0000, v167
    v_mfma_f32_16x16x32_bf16 a[204:207], a[16:19], v[88:91], a[204:207]
    ds_read2_b32 v[120:121], v251 offset0:0 offset1:32
    ds_read2_b32 v[122:123], v251 offset0:64 offset1:96
    v_mfma_f32_16x16x32_bf16 a[212:215], v[172:175], v[88:91], a[212:215]
    s_waitcnt lgkmcnt(8)
    v_mfma_f32_16x16x32_bf16 a[212:215], v[176:179], v[92:95], a[212:215]
    ds_read2_b32 v[124:125], v253 offset0:0 offset1:32
    ds_read2_b32 v[126:127], v253 offset0:64 offset1:96
    v_mfma_f32_16x16x32_bf16 a[204:207], a[88:91], v[92:95], a[204:207]
    s_waitcnt lgkmcnt(9)
    v_mfma_f32_16x16x32_bf16 a[204:207], a[80:83], v[96:99], a[204:207]
    v_mfma_f32_16x16x32_bf16 a[212:215], v[180:183], v[96:99], a[212:215]
    s_waitcnt lgkmcnt(8)
    v_mfma_f32_16x16x32_bf16 a[212:215], v[184:187], v[100:103], a[212:215]
    v_mfma_f32_16x16x32_bf16 a[204:207], a[72:75], v[100:103], a[204:207]
    s_waitcnt lgkmcnt(7)
    v_mfma_f32_16x16x32_bf16 a[204:207], a[148:151], v[104:107], a[204:207]
    v_mfma_f32_16x16x32_bf16 a[212:215], v[188:191], v[104:107], a[212:215]
    s_waitcnt lgkmcnt(6)
    v_mfma_f32_16x16x32_bf16 a[212:215], v[192:195], v[108:111], a[212:215]
    v_mfma_f32_16x16x32_bf16 a[204:207], a[156:159], v[108:111], a[204:207]
    s_waitcnt lgkmcnt(5)
    v_mfma_f32_16x16x32_bf16 a[204:207], a[164:167], v[112:115], a[204:207]
    v_mfma_f32_16x16x32_bf16 a[212:215], v[196:199], v[112:115], a[212:215]
    s_waitcnt lgkmcnt(4)
    v_mfma_f32_16x16x32_bf16 a[212:215], v[200:203], v[116:119], a[212:215]
    v_mfma_f32_16x16x32_bf16 a[204:207], a[4:7], v[116:119], a[204:207]
    s_waitcnt lgkmcnt(2)
    v_mfma_f32_16x16x32_bf16 a[204:207], a[12:15], v[120:123], a[204:207]
    v_mfma_f32_16x16x32_bf16 a[212:215], v[204:207], v[120:123], a[212:215]
    v_mfma_f32_16x16x32_bf16 a[220:223], v[228:231], v[120:123], a[220:223]
    s_waitcnt lgkmcnt(0)
    v_mfma_f32_16x16x32_bf16 a[220:223], v[160:163], v[124:127], a[220:223]
    v_mfma_f32_16x16x32_bf16 a[212:215], v[208:211], v[124:127], a[212:215]
    v_mfma_f32_16x16x32_bf16 a[204:207], a[20:23], v[124:127], a[204:207]
    s_nop 5
    ds_write_b128 v49, a[220:223] offset:512
    ds_write_b128 v48, a[212:215] offset:64
    ds_write_b128 v48, a[204:207] offset:0
    s_waitcnt lgkmcnt(0)
    s_barrier
    ds_read_b128 v[56:59], v50 offset:0
    ds_read_b128 v[60:63], v50 offset:16
    ds_read_b128 v[64:67], v51 offset:512
    ds_read_b128 v[68:71], v51 offset:528
    ds_read_b128 v[72:75], v51 offset:576
    ds_read_b128 v[76:79], v51 offset:592
    ds_read_b128 v[80:83], v51 offset:640
    ds_read_b128 v[84:87], v51 offset:656
    ds_read_b128 v[88:91], v51 offset:704
    ds_read_b128 v[92:95], v51 offset:720
    s_waitcnt lgkmcnt(8)
    v_pk_add_f32 v[32:33], v[32:33], v[56:57]
    v_pk_add_f32 v[34:35], v[34:35], v[58:59]
    v_pk_add_f32 v[36:37], v[36:37], v[60:61]
    v_pk_add_f32 v[38:39], v[38:39], v[62:63]
    v_cvt_pk_bf16_f32 v240, v32, v33
    v_cvt_pk_bf16_f32 v241, v34, v35
    v_cvt_pk_bf16_f32 v242, v36, v37
    v_cvt_pk_bf16_f32 v243, v38, v39
    buffer_store_dwordx4 v[240:243], v247, s[16:19], s35 offen
    s_waitcnt lgkmcnt(6)
    v_pk_add_f32 v[40:41], v[40:41], v[64:65]
    v_pk_add_f32 v[42:43], v[42:43], v[66:67]
    v_pk_add_f32 v[44:45], v[44:45], v[68:69]
    v_pk_add_f32 v[46:47], v[46:47], v[70:71]
    s_waitcnt lgkmcnt(4)
    v_pk_add_f32 v[40:41], v[40:41], v[72:73]
    v_pk_add_f32 v[42:43], v[42:43], v[74:75]
    v_pk_add_f32 v[44:45], v[44:45], v[76:77]
    v_pk_add_f32 v[46:47], v[46:47], v[78:79]
    s_waitcnt lgkmcnt(2)
    v_pk_add_f32 v[40:41], v[40:41], v[80:81]
    v_pk_add_f32 v[42:43], v[42:43], v[82:83]
    v_pk_add_f32 v[44:45], v[44:45], v[84:85]
    v_pk_add_f32 v[46:47], v[46:47], v[86:87]
    s_waitcnt lgkmcnt(0)
    v_pk_add_f32 v[40:41], v[40:41], v[88:89]
    v_pk_add_f32 v[42:43], v[42:43], v[90:91]
    v_pk_add_f32 v[44:45], v[44:45], v[92:93]
    v_pk_add_f32 v[46:47], v[46:47], v[94:95]
    v_cvt_pk_bf16_f32 v164, v40, v41
    v_cvt_pk_bf16_f32 v165, v42, v43
    v_cvt_pk_bf16_f32 v166, v44, v45
    v_cvt_pk_bf16_f32 v167, v46, v47
    buffer_store_dwordx4 v[164:167], v250, s[16:19], s35 offen
L_end:
    s_endpgm
L_k_z:
    s_lshl_b32 s48, s44, 11
    s_add_u32 s48, s48, 12582912
    buffer_store_dwordx4 v[184:187], v1, s[12:15], s48 offen sc1
    buffer_store_dwordx4 v[184:187], v1, s[12:15], s48 offen offset:1024 sc1
    s_branch L_k_noz
L_k_c:
    buffer_store_dword v22, v21, s[92:95], 0 offen sc1
    s_branch L_k_noc
L_c0_spin:
    s_mov_b32 s98, 0
L_c0_loop:
    s_sleep 1
    buffer_load_dword v244, off, s[92:95], 0 sc1
    s_waitcnt vmcnt(0)
    v_cmp_ne_u32 vcc, 1, v244
    s_add_u32 s98, s98, 1
    s_cmp_gt_u32 s98, 200000
    s_cbranch_scc1 L_c0_ok
    s_nop 1
    s_cbranch_vccnz L_c0_loop
    s_branch L_c0_ok
L_f1_spin:
    s_mov_b32 s98, 0
L_f1_loop:
    s_sleep 1
    buffer_load_dwordx4 v[244:247], v1, s[12:15], s54 offen sc1
    s_waitcnt vmcnt(0)
    v_and_b32 v244, v244, v245
    v_and_b32 v246, v246, v247
    v_and_b32 v244, v244, v246
    v_cmp_ne_u32 vcc, 1, v244
    s_add_u32 s98, s98, 1
    s_cmp_gt_u32 s98, 200000
    s_cbranch_scc1 L_f1_ok
    s_nop 1
    s_cbranch_vccnz L_f1_loop
    s_branch L_f1_ok
L_k_t0:
    s_memtime s[80:81]
    s_memrealtime s[82:83]
    s_waitcnt lgkmcnt(0)
    s_branch L_k_u
L_rk_spin:
    s_mov_b32 s98, 0
L_rk_loop:
    s_sleep 1
    buffer_load_dword v20, v1, s[92:95], 0 offen offset:128 sc1
    s_waitcnt vmcnt(0)
    v_cmp_eq_u32 vcc, 0, v20
    s_nop 0
    s_and_b64 vcc, vcc, 0xff
    s_add_u32 s98, s98, 1
    s_cmp_gt_u32 s98, 200000
    s_cbranch_scc1 L_rk_ok
    s_nop 1
    s_cbranch_vccnz L_rk_loop
    s_branch L_rk_ok
L_rk_ok:
    v_readlane_b32 s64, v20, s28
    s_nop 1
    s_branch L_rk_ret
L_k_s1:
    s_memtime s[76:77]
    s_memrealtime s[78:79]
    s_waitcnt lgkmcnt(0)
    s_sub_u32 s76, s76, s80
    s_sub_u32 s78, s78, s82
    v_cvt_f32_u32 v232, s78
    v_rcp_f32 v232, v232
    v_cvt_f32_u32 v233, s76
    s_lshl_b32 s77, s2, 4
    v_mul_f32 v232, v232, v233
    v_and_or_b32 v232, v232, -8, s2
    v_or_b32 v232, 8, v232
    buffer_store_dword v232, v21, s[92:95], s77 offen offset:128 sc1
    s_branch L_k_u
L_k_vs:
    s_cmp_ge_u32 s45, 11
    s_cbranch_scc1 L_k_s
    v_mfma_f32_16x16x32_bf16 v[104:107], a[144:147], a[216:219], 0
    s_add_u32 m0, m0, s43
    v_fma_f32 v232, -v168, v168, s68
    v_mul_f32 v232, v232, v168
    v_mfma_f32_16x16x32_bf16 v[104:107], a[148:151], a[220:223], v[104:107]
    s_add_u32 s49, s49, s50
    v_exp_f32 v232, v232
    v_mfma_f32_16x16x32_bf16 v[108:111], v[36:39], a[220:223], 0
    s_lshl2_add_u32 s63, s46, s44
    ds_read_b64_tr_b16 a[232:233], v9 offset:8448
    v_mul_f32 v233, v168, v200
    v_mfma_f32_16x16x32_bf16 v[108:111], v[32:35], a[216:219], v[108:111]
    s_xor_b32 s64, s63, 1
    ds_read_b64_tr_b16 a[234:235], v9 offset:8960
    v_fma_f32 v232, v232, s3, s3
    v_mfma_f32_16x16x32_bf16 v[112:115], a[0:3], a[216:219], 0
    s_mul_i32 s63, s63, 37376
    ds_read_b64_tr_b16 a[236:237], v9 offset:12672
    v_fma_f32 v234, -v169, v169, s68
    v_mfma_f32_16x16x32_bf16 v[112:115], a[4:7], a[220:223], v[112:115]
    s_mul_i32 s64, s64, 37376
    ds_read_b64_tr_b16 a[238:239], v9 offset:13184
    v_mul_f32 v234, v234, v169
    v_mfma_f32_16x16x32_bf16 v[116:119], a[76:79], a[220:223], 0
    s_and_b32 s65, s44, 1
    buffer_load_dwordx4 v6, s[20:23], s49 offen nt lds
    v_mfma_f32_16x16x32_bf16 v[116:119], a[72:75], a[216:219], v[116:119]
    s_waitcnt lgkmcnt(4)
    v_rcp_f32 v232, v232
    v_mfma_f32_16x16x32_bf16 v[132:135], a[72:75], a[224:227], 0
    s_add_u32 m0, m0, s43
    ds_read_b64_tr_b16 a[216:217], v9 offset:8480
    v_mul_f32 v232, v232, v233
    v_mfma_f32_16x16x32_bf16 v[132:135], a[76:79], a[228:231], v[132:135]
    s_add_u32 s48, s39, s41
    ds_read_b64_tr_b16 a[218:219], v9 offset:8992
    v_mul_f32 v235, v169, v201
    v_mfma_f32_16x16x32_bf16 v[128:131], a[4:7], a[228:231], 0
    s_lshl_b32 s65, s65, 6
    ds_read_b64_tr_b16 a[220:221], v9 offset:12704
    v_fma_f32 v236, -v170, v170, s68
    v_mfma_f32_16x16x32_bf16 v[128:131], a[0:3], a[224:227], v[128:131]
    s_add_u32 s65, s65, s60
    ds_read_b64_tr_b16 a[222:223], v9 offset:13216
    v_mul_f32 v236, v236, v170
    v_mfma_f32_16x16x32_bf16 v[124:127], v[32:35], a[224:227], 0
    s_lshl_b32 s65, s65, 3
    v_exp_f32 v234, v234
    v_mfma_f32_16x16x32_bf16 v[124:127], v[36:39], a[228:231], v[124:127]
    s_add_u32 s65, s65, 5224448
    v_exp_f32 v236, v236
    v_mfma_f32_16x16x32_bf16 v[120:123], a[148:151], a[228:231], 0
    s_add_u32 s76, s65, s63
    buffer_load_dwordx4 v6, s[16:19], s48 offen nt lds
    v_mfma_f32_16x16x32_bf16 v[120:123], a[144:147], a[224:227], v[120:123]
    s_waitcnt lgkmcnt(4)
    v_fma_f32 v234, v234, s3, s3
    v_mul_f32 v237, v170, v202
    v_mfma_f32_16x16x32_bf16 v[136:139], a[144:147], a[232:235], 0
    s_add_u32 m0, m0, s43
    ds_read_b64_tr_b16 a[224:225], v9 offset:16896
    v_fma_f32 v236, v236, s3, s3
    v_mfma_f32_16x16x32_bf16 v[136:139], a[148:151], a[236:239], v[136:139]
    s_add_u32 s48, s48, s50
    ds_read_b64_tr_b16 a[226:227], v9 offset:17408
    v_fma_f32 v238, -v171, v171, s68
    v_mfma_f32_16x16x32_bf16 v[140:143], v[36:39], a[236:239], 0
    s_add_u32 s77, s65, s64
    ds_read_b64_tr_b16 a[228:229], v9 offset:21120
    v_mul_f32 v238, v238, v171
    v_mfma_f32_16x16x32_bf16 v[140:143], v[32:35], a[232:235], v[140:143]
    s_add_u32 s78, s76, 256
    ds_read_b64_tr_b16 a[230:231], v9 offset:21632
    v_mul_f32 v239, v171, v203
    v_mfma_f32_16x16x32_bf16 v[144:147], a[0:3], a[232:235], 0
    s_add_u32 s79, s77, 256
    v_rcp_f32 v234, v234
    v_mfma_f32_16x16x32_bf16 v[144:147], a[4:7], a[236:239], v[144:147]
    s_add_u32 s80, s76, 1024
    v_rcp_f32 v236, v236
    v_mfma_f32_16x16x32_bf16 v[148:151], a[76:79], a[236:239], 0
    s_add_u32 s81, s77, 1024
    buffer_load_dwordx4 v6, s[16:19], s48 offen nt lds
    v_mfma_f32_16x16x32_bf16 v[148:151], a[72:75], a[232:235], v[148:151]
    s_waitcnt lgkmcnt(4)
    v_exp_f32 v238, v238
    v_mfma_f32_16x16x32_bf16 v[164:167], a[72:75], a[216:219], 0
    s_mov_b32 m0, s47
    ds_read_b64_tr_b16 a[232:233], v9 offset:16928
    v_mul_f32 v234, v234, v235
    v_mfma_f32_16x16x32_bf16 v[164:167], a[76:79], a[220:223], v[164:167]
    s_add_u32 s49, s39, s42
    ds_read_b64_tr_b16 a[234:235], v9 offset:17440
    v_cvt_pk_bf16_f32 v248, v232, v234
    v_mfma_f32_16x16x32_bf16 v[160:163], a[4:7], a[220:223], 0
    s_add_u32 s82, s78, 1024
    ds_read_b64_tr_b16 a[236:237], v9 offset:21152
    v_mul_f32 v236, v236, v237
    v_mfma_f32_16x16x32_bf16 v[160:163], a[0:3], a[216:219], v[160:163]
    s_mul_i32 s39, s84, s40
    ds_read_b64_tr_b16 a[238:239], v9 offset:21664
    v_fma_f32 v238, v238, s3, s3
    v_mfma_f32_16x16x32_bf16 v[156:159], v[32:35], a[216:219], 0
    s_add_u32 s83, s79, 1024
    v_rcp_f32 v238, v238
    v_mfma_f32_16x16x32_bf16 v[156:159], v[36:39], a[220:223], v[156:159]
    s_waitcnt vmcnt(8)
    v_mul_f32 v238, v238, v239
    v_cvt_pk_bf16_f32 v249, v236, v238
    v_mfma_f32_16x16x32_bf16 v[152:155], a[148:151], a[220:223], 0
    s_barrier
    buffer_load_dwordx4 v6, s[20:23], s49 offen nt lds
    v_mfma_f32_16x16x32_bf16 v[152:155], a[144:147], a[216:219], v[152:155]
    s_waitcnt lgkmcnt(4)
    v_fma_f32 v240, -v172, v172, s68
    v_mul_f32 v240, v240, v172
    v_mfma_f32_16x16x32_bf16 v[104:107], a[152:155], a[224:227], v[104:107]
    s_add_u32 m0, m0, s43
    ds_read_b64_tr_b16 a[216:217], v9 offset:25344
    v_mul_f32 v241, v172, v204
    v_mfma_f32_16x16x32_bf16 v[104:107], a[156:159], a[228:231], v[104:107]
    s_add_u32 s49, s49, s50
    ds_read_b64_tr_b16 a[218:219], v9 offset:25856
    v_fma_f32 v242, -v173, v173, s68
    v_mfma_f32_16x16x32_bf16 v[108:111], v[44:47], a[228:231], v[108:111]
    s_mov_b32 s72, 1074302617
    ds_read_b64_tr_b16 a[220:221], v9 offset:29568
    v_mul_f32 v242, v242, v173
    v_mfma_f32_16x16x32_bf16 v[108:111], v[40:43], a[224:227], v[108:111]
    ds_read_b64_tr_b16 a[222:223], v9 offset:30080
    v_mul_f32 v243, v173, v205
    v_mfma_f32_16x16x32_bf16 v[112:115], a[8:11], a[224:227], v[112:115]
    v_exp_f32 v240, v240
    v_mfma_f32_16x16x32_bf16 v[112:115], a[12:15], a[228:231], v[112:115]
    v_exp_f32 v242, v242
    v_mfma_f32_16x16x32_bf16 v[116:119], a[84:87], a[228:231], v[116:119]
    buffer_load_dwordx4 v6, s[20:23], s49 offen nt lds
    v_mfma_f32_16x16x32_bf16 v[116:119], a[80:83], a[224:227], v[116:119]
    s_waitcnt lgkmcnt(4)
    v_fma_f32 v240, v240, s3, s3
    v_fma_f32 v242, v242, s3, s3
    v_mfma_f32_16x16x32_bf16 v[132:135], a[80:83], a[232:235], v[132:135]
    s_add_u32 m0, m0, s43
    ds_read_b64_tr_b16 a[224:225], v9 offset:25376
    v_fma_f32 v244, -v174, v174, s68
    v_mfma_f32_16x16x32_bf16 v[132:135], a[84:87], a[236:239], v[132:135]
    s_add_u32 s48, s39, s41
    ds_read_b64_tr_b16 a[226:227], v9 offset:25888
    v_mul_f32 v244, v244, v174
    v_mfma_f32_16x16x32_bf16 v[128:131], a[12:15], a[236:239], v[128:131]
    ds_read_b64_tr_b16 a[228:229], v9 offset:29600
    v_mul_f32 v245, v174, v206
    v_mfma_f32_16x16x32_bf16 v[128:131], a[8:11], a[232:235], v[128:131]
    ds_read_b64_tr_b16 a[230:231], v9 offset:30112
    v_fma_f32 v246, -v175, v175, s68
    v_mfma_f32_16x16x32_bf16 v[124:127], v[40:43], a[232:235], v[124:127]
    v_rcp_f32 v240, v240
    v_mfma_f32_16x16x32_bf16 v[124:127], v[44:47], a[236:239], v[124:127]
    v_rcp_f32 v242, v242
    v_mfma_f32_16x16x32_bf16 v[120:123], a[156:159], a[236:239], v[120:123]
    buffer_load_dwordx4 v6, s[16:19], s48 offen nt lds
    v_mfma_f32_16x16x32_bf16 v[120:123], a[152:155], a[232:235], v[120:123]
    s_waitcnt lgkmcnt(4)
    v_exp_f32 v244, v244
    v_mfma_f32_16x16x32_bf16 v[136:139], a[152:155], a[216:219], v[136:139]
    s_add_u32 m0, m0, s43
    ds_read_b64_tr_b16 a[232:233], v9 offset:33792
    v_mul_f32 v240, v240, v241
    v_mfma_f32_16x16x32_bf16 v[136:139], a[156:159], a[220:223], v[136:139]
    s_add_u32 s48, s48, s50
    ds_read_b64_tr_b16 a[234:235], v9 offset:34304
    v_mul_f32 v242, v242, v243
    v_mfma_f32_16x16x32_bf16 v[140:143], v[44:47], a[220:223], v[140:143]
    ds_read_b64_tr_b16 a[236:237], v10 offset:0
    v_cvt_pk_bf16_f32 v250, v240, v242
    v_mfma_f32_16x16x32_bf16 v[140:143], v[40:43], a[216:219], v[140:143]
    ds_read_b64_tr_b16 a[238:239], v10 offset:512
    v_fma_f32 v244, v244, s3, s3
    v_mfma_f32_16x16x32_bf16 v[144:147], a[8:11], a[216:219], v[144:147]
    v_rcp_f32 v244, v244
    v_mfma_f32_16x16x32_bf16 v[144:147], a[12:15], a[220:223], v[144:147]
    v_mul_f32 v244, v244, v245
    v_mul_f32 v246, v246, v175
    v_mfma_f32_16x16x32_bf16 v[148:151], a[84:87], a[220:223], v[148:151]
    buffer_load_dwordx4 v6, s[16:19], s48 offen nt lds
    v_mfma_f32_16x16x32_bf16 v[148:151], a[80:83], a[216:219], v[148:151]
    s_waitcnt lgkmcnt(4)
    v_exp_f32 v246, v246
    v_mfma_f32_16x16x32_bf16 v[164:167], a[80:83], a[224:227], v[164:167]
    s_add_u32 m0, m0, s43
    ds_read_b64_tr_b16 a[216:217], v9 offset:33824
    v_mul_f32 v247, v175, v207
    v_mfma_f32_16x16x32_bf16 v[164:167], a[84:87], a[228:231], v[164:167]
    s_add_u32 s49, s39, s42
    ds_read_b64_tr_b16 a[218:219], v9 offset:34336
    v_fma_f32 v246, v246, s3, s3
    v_mfma_f32_16x16x32_bf16 v[160:163], a[12:15], a[228:231], v[160:163]
    ds_read_b64_tr_b16 a[220:221], v10 offset:32
    v_fma_f32 v232, -v176, v176, s68
    v_mfma_f32_16x16x32_bf16 v[160:163], a[8:11], a[224:227], v[160:163]
    s_mul_i32 s39, s85, s40
    ds_read_b64_tr_b16 a[222:223], v10 offset:544
    v_mul_f32 v232, v232, v176
    v_mfma_f32_16x16x32_bf16 v[156:159], v[40:43], a[224:227], v[156:159]
    v_rcp_f32 v246, v246
    v_mfma_f32_16x16x32_bf16 v[156:159], v[44:47], a[228:231], v[156:159]
    s_waitcnt vmcnt(8)
    v_exp_f32 v232, v232
    v_mfma_f32_16x16x32_bf16 v[152:155], a[156:159], a[228:231], v[152:155]
    s_barrier
    buffer_load_dwordx4 v6, s[20:23], s49 offen nt lds
    v_mfma_f32_16x16x32_bf16 v[152:155], a[152:155], a[224:227], v[152:155]
    s_waitcnt lgkmcnt(4)
    v_mul_f32 v246, v246, v247
    v_cvt_pk_bf16_f32 v251, v244, v246
    v_mfma_f32_16x16x32_bf16 v[104:107], a[160:163], a[232:235], v[104:107]
    s_add_u32 m0, m0, s43
    ds_read_b64_tr_b16 a[224:225], v10 offset:4224
    v_mul_f32 v233, v176, v208
    v_mfma_f32_16x16x32_bf16 v[104:107], a[164:167], a[236:239], v[104:107]
    s_add_u32 s49, s49, s50
    ds_read_b64_tr_b16 a[226:227], v10 offset:4736
    v_fma_f32 v232, v232, s3, s3
    v_mfma_f32_16x16x32_bf16 v[108:111], v[52:55], a[236:239], v[108:111]
    ds_read_b64_tr_b16 a[228:229], v10 offset:8448
    v_fma_f32 v234, -v177, v177, s68
    v_mfma_f32_16x16x32_bf16 v[108:111], v[48:51], a[232:235], v[108:111]
    ds_read_b64_tr_b16 a[230:231], v10 offset:8960
    v_mul_f32 v234, v234, v177
    v_mfma_f32_16x16x32_bf16 v[112:115], a[16:19], a[232:235], v[112:115]
    v_rcp_f32 v232, v232
    v_mfma_f32_16x16x32_bf16 v[112:115], a[20:23], a[236:239], v[112:115]
    v_exp_f32 v234, v234
    v_mfma_f32_16x16x32_bf16 v[116:119], a[92:95], a[236:239], v[116:119]
    buffer_load_dwordx4 v6, s[20:23], s49 offen nt lds
    v_mfma_f32_16x16x32_bf16 v[116:119], a[88:91], a[232:235], v[116:119]
    s_waitcnt lgkmcnt(4)
    v_mul_f32 v232, v232, v233
    v_mul_f32 v235, v177, v209
    v_mfma_f32_16x16x32_bf16 v[132:135], a[88:91], a[216:219], v[132:135]
    s_add_u32 m0, m0, s43
    ds_read_b64_tr_b16 a[232:233], v10 offset:4256
    v_fma_f32 v234, v234, s3, s3
    v_mfma_f32_16x16x32_bf16 v[132:135], a[92:95], a[220:223], v[132:135]
    s_add_u32 s48, s39, s41
    ds_read_b64_tr_b16 a[234:235], v10 offset:4768
    v_fma_f32 v236, -v178, v178, s68
    v_mfma_f32_16x16x32_bf16 v[128:131], a[20:23], a[220:223], v[128:131]
    ds_read_b64_tr_b16 a[236:237], v10 offset:8480
    v_mul_f32 v236, v236, v178
    v_mfma_f32_16x16x32_bf16 v[128:131], a[16:19], a[216:219], v[128:131]
    ds_read_b64_tr_b16 a[238:239], v10 offset:8992
    v_mul_f32 v237, v178, v210
    v_mfma_f32_16x16x32_bf16 v[124:127], v[48:51], a[216:219], v[124:127]
    ds_write2st64_b64 v12, v[248:249], v[250:251] offset0:0 offset1:2
    v_mfma_f32_16x16x32_bf16 v[124:127], v[52:55], a[220:223], v[124:127]
    v_rcp_f32 v234, v234
    v_mfma_f32_16x16x32_bf16 v[120:123], a[164:167], a[220:223], v[120:123]
    buffer_load_dwordx4 v6, s[16:19], s48 offen nt lds
    v_mfma_f32_16x16x32_bf16 v[120:123], a[160:163], a[216:219], v[120:123]
    s_waitcnt lgkmcnt(5)
    v_exp_f32 v236, v236
    v_mfma_f32_16x16x32_bf16 v[136:139], a[160:163], a[224:227], v[136:139]
    s_add_u32 m0, m0, s43
    v_mul_f32 v234, v234, v235
    v_cvt_pk_bf16_f32 v252, v232, v234
    v_mfma_f32_16x16x32_bf16 v[136:139], a[164:167], a[228:231], v[136:139]
    s_add_u32 s48, s48, s50
    v_fma_f32 v236, v236, s3, s3
    v_fma_f32 v238, -v179, v179, s68
    v_mfma_f32_16x16x32_bf16 v[140:143], v[52:55], a[228:231], v[140:143]
    ds_read_b64_tr_b16 a[216:217], v10 offset:12672
    v_mul_f32 v238, v238, v179
    v_mfma_f32_16x16x32_bf16 v[140:143], v[48:51], a[224:227], v[140:143]
    ds_read_b64_tr_b16 a[218:219], v10 offset:13184
    v_mul_f32 v239, v179, v211
    v_mfma_f32_16x16x32_bf16 v[144:147], a[16:19], a[224:227], v[144:147]
    ds_read_b64_tr_b16 a[220:221], v10 offset:16896
    v_fma_f32 v240, -v180, v180, s68
    v_mfma_f32_16x16x32_bf16 v[144:147], a[20:23], a[228:231], v[144:147]
    ds_read_b64_tr_b16 a[222:223], v10 offset:17408
    v_mul_f32 v240, v240, v180
    v_mfma_f32_16x16x32_bf16 v[148:151], a[92:95], a[228:231], v[148:151]
    buffer_load_dwordx4 v6, s[16:19], s48 offen nt lds
    v_mfma_f32_16x16x32_bf16 v[148:151], a[88:91], a[224:227], v[148:151]
    s_waitcnt lgkmcnt(5)
    v_rcp_f32 v236, v236
    v_mfma_f32_16x16x32_bf16 v[164:167], a[88:91], a[232:235], v[164:167]
    s_add_u32 m0, m0, s43
    ds_read_b64_tr_b16 a[224:225], v10 offset:12704
    v_mul_f32 v236, v236, v237
    v_mfma_f32_16x16x32_bf16 v[164:167], a[92:95], a[236:239], v[164:167]
    s_add_u32 s49, s39, s42
    ds_read_b64_tr_b16 a[226:227], v10 offset:13216
    v_mul_f32 v241, v180, v212
    v_mfma_f32_16x16x32_bf16 v[160:163], a[20:23], a[236:239], v[160:163]
    ds_read_b64_tr_b16 a[228:229], v10 offset:16928
    v_fma_f32 v242, -v181, v181, s68
    v_mfma_f32_16x16x32_bf16 v[160:163], a[16:19], a[232:235], v[160:163]
    s_mul_i32 s39, s97, s40
    ds_read_b64_tr_b16 a[230:231], v10 offset:17440
    v_mul_f32 v242, v242, v181
    v_mfma_f32_16x16x32_bf16 v[156:159], v[48:51], a[232:235], v[156:159]
    v_exp_f32 v238, v238
    v_mfma_f32_16x16x32_bf16 v[156:159], v[52:55], a[236:239], v[156:159]
    s_waitcnt vmcnt(8)
    v_exp_f32 v240, v240
    v_mfma_f32_16x16x32_bf16 v[152:155], a[164:167], a[236:239], v[152:155]
    s_barrier
    buffer_load_dwordx4 v6, s[20:23], s49 offen nt lds
    v_mfma_f32_16x16x32_bf16 v[152:155], a[160:163], a[232:235], v[152:155]
    s_waitcnt lgkmcnt(4)
    v_exp_f32 v242, v242
    v_mfma_f32_16x16x32_bf16 v[104:107], a[168:171], a[216:219], v[104:107]
    s_add_u32 m0, m0, s43
    ds_read_b64_tr_b16 a[232:233], v10 offset:21120
    v_fma_f32 v238, v238, s3, s3
    v_mfma_f32_16x16x32_bf16 v[104:107], a[172:175], a[220:223], v[104:107]
    s_add_u32 s49, s49, s50
    ds_read_b64_tr_b16 a[234:235], v10 offset:21632
    v_fma_f32 v240, v240, s3, s3
    v_mfma_f32_16x16x32_bf16 v[108:111], v[60:63], a[220:223], v[108:111]
    ds_read_b64_tr_b16 a[236:237], v10 offset:25344
    v_mul_f32 v243, v181, v213
    v_mfma_f32_16x16x32_bf16 v[108:111], v[56:59], a[216:219], v[108:111]
    ds_read_b64_tr_b16 a[238:239], v10 offset:25856
    v_fma_f32 v242, v242, s3, s3
    v_mfma_f32_16x16x32_bf16 v[112:115], a[24:27], a[216:219], v[112:115]
    v_rcp_f32 v238, v238
    v_mfma_f32_16x16x32_bf16 v[112:115], a[28:31], a[220:223], v[112:115]
    v_rcp_f32 v240, v240
    v_mfma_f32_16x16x32_bf16 v[116:119], a[100:103], a[220:223], v[116:119]
    buffer_load_dwordx4 v6, s[20:23], s49 offen nt lds
    v_mfma_f32_16x16x32_bf16 v[116:119], a[96:99], a[216:219], v[116:119]
    s_waitcnt lgkmcnt(4)
    v_rcp_f32 v242, v242
    v_mfma_f32_16x16x32_bf16 v[132:135], a[96:99], a[224:227], v[132:135]
    s_add_u32 m0, m0, s43
    ds_read_b64_tr_b16 a[216:217], v10 offset:21152
    v_mul_f32 v238, v238, v239
    v_mfma_f32_16x16x32_bf16 v[132:135], a[100:103], a[228:231], v[132:135]
    s_add_u32 s48, s39, s41
    ds_read_b64_tr_b16 a[218:219], v10 offset:21664
    v_cvt_pk_bf16_f32 v253, v236, v238
    v_mfma_f32_16x16x32_bf16 v[128:131], a[28:31], a[228:231], v[128:131]
    ds_read_b64_tr_b16 a[220:221], v10 offset:25376
    v_mul_f32 v240, v240, v241
    v_mfma_f32_16x16x32_bf16 v[128:131], a[24:27], a[224:227], v[128:131]
    ds_read_b64_tr_b16 a[222:223], v10 offset:25888
    v_mul_f32 v242, v242, v243
    v_mfma_f32_16x16x32_bf16 v[124:127], v[56:59], a[224:227], v[124:127]
    v_cvt_pk_bf16_f32 v254, v240, v242
    v_fma_f32 v244, -v182, v182, s68
    v_mfma_f32_16x16x32_bf16 v[124:127], v[60:63], a[228:231], v[124:127]
    v_mul_f32 v244, v244, v182
    v_mul_f32 v245, v182, v214
    v_mfma_f32_16x16x32_bf16 v[120:123], a[172:175], a[228:231], v[120:123]
    buffer_load_dwordx4 v6, s[16:19], s48 offen nt lds
    v_mfma_f32_16x16x32_bf16 v[120:123], a[168:171], a[224:227], v[120:123]
    s_waitcnt lgkmcnt(4)
    v_exp_f32 v244, v244
    v_mfma_f32_16x16x32_bf16 v[136:139], a[168:171], a[232:235], v[136:139]
    s_add_u32 m0, m0, s43
    ds_read_b64_tr_b16 a[224:225], v10 offset:29568
    v_fma_f32 v244, v244, s3, s3
    v_mfma_f32_16x16x32_bf16 v[136:139], a[172:175], a[236:239], v[136:139]
    s_add_u32 s48, s48, s50
    ds_read_b64_tr_b16 a[226:227], v10 offset:30080
    v_fma_f32 v246, -v183, v183, s68
    v_mfma_f32_16x16x32_bf16 v[140:143], v[60:63], a[236:239], v[140:143]
    ds_read_b64_tr_b16 a[228:229], v10 offset:33792
    v_mul_f32 v246, v246, v183
    v_mfma_f32_16x16x32_bf16 v[140:143], v[56:59], a[232:235], v[140:143]
    ds_read_b64_tr_b16 a[230:231], v10 offset:34304
    v_mul_f32 v247, v183, v215
    v_mfma_f32_16x16x32_bf16 v[144:147], a[24:27], a[232:235], v[144:147]
    v_rcp_f32 v244, v244
    v_mfma_f32_16x16x32_bf16 v[144:147], a[28:31], a[236:239], v[144:147]
    ds_read_b128 a[144:147], v16 offset:0
    v_mul_f32 v244, v244, v245
    v_mfma_f32_16x16x32_bf16 v[148:151], a[100:103], a[236:239], v[148:151]
    buffer_load_dwordx4 v6, s[16:19], s48 offen nt lds
    v_mfma_f32_16x16x32_bf16 v[148:151], a[96:99], a[232:235], v[148:151]
    s_waitcnt lgkmcnt(5)
    v_exp_f32 v246, v246
    v_mfma_f32_16x16x32_bf16 v[164:167], a[96:99], a[216:219], v[164:167]
    s_add_u32 m0, m0, s43
    ds_read_b64_tr_b16 a[232:233], v10 offset:29600
    v_fma_f32 v246, v246, s3, s3
    v_mfma_f32_16x16x32_bf16 v[164:167], a[100:103], a[220:223], v[164:167]
    s_add_u32 s49, s39, s42
    ds_read_b64_tr_b16 a[234:235], v10 offset:30112
    v_fma_f32 v232, -v196, v196, s68
    v_mfma_f32_16x16x32_bf16 v[160:163], a[28:31], a[220:223], v[160:163]
    ds_read_b64_tr_b16 a[236:237], v10 offset:33824
    v_mul_f32 v232, v232, v196
    v_mfma_f32_16x16x32_bf16 v[160:163], a[24:27], a[216:219], v[160:163]
    s_mul_i32 s39, s99, s40
    ds_read_b64_tr_b16 a[238:239], v10 offset:34336
    v_mul_f32 v233, v196, v228
    v_mfma_f32_16x16x32_bf16 v[156:159], v[56:59], a[216:219], v[156:159]
    v_rcp_f32 v246, v246
    v_mfma_f32_16x16x32_bf16 v[156:159], v[60:63], a[220:223], v[156:159]
    s_waitcnt vmcnt(8)
    ds_read_b128 a[152:155], v16 offset:8192
    v_mul_f32 v246, v246, v247
    v_mfma_f32_16x16x32_bf16 v[152:155], a[172:175], a[220:223], v[152:155]
    s_barrier
    buffer_load_dwordx4 v6, s[20:23], s49 offen nt lds
    v_mfma_f32_16x16x32_bf16 v[152:155], a[168:171], a[216:219], v[152:155]
    s_waitcnt lgkmcnt(6)
    v_exp_f32 v232, v232
    v_mfma_f32_16x16x32_bf16 v[104:107], a[176:179], a[224:227], v[104:107]
    s_add_u32 m0, m0, s43
    ds_read_b64_tr_b16 a[216:217], v9 offset:0
    v_cvt_pk_bf16_f32 v255, v244, v246
    v_mfma_f32_16x16x32_bf16 v[104:107], a[180:183], a[228:231], v[104:107]
    s_add_u32 s49, s49, s50
    ds_read_b64_tr_b16 a[218:219], v9 offset:512
    v_fma_f32 v232, v232, s3, s3
    v_mfma_f32_16x16x32_bf16 v[108:111], v[68:71], a[228:231], v[108:111]
    ds_read_b64_tr_b16 a[220:221], v9 offset:4224
    v_fma_f32 v234, -v197, v197, s68
    v_mfma_f32_16x16x32_bf16 v[108:111], v[64:67], a[224:227], v[108:111]
    ds_read_b64_tr_b16 a[222:223], v9 offset:4736
    v_mul_f32 v234, v234, v197
    v_mfma_f32_16x16x32_bf16 v[112:115], a[32:35], a[224:227], v[112:115]
    v_rcp_f32 v232, v232
    v_mfma_f32_16x16x32_bf16 v[112:115], a[36:39], a[228:231], v[112:115]
    ds_read_b128 a[160:163], v16 offset:16384
    v_mul_f32 v232, v232, v233
    v_mfma_f32_16x16x32_bf16 v[116:119], a[108:111], a[228:231], v[116:119]
    buffer_load_dwordx4 v6, s[20:23], s49 offen nt lds
    v_mfma_f32_16x16x32_bf16 v[116:119], a[104:107], a[224:227], v[116:119]
    s_waitcnt lgkmcnt(6)
    v_exp_f32 v234, v234
    v_mfma_f32_16x16x32_bf16 v[132:135], a[104:107], a[232:235], v[132:135]
    s_add_u32 m0, m0, s43
    ds_read_b64_tr_b16 a[224:225], v9 offset:32
    v_mul_f32 v235, v197, v229
    v_mfma_f32_16x16x32_bf16 v[132:135], a[108:111], a[236:239], v[132:135]
    s_add_u32 s48, s39, s41
    ds_read_b64_tr_b16 a[226:227], v9 offset:544
    v_fma_f32 v234, v234, s3, s3
    v_mfma_f32_16x16x32_bf16 v[128:131], a[36:39], a[236:239], v[128:131]
    ds_read_b64_tr_b16 a[228:229], v9 offset:4256
    v_fma_f32 v236, -v198, v198, s68
    v_mfma_f32_16x16x32_bf16 v[128:131], a[32:35], a[232:235], v[128:131]
    ds_read_b64_tr_b16 a[230:231], v9 offset:4768
    v_mul_f32 v236, v236, v198
    v_mfma_f32_16x16x32_bf16 v[124:127], v[64:67], a[232:235], v[124:127]
    ds_write2st64_b64 v14, v[252:253], v[254:255] offset0:0 offset1:2
    v_mfma_f32_16x16x32_bf16 v[124:127], v[68:71], a[236:239], v[124:127]
    v_rcp_f32 v234, v234
    v_mfma_f32_16x16x32_bf16 v[120:123], a[180:183], a[236:239], v[120:123]
    buffer_load_dwordx4 v6, s[16:19], s48 offen nt lds
    v_mfma_f32_16x16x32_bf16 v[120:123], a[176:179], a[232:235], v[120:123]
    s_waitcnt lgkmcnt(6)
    v_exp_f32 v236, v236
    v_mfma_f32_16x16x32_bf16 v[136:139], a[176:179], a[216:219], v[136:139]
    s_add_u32 m0, m0, s43
    v_mul_f32 v234, v234, v235
    v_cvt_pk_bf16_f32 v248, v232, v234
    v_mfma_f32_16x16x32_bf16 v[136:139], a[180:183], a[220:223], v[136:139]
    s_add_u32 s48, s48, s50
    v_mul_f32 v237, v198, v230
    v_fma_f32 v236, v236, s3, s3
    v_mfma_f32_16x16x32_bf16 v[140:143], v[68:71], a[220:223], v[140:143]
    ds_read_b64_tr_b16 a[232:233], v9 offset:8448
    v_fma_f32 v238, -v199, v199, s68
    v_mfma_f32_16x16x32_bf16 v[140:143], v[64:67], a[216:219], v[140:143]
    ds_read_b64_tr_b16 a[234:235], v9 offset:8960
    v_mul_f32 v238, v238, v199
    v_mfma_f32_16x16x32_bf16 v[144:147], a[32:35], a[216:219], v[144:147]
    ds_read_b64_tr_b16 a[236:237], v9 offset:12672
    v_mul_f32 v239, v199, v231
    v_mfma_f32_16x16x32_bf16 v[144:147], a[36:39], a[220:223], v[144:147]
    ds_read_b64_tr_b16 a[238:239], v9 offset:13184
    v_fma_f32 v240, -v192, v192, s68
    v_mfma_f32_16x16x32_bf16 v[148:151], a[108:111], a[220:223], v[148:151]
    buffer_load_dwordx4 v6, s[16:19], s48 offen nt lds
    v_mfma_f32_16x16x32_bf16 v[148:151], a[104:107], a[216:219], v[148:151]
    s_waitcnt lgkmcnt(5)
    ds_read_b128 v[48:51], v16 offset:17408
    v_mul_f32 v240, v240, v192
    v_mfma_f32_16x16x32_bf16 v[164:167], a[104:107], a[224:227], v[164:167]
    s_add_u32 m0, m0, s43
    ds_read_b64_tr_b16 a[216:217], v9 offset:8480
    v_mul_f32 v241, v192, v224
    v_mfma_f32_16x16x32_bf16 v[164:167], a[108:111], a[228:231], v[164:167]
    s_add_u32 s49, s39, s42
    ds_read_b64_tr_b16 a[218:219], v9 offset:8992
    v_fma_f32 v242, -v193, v193, s68
    v_mfma_f32_16x16x32_bf16 v[160:163], a[36:39], a[228:231], v[160:163]
    ds_read_b64_tr_b16 a[220:221], v9 offset:12704
    v_mul_f32 v242, v242, v193
    v_mfma_f32_16x16x32_bf16 v[160:163], a[32:35], a[224:227], v[160:163]
    s_mul_i32 s39, s36, s40
    ds_read_b64_tr_b16 a[222:223], v9 offset:13216
    v_mul_f32 v243, v193, v225
    v_mfma_f32_16x16x32_bf16 v[156:159], v[64:67], a[224:227], v[156:159]
    v_rcp_f32 v236, v236
    v_mfma_f32_16x16x32_bf16 v[156:159], v[68:71], a[228:231], v[156:159]
    s_waitcnt vmcnt(8)
    ds_read_b128 v[40:43], v16 offset:9216
    v_mul_f32 v236, v236, v237
    v_mfma_f32_16x16x32_bf16 v[152:155], a[180:183], a[228:231], v[152:155]
    s_barrier
    buffer_load_dwordx4 v6, s[20:23], s49 offen nt lds
    v_mfma_f32_16x16x32_bf16 v[152:155], a[176:179], a[224:227], v[152:155]
    s_waitcnt lgkmcnt(6)
    v_exp_f32 v238, v238
    v_mfma_f32_16x16x32_bf16 v[104:107], a[184:187], a[232:235], v[104:107]
    s_add_u32 m0, m0, s43
    ds_read_b64_tr_b16 a[224:225], v9 offset:16896
    v_fma_f32 v238, v238, s3, s3
    v_mfma_f32_16x16x32_bf16 v[104:107], a[188:191], a[236:239], v[104:107]
    s_add_u32 s49, s49, s50
    ds_read_b64_tr_b16 a[226:227], v9 offset:17408
    v_fma_f32 v244, -v194, v194, s68
    v_mfma_f32_16x16x32_bf16 v[108:111], v[76:79], a[236:239], v[108:111]
    ds_read_b64_tr_b16 a[228:229], v9 offset:21120
    v_mul_f32 v244, v244, v194
    v_mfma_f32_16x16x32_bf16 v[108:111], v[72:75], a[232:235], v[108:111]
    ds_read_b64_tr_b16 a[230:231], v9 offset:21632
    v_mul_f32 v245, v194, v226
    v_mfma_f32_16x16x32_bf16 v[112:115], a[40:43], a[232:235], v[112:115]
    v_rcp_f32 v238, v238
    v_mfma_f32_16x16x32_bf16 v[112:115], a[44:47], a[236:239], v[112:115]
    ds_read_b128 v[32:35], v16 offset:1024
    v_mul_f32 v238, v238, v239
    v_mfma_f32_16x16x32_bf16 v[116:119], a[116:119], a[236:239], v[116:119]
    buffer_load_dwordx4 v6, s[20:23], s49 offen nt lds
    v_mfma_f32_16x16x32_bf16 v[116:119], a[112:115], a[232:235], v[116:119]
    s_waitcnt lgkmcnt(6)
    v_exp_f32 v240, v240
    v_mfma_f32_16x16x32_bf16 v[132:135], a[112:115], a[216:219], v[132:135]
    s_mov_b32 m0, s47
    ds_read_b64_tr_b16 a[232:233], v9 offset:16928
    v_cvt_pk_bf16_f32 v249, v236, v238
    v_mfma_f32_16x16x32_bf16 v[132:135], a[116:119], a[220:223], v[132:135]
    s_add_u32 s69, s62, 0
    ds_read_b64_tr_b16 a[234:235], v9 offset:17440
    v_fma_f32 v240, v240, s3, s3
    v_mfma_f32_16x16x32_bf16 v[128:131], a[44:47], a[220:223], v[128:131]
    ds_read_b64_tr_b16 a[236:237], v9 offset:21152
    v_fma_f32 v246, -v195, v195, s68
    v_mfma_f32_16x16x32_bf16 v[128:131], a[40:43], a[216:219], v[128:131]
    ds_read_b64_tr_b16 a[238:239], v9 offset:21664
    v_mul_f32 v246, v246, v195
    v_mfma_f32_16x16x32_bf16 v[124:127], v[72:75], a[216:219], v[124:127]
    v_rcp_f32 v240, v240
    v_mfma_f32_16x16x32_bf16 v[124:127], v[76:79], a[220:223], v[124:127]
    v_exp_f32 v242, v242
    v_mfma_f32_16x16x32_bf16 v[120:123], a[188:191], a[220:223], v[120:123]
    buffer_load_dwordx4 v5, s[24:27], s69 offen lds
    v_mfma_f32_16x16x32_bf16 v[120:123], a[184:187], a[216:219], v[120:123]
    s_waitcnt lgkmcnt(5)
    v_exp_f32 v244, v244
    v_mfma_f32_16x16x32_bf16 v[136:139], a[184:187], a[224:227], v[136:139]
    s_add_u32 m0, m0, s43
    ds_read_b64_tr_b16 a[216:217], v9 offset:25344
    v_mul_f32 v240, v240, v241
    v_mfma_f32_16x16x32_bf16 v[136:139], a[188:191], a[228:231], v[136:139]
    s_add_u32 s69, s69, s86
    ds_read_b64_tr_b16 a[218:219], v9 offset:25856
    v_fma_f32 v242, v242, s3, s3
    v_mfma_f32_16x16x32_bf16 v[140:143], v[76:79], a[228:231], v[140:143]
    ds_read_b64_tr_b16 a[220:221], v9 offset:29568
    v_fma_f32 v244, v244, s3, s3
    v_mfma_f32_16x16x32_bf16 v[140:143], v[72:75], a[224:227], v[140:143]
    ds_read_b64_tr_b16 a[222:223], v9 offset:30080
    v_mul_f32 v247, v195, v227
    v_mfma_f32_16x16x32_bf16 v[144:147], a[40:43], a[224:227], v[144:147]
    v_rcp_f32 v242, v242
    v_mfma_f32_16x16x32_bf16 v[144:147], a[44:47], a[228:231], v[144:147]
    ds_read_b128 a[0:3], v16 offset:2048
    v_mul_f32 v242, v242, v243
    v_mfma_f32_16x16x32_bf16 v[148:151], a[116:119], a[228:231], v[148:151]
    buffer_load_dwordx4 v5, s[24:27], s69 offen lds
    v_mfma_f32_16x16x32_bf16 v[148:151], a[112:115], a[224:227], v[148:151]
    s_waitcnt lgkmcnt(5)
    v_rcp_f32 v244, v244
    v_mfma_f32_16x16x32_bf16 v[164:167], a[112:115], a[232:235], v[164:167]
    s_add_u32 m0, m0, s43
    ds_read_b64_tr_b16 a[224:225], v9 offset:25376
    v_cvt_pk_bf16_f32 v250, v240, v242
    v_mfma_f32_16x16x32_bf16 v[164:167], a[116:119], a[236:239], v[164:167]
    s_add_u32 s69, s69, s86
    ds_read_b64_tr_b16 a[226:227], v9 offset:25888
    v_mul_f32 v244, v244, v245
    v_mfma_f32_16x16x32_bf16 v[160:163], a[44:47], a[236:239], v[160:163]
    ds_read_b64_tr_b16 a[228:229], v9 offset:29600
    v_fma_f32 v232, -v188, v188, s68
    v_mfma_f32_16x16x32_bf16 v[160:163], a[40:43], a[232:235], v[160:163]
    ds_read_b64_tr_b16 a[230:231], v9 offset:30112
    v_mul_f32 v232, v232, v188
    v_mfma_f32_16x16x32_bf16 v[156:159], v[72:75], a[232:235], v[156:159]
    v_exp_f32 v246, v246
    v_mfma_f32_16x16x32_bf16 v[156:159], v[76:79], a[236:239], v[156:159]
    s_waitcnt vmcnt(8)
    ds_read_b128 a[8:11], v16 offset:10240
    v_fma_f32 v246, v246, s3, s3
    v_mfma_f32_16x16x32_bf16 v[152:155], a[188:191], a[236:239], v[152:155]
    s_barrier
    buffer_load_dwordx4 v5, s[24:27], s69 offen lds
    v_mfma_f32_16x16x32_bf16 v[152:155], a[184:187], a[232:235], v[152:155]
    s_waitcnt lgkmcnt(6)
    v_rcp_f32 v246, v246
    v_mfma_f32_16x16x32_bf16 v[104:107], a[192:195], a[216:219], v[104:107]
    s_add_u32 m0, m0, s43
    ds_read_b64_tr_b16 a[232:233], v9 offset:33792
    v_mul_f32 v246, v246, v247
    v_mfma_f32_16x16x32_bf16 v[104:107], a[196:199], a[220:223], v[104:107]
    s_add_u32 s69, s69, s86
    ds_read_b64_tr_b16 a[234:235], v9 offset:34304
    v_cvt_pk_bf16_f32 v251, v244, v246
    v_mfma_f32_16x16x32_bf16 v[108:111], v[84:87], a[220:223], v[108:111]
    ds_read_b64_tr_b16 a[236:237], v10 offset:0
    v_mul_f32 v233, v188, v220
    v_mfma_f32_16x16x32_bf16 v[108:111], v[80:83], a[216:219], v[108:111]
    ds_read_b64_tr_b16 a[238:239], v10 offset:512
    v_fma_f32 v234, -v189, v189, s68
    v_mfma_f32_16x16x32_bf16 v[112:115], a[48:51], a[216:219], v[112:115]
    v_exp_f32 v232, v232
    v_mfma_f32_16x16x32_bf16 v[112:115], a[52:55], a[220:223], v[112:115]
    ds_read_b128 a[16:19], v16 offset:18432
    v_fma_f32 v232, v232, s3, s3
    v_mfma_f32_16x16x32_bf16 v[116:119], a[124:127], a[220:223], v[116:119]
    buffer_load_dwordx4 v5, s[24:27], s69 offen lds
    v_mfma_f32_16x16x32_bf16 v[116:119], a[120:123], a[216:219], v[116:119]
    s_waitcnt lgkmcnt(6)
    v_rcp_f32 v232, v232
    v_mfma_f32_16x16x32_bf16 v[132:135], a[120:123], a[224:227], v[132:135]
    s_add_u32 m0, m0, s43
    ds_read_b64_tr_b16 a[216:217], v9 offset:33824
    v_mul_f32 v232, v232, v233
    v_mfma_f32_16x16x32_bf16 v[132:135], a[124:127], a[228:231], v[132:135]
    s_add_u32 s69, s69, s86
    ds_read_b64_tr_b16 a[218:219], v9 offset:34336
    v_mul_f32 v234, v234, v189
    v_mfma_f32_16x16x32_bf16 v[128:131], a[52:55], a[228:231], v[128:131]
    ds_read_b64_tr_b16 a[220:221], v10 offset:32
    v_mul_f32 v235, v189, v221
    v_mfma_f32_16x16x32_bf16 v[128:131], a[48:51], a[224:227], v[128:131]
    ds_read_b64_tr_b16 a[222:223], v10 offset:544
    v_fma_f32 v236, -v190, v190, s68
    v_mfma_f32_16x16x32_bf16 v[124:127], v[80:83], a[224:227], v[124:127]
    ds_write2st64_b64 v15, v[248:249], v[250:251] offset0:2 offset1:0
    v_mfma_f32_16x16x32_bf16 v[124:127], v[84:87], a[228:231], v[124:127]
    v_exp_f32 v234, v234
    v_mfma_f32_16x16x32_bf16 v[120:123], a[196:199], a[228:231], v[120:123]
    buffer_load_dwordx4 v5, s[24:27], s69 offen lds
    v_mfma_f32_16x16x32_bf16 v[120:123], a[192:195], a[224:227], v[120:123]
    s_waitcnt lgkmcnt(6)
    v_fma_f32 v234, v234, s3, s3
    v_mul_f32 v236, v236, v190
    v_mfma_f32_16x16x32_bf16 v[136:139], a[192:195], a[232:235], v[136:139]
    s_add_u32 m0, m0, s43
    v_rcp_f32 v234, v234
    v_mfma_f32_16x16x32_bf16 v[136:139], a[196:199], a[236:239], v[136:139]
    s_add_u32 s69, s69, s86
    v_exp_f32 v236, v236
    v_mfma_f32_16x16x32_bf16 v[140:143], v[84:87], a[236:239], v[140:143]
    ds_read_b64_tr_b16 a[224:225], v10 offset:4224
    v_mul_f32 v234, v234, v235
    v_mfma_f32_16x16x32_bf16 v[140:143], v[80:83], a[232:235], v[140:143]
    ds_read_b64_tr_b16 a[226:227], v10 offset:4736
    v_cvt_pk_bf16_f32 v252, v232, v234
    v_mfma_f32_16x16x32_bf16 v[144:147], a[48:51], a[232:235], v[144:147]
    ds_read_b64_tr_b16 a[228:229], v10 offset:8448
    v_mul_f32 v237, v190, v222
    v_mfma_f32_16x16x32_bf16 v[144:147], a[52:55], a[236:239], v[144:147]
    ds_read_b64_tr_b16 a[230:231], v10 offset:8960
    v_fma_f32 v236, v236, s3, s3
    v_mfma_f32_16x16x32_bf16 v[148:151], a[124:127], a[236:239], v[148:151]
    buffer_load_dwordx4 v5, s[24:27], s69 offen lds
    v_mfma_f32_16x16x32_bf16 v[148:151], a[120:123], a[232:235], v[148:151]
    s_waitcnt lgkmcnt(5)
    ds_read_b128 a[88:91], v16 offset:19456
    v_fma_f32 v238, -v191, v191, s68
    v_mfma_f32_16x16x32_bf16 v[164:167], a[120:123], a[216:219], v[164:167]
    s_add_u32 m0, m0, s43
    ds_read_b64_tr_b16 a[232:233], v10 offset:4256
    v_mul_f32 v238, v238, v191
    v_mfma_f32_16x16x32_bf16 v[164:167], a[124:127], a[220:223], v[164:167]
    s_add_u32 s69, s69, s86
    ds_read_b64_tr_b16 a[234:235], v10 offset:4768
    v_mul_f32 v239, v191, v223
    v_mfma_f32_16x16x32_bf16 v[160:163], a[52:55], a[220:223], v[160:163]
    ds_read_b64_tr_b16 a[236:237], v10 offset:8480
    v_fma_f32 v240, -v184, v184, s68
    v_mfma_f32_16x16x32_bf16 v[160:163], a[48:51], a[216:219], v[160:163]
    ds_read_b64_tr_b16 a[238:239], v10 offset:8992
    v_mul_f32 v240, v240, v184
    v_mfma_f32_16x16x32_bf16 v[156:159], v[80:83], a[216:219], v[156:159]
    v_rcp_f32 v236, v236
    v_mfma_f32_16x16x32_bf16 v[156:159], v[84:87], a[220:223], v[156:159]
    s_waitcnt vmcnt(8)
    ds_read_b128 a[80:83], v16 offset:11264
    v_mul_f32 v236, v236, v237
    v_mfma_f32_16x16x32_bf16 v[152:155], a[196:199], a[220:223], v[152:155]
    s_barrier
    buffer_load_dwordx4 v5, s[24:27], s69 offen lds
    v_mfma_f32_16x16x32_bf16 v[152:155], a[192:195], a[216:219], v[152:155]
    s_waitcnt lgkmcnt(6)
    v_exp_f32 v238, v238
    v_mfma_f32_16x16x32_bf16 v[104:107], a[200:203], a[224:227], v[104:107]
    s_add_u32 m0, m0, s43
    ds_read_b64_tr_b16 a[216:217], v10 offset:12672
    v_fma_f32 v238, v238, s3, s3
    v_mfma_f32_16x16x32_bf16 v[104:107], a[204:207], a[228:231], v[104:107]
    s_add_u32 s69, s69, s86
    ds_read_b64_tr_b16 a[218:219], v10 offset:13184
    v_mul_f32 v241, v184, v216
    v_mfma_f32_16x16x32_bf16 v[108:111], v[92:95], a[228:231], v[108:111]
    ds_read_b64_tr_b16 a[220:221], v10 offset:16896
    v_fma_f32 v242, -v185, v185, s68
    v_mfma_f32_16x16x32_bf16 v[108:111], v[88:91], a[224:227], v[108:111]
    ds_read_b64_tr_b16 a[222:223], v10 offset:17408
    v_mul_f32 v242, v242, v185
    v_mfma_f32_16x16x32_bf16 v[112:115], a[56:59], a[224:227], v[112:115]
    v_rcp_f32 v238, v238
    v_mfma_f32_16x16x32_bf16 v[112:115], a[60:63], a[228:231], v[112:115]
    ds_read_b128 a[72:75], v16 offset:3072
    v_mul_f32 v238, v238, v239
    v_mfma_f32_16x16x32_bf16 v[116:119], a[132:135], a[228:231], v[116:119]
    buffer_load_dwordx4 v5, s[24:27], s69 offen lds
    v_mfma_f32_16x16x32_bf16 v[116:119], a[128:131], a[224:227], v[116:119]
    s_waitcnt lgkmcnt(6)
    v_exp_f32 v240, v240
    v_mfma_f32_16x16x32_bf16 v[132:135], a[128:131], a[232:235], v[132:135]
    s_add_u32 m0, m0, s43
    ds_read_b64_tr_b16 a[224:225], v10 offset:12704
    v_cvt_pk_bf16_f32 v253, v236, v238
    v_mfma_f32_16x16x32_bf16 v[132:135], a[132:135], a[236:239], v[132:135]
    s_add_u32 s69, s69, s86
    ds_read_b64_tr_b16 a[226:227], v10 offset:13216
    v_fma_f32 v240, v240, s3, s3
    v_mfma_f32_16x16x32_bf16 v[128:131], a[60:63], a[236:239], v[128:131]
    ds_read_b64_tr_b16 a[228:229], v10 offset:16928
    v_mul_f32 v243, v185, v217
    v_mfma_f32_16x16x32_bf16 v[128:131], a[56:59], a[232:235], v[128:131]
    ds_read_b64_tr_b16 a[230:231], v10 offset:17440
    v_fma_f32 v244, -v186, v186, s68
    v_mfma_f32_16x16x32_bf16 v[124:127], v[88:91], a[232:235], v[124:127]
    v_rcp_f32 v240, v240
    v_mfma_f32_16x16x32_bf16 v[124:127], v[92:95], a[236:239], v[124:127]
    v_exp_f32 v242, v242
    v_mfma_f32_16x16x32_bf16 v[120:123], a[204:207], a[236:239], v[120:123]
    buffer_load_dwordx4 v5, s[24:27], s69 offen lds
    v_mfma_f32_16x16x32_bf16 v[120:123], a[200:203], a[232:235], v[120:123]
    s_waitcnt lgkmcnt(5)
    v_mul_f32 v240, v240, v241
    v_fma_f32 v242, v242, s3, s3
    v_mfma_f32_16x16x32_bf16 v[136:139], a[200:203], a[216:219], v[136:139]
    s_add_u32 m0, m0, s43
    ds_read_b64_tr_b16 a[232:233], v10 offset:21120
    v_mul_f32 v244, v244, v186
    v_mfma_f32_16x16x32_bf16 v[136:139], a[204:207], a[220:223], v[136:139]
    s_add_u32 s69, s62, 128
    ds_read_b64_tr_b16 a[234:235], v10 offset:21632
    v_mul_f32 v245, v186, v218
    v_mfma_f32_16x16x32_bf16 v[140:143], v[92:95], a[220:223], v[140:143]
    ds_read_b64_tr_b16 a[236:237], v10 offset:25344
    v_fma_f32 v246, -v187, v187, s68
    v_mfma_f32_16x16x32_bf16 v[140:143], v[88:91], a[216:219], v[140:143]
    ds_read_b64_tr_b16 a[238:239], v10 offset:25856
    v_mul_f32 v246, v246, v187
    v_mfma_f32_16x16x32_bf16 v[144:147], a[56:59], a[216:219], v[144:147]
    ds_read_b128 a[148:151], v16 offset:4096
    v_mul_f32 v247, v187, v219
    v_mfma_f32_16x16x32_bf16 v[144:147], a[60:63], a[220:223], v[144:147]
    v_rcp_f32 v242, v242
    v_mfma_f32_16x16x32_bf16 v[148:151], a[132:135], a[220:223], v[148:151]
    buffer_load_dwordx4 v5, s[24:27], s69 offen lds
    v_mfma_f32_16x16x32_bf16 v[148:151], a[128:131], a[216:219], v[148:151]
    s_waitcnt lgkmcnt(5)
    ds_read_b128 a[156:159], v16 offset:12288
    v_mul_f32 v242, v242, v243
    v_mfma_f32_16x16x32_bf16 v[164:167], a[128:131], a[224:227], v[164:167]
    s_add_u32 m0, m0, s43
    ds_read_b64_tr_b16 a[216:217], v10 offset:21152
    v_cvt_pk_bf16_f32 v254, v240, v242
    v_mfma_f32_16x16x32_bf16 v[164:167], a[132:135], a[228:231], v[164:167]
    s_add_u32 s69, s69, s86
    ds_read_b64_tr_b16 a[218:219], v10 offset:21664
    v_lshrrev_b32 v20, 4, v29
    v_mfma_f32_16x16x32_bf16 v[160:163], a[60:63], a[228:231], v[160:163]
    ds_read_b64_tr_b16 a[220:221], v10 offset:25376
    v_mul_u32_u24 v20, 9088, v20
    v_mfma_f32_16x16x32_bf16 v[160:163], a[56:59], a[224:227], v[160:163]
    ds_read_b64_tr_b16 a[222:223], v10 offset:25888
    v_add_u32 v20, v20, v1
    v_mfma_f32_16x16x32_bf16 v[156:159], v[88:91], a[224:227], v[156:159]
    ds_read_b128 a[164:167], v16 offset:20480
    v_mfma_f32_16x16x32_bf16 v[156:159], v[92:95], a[228:231], v[156:159]
    s_waitcnt vmcnt(7)
    v_exp_f32 v244, v244
    v_mfma_f32_16x16x32_bf16 v[152:155], a[204:207], a[228:231], v[152:155]
    s_barrier
    buffer_load_dwordx4 v5, s[24:27], s69 offen lds
    v_mfma_f32_16x16x32_bf16 v[152:155], a[200:203], a[224:227], v[152:155]
    s_waitcnt lgkmcnt(7)
    ds_read_b128 v[52:55], v16 offset:21504
    v_fma_f32 v244, v244, s3, s3
    v_mfma_f32_16x16x32_bf16 v[104:107], a[208:211], a[232:235], v[104:107]
    s_add_u32 m0, m0, s43
    ds_read_b64_tr_b16 a[224:225], v10 offset:29568
    v_mfma_f32_16x16x32_bf16 v[168:171], a[212:215], a[236:239], v[104:107]
    s_add_u32 s69, s69, s86
    ds_read_b64_tr_b16 a[226:227], v10 offset:30080
    v_mfma_f32_16x16x32_bf16 v[108:111], v[100:103], a[236:239], v[108:111]
    ds_read_b64_tr_b16 a[228:229], v10 offset:33792
    v_mfma_f32_16x16x32_bf16 v[172:175], v[96:99], a[232:235], v[108:111]
    ds_read_b64_tr_b16 a[230:231], v10 offset:34304
    v_mfma_f32_16x16x32_bf16 v[112:115], a[64:67], a[232:235], v[112:115]
    ds_read_b128 v[44:47], v16 offset:13312
    v_mfma_f32_16x16x32_bf16 v[176:179], a[68:71], a[236:239], v[112:115]
    v_rcp_f32 v244, v244
    v_mfma_f32_16x16x32_bf16 v[116:119], a[140:143], a[236:239], v[116:119]
    buffer_load_dwordx4 v5, s[24:27], s69 offen lds
    v_mfma_f32_16x16x32_bf16 v[180:183], a[136:139], a[232:235], v[116:119]
    s_waitcnt lgkmcnt(7)
    ds_read_b128 v[36:39], v16 offset:5120
    v_mul_f32 v244, v244, v245
    v_mfma_f32_16x16x32_bf16 v[132:135], a[136:139], a[216:219], v[132:135]
    s_add_u32 m0, m0, s43
    ds_read_b64_tr_b16 a[232:233], v10 offset:29600
    v_mfma_f32_16x16x32_bf16 v[196:199], a[140:143], a[220:223], v[132:135]
    s_add_u32 s69, s69, s86
    ds_read_b64_tr_b16 a[234:235], v10 offset:30112
    v_mfma_f32_16x16x32_bf16 v[128:131], a[68:71], a[220:223], v[128:131]
    ds_read_b64_tr_b16 a[236:237], v10 offset:33824
    v_mfma_f32_16x16x32_bf16 v[192:195], a[64:67], a[216:219], v[128:131]
    ds_read_b64_tr_b16 a[238:239], v10 offset:34336
    v_mfma_f32_16x16x32_bf16 v[124:127], v[96:99], a[216:219], v[124:127]
    ds_read_b128 a[4:7], v16 offset:6144
    v_mfma_f32_16x16x32_bf16 v[188:191], v[100:103], a[220:223], v[124:127]
    v_exp_f32 v246, v246
    v_mfma_f32_16x16x32_bf16 v[120:123], a[212:215], a[220:223], v[120:123]
    buffer_load_dwordx4 v5, s[24:27], s69 offen lds
    v_mfma_f32_16x16x32_bf16 v[184:187], a[208:211], a[216:219], v[120:123]
    s_waitcnt lgkmcnt(7)
    ds_read_b128 a[12:15], v16 offset:14336
    v_fma_f32 v246, v246, s3, s3
    v_mfma_f32_16x16x32_bf16 v[136:139], a[208:211], a[224:227], v[136:139]
    s_add_u32 m0, m0, s43
    ds_read_b64_tr_b16 a[216:217], v11 offset:0
    v_mfma_f32_16x16x32_bf16 v[200:203], a[212:215], a[228:231], v[136:139]
    s_add_u32 s69, s69, s86
    ds_read_b64_tr_b16 a[218:219], v11 offset:2112
    v_mfma_f32_16x16x32_bf16 v[140:143], v[100:103], a[228:231], v[140:143]
    ds_read_b64_tr_b16 a[220:221], v11 offset:4224
    v_mfma_f32_16x16x32_bf16 v[204:207], v[96:99], a[224:227], v[140:143]
    ds_read_b64_tr_b16 a[222:223], v11 offset:6336
    v_mfma_f32_16x16x32_bf16 v[144:147], a[64:67], a[224:227], v[144:147]
    ds_read_b128 a[20:23], v16 offset:22528
    v_mfma_f32_16x16x32_bf16 v[208:211], a[68:71], a[228:231], v[144:147]
    v_rcp_f32 v246, v246
    v_mfma_f32_16x16x32_bf16 v[148:151], a[140:143], a[228:231], v[148:151]
    buffer_load_dwordx4 v5, s[24:27], s69 offen lds
    v_mfma_f32_16x16x32_bf16 v[212:215], a[136:139], a[224:227], v[148:151]
    s_waitcnt lgkmcnt(7)
    ds_read_b128 a[92:95], v16 offset:23552
    v_mul_f32 v246, v246, v247
    v_mfma_f32_16x16x32_bf16 v[164:167], a[136:139], a[232:235], v[164:167]
    s_add_u32 m0, m0, s43
    ds_read_b64_tr_b16 a[224:225], v11 offset:8448
    v_cvt_pk_bf16_f32 v255, v244, v246
    v_mfma_f32_16x16x32_bf16 v[228:231], a[140:143], a[236:239], v[164:167]
    s_add_u32 s69, s69, s86
    ds_read_b64_tr_b16 a[226:227], v11 offset:10560
    v_mfma_f32_16x16x32_bf16 v[160:163], a[68:71], a[236:239], v[160:163]
    ds_read_b128 a[84:87], v16 offset:15360
    v_mfma_f32_16x16x32_bf16 v[224:227], a[64:67], a[232:235], v[160:163]
    ds_read_b128 a[76:79], v16 offset:7168
    v_mfma_f32_16x16x32_bf16 v[156:159], v[96:99], a[232:235], v[156:159]
    s_waitcnt lgkmcnt(6)
    ds_write2st64_b64 v13, v[252:253], v[254:255] offset0:2 offset1:0
    v_mfma_f32_16x16x32_bf16 v[220:223], v[100:103], a[236:239], v[156:159]
    s_waitcnt vmcnt(8)
    v_mfma_f32_16x16x32_bf16 v[152:155], a[212:215], a[236:239], v[152:155]
    s_barrier
    buffer_load_dwordx4 v5, s[24:27], s69 offen lds
    v_mfma_f32_16x16x32_bf16 v[216:219], a[208:211], a[232:235], v[152:155]
    s_branch L_k_d
L_k_s:
    v_mfma_f32_16x16x32_bf16 v[104:107], a[144:147], a[216:219], 0
    s_add_u32 s48, s39, s41
    v_fma_f32 v232, -v168, v168, s68
    v_mul_f32 v232, v232, v168
    v_exp_f32 v232, v232
    v_mfma_f32_16x16x32_bf16 v[104:107], a[148:151], a[220:223], v[104:107]
    s_mul_i32 s39, s84, s40
    buffer_load_dwordx4 v6, s[16:19], s48 offen nt lds
    v_mul_f32 v233, v168, v200
    v_fma_f32 v232, v232, s3, s3
    v_mfma_f32_16x16x32_bf16 v[108:111], v[36:39], a[220:223], 0
    s_lshl2_add_u32 s63, s46, s44
    ds_read_b64_tr_b16 a[232:233], v9 offset:8448
    v_rcp_f32 v232, v232
    v_fma_f32 v234, -v169, v169, s68
    v_mfma_f32_16x16x32_bf16 v[108:111], v[32:35], a[216:219], v[108:111]
    s_add_u32 m0, m0, s43
    ds_read_b64_tr_b16 a[234:235], v9 offset:8960
    v_mul_f32 v232, v232, v233
    v_mul_f32 v234, v234, v169
    v_mul_f32 v235, v169, v201
    v_mfma_f32_16x16x32_bf16 v[112:115], a[0:3], a[216:219], 0
    s_add_u32 s48, s48, s50
    ds_read_b64_tr_b16 a[236:237], v9 offset:12672
    v_exp_f32 v234, v234
    v_fma_f32 v236, -v170, v170, s68
    v_mfma_f32_16x16x32_bf16 v[112:115], a[4:7], a[220:223], v[112:115]
    s_xor_b32 s64, s63, 1
    ds_read_b64_tr_b16 a[238:239], v9 offset:13184
    v_fma_f32 v234, v234, s3, s3
    v_rcp_f32 v234, v234
    v_mfma_f32_16x16x32_bf16 v[116:119], a[76:79], a[220:223], 0
    s_mul_i32 s63, s63, 37376
    buffer_load_dwordx4 v6, s[16:19], s48 offen nt lds
    v_mul_f32 v234, v234, v235
    v_cvt_pk_bf16_f32 v248, v232, v234
    v_mfma_f32_16x16x32_bf16 v[116:119], a[72:75], a[216:219], v[116:119]
    s_waitcnt lgkmcnt(4)
    v_mul_f32 v236, v236, v170
    v_exp_f32 v236, v236
    v_mul_f32 v237, v170, v202
    v_mfma_f32_16x16x32_bf16 v[132:135], a[72:75], a[224:227], 0
    s_add_u32 m0, m0, s43
    ds_read_b64_tr_b16 a[216:217], v9 offset:8480
    v_fma_f32 v236, v236, s3, s3
    v_rcp_f32 v236, v236
    v_mfma_f32_16x16x32_bf16 v[132:135], a[76:79], a[228:231], v[132:135]
    s_add_u32 s48, s39, s41
    ds_read_b64_tr_b16 a[218:219], v9 offset:8992
    v_mul_f32 v236, v236, v237
    v_fma_f32 v238, -v171, v171, s68
    v_mul_f32 v238, v238, v171
    v_mfma_f32_16x16x32_bf16 v[128:131], a[4:7], a[228:231], 0
    s_mul_i32 s64, s64, 37376
    ds_read_b64_tr_b16 a[220:221], v9 offset:12704
    v_exp_f32 v238, v238
    v_mul_f32 v239, v171, v203
    v_mfma_f32_16x16x32_bf16 v[128:131], a[0:3], a[224:227], v[128:131]
    s_and_b32 s65, s44, 1
    ds_read_b64_tr_b16 a[222:223], v9 offset:13216
    v_fma_f32 v238, v238, s3, s3
    v_rcp_f32 v238, v238
    v_mfma_f32_16x16x32_bf16 v[124:127], v[32:35], a[224:227], 0
    s_lshl_b32 s65, s65, 6
    v_mul_f32 v238, v238, v239
    v_cvt_pk_bf16_f32 v249, v236, v238
    v_fma_f32 v240, -v172, v172, s68
    v_mul_f32 v240, v240, v172
    v_mfma_f32_16x16x32_bf16 v[124:127], v[36:39], a[228:231], v[124:127]
    s_add_u32 s65, s65, s60
    v_exp_f32 v240, v240
    v_mul_f32 v241, v172, v204
    v_fma_f32 v242, -v173, v173, s68
    v_mfma_f32_16x16x32_bf16 v[120:123], a[148:151], a[228:231], 0
    s_lshl_b32 s65, s65, 3
    buffer_load_dwordx4 v6, s[16:19], s48 offen nt lds
    v_fma_f32 v240, v240, s3, s3
    v_mul_f32 v242, v242, v173
    v_mfma_f32_16x16x32_bf16 v[120:123], a[144:147], a[224:227], v[120:123]
    s_waitcnt lgkmcnt(4)
    v_rcp_f32 v240, v240
    v_exp_f32 v242, v242
    v_mfma_f32_16x16x32_bf16 v[104:107], a[192:195], a[232:235], v[104:107]
    s_add_u32 m0, m0, s43
    ds_read_b64_tr_b16 a[224:225], v9 offset:16896
    v_mul_f32 v240, v240, v241
    v_mul_f32 v243, v173, v205
    v_fma_f32 v242, v242, s3, s3
    v_mfma_f32_16x16x32_bf16 v[104:107], a[196:199], a[236:239], v[104:107]
    s_add_u32 s48, s48, s50
    ds_read_b64_tr_b16 a[226:227], v9 offset:17408
    v_rcp_f32 v242, v242
    v_fma_f32 v244, -v174, v174, s68
    v_mfma_f32_16x16x32_bf16 v[108:111], v[84:87], a[236:239], v[108:111]
    s_add_u32 s65, s65, 5224448
    ds_read_b64_tr_b16 a[228:229], v9 offset:21120
    v_mul_f32 v242, v242, v243
    v_cvt_pk_bf16_f32 v250, v240, v242
    v_mul_f32 v244, v244, v174
    v_mfma_f32_16x16x32_bf16 v[108:111], v[80:83], a[232:235], v[108:111]
    s_add_u32 s76, s65, s63
    ds_read_b64_tr_b16 a[230:231], v9 offset:21632
    v_exp_f32 v244, v244
    v_mul_f32 v245, v174, v206
    v_mfma_f32_16x16x32_bf16 v[112:115], a[48:51], a[232:235], v[112:115]
    s_add_u32 s77, s65, s64
    v_fma_f32 v244, v244, s3, s3
    v_rcp_f32 v244, v244
    v_fma_f32 v246, -v175, v175, s68
    v_mfma_f32_16x16x32_bf16 v[112:115], a[52:55], a[236:239], v[112:115]
    s_add_u32 s78, s76, 256
    v_mul_f32 v244, v244, v245
    v_mul_f32 v246, v246, v175
    v_exp_f32 v246, v246
    v_mfma_f32_16x16x32_bf16 v[116:119], a[124:127], a[236:239], v[116:119]
    s_add_u32 s79, s77, 256
    buffer_load_dwordx4 v6, s[16:19], s48 offen nt lds
    v_mul_f32 v247, v175, v207
    v_fma_f32 v246, v246, s3, s3
    v_mfma_f32_16x16x32_bf16 v[116:119], a[120:123], a[232:235], v[116:119]
    s_waitcnt lgkmcnt(4)
    v_rcp_f32 v246, v246
    v_fma_f32 v232, -v176, v176, s68
    v_mul_f32 v232, v232, v176
    v_mfma_f32_16x16x32_bf16 v[132:135], a[120:123], a[216:219], v[132:135]
    s_mov_b32 m0, s47
    ds_read_b64_tr_b16 a[232:233], v9 offset:16928
    v_exp_f32 v232, v232
    v_mul_f32 v246, v246, v247
    v_mfma_f32_16x16x32_bf16 v[132:135], a[124:127], a[220:223], v[132:135]
    s_add_u32 s69, s62, 0
    ds_read_b64_tr_b16 a[234:235], v9 offset:17440
    v_cvt_pk_bf16_f32 v251, v244, v246
    v_mul_f32 v233, v176, v208
    v_fma_f32 v232, v232, s3, s3
    v_mfma_f32_16x16x32_bf16 v[128:131], a[52:55], a[220:223], v[128:131]
    s_mov_b32 s80, 536870912
    ds_read_b64_tr_b16 a[236:237], v9 offset:21152
    v_rcp_f32 v232, v232
    v_fma_f32 v234, -v177, v177, s68
    v_mfma_f32_16x16x32_bf16 v[128:131], a[48:51], a[216:219], v[128:131]
    s_mov_b32 s81, 536870912
    ds_read_b64_tr_b16 a[238:239], v9 offset:21664
    v_mul_f32 v232, v232, v233
    v_mul_f32 v234, v234, v177
    v_mul_f32 v235, v177, v209
    v_mfma_f32_16x16x32_bf16 v[124:127], v[80:83], a[216:219], v[124:127]
    s_mov_b32 s82, 536870912
    ds_write2st64_b64 v12, v[248:249], v[250:251] offset0:0 offset1:2
    v_mfma_f32_16x16x32_bf16 v[124:127], v[84:87], a[220:223], v[124:127]
    s_waitcnt vmcnt(9)
    v_exp_f32 v234, v234
    v_fma_f32 v236, -v178, v178, s68
    v_mul_f32 v236, v236, v178
    v_mfma_f32_16x16x32_bf16 v[120:123], a[196:199], a[220:223], v[120:123]
    s_barrier
    buffer_load_dwordx4 v5, s[24:27], s69 offen lds
    v_exp_f32 v236, v236
    v_mfma_f32_16x16x32_bf16 v[120:123], a[192:195], a[216:219], v[120:123]
    s_waitcnt lgkmcnt(5)
    v_fma_f32 v234, v234, s3, s3
    v_rcp_f32 v234, v234
    v_mul_f32 v237, v178, v210
    v_mfma_f32_16x16x32_bf16 v[104:107], a[152:155], a[224:227], v[104:107]
    s_add_u32 m0, m0, s43
    ds_read_b64_tr_b16 a[216:217], v9 offset:25344
    v_mul_f32 v234, v234, v235
    v_cvt_pk_bf16_f32 v252, v232, v234
    v_fma_f32 v236, v236, s3, s3
    v_mfma_f32_16x16x32_bf16 v[104:107], a[156:159], a[228:231], v[104:107]
    s_add_u32 s69, s69, s86
    ds_read_b64_tr_b16 a[218:219], v9 offset:25856
    v_rcp_f32 v236, v236
    v_fma_f32 v238, -v179, v179, s68
    v_mfma_f32_16x16x32_bf16 v[108:111], v[44:47], a[228:231], v[108:111]
    s_mov_b32 s83, 536870912
    ds_read_b64_tr_b16 a[220:221], v9 offset:29568
    v_mul_f32 v236, v236, v237
    v_mul_f32 v238, v238, v179
    v_mul_f32 v239, v179, v211
    v_mfma_f32_16x16x32_bf16 v[108:111], v[40:43], a[224:227], v[108:111]
    s_mov_b32 s72, 1074302617
    ds_read_b64_tr_b16 a[222:223], v9 offset:30080
    v_exp_f32 v238, v238
    v_fma_f32 v240, -v180, v180, s68
    v_mfma_f32_16x16x32_bf16 v[112:115], a[8:11], a[224:227], v[112:115]
    v_fma_f32 v238, v238, s3, s3
    v_rcp_f32 v238, v238
    v_mul_f32 v240, v240, v180
    v_mfma_f32_16x16x32_bf16 v[112:115], a[12:15], a[228:231], v[112:115]
    v_exp_f32 v240, v240
    v_mul_f32 v238, v238, v239
    v_cvt_pk_bf16_f32 v253, v236, v238
    v_mfma_f32_16x16x32_bf16 v[116:119], a[84:87], a[228:231], v[116:119]
    buffer_load_dwordx4 v5, s[24:27], s69 offen lds
    v_mul_f32 v241, v180, v212
    v_fma_f32 v240, v240, s3, s3
    v_mfma_f32_16x16x32_bf16 v[116:119], a[80:83], a[224:227], v[116:119]
    s_waitcnt lgkmcnt(5)
    v_rcp_f32 v240, v240
    v_fma_f32 v242, -v181, v181, s68
    v_mul_f32 v242, v242, v181
    v_mfma_f32_16x16x32_bf16 v[132:135], a[80:83], a[232:235], v[132:135]
    s_add_u32 m0, m0, s43
    ds_read_b64_tr_b16 a[224:225], v9 offset:25376
    v_exp_f32 v242, v242
    v_mul_f32 v240, v240, v241
    v_mfma_f32_16x16x32_bf16 v[132:135], a[84:87], a[236:239], v[132:135]
    s_add_u32 s69, s69, s86
    ds_read_b64_tr_b16 a[226:227], v9 offset:25888
    v_mul_f32 v243, v181, v213
    v_fma_f32 v242, v242, s3, s3
    v_fma_f32 v244, -v182, v182, s68
    v_mfma_f32_16x16x32_bf16 v[128:131], a[12:15], a[236:239], v[128:131]
    ds_read_b64_tr_b16 a[228:229], v9 offset:29600
    v_rcp_f32 v242, v242
    v_mul_f32 v244, v244, v182
    v_mfma_f32_16x16x32_bf16 v[128:131], a[8:11], a[232:235], v[128:131]
    ds_read_b64_tr_b16 a[230:231], v9 offset:30112
    v_exp_f32 v244, v244
    v_mul_f32 v242, v242, v243
    v_mfma_f32_16x16x32_bf16 v[124:127], v[40:43], a[232:235], v[124:127]
    v_cvt_pk_bf16_f32 v254, v240, v242
    v_mul_f32 v245, v182, v214
    v_fma_f32 v244, v244, s3, s3
    v_fma_f32 v246, -v183, v183, s68
    v_mfma_f32_16x16x32_bf16 v[124:127], v[44:47], a[236:239], v[124:127]
    v_rcp_f32 v244, v244
    v_mul_f32 v246, v246, v183
    v_mul_f32 v247, v183, v215
    v_mfma_f32_16x16x32_bf16 v[120:123], a[156:159], a[236:239], v[120:123]
    buffer_load_dwordx4 v5, s[24:27], s69 offen lds
    v_exp_f32 v246, v246
    v_mfma_f32_16x16x32_bf16 v[120:123], a[152:155], a[232:235], v[120:123]
    s_waitcnt lgkmcnt(4)
    v_mul_f32 v244, v244, v245
    v_fma_f32 v246, v246, s3, s3
    v_rcp_f32 v246, v246
    v_mfma_f32_16x16x32_bf16 v[104:107], a[200:203], a[216:219], v[104:107]
    s_add_u32 m0, m0, s43
    ds_read_b64_tr_b16 a[232:233], v9 offset:33792
    v_mul_f32 v246, v246, v247
    v_cvt_pk_bf16_f32 v255, v244, v246
    v_fma_f32 v232, -v196, v196, s68
    v_mfma_f32_16x16x32_bf16 v[104:107], a[204:207], a[220:223], v[104:107]
    s_add_u32 s69, s69, s86
    ds_read_b64_tr_b16 a[234:235], v9 offset:34304
    v_mul_f32 v232, v232, v196
    v_exp_f32 v232, v232
    v_mfma_f32_16x16x32_bf16 v[108:111], v[92:95], a[220:223], v[108:111]
    ds_read_b64_tr_b16 a[236:237], v10 offset:0
    v_mul_f32 v233, v196, v228
    v_fma_f32 v232, v232, s3, s3
    v_fma_f32 v234, -v197, v197, s68
    v_mfma_f32_16x16x32_bf16 v[108:111], v[88:91], a[216:219], v[108:111]
    ds_read_b64_tr_b16 a[238:239], v10 offset:512
    v_rcp_f32 v232, v232
    v_mul_f32 v234, v234, v197
    v_mfma_f32_16x16x32_bf16 v[112:115], a[56:59], a[216:219], v[112:115]
    ds_write2st64_b64 v14, v[252:253], v[254:255] offset0:0 offset1:2
    v_mfma_f32_16x16x32_bf16 v[112:115], a[60:63], a[220:223], v[112:115]
    v_exp_f32 v234, v234
    v_mul_f32 v232, v232, v233
    v_mul_f32 v235, v197, v229
    v_mfma_f32_16x16x32_bf16 v[116:119], a[132:135], a[220:223], v[116:119]
    buffer_load_dwordx4 v5, s[24:27], s69 offen lds
    v_fma_f32 v234, v234, s3, s3
    v_fma_f32 v236, -v198, v198, s68
    v_mfma_f32_16x16x32_bf16 v[116:119], a[128:131], a[216:219], v[116:119]
    s_waitcnt lgkmcnt(5)
    v_rcp_f32 v234, v234
    v_mul_f32 v236, v236, v198
    v_mul_f32 v237, v198, v230
    v_mfma_f32_16x16x32_bf16 v[132:135], a[128:131], a[224:227], v[132:135]
    s_add_u32 m0, m0, s43
    ds_read_b64_tr_b16 a[216:217], v9 offset:33824
    v_exp_f32 v236, v236
    v_mul_f32 v234, v234, v235
    v_mfma_f32_16x16x32_bf16 v[132:135], a[132:135], a[228:231], v[132:135]
    s_add_u32 s69, s69, s86
    ds_read_b64_tr_b16 a[218:219], v9 offset:34336
    v_cvt_pk_bf16_f32 v248, v232, v234
    v_fma_f32 v236, v236, s3, s3
    v_fma_f32 v238, -v199, v199, s68
    v_mfma_f32_16x16x32_bf16 v[128:131], a[60:63], a[228:231], v[128:131]
    ds_read_b64_tr_b16 a[220:221], v10 offset:32
    v_rcp_f32 v236, v236
    v_mul_f32 v238, v238, v199
    v_mfma_f32_16x16x32_bf16 v[128:131], a[56:59], a[224:227], v[128:131]
    ds_read_b64_tr_b16 a[222:223], v10 offset:544
    v_exp_f32 v238, v238
    v_mul_f32 v236, v236, v237
    v_mfma_f32_16x16x32_bf16 v[124:127], v[88:91], a[224:227], v[124:127]
    v_mul_f32 v239, v199, v231
    v_fma_f32 v238, v238, s3, s3
    v_rcp_f32 v238, v238
    v_mfma_f32_16x16x32_bf16 v[124:127], v[92:95], a[228:231], v[124:127]
    s_waitcnt vmcnt(9)
    v_mul_f32 v238, v238, v239
    v_cvt_pk_bf16_f32 v249, v236, v238
    v_fma_f32 v240, -v192, v192, s68
    v_mul_f32 v240, v240, v192
    v_mfma_f32_16x16x32_bf16 v[120:123], a[204:207], a[228:231], v[120:123]
    s_barrier
    buffer_load_dwordx4 v5, s[24:27], s69 offen lds
    v_exp_f32 v240, v240
    v_mfma_f32_16x16x32_bf16 v[120:123], a[200:203], a[224:227], v[120:123]
    s_waitcnt lgkmcnt(5)
    v_mul_f32 v241, v192, v224
    v_fma_f32 v240, v240, s3, s3
    v_rcp_f32 v240, v240
    v_mfma_f32_16x16x32_bf16 v[104:107], a[160:163], a[232:235], v[104:107]
    s_add_u32 m0, m0, s43
    ds_read_b64_tr_b16 a[224:225], v10 offset:4224
    v_mul_f32 v240, v240, v241
    v_fma_f32 v242, -v193, v193, s68
    v_mul_f32 v242, v242, v193
    v_mfma_f32_16x16x32_bf16 v[104:107], a[164:167], a[236:239], v[104:107]
    s_add_u32 s69, s69, s86
    ds_read_b64_tr_b16 a[226:227], v10 offset:4736
    v_exp_f32 v242, v242
    v_mul_f32 v243, v193, v225
    v_mfma_f32_16x16x32_bf16 v[108:111], v[52:55], a[236:239], v[108:111]
    ds_read_b64_tr_b16 a[228:229], v10 offset:8448
    v_fma_f32 v242, v242, s3, s3
    v_rcp_f32 v242, v242
    v_mfma_f32_16x16x32_bf16 v[108:111], v[48:51], a[232:235], v[108:111]
    ds_read_b64_tr_b16 a[230:231], v10 offset:8960
    v_mul_f32 v242, v242, v243
    v_cvt_pk_bf16_f32 v250, v240, v242
    v_fma_f32 v244, -v194, v194, s68
    v_mfma_f32_16x16x32_bf16 v[112:115], a[16:19], a[232:235], v[112:115]
    v_mul_f32 v244, v244, v194
    v_exp_f32 v244, v244
    v_mul_f32 v245, v194, v226
    v_mfma_f32_16x16x32_bf16 v[112:115], a[20:23], a[236:239], v[112:115]
    v_fma_f32 v244, v244, s3, s3
    v_rcp_f32 v244, v244
    v_fma_f32 v246, -v195, v195, s68
    v_mfma_f32_16x16x32_bf16 v[116:119], a[92:95], a[236:239], v[116:119]
    buffer_load_dwordx4 v5, s[24:27], s69 offen lds
    v_mul_f32 v244, v244, v245
    v_mul_f32 v246, v246, v195
    v_mfma_f32_16x16x32_bf16 v[116:119], a[88:91], a[232:235], v[116:119]
    s_waitcnt lgkmcnt(4)
    v_exp_f32 v246, v246
    v_mul_f32 v247, v195, v227
    v_fma_f32 v232, -v188, v188, s68
    v_mfma_f32_16x16x32_bf16 v[132:135], a[88:91], a[216:219], v[132:135]
    s_add_u32 m0, m0, s43
    ds_read_b64_tr_b16 a[232:233], v10 offset:4256
    v_fma_f32 v246, v246, s3, s3
    v_rcp_f32 v246, v246
    v_mfma_f32_16x16x32_bf16 v[132:135], a[92:95], a[220:223], v[132:135]
    s_add_u32 s69, s69, s86
    ds_read_b64_tr_b16 a[234:235], v10 offset:4768
    v_mul_f32 v246, v246, v247
    v_cvt_pk_bf16_f32 v251, v244, v246
    v_mul_f32 v232, v232, v188
    v_mfma_f32_16x16x32_bf16 v[128:131], a[20:23], a[220:223], v[128:131]
    ds_read_b64_tr_b16 a[236:237], v10 offset:8480
    v_exp_f32 v232, v232
    v_mul_f32 v233, v188, v220
    v_mfma_f32_16x16x32_bf16 v[128:131], a[16:19], a[216:219], v[128:131]
    ds_read_b64_tr_b16 a[238:239], v10 offset:8992
    v_fma_f32 v232, v232, s3, s3
    v_rcp_f32 v232, v232
    v_mfma_f32_16x16x32_bf16 v[124:127], v[48:51], a[216:219], v[124:127]
    ds_write2st64_b64 v15, v[248:249], v[250:251] offset0:2 offset1:0
    v_mfma_f32_16x16x32_bf16 v[124:127], v[52:55], a[220:223], v[124:127]
    v_mul_f32 v232, v232, v233
    v_fma_f32 v234, -v189, v189, s68
    v_mul_f32 v234, v234, v189
    v_mul_f32 v235, v189, v221
    v_mfma_f32_16x16x32_bf16 v[120:123], a[164:167], a[220:223], v[120:123]
    buffer_load_dwordx4 v5, s[24:27], s69 offen lds
    v_exp_f32 v234, v234
    v_mfma_f32_16x16x32_bf16 v[120:123], a[160:163], a[216:219], v[120:123]
    s_waitcnt lgkmcnt(5)
    v_fma_f32 v234, v234, s3, s3
    v_rcp_f32 v234, v234
    v_fma_f32 v236, -v190, v190, s68
    v_mfma_f32_16x16x32_bf16 v[104:107], a[208:211], a[224:227], v[104:107]
    s_add_u32 m0, m0, s43
    ds_read_b64_tr_b16 a[216:217], v10 offset:12672
    v_mul_f32 v234, v234, v235
    v_cvt_pk_bf16_f32 v252, v232, v234
    v_mul_f32 v236, v236, v190
    v_mfma_f32_16x16x32_bf16 v[104:107], a[212:215], a[228:231], v[104:107]
    s_add_u32 s69, s69, s86
    ds_read_b64_tr_b16 a[218:219], v10 offset:13184
    v_exp_f32 v236, v236
    v_mul_f32 v237, v190, v222
    v_mfma_f32_16x16x32_bf16 v[108:111], v[100:103], a[228:231], v[108:111]
    ds_read_b64_tr_b16 a[220:221], v10 offset:16896
    v_fma_f32 v236, v236, s3, s3
    v_rcp_f32 v236, v236
    v_mfma_f32_16x16x32_bf16 v[108:111], v[96:99], a[224:227], v[108:111]
    ds_read_b64_tr_b16 a[222:223], v10 offset:17408
    v_mul_f32 v236, v236, v237
    v_fma_f32 v238, -v191, v191, s68
    v_mul_f32 v238, v238, v191
    v_mfma_f32_16x16x32_bf16 v[112:115], a[64:67], a[224:227], v[112:115]
    ds_read_b128 a[144:147], v16 offset:0
    v_exp_f32 v238, v238
    v_mul_f32 v239, v191, v223
    v_mfma_f32_16x16x32_bf16 v[112:115], a[68:71], a[228:231], v[112:115]
    ds_read_b128 a[152:155], v16 offset:8192
    v_fma_f32 v238, v238, s3, s3
    v_rcp_f32 v238, v238
    v_mfma_f32_16x16x32_bf16 v[116:119], a[140:143], a[228:231], v[116:119]
    buffer_load_dwordx4 v5, s[24:27], s69 offen lds
    v_mul_f32 v238, v238, v239
    v_cvt_pk_bf16_f32 v253, v236, v238
    v_mfma_f32_16x16x32_bf16 v[116:119], a[136:139], a[224:227], v[116:119]
    s_waitcnt lgkmcnt(7)
    ds_read_b128 a[160:163], v16 offset:16384
    v_fma_f32 v240, -v184, v184, s68
    v_mul_f32 v240, v240, v184
    v_mul_f32 v241, v184, v216
    v_mfma_f32_16x16x32_bf16 v[132:135], a[136:139], a[232:235], v[132:135]
    s_add_u32 m0, m0, s43
    ds_read_b64_tr_b16 a[224:225], v10 offset:12704
    ds_read_b128 v[48:51], v16 offset:17408
    v_fma_f32 v242, -v185, v185, s68
    v_mfma_f32_16x16x32_bf16 v[132:135], a[140:143], a[236:239], v[132:135]
    s_add_u32 s69, s69, s86
    ds_read_b64_tr_b16 a[226:227], v10 offset:13216
    ds_read_b128 v[40:43], v16 offset:9216
    v_mul_f32 v242, v242, v185
    v_mfma_f32_16x16x32_bf16 v[128:131], a[68:71], a[236:239], v[128:131]
    ds_read_b64_tr_b16 a[228:229], v10 offset:16928
    ds_read_b128 v[32:35], v16 offset:1024
    v_mul_f32 v243, v185, v217
    v_mfma_f32_16x16x32_bf16 v[128:131], a[64:67], a[232:235], v[128:131]
    ds_read_b64_tr_b16 a[230:231], v10 offset:17440
    v_exp_f32 v240, v240
    v_fma_f32 v244, -v186, v186, s68
    v_mfma_f32_16x16x32_bf16 v[124:127], v[96:99], a[232:235], v[124:127]
    ds_read_b128 a[0:3], v16 offset:2048
    v_exp_f32 v242, v242
    v_fma_f32 v240, v240, s3, s3
    v_mfma_f32_16x16x32_bf16 v[124:127], v[100:103], a[236:239], v[124:127]
    s_waitcnt vmcnt(8)
    ds_read_b128 a[8:11], v16 offset:10240
    v_rcp_f32 v240, v240
    v_fma_f32 v242, v242, s3, s3
    v_mfma_f32_16x16x32_bf16 v[120:123], a[212:215], a[236:239], v[120:123]
    s_barrier
    buffer_load_dwordx4 v5, s[24:27], s69 offen lds
    v_rcp_f32 v242, v242
    v_mfma_f32_16x16x32_bf16 v[120:123], a[208:211], a[232:235], v[120:123]
    s_waitcnt lgkmcnt(12)
    ds_read_b128 a[16:19], v16 offset:18432
    v_mul_f32 v240, v240, v241
    v_mul_f32 v242, v242, v243
    v_cvt_pk_bf16_f32 v254, v240, v242
    v_mfma_f32_16x16x32_bf16 v[104:107], a[168:171], a[216:219], v[104:107]
    s_add_u32 m0, m0, s43
    ds_read_b64_tr_b16 a[232:233], v10 offset:21120
    ds_read_b128 a[88:91], v16 offset:19456
    v_mul_f32 v244, v244, v186
    v_mfma_f32_16x16x32_bf16 v[104:107], a[172:175], a[220:223], v[104:107]
    s_add_u32 s69, s62, 128
    ds_read_b64_tr_b16 a[234:235], v10 offset:21632
    ds_read_b128 a[80:83], v16 offset:11264
    v_mul_f32 v245, v186, v218
    v_mfma_f32_16x16x32_bf16 v[108:111], v[60:63], a[220:223], v[108:111]
    ds_read_b64_tr_b16 a[236:237], v10 offset:25344
    ds_read_b128 a[72:75], v16 offset:3072
    v_fma_f32 v246, -v187, v187, s68
    v_mfma_f32_16x16x32_bf16 v[108:111], v[56:59], a[216:219], v[108:111]
    ds_read_b64_tr_b16 a[238:239], v10 offset:25856
    v_exp_f32 v244, v244
    v_mul_f32 v246, v246, v187
    v_mfma_f32_16x16x32_bf16 v[112:115], a[24:27], a[216:219], v[112:115]
    ds_read_b128 a[148:151], v16 offset:4096
    v_exp_f32 v246, v246
    v_fma_f32 v244, v244, s3, s3
    v_mfma_f32_16x16x32_bf16 v[112:115], a[28:31], a[220:223], v[112:115]
    v_rcp_f32 v244, v244
    v_mul_f32 v247, v187, v219
    v_fma_f32 v246, v246, s3, s3
    v_mfma_f32_16x16x32_bf16 v[116:119], a[100:103], a[220:223], v[116:119]
    buffer_load_dwordx4 v5, s[24:27], s69 offen lds
    v_rcp_f32 v246, v246
    v_mfma_f32_16x16x32_bf16 v[116:119], a[96:99], a[216:219], v[116:119]
    s_waitcnt lgkmcnt(11)
    ds_read_b128 a[156:159], v16 offset:12288
    v_mul_f32 v244, v244, v245
    v_mul_f32 v246, v246, v247
    v_cvt_pk_bf16_f32 v255, v244, v246
    v_mfma_f32_16x16x32_bf16 v[132:135], a[96:99], a[224:227], v[132:135]
    s_add_u32 m0, m0, s43
    ds_read_b64_tr_b16 a[216:217], v10 offset:21152
    v_lshrrev_b32 v20, 4, v29
    v_mul_u32_u24 v20, 9088, v20
    v_add_u32 v20, v20, v1
    v_mfma_f32_16x16x32_bf16 v[132:135], a[100:103], a[228:231], v[132:135]
    s_add_u32 s69, s69, s86
    ds_read_b64_tr_b16 a[218:219], v10 offset:21664
    v_mfma_f32_16x16x32_bf16 v[128:131], a[28:31], a[228:231], v[128:131]
    ds_read_b64_tr_b16 a[220:221], v10 offset:25376
    v_mfma_f32_16x16x32_bf16 v[128:131], a[24:27], a[224:227], v[128:131]
    ds_read_b64_tr_b16 a[222:223], v10 offset:25888
    v_mfma_f32_16x16x32_bf16 v[124:127], v[56:59], a[224:227], v[124:127]
    ds_read_b128 a[164:167], v16 offset:20480
    v_mfma_f32_16x16x32_bf16 v[124:127], v[60:63], a[228:231], v[124:127]
    ds_write2st64_b64 v13, v[252:253], v[254:255] offset0:2 offset1:0
    v_mfma_f32_16x16x32_bf16 v[120:123], a[172:175], a[228:231], v[120:123]
    buffer_load_dwordx4 v5, s[24:27], s69 offen lds
    v_mfma_f32_16x16x32_bf16 v[120:123], a[168:171], a[224:227], v[120:123]
    s_waitcnt lgkmcnt(8)
    ds_read_b128 v[52:55], v16 offset:21504
    v_mfma_f32_16x16x32_bf16 v[104:107], a[176:179], a[232:235], v[104:107]
    s_add_u32 m0, m0, s43
    ds_read_b64_tr_b16 a[224:225], v10 offset:29568
    v_mfma_f32_16x16x32_bf16 v[104:107], a[180:183], a[236:239], v[104:107]
    s_add_u32 s69, s69, s86
    ds_read_b64_tr_b16 a[226:227], v10 offset:30080
    v_mfma_f32_16x16x32_bf16 v[108:111], v[68:71], a[236:239], v[108:111]
    ds_read_b64_tr_b16 a[228:229], v10 offset:33792
    v_mfma_f32_16x16x32_bf16 v[108:111], v[64:67], a[232:235], v[108:111]
    ds_read_b64_tr_b16 a[230:231], v10 offset:34304
    v_mfma_f32_16x16x32_bf16 v[112:115], a[32:35], a[232:235], v[112:115]
    ds_read_b128 v[44:47], v16 offset:13312
    v_mfma_f32_16x16x32_bf16 v[112:115], a[36:39], a[236:239], v[112:115]
    v_mfma_f32_16x16x32_bf16 v[116:119], a[108:111], a[236:239], v[116:119]
    buffer_load_dwordx4 v5, s[24:27], s69 offen lds
    v_mfma_f32_16x16x32_bf16 v[116:119], a[104:107], a[232:235], v[116:119]
    s_waitcnt lgkmcnt(8)
    ds_read_b128 v[36:39], v16 offset:5120
    v_mfma_f32_16x16x32_bf16 v[132:135], a[104:107], a[216:219], v[132:135]
    s_add_u32 m0, m0, s43
    ds_read_b64_tr_b16 a[232:233], v10 offset:29600
    v_mfma_f32_16x16x32_bf16 v[132:135], a[108:111], a[220:223], v[132:135]
    s_add_u32 s69, s69, s86
    ds_read_b64_tr_b16 a[234:235], v10 offset:30112
    v_mfma_f32_16x16x32_bf16 v[128:131], a[36:39], a[220:223], v[128:131]
    ds_read_b64_tr_b16 a[236:237], v10 offset:33824
    v_mfma_f32_16x16x32_bf16 v[128:131], a[32:35], a[216:219], v[128:131]
    ds_read_b64_tr_b16 a[238:239], v10 offset:34336
    v_mfma_f32_16x16x32_bf16 v[124:127], v[64:67], a[216:219], v[124:127]
    ds_read_b128 a[4:7], v16 offset:6144
    v_mfma_f32_16x16x32_bf16 v[124:127], v[68:71], a[220:223], v[124:127]
    s_waitcnt vmcnt(9)
    v_mfma_f32_16x16x32_bf16 v[120:123], a[180:183], a[220:223], v[120:123]
    s_barrier
    buffer_load_dwordx4 v5, s[24:27], s69 offen lds
    v_mfma_f32_16x16x32_bf16 v[120:123], a[176:179], a[216:219], v[120:123]
    s_waitcnt lgkmcnt(7)
    ds_read_b128 a[12:15], v16 offset:14336
    v_mfma_f32_16x16x32_bf16 v[104:107], a[184:187], a[224:227], v[104:107]
    s_add_u32 m0, m0, s43
    ds_read_b64_tr_b16 a[216:217], v11 offset:0
    v_mfma_f32_16x16x32_bf16 v[168:171], a[188:191], a[228:231], v[104:107]
    s_add_u32 s69, s69, s86
    ds_read_b64_tr_b16 a[218:219], v11 offset:2112
    v_mfma_f32_16x16x32_bf16 v[108:111], v[76:79], a[228:231], v[108:111]
    ds_read_b64_tr_b16 a[220:221], v11 offset:4224
    v_mfma_f32_16x16x32_bf16 v[172:175], v[72:75], a[224:227], v[108:111]
    ds_read_b64_tr_b16 a[222:223], v11 offset:6336
    v_mfma_f32_16x16x32_bf16 v[112:115], a[40:43], a[224:227], v[112:115]
    ds_read_b128 a[20:23], v16 offset:22528
    v_mfma_f32_16x16x32_bf16 v[176:179], a[44:47], a[228:231], v[112:115]
    v_mfma_f32_16x16x32_bf16 v[116:119], a[116:119], a[228:231], v[116:119]
    buffer_load_dwordx4 v5, s[24:27], s69 offen lds
    v_mfma_f32_16x16x32_bf16 v[180:183], a[112:115], a[224:227], v[116:119]
    s_waitcnt lgkmcnt(7)
    ds_read_b128 a[92:95], v16 offset:23552
    v_mfma_f32_16x16x32_bf16 v[132:135], a[112:115], a[232:235], v[132:135]
    s_add_u32 m0, m0, s43
    ds_read_b64_tr_b16 a[224:225], v11 offset:8448
    v_mfma_f32_16x16x32_bf16 v[196:199], a[116:119], a[236:239], v[132:135]
    s_add_u32 s69, s69, s86
    ds_read_b64_tr_b16 a[226:227], v11 offset:10560
    v_mfma_f32_16x16x32_bf16 v[128:131], a[44:47], a[236:239], v[128:131]
    ds_read_b128 a[84:87], v16 offset:15360
    v_mfma_f32_16x16x32_bf16 v[192:195], a[40:43], a[232:235], v[128:131]
    ds_read_b128 a[76:79], v16 offset:7168
    v_mfma_f32_16x16x32_bf16 v[124:127], v[72:75], a[232:235], v[124:127]
    s_waitcnt lgkmcnt(6)
    v_mfma_f32_16x16x32_bf16 v[188:191], v[76:79], a[236:239], v[124:127]
    s_waitcnt vmcnt(8)
    v_mfma_f32_16x16x32_bf16 v[120:123], a[188:191], a[236:239], v[120:123]
    s_barrier
    buffer_load_dwordx4 v5, s[24:27], s69 offen lds
    v_mfma_f32_16x16x32_bf16 v[184:187], a[184:187], a[232:235], v[120:123]
    s_branch L_k_d
L_f2_spin:
    s_mov_b32 s98, 0
L_f2_loop:
    s_sleep 1
    buffer_load_dword v255, v24, s[12:15], s63 offen sc1
    s_waitcnt vmcnt(0)
    v_cmp_ne_u32 vcc, 1, v255
    s_add_u32 s98, s98, 1
    s_cmp_gt_u32 s98, 200000
    s_cbranch_scc1 L_f2_ok
    s_nop 1
    s_cbranch_vccnz L_f2_loop
    s_branch L_f2_ok
L_at_flag:
    ds_write_b32 v244, v22
    s_waitcnt lgkmcnt(0)
    s_branch L_at_noflag
L_o0_again:
    s_add_u32 s98, s98, 1
    s_cmp_gt_u32 s98, 200000
    s_cbranch_scc1 L_o0_ok
    s_add_u32 m0, s33, 102400
    s_add_u32 s22, s5, 0
    buffer_load_dwordx4 v1, s[12:15], s22 offen sc1 lds
    buffer_load_dwordx4 v1, s[12:15], s22 offen offset:1024 sc1 lds
    buffer_load_dwordx4 v1, s[12:15], s22 offen offset:2048 sc1 lds
    buffer_load_dwordx4 v1, s[12:15], s22 offen offset:3072 sc1 lds
    s_add_u32 m0, s34, 118784
    s_add_u32 s22, s32, 0
    buffer_load_dwordx4 v1, s[12:15], s22 offen sc1 lds
    s_waitcnt vmcnt(0)
    ds_read_b128 v[128:131], v2 offset:0
    ds_read_b128 v[132:135], v2 offset:1024
    ds_read_b128 v[136:139], v2 offset:2048
    ds_read_b128 v[140:143], v2 offset:3072
    ds_read_b128 v[152:155], v3 offset:16384
    s_branch L_o0_chk
L_o1_again:
    s_add_u32 s98, s98, 1
    s_cmp_gt_u32 s98, 200000
    s_cbranch_scc1 L_o1_ok
    s_add_u32 m0, s33, 125952
    s_add_u32 s22, s5, 16384
    buffer_load_dwordx4 v1, s[12:15], s22 offen sc1 lds
    buffer_load_dwordx4 v1, s[12:15], s22 offen offset:1024 sc1 lds
    buffer_load_dwordx4 v1, s[12:15], s22 offen offset:2048 sc1 lds
    buffer_load_dwordx4 v1, s[12:15], s22 offen offset:3072 sc1 lds
    s_add_u32 m0, s34, 142336
    s_add_u32 s22, s32, 4096
    buffer_load_dwordx4 v1, s[12:15], s22 offen sc1 lds
    s_waitcnt vmcnt(0)
    ds_read_b128 v[128:131], v2 offset:23552
    ds_read_b128 v[132:135], v2 offset:24576
    ds_read_b128 v[136:139], v2 offset:25600
    ds_read_b128 v[140:143], v2 offset:26624
    ds_read_b128 v[152:155], v3 offset:39936
    s_branch L_o1_chk
L_code_end:
L_at_fallback:
    s_waitcnt vmcnt(0) lgkmcnt(0)
    s_mov_b32 s97, 0
L_at_mx:
    s_lshl_b32 s54, s97, 8
    v_add_u32 v7, s54, v19
    s_and_b32 s54, s97, 3
    s_lshl_b32 s54, s54, 8
    s_and_b32 s22, s97, 4
    s_add_u32 s54, s54, s22
    v_lshl_add_u32 v6, s54, 1, v23
    ds_read_b64 v[16:17], v7
    ds_read2st64_b64 v[12:15], v6 offset0:0 offset1:4
    v_mov_b32 v80, 0xff800000
    s_waitcnt lgkmcnt(0)
    v_mfma_f32_32x32x4_2b_bf16 v[48:79], a[252:253], v[16:17], 0
    s_nop 15
    s_nop 1
    v_mfma_f32_32x32x16_bf16 v[48:63], a[240:243], v[12:15], v[48:63]
    v_mfma_f32_32x32x16_bf16 v[64:79], a[244:247], v[12:15], v[64:79]
    s_nop 11
    v_max3_f32 v80, v48, v49, v80
    v_max3_f32 v80, v50, v51, v80
    v_max3_f32 v80, v52, v53, v80
    v_max3_f32 v80, v54, v55, v80
    v_max3_f32 v80, v56, v57, v80
    v_max3_f32 v80, v58, v59, v80
    v_max3_f32 v80, v60, v61, v80
    v_max3_f32 v80, v62, v63, v80
    v_max3_f32 v80, v64, v65, v80
    v_max3_f32 v80, v66, v67, v80
    v_max3_f32 v80, v68, v69, v80
    v_max3_f32 v80, v70, v71, v80
    v_max3_f32 v80, v72, v73, v80
    v_max3_f32 v80, v74, v75, v80
    v_max3_f32 v80, v76, v77, v80
    v_max3_f32 v80, v78, v79, v80
    v_mfma_f32_32x32x4_2b_bf16 v[48:79], v[34:35], v[16:17], 0
    s_nop 15
    s_nop 1
    v_mfma_f32_32x32x16_bf16 v[48:63], a[0:3], v[12:15], v[48:63]
    v_mfma_f32_32x32x16_bf16 v[64:79], a[8:11], v[12:15], v[64:79]
    s_nop 11
    v_max3_f32 v80, v48, v49, v80
    v_max3_f32 v80, v50, v51, v80
    v_max3_f32 v80, v52, v53, v80
    v_max3_f32 v80, v54, v55, v80
    v_max3_f32 v80, v56, v57, v80
    v_max3_f32 v80, v58, v59, v80
    v_max3_f32 v80, v60, v61, v80
    v_max3_f32 v80, v62, v63, v80
    v_max3_f32 v80, v64, v65, v80
    v_max3_f32 v80, v66, v67, v80
    v_max3_f32 v80, v68, v69, v80
    v_max3_f32 v80, v70, v71, v80
    v_max3_f32 v80, v72, v73, v80
    v_max3_f32 v80, v74, v75, v80
    v_max3_f32 v80, v76, v77, v80
    v_max3_f32 v80, v78, v79, v80
    v_mfma_f32_32x32x4_2b_bf16 v[48:79], v[36:37], v[16:17], 0
    s_nop 15
    s_nop 1
    v_mfma_f32_32x32x16_bf16 v[48:63], a[148:151], v[12:15], v[48:63]
    v_mfma_f32_32x32x16_bf16 v[64:79], a[156:159], v[12:15], v[64:79]
    s_nop 11
    v_max3_f32 v80, v48, v49, v80
    v_max3_f32 v80, v50, v51, v80
    v_max3_f32 v80, v52, v53, v80
    v_max3_f32 v80, v54, v55, v80
    v_max3_f32 v80, v56, v57, v80
    v_max3_f32 v80, v58, v59, v80
    v_max3_f32 v80, v60, v61, v80
    v_max3_f32 v80, v62, v63, v80
    v_max3_f32 v80, v64, v65, v80
    v_max3_f32 v80, v66, v67, v80
    v_max3_f32 v80, v68, v69, v80
    v_max3_f32 v80, v70, v71, v80
    v_max3_f32 v80, v72, v73, v80
    v_max3_f32 v80, v74, v75, v80
    v_max3_f32 v80, v76, v77, v80
    v_max3_f32 v80, v78, v79, v80
    v_mfma_f32_32x32x4_2b_bf16 v[48:79], v[38:39], v[16:17], 0
    s_nop 15
    s_nop 1
    v_mfma_f32_32x32x16_bf16 v[48:63], a[92:95], v[12:15], v[48:63]
    v_mfma_f32_32x32x16_bf16 v[64:79], a[84:87], v[12:15], v[64:79]
    s_nop 11
    v_max3_f32 v80, v48, v49, v80
    v_max3_f32 v80, v50, v51, v80
    v_max3_f32 v80, v52, v53, v80
    v_max3_f32 v80, v54, v55, v80
    v_max3_f32 v80, v56, v57, v80
    v_max3_f32 v80, v58, v59, v80
    v_max3_f32 v80, v60, v61, v80
    v_max3_f32 v80, v62, v63, v80
    v_max3_f32 v80, v64, v65, v80
    v_max3_f32 v80, v66, v67, v80
    v_max3_f32 v80, v68, v69, v80
    v_max3_f32 v80, v70, v71, v80
    v_max3_f32 v80, v72, v73, v80
    v_max3_f32 v80, v74, v75, v80
    v_max3_f32 v80, v76, v77, v80
    v_max3_f32 v80, v78, v79, v80
    v_mfma_f32_32x32x4_2b_bf16 v[48:79], v[40:41], v[16:17], 0
    s_nop 15
    s_nop 1
    v_mfma_f32_32x32x16_bf16 v[48:63], a[24:27], v[12:15], v[48:63]
    v_mfma_f32_32x32x16_bf16 v[64:79], a[32:35], v[12:15], v[64:79]
    s_nop 11
    v_max3_f32 v80, v48, v49, v80
    v_max3_f32 v80, v50, v51, v80
    v_max3_f32 v80, v52, v53, v80
    v_max3_f32 v80, v54, v55, v80
    v_max3_f32 v80, v56, v57, v80
    v_max3_f32 v80, v58, v59, v80
    v_max3_f32 v80, v60, v61, v80
    v_max3_f32 v80, v62, v63, v80
    v_max3_f32 v80, v64, v65, v80
    v_max3_f32 v80, v66, v67, v80
    v_max3_f32 v80, v68, v69, v80
    v_max3_f32 v80, v70, v71, v80
    v_max3_f32 v80, v72, v73, v80
    v_max3_f32 v80, v74, v75, v80
    v_max3_f32 v80, v76, v77, v80
    v_max3_f32 v80, v78, v79, v80
    v_mfma_f32_32x32x4_2b_bf16 v[48:79], v[42:43], v[16:17], 0
    s_nop 15
    s_nop 1
    v_mfma_f32_32x32x16_bf16 v[48:63], a[172:175], v[12:15], v[48:63]
    v_mfma_f32_32x32x16_bf16 v[64:79], a[180:183], v[12:15], v[64:79]
    s_nop 11
    v_max3_f32 v80, v48, v49, v80
    v_max3_f32 v80, v50, v51, v80
    v_max3_f32 v80, v52, v53, v80
    v_max3_f32 v80, v54, v55, v80
    v_max3_f32 v80, v56, v57, v80
    v_max3_f32 v80, v58, v59, v80
    v_max3_f32 v80, v60, v61, v80
    v_max3_f32 v80, v62, v63, v80
    v_max3_f32 v80, v64, v65, v80
    v_max3_f32 v80, v66, v67, v80
    v_max3_f32 v80, v68, v69, v80
    v_max3_f32 v80, v70, v71, v80
    v_max3_f32 v80, v72, v73, v80
    v_max3_f32 v80, v74, v75, v80
    v_max3_f32 v80, v76, v77, v80
    v_max3_f32 v80, v78, v79, v80
    v_mfma_f32_32x32x4_2b_bf16 v[48:79], v[44:45], v[16:17], 0
    s_nop 15
    s_nop 1
    v_mfma_f32_32x32x16_bf16 v[48:63], a[116:119], v[12:15], v[48:63]
    v_mfma_f32_32x32x16_bf16 v[64:79], a[108:111], v[12:15], v[64:79]
    s_nop 11
    v_max3_f32 v80, v48, v49, v80
    v_max3_f32 v80, v50, v51, v80
    v_max3_f32 v80, v52, v53, v80
    v_max3_f32 v80, v54, v55, v80
    v_max3_f32 v80, v56, v57, v80
    v_max3_f32 v80, v58, v59, v80
    v_max3_f32 v80, v60, v61, v80
    v_max3_f32 v80, v62, v63, v80
    v_max3_f32 v80, v64, v65, v80
    v_max3_f32 v80, v66, v67, v80
    v_max3_f32 v80, v68, v69, v80
    v_max3_f32 v80, v70, v71, v80
    v_max3_f32 v80, v72, v73, v80
    v_max3_f32 v80, v74, v75, v80
    v_max3_f32 v80, v76, v77, v80
    v_max3_f32 v80, v78, v79, v80
    v_mfma_f32_32x32x4_2b_bf16 v[48:79], v[46:47], v[16:17], 0
    s_nop 15
    s_nop 1
    v_mfma_f32_32x32x16_bf16 v[48:63], a[136:139], v[12:15], v[48:63]
    v_mfma_f32_32x32x16_bf16 v[64:79], a[128:131], v[12:15], v[64:79]
    s_nop 11
    v_max3_f32 v80, v48, v49, v80
    v_max3_f32 v80, v50, v51, v80
    v_max3_f32 v80, v52, v53, v80
    v_max3_f32 v80, v54, v55, v80
    v_max3_f32 v80, v56, v57, v80
    v_max3_f32 v80, v58, v59, v80
    v_max3_f32 v80, v60, v61, v80
    v_max3_f32 v80, v62, v63, v80
    v_max3_f32 v80, v64, v65, v80
    v_max3_f32 v80, v66, v67, v80
    v_max3_f32 v80, v68, v69, v80
    v_max3_f32 v80, v70, v71, v80
    v_max3_f32 v80, v72, v73, v80
    v_max3_f32 v80, v74, v75, v80
    v_max3_f32 v80, v76, v77, v80
    v_max3_f32 v80, v78, v79, v80
    s_lshl2_add_u32 s54, s97, s44
    s_lshl_b32 s54, s54, 8
    s_add_u32 s54, s54, 136192
    v_lshl_add_u32 v81, v29, 2, s54
    ds_write_b32 v81, v80
    s_add_u32 s97, s97, 1
    s_cmp_lt_u32 s97, 8
    s_cbranch_scc1 L_at_mx
    s_waitcnt lgkmcnt(0)
    s_barrier
    s_lshl_b32 s54, s44, 11
    s_add_u32 s54, s54, 136192
    v_lshrrev_b32 v81, 5, v29
    v_lshlrev_b32 v81, 10, v81
    v_add3_u32 v81, v81, v252, s54
    ds_read_b32 v48, v81 offset:0
    ds_read_b32 v49, v81 offset:128
    ds_read_b32 v50, v81 offset:256
    ds_read_b32 v51, v81 offset:384
    ds_read_b32 v52, v81 offset:512
    ds_read_b32 v53, v81 offset:640
    ds_read_b32 v54, v81 offset:768
    ds_read_b32 v55, v81 offset:896
    s_waitcnt lgkmcnt(0)
    v_max3_f32 v48, v48, v49, v50
    v_max3_f32 v48, v48, v51, v52
    v_max3_f32 v48, v48, v53, v54
    v_max_f32 v48, v48, v55
    v_sub_f32 v48, 0, v48
    v_and_b32 v49, 0xffff0000, v48
    v_sub_f32 v50, v48, v49
    v_cvt_pk_bf16_f32 v51, v49, v50
    s_lshl_b32 s54, s44, 9
    s_add_u32 s54, s54, 134148
    v_lshl_add_u32 v81, v29, 3, s54
    ds_write_b32 v81, v51
    s_waitcnt lgkmcnt(0)
    s_barrier
    s_mov_b32 s99, 0
L_at_p2:
    s_and_b32 s55, s99, 3
    s_add_u32 s97, s55, s44
    s_and_b32 s97, s97, 3
    s_and_b32 s54, s99, 4
    s_or_b32 s97, s97, s54
    s_lshl_b32 s54, s97, 8
    v_add_u32 v7, s54, v19
    s_and_b32 s54, s97, 3
    s_lshl_b32 s54, s54, 8
    s_and_b32 s22, s97, 4
    s_add_u32 s54, s54, s22
    v_lshl_add_u32 v6, s54, 1, v23
    ds_read_b64 v[16:17], v7
    ds_read2st64_b64 v[12:15], v6 offset0:0 offset1:4
    v_mov_b32 v144, 0
    v_mov_b32 v145, 0
    v_mov_b32 v146, 0
    v_mov_b32 v147, 0
    v_mov_b32 v148, 0
    v_mov_b32 v149, 0
    v_mov_b32 v150, 0
    v_mov_b32 v151, 0
    v_mov_b32 v152, 0
    v_mov_b32 v153, 0
    v_mov_b32 v154, 0
    v_mov_b32 v155, 0
    v_mov_b32 v156, 0
    v_mov_b32 v157, 0
    v_mov_b32 v158, 0
    v_mov_b32 v159, 0
    s_cmp_eq_u32 s55, 0
    s_cbranch_scc1 L_at_p2z
    ds_read_b128 v[144:147], v8
    ds_read_b128 v[148:151], v8 offset:1024
    ds_read_b64 v[152:153], v9 offset:2048
L_at_p2z:
    s_waitcnt lgkmcnt(0)
    s_barrier
    v_mfma_f32_32x32x4_2b_bf16 v[48:79], a[252:253], v[16:17], 0
    s_nop 15
    s_nop 1
    v_mfma_f32_32x32x16_bf16 v[48:63], a[240:243], v[12:15], v[48:63]
    v_mfma_f32_32x32x16_bf16 v[64:79], a[244:247], v[12:15], v[64:79]
    s_nop 11
    v_exp_f32 v48, v48
    v_exp_f32 v49, v49
    v_exp_f32 v50, v50
    v_exp_f32 v51, v51
    v_exp_f32 v52, v52
    v_exp_f32 v53, v53
    v_exp_f32 v54, v54
    v_exp_f32 v55, v55
    v_exp_f32 v56, v56
    v_exp_f32 v57, v57
    v_exp_f32 v58, v58
    v_exp_f32 v59, v59
    v_exp_f32 v60, v60
    v_exp_f32 v61, v61
    v_exp_f32 v62, v62
    v_exp_f32 v63, v63
    v_exp_f32 v64, v64
    v_exp_f32 v65, v65
    v_exp_f32 v66, v66
    v_exp_f32 v67, v67
    v_exp_f32 v68, v68
    v_exp_f32 v69, v69
    v_exp_f32 v70, v70
    v_exp_f32 v71, v71
    v_exp_f32 v72, v72
    v_exp_f32 v73, v73
    v_exp_f32 v74, v74
    v_exp_f32 v75, v75
    v_exp_f32 v76, v76
    v_exp_f32 v77, v77
    v_exp_f32 v78, v78
    v_exp_f32 v79, v79
    v_cvt_pk_bf16_f32 v112, v48, v49
    v_cvt_pk_bf16_f32 v113, v50, v51
    v_cvt_pk_bf16_f32 v114, v52, v53
    v_cvt_pk_bf16_f32 v115, v54, v55
    v_cvt_pk_bf16_f32 v116, v56, v57
    v_cvt_pk_bf16_f32 v117, v58, v59
    v_cvt_pk_bf16_f32 v118, v60, v61
    v_cvt_pk_bf16_f32 v119, v62, v63
    v_cvt_pk_bf16_f32 v120, v64, v65
    v_cvt_pk_bf16_f32 v121, v66, v67
    v_cvt_pk_bf16_f32 v122, v68, v69
    v_cvt_pk_bf16_f32 v123, v70, v71
    v_cvt_pk_bf16_f32 v124, v72, v73
    v_cvt_pk_bf16_f32 v125, v74, v75
    v_cvt_pk_bf16_f32 v126, v76, v77
    v_cvt_pk_bf16_f32 v127, v78, v79
    s_nop 1
    v_mfma_f32_32x32x16_bf16 v[144:159], a[248:251], v[112:115], v[144:159]
    v_mfma_f32_32x32x16_bf16 v[144:159], a[144:147], v[116:119], v[144:159]
    v_mfma_f32_32x32x16_bf16 v[144:159], a[152:155], v[120:123], v[144:159]
    v_mfma_f32_32x32x16_bf16 v[144:159], a[160:163], v[124:127], v[144:159]
    v_mfma_f32_32x32x4_2b_bf16 v[48:79], v[34:35], v[16:17], 0
    s_nop 15
    s_nop 1
    v_mfma_f32_32x32x16_bf16 v[48:63], a[0:3], v[12:15], v[48:63]
    v_mfma_f32_32x32x16_bf16 v[64:79], a[8:11], v[12:15], v[64:79]
    s_nop 11
    v_exp_f32 v48, v48
    v_exp_f32 v49, v49
    v_exp_f32 v50, v50
    v_exp_f32 v51, v51
    v_exp_f32 v52, v52
    v_exp_f32 v53, v53
    v_exp_f32 v54, v54
    v_exp_f32 v55, v55
    v_exp_f32 v56, v56
    v_exp_f32 v57, v57
    v_exp_f32 v58, v58
    v_exp_f32 v59, v59
    v_exp_f32 v60, v60
    v_exp_f32 v61, v61
    v_exp_f32 v62, v62
    v_exp_f32 v63, v63
    v_exp_f32 v64, v64
    v_exp_f32 v65, v65
    v_exp_f32 v66, v66
    v_exp_f32 v67, v67
    v_exp_f32 v68, v68
    v_exp_f32 v69, v69
    v_exp_f32 v70, v70
    v_exp_f32 v71, v71
    v_exp_f32 v72, v72
    v_exp_f32 v73, v73
    v_exp_f32 v74, v74
    v_exp_f32 v75, v75
    v_exp_f32 v76, v76
    v_exp_f32 v77, v77
    v_exp_f32 v78, v78
    v_exp_f32 v79, v79
    v_cvt_pk_bf16_f32 v112, v48, v49
    v_cvt_pk_bf16_f32 v113, v50, v51
    v_cvt_pk_bf16_f32 v114, v52, v53
    v_cvt_pk_bf16_f32 v115, v54, v55
    v_cvt_pk_bf16_f32 v116, v56, v57
    v_cvt_pk_bf16_f32 v117, v58, v59
    v_cvt_pk_bf16_f32 v118, v60, v61
    v_cvt_pk_bf16_f32 v119, v62, v63
    v_cvt_pk_bf16_f32 v120, v64, v65
    v_cvt_pk_bf16_f32 v121, v66, v67
    v_cvt_pk_bf16_f32 v122, v68, v69
    v_cvt_pk_bf16_f32 v123, v70, v71
    v_cvt_pk_bf16_f32 v124, v72, v73
    v_cvt_pk_bf16_f32 v125, v74, v75
    v_cvt_pk_bf16_f32 v126, v76, v77
    v_cvt_pk_bf16_f32 v127, v78, v79
    s_nop 1
    v_mfma_f32_32x32x16_bf16 v[144:159], a[16:19], v[112:115], v[144:159]
    v_mfma_f32_32x32x16_bf16 v[144:159], a[88:91], v[116:119], v[144:159]
    v_mfma_f32_32x32x16_bf16 v[144:159], a[80:83], v[120:123], v[144:159]
    v_mfma_f32_32x32x16_bf16 v[144:159], a[72:75], v[124:127], v[144:159]
    v_mfma_f32_32x32x4_2b_bf16 v[48:79], v[36:37], v[16:17], 0
    s_nop 15
    s_nop 1
    v_mfma_f32_32x32x16_bf16 v[48:63], a[148:151], v[12:15], v[48:63]
    v_mfma_f32_32x32x16_bf16 v[64:79], a[156:159], v[12:15], v[64:79]
    s_nop 11
    v_exp_f32 v48, v48
    v_exp_f32 v49, v49
    v_exp_f32 v50, v50
    v_exp_f32 v51, v51
    v_exp_f32 v52, v52
    v_exp_f32 v53, v53
    v_exp_f32 v54, v54
    v_exp_f32 v55, v55
    v_exp_f32 v56, v56
    v_exp_f32 v57, v57
    v_exp_f32 v58, v58
    v_exp_f32 v59, v59
    v_exp_f32 v60, v60
    v_exp_f32 v61, v61
    v_exp_f32 v62, v62
    v_exp_f32 v63, v63
    v_exp_f32 v64, v64
    v_exp_f32 v65, v65
    v_exp_f32 v66, v66
    v_exp_f32 v67, v67
    v_exp_f32 v68, v68
    v_exp_f32 v69, v69
    v_exp_f32 v70, v70
    v_exp_f32 v71, v71
    v_exp_f32 v72, v72
    v_exp_f32 v73, v73
    v_exp_f32 v74, v74
    v_exp_f32 v75, v75
    v_exp_f32 v76, v76
    v_exp_f32 v77, v77
    v_exp_f32 v78, v78
    v_exp_f32 v79, v79
    v_cvt_pk_bf16_f32 v112, v48, v49
    v_cvt_pk_bf16_f32 v113, v50, v51
    v_cvt_pk_bf16_f32 v114, v52, v53
    v_cvt_pk_bf16_f32 v115, v54, v55
    v_cvt_pk_bf16_f32 v116, v56, v57
    v_cvt_pk_bf16_f32 v117, v58, v59
    v_cvt_pk_bf16_f32 v118, v60, v61
    v_cvt_pk_bf16_f32 v119, v62, v63
    v_cvt_pk_bf16_f32 v120, v64, v65
    v_cvt_pk_bf16_f32 v121, v66, v67
    v_cvt_pk_bf16_f32 v122, v68, v69
    v_cvt_pk_bf16_f32 v123, v70, v71
    v_cvt_pk_bf16_f32 v124, v72, v73
    v_cvt_pk_bf16_f32 v125, v74, v75
    v_cvt_pk_bf16_f32 v126, v76, v77
    v_cvt_pk_bf16_f32 v127, v78, v79
    s_nop 1
    v_mfma_f32_32x32x16_bf16 v[144:159], a[164:167], v[112:115], v[144:159]
    v_mfma_f32_32x32x16_bf16 v[144:159], a[4:7], v[116:119], v[144:159]
    v_mfma_f32_32x32x16_bf16 v[144:159], a[12:15], v[120:123], v[144:159]
    v_mfma_f32_32x32x16_bf16 v[144:159], a[20:23], v[124:127], v[144:159]
    v_mfma_f32_32x32x4_2b_bf16 v[48:79], v[38:39], v[16:17], 0
    s_nop 15
    s_nop 1
    v_mfma_f32_32x32x16_bf16 v[48:63], a[92:95], v[12:15], v[48:63]
    v_mfma_f32_32x32x16_bf16 v[64:79], a[84:87], v[12:15], v[64:79]
    s_nop 11
    v_exp_f32 v48, v48
    v_exp_f32 v49, v49
    v_exp_f32 v50, v50
    v_exp_f32 v51, v51
    v_exp_f32 v52, v52
    v_exp_f32 v53, v53
    v_exp_f32 v54, v54
    v_exp_f32 v55, v55
    v_exp_f32 v56, v56
    v_exp_f32 v57, v57
    v_exp_f32 v58, v58
    v_exp_f32 v59, v59
    v_exp_f32 v60, v60
    v_exp_f32 v61, v61
    v_exp_f32 v62, v62
    v_exp_f32 v63, v63
    v_exp_f32 v64, v64
    v_exp_f32 v65, v65
    v_exp_f32 v66, v66
    v_exp_f32 v67, v67
    v_exp_f32 v68, v68
    v_exp_f32 v69, v69
    v_exp_f32 v70, v70
    v_exp_f32 v71, v71
    v_exp_f32 v72, v72
    v_exp_f32 v73, v73
    v_exp_f32 v74, v74
    v_exp_f32 v75, v75
    v_exp_f32 v76, v76
    v_exp_f32 v77, v77
    v_exp_f32 v78, v78
    v_exp_f32 v79, v79
    v_cvt_pk_bf16_f32 v112, v48, v49
    v_cvt_pk_bf16_f32 v113, v50, v51
    v_cvt_pk_bf16_f32 v114, v52, v53
    v_cvt_pk_bf16_f32 v115, v54, v55
    v_cvt_pk_bf16_f32 v116, v56, v57
    v_cvt_pk_bf16_f32 v117, v58, v59
    v_cvt_pk_bf16_f32 v118, v60, v61
    v_cvt_pk_bf16_f32 v119, v62, v63
    v_cvt_pk_bf16_f32 v120, v64, v65
    v_cvt_pk_bf16_f32 v121, v66, v67
    v_cvt_pk_bf16_f32 v122, v68, v69
    v_cvt_pk_bf16_f32 v123, v70, v71
    v_cvt_pk_bf16_f32 v124, v72, v73
    v_cvt_pk_bf16_f32 v125, v74, v75
    v_cvt_pk_bf16_f32 v126, v76, v77
    v_cvt_pk_bf16_f32 v127, v78, v79
    s_nop 1
    v_mfma_f32_32x32x16_bf16 v[144:159], a[76:79], v[112:115], v[144:159]
    v_mfma_f32_32x32x16_bf16 v[144:159], a[168:171], v[116:119], v[144:159]
    v_mfma_f32_32x32x16_bf16 v[144:159], a[176:179], v[120:123], v[144:159]
    v_mfma_f32_32x32x16_bf16 v[144:159], a[184:187], v[124:127], v[144:159]
    v_mfma_f32_32x32x4_2b_bf16 v[48:79], v[40:41], v[16:17], 0
    s_nop 15
    s_nop 1
    v_mfma_f32_32x32x16_bf16 v[48:63], a[24:27], v[12:15], v[48:63]
    v_mfma_f32_32x32x16_bf16 v[64:79], a[32:35], v[12:15], v[64:79]
    s_nop 11
    v_exp_f32 v48, v48
    v_exp_f32 v49, v49
    v_exp_f32 v50, v50
    v_exp_f32 v51, v51
    v_exp_f32 v52, v52
    v_exp_f32 v53, v53
    v_exp_f32 v54, v54
    v_exp_f32 v55, v55
    v_exp_f32 v56, v56
    v_exp_f32 v57, v57
    v_exp_f32 v58, v58
    v_exp_f32 v59, v59
    v_exp_f32 v60, v60
    v_exp_f32 v61, v61
    v_exp_f32 v62, v62
    v_exp_f32 v63, v63
    v_exp_f32 v64, v64
    v_exp_f32 v65, v65
    v_exp_f32 v66, v66
    v_exp_f32 v67, v67
    v_exp_f32 v68, v68
    v_exp_f32 v69, v69
    v_exp_f32 v70, v70
    v_exp_f32 v71, v71
    v_exp_f32 v72, v72
    v_exp_f32 v73, v73
    v_exp_f32 v74, v74
    v_exp_f32 v75, v75
    v_exp_f32 v76, v76
    v_exp_f32 v77, v77
    v_exp_f32 v78, v78
    v_exp_f32 v79, v79
    v_cvt_pk_bf16_f32 v112, v48, v49
    v_cvt_pk_bf16_f32 v113, v50, v51
    v_cvt_pk_bf16_f32 v114, v52, v53
    v_cvt_pk_bf16_f32 v115, v54, v55
    v_cvt_pk_bf16_f32 v116, v56, v57
    v_cvt_pk_bf16_f32 v117, v58, v59
    v_cvt_pk_bf16_f32 v118, v60, v61
    v_cvt_pk_bf16_f32 v119, v62, v63
    v_cvt_pk_bf16_f32 v120, v64, v65
    v_cvt_pk_bf16_f32 v121, v66, v67
    v_cvt_pk_bf16_f32 v122, v68, v69
    v_cvt_pk_bf16_f32 v123, v70, v71
    v_cvt_pk_bf16_f32 v124, v72, v73
    v_cvt_pk_bf16_f32 v125, v74, v75
    v_cvt_pk_bf16_f32 v126, v76, v77
    v_cvt_pk_bf16_f32 v127, v78, v79
    s_nop 1
    v_mfma_f32_32x32x16_bf16 v[144:159], a[40:43], v[112:115], v[144:159]
    v_mfma_f32_32x32x16_bf16 v[144:159], a[112:115], v[116:119], v[144:159]
    v_mfma_f32_32x32x16_bf16 v[144:159], a[104:107], v[120:123], v[144:159]
    v_mfma_f32_32x32x16_bf16 v[144:159], a[96:99], v[124:127], v[144:159]
    v_mfma_f32_32x32x4_2b_bf16 v[48:79], v[42:43], v[16:17], 0
    s_nop 15
    s_nop 1
    v_mfma_f32_32x32x16_bf16 v[48:63], a[172:175], v[12:15], v[48:63]
    v_mfma_f32_32x32x16_bf16 v[64:79], a[180:183], v[12:15], v[64:79]
    s_nop 11
    v_exp_f32 v48, v48
    v_exp_f32 v49, v49
    v_exp_f32 v50, v50
    v_exp_f32 v51, v51
    v_exp_f32 v52, v52
    v_exp_f32 v53, v53
    v_exp_f32 v54, v54
    v_exp_f32 v55, v55
    v_exp_f32 v56, v56
    v_exp_f32 v57, v57
    v_exp_f32 v58, v58
    v_exp_f32 v59, v59
    v_exp_f32 v60, v60
    v_exp_f32 v61, v61
    v_exp_f32 v62, v62
    v_exp_f32 v63, v63
    v_exp_f32 v64, v64
    v_exp_f32 v65, v65
    v_exp_f32 v66, v66
    v_exp_f32 v67, v67
    v_exp_f32 v68, v68
    v_exp_f32 v69, v69
    v_exp_f32 v70, v70
    v_exp_f32 v71, v71
    v_exp_f32 v72, v72
    v_exp_f32 v73, v73
    v_exp_f32 v74, v74
    v_exp_f32 v75, v75
    v_exp_f32 v76, v76
    v_exp_f32 v77, v77
    v_exp_f32 v78, v78
    v_exp_f32 v79, v79
    v_cvt_pk_bf16_f32 v112, v48, v49
    v_cvt_pk_bf16_f32 v113, v50, v51
    v_cvt_pk_bf16_f32 v114, v52, v53
    v_cvt_pk_bf16_f32 v115, v54, v55
    v_cvt_pk_bf16_f32 v116, v56, v57
    v_cvt_pk_bf16_f32 v117, v58, v59
    v_cvt_pk_bf16_f32 v118, v60, v61
    v_cvt_pk_bf16_f32 v119, v62, v63
    v_cvt_pk_bf16_f32 v120, v64, v65
    v_cvt_pk_bf16_f32 v121, v66, v67
    v_cvt_pk_bf16_f32 v122, v68, v69
    v_cvt_pk_bf16_f32 v123, v70, v71
    v_cvt_pk_bf16_f32 v124, v72, v73
    v_cvt_pk_bf16_f32 v125, v74, v75
    v_cvt_pk_bf16_f32 v126, v76, v77
    v_cvt_pk_bf16_f32 v127, v78, v79
    s_nop 1
    v_mfma_f32_32x32x16_bf16 v[144:159], a[188:191], v[112:115], v[144:159]
    v_mfma_f32_32x32x16_bf16 v[144:159], a[28:31], v[116:119], v[144:159]
    v_mfma_f32_32x32x16_bf16 v[144:159], a[36:39], v[120:123], v[144:159]
    v_mfma_f32_32x32x16_bf16 v[144:159], a[44:47], v[124:127], v[144:159]
    v_mfma_f32_32x32x4_2b_bf16 v[48:79], v[44:45], v[16:17], 0
    s_nop 15
    s_nop 1
    v_mfma_f32_32x32x16_bf16 v[48:63], a[116:119], v[12:15], v[48:63]
    v_mfma_f32_32x32x16_bf16 v[64:79], a[108:111], v[12:15], v[64:79]
    s_nop 11
    v_exp_f32 v48, v48
    v_exp_f32 v49, v49
    v_exp_f32 v50, v50
    v_exp_f32 v51, v51
    v_exp_f32 v52, v52
    v_exp_f32 v53, v53
    v_exp_f32 v54, v54
    v_exp_f32 v55, v55
    v_exp_f32 v56, v56
    v_exp_f32 v57, v57
    v_exp_f32 v58, v58
    v_exp_f32 v59, v59
    v_exp_f32 v60, v60
    v_exp_f32 v61, v61
    v_exp_f32 v62, v62
    v_exp_f32 v63, v63
    v_exp_f32 v64, v64
    v_exp_f32 v65, v65
    v_exp_f32 v66, v66
    v_exp_f32 v67, v67
    v_exp_f32 v68, v68
    v_exp_f32 v69, v69
    v_exp_f32 v70, v70
    v_exp_f32 v71, v71
    v_exp_f32 v72, v72
    v_exp_f32 v73, v73
    v_exp_f32 v74, v74
    v_exp_f32 v75, v75
    v_exp_f32 v76, v76
    v_exp_f32 v77, v77
    v_exp_f32 v78, v78
    v_exp_f32 v79, v79
    v_cvt_pk_bf16_f32 v112, v48, v49
    v_cvt_pk_bf16_f32 v113, v50, v51
    v_cvt_pk_bf16_f32 v114, v52, v53
    v_cvt_pk_bf16_f32 v115, v54, v55
    v_cvt_pk_bf16_f32 v116, v56, v57
    v_cvt_pk_bf16_f32 v117, v58, v59
    v_cvt_pk_bf16_f32 v118, v60, v61
    v_cvt_pk_bf16_f32 v119, v62, v63
    v_cvt_pk_bf16_f32 v120, v64, v65
    v_cvt_pk_bf16_f32 v121, v66, v67
    v_cvt_pk_bf16_f32 v122, v68, v69
    v_cvt_pk_bf16_f32 v123, v70, v71
    v_cvt_pk_bf16_f32 v124, v72, v73
    v_cvt_pk_bf16_f32 v125, v74, v75
    v_cvt_pk_bf16_f32 v126, v76, v77
    v_cvt_pk_bf16_f32 v127, v78, v79
    s_nop 1
    v_mfma_f32_32x32x16_bf16 v[144:159], a[100:103], v[112:115], v[144:159]
    v_mfma_f32_32x32x16_bf16 v[144:159], a[48:51], v[116:119], v[144:159]
    v_mfma_f32_32x32x16_bf16 v[144:159], a[56:59], v[120:123], v[144:159]
    v_mfma_f32_32x32x16_bf16 v[144:159], a[64:67], v[124:127], v[144:159]
    v_mfma_f32_32x32x4_2b_bf16 v[48:79], v[46:47], v[16:17], 0
    s_nop 15
    s_nop 1
    v_mfma_f32_32x32x16_bf16 v[48:63], a[136:139], v[12:15], v[48:63]
    v_mfma_f32_32x32x16_bf16 v[64:79], a[128:131], v[12:15], v[64:79]
    s_nop 11
    v_exp_f32 v48, v48
    v_exp_f32 v49, v49
    v_exp_f32 v50, v50
    v_exp_f32 v51, v51
    v_exp_f32 v52, v52
    v_exp_f32 v53, v53
    v_exp_f32 v54, v54
    v_exp_f32 v55, v55
    v_exp_f32 v56, v56
    v_exp_f32 v57, v57
    v_exp_f32 v58, v58
    v_exp_f32 v59, v59
    v_exp_f32 v60, v60
    v_exp_f32 v61, v61
    v_exp_f32 v62, v62
    v_exp_f32 v63, v63
    v_exp_f32 v64, v64
    v_exp_f32 v65, v65
    v_exp_f32 v66, v66
    v_exp_f32 v67, v67
    v_exp_f32 v68, v68
    v_exp_f32 v69, v69
    v_exp_f32 v70, v70
    v_exp_f32 v71, v71
    v_exp_f32 v72, v72
    v_exp_f32 v73, v73
    v_exp_f32 v74, v74
    v_exp_f32 v75, v75
    v_exp_f32 v76, v76
    v_exp_f32 v77, v77
    v_exp_f32 v78, v78
    v_exp_f32 v79, v79
    v_cvt_pk_bf16_f32 v112, v48, v49
    v_cvt_pk_bf16_f32 v113, v50, v51
    v_cvt_pk_bf16_f32 v114, v52, v53
    v_cvt_pk_bf16_f32 v115, v54, v55
    v_cvt_pk_bf16_f32 v116, v56, v57
    v_cvt_pk_bf16_f32 v117, v58, v59
    v_cvt_pk_bf16_f32 v118, v60, v61
    v_cvt_pk_bf16_f32 v119, v62, v63
    v_cvt_pk_bf16_f32 v120, v64, v65
    v_cvt_pk_bf16_f32 v121, v66, v67
    v_cvt_pk_bf16_f32 v122, v68, v69
    v_cvt_pk_bf16_f32 v123, v70, v71
    v_cvt_pk_bf16_f32 v124, v72, v73
    v_cvt_pk_bf16_f32 v125, v74, v75
    v_cvt_pk_bf16_f32 v126, v76, v77
    v_cvt_pk_bf16_f32 v127, v78, v79
    s_nop 1
    v_mfma_f32_32x32x16_bf16 v[144:159], a[120:123], v[112:115], v[144:159]
    v_mfma_f32_32x32x16_bf16 v[144:159], a[52:55], v[116:119], v[144:159]
    v_mfma_f32_32x32x16_bf16 v[144:159], a[60:63], v[120:123], v[144:159]
    v_mfma_f32_32x32x16_bf16 v[144:159], a[68:71], v[124:127], v[144:159]
    s_nop 11
    ds_write_b128 v10, v[144:147]
    ds_write_b128 v10, v[148:151] offset:1024
    ds_write_b64 v18, v[152:153] offset:2048
    s_cmp_lg_u32 s99, 3
    s_cbranch_scc1 L_at_p2n
    v_mov_b32 v128, v144
    v_mov_b32 v129, v145
    v_mov_b32 v130, v146
    v_mov_b32 v131, v147
    v_mov_b32 v132, v148
    v_mov_b32 v133, v149
    v_mov_b32 v134, v150
    v_mov_b32 v135, v151
    v_mov_b32 v136, v152
    v_mov_b32 v137, v153
L_at_p2n:
    s_waitcnt lgkmcnt(0)
    s_barrier
    s_add_u32 s99, s99, 1
    s_cmp_lt_u32 s99, 8
    s_cbranch_scc1 L_at_p2
    v_cmp_nle_f32 vcc, 0x2b800000, v137
    v_rcp_f32 v249, v137
    s_or_b64 s[20:21], s[20:21], vcc
    v_cmp_nge_f32 vcc, 0x53800000, v137
    v_mul_f32 v128, v128, v249
    v_mul_f32 v129, v129, v249
    v_mul_f32 v130, v130, v249
    v_mul_f32 v131, v131, v249
    v_mul_f32 v132, v132, v249
    v_mul_f32 v133, v133, v249
    v_mul_f32 v134, v134, v249
    v_mul_f32 v135, v135, v249
    v_mul_f32 v136, v136, v249
    s_or_b64 s[20:21], s[20:21], vcc
    v_cvt_pk_bf16_f32 v128, v128, v129
    v_cvt_pk_bf16_f32 v129, v130, v131
    v_cvt_pk_bf16_f32 v130, v132, v133
    v_cvt_pk_bf16_f32 v131, v134, v135
    v_cvt_pk_bf16_f32 v132, v136, v136
    s_add_u32 s54, s66, 0
    buffer_store_dwordx4 v[128:131], v26, s[12:15], s54 offen sc1
    s_add_u32 s55, s68, 0
    buffer_store_short v132, v28, s[12:15], s55 offen sc1
    v_cmp_nle_f32 vcc, 0x2b800000, v153
    v_rcp_f32 v249, v153
    s_or_b64 s[20:21], s[20:21], vcc
    v_cmp_nge_f32 vcc, 0x53800000, v153
    v_mul_f32 v144, v144, v249
    v_mul_f32 v145, v145, v249
    v_mul_f32 v146, v146, v249
    v_mul_f32 v147, v147, v249
    v_mul_f32 v148, v148, v249
    v_mul_f32 v149, v149, v249
    v_mul_f32 v150, v150, v249
    v_mul_f32 v151, v151, v249
    v_mul_f32 v152, v152, v249
    s_or_b64 s[20:21], s[20:21], vcc
    v_cvt_pk_bf16_f32 v144, v144, v145
    v_cvt_pk_bf16_f32 v145, v146, v147
    v_cvt_pk_bf16_f32 v146, v148, v149
    v_cvt_pk_bf16_f32 v147, v150, v151
    v_cvt_pk_bf16_f32 v148, v152, v152
    s_add_u32 s54, s66, 16384
    buffer_store_dwordx4 v[144:147], v26, s[12:15], s54 offen sc1
    s_add_u32 s55, s68, 4096
    buffer_store_short v148, v28, s[12:15], s55 offen sc1
    s_mov_b32 s98, 0
    s_branch L_o0_again
.section .rodata,"a"
.p2align 6
.amdhsa_kernel parallel_sum__mha_block__glu_gated_geglu__prompt_kernel
  .amdhsa_next_free_vgpr 512
  .amdhsa_next_free_sgpr 102
  .amdhsa_accum_offset 256
  .amdhsa_group_segment_fixed_size 0
  .amdhsa_kernarg_size 80
  .amdhsa_user_sgpr_count 2
  .amdhsa_user_sgpr_kernarg_segment_ptr 1
  .amdhsa_system_sgpr_workgroup_id_x 1
.end_amdhsa_kernel
```
